```python
import torch

def _softmax(x, axis=-1):
    return torch.softmax(x, dim=axis)
def _gelu(x):
    return torch.nn.functional.gelu(x, approximate="tanh")
def _silu(x):
    return torch.nn.functional.silu(x)
def _sigmoid(x):
    return torch.sigmoid(x)
def _layernorm(x, axis=-1, eps=1e-5):
    m = x.mean(dim=axis, keepdim=True)
    v = x.var(dim=axis, keepdim=True, unbiased=False)
    return (x - m) / torch.sqrt(v + eps)
def _scatter_add(tgt, idx, src, axis=0):
    return tgt.clone().index_add_(axis, idx, src)
def _segment_sum(src, seg, n):
    out = torch.zeros((n,) + src.shape[1:], dtype=src.dtype)
    return out.index_add_(0, seg, src)
def _pad(x, pw):
    flat = tuple(v for pair in reversed(pw) for v in pair)
    return torch.nn.functional.pad(x, flat)

kernel_name = 'parallel_sum__ssm_conv_s5__geglu_ffn__prompt'

def setup_inputs():

    _w = (lambda a: (lambda t: t.to(torch.bfloat16) if t.is_floating_point() else t)(torch.as_tensor(a)))
    def _A_setup():
        B, S, D = 1, 2048, 640
        P = D
        Lambda_re = -0.5 * (lambda _x: torch.exp(torch.as_tensor(_x)))((lambda *s: torch.randn(*s, dtype=torch.bfloat16) * 0.8)(P))
        Lambda_im = (lambda *s: torch.randn(*s, dtype=torch.bfloat16) * 0.8)(P) * 1.0
        B_re = (lambda *s: torch.randn(*s, dtype=torch.bfloat16) * 0.8)(P, D) * (D ** -0.5)
        B_im = (lambda *s: torch.randn(*s, dtype=torch.bfloat16) * 0.8)(P, D) * (D ** -0.5)
        C_re = (lambda *s: torch.randn(*s, dtype=torch.bfloat16) * 0.8)(D, P) * (P ** -0.5)
        C_im = (lambda *s: torch.randn(*s, dtype=torch.bfloat16) * 0.8)(D, P) * (P ** -0.5)
        log_dt = (lambda *s: torch.randn(*s, dtype=torch.bfloat16) * 0.8)(P) * 0.3 - 2.0
        Dskip = (lambda *s: torch.randn(*s, dtype=torch.bfloat16) * 0.8)(D)
        return {
            "x": _w((lambda *s: torch.randn(*s, dtype=torch.bfloat16) * 0.05)(B, S, D)),
            "Lambda_re": _w(Lambda_re),
            "Lambda_im": _w(Lambda_im),
            "B_re": _w(B_re),
            "B_im": _w(B_im),
            "C_re": _w(C_re),
            "C_im": _w(C_im),
            "log_dt": _w(log_dt),
            "Dskip": _w(Dskip),
        }
    _A_in = _A_setup()

    def _B_setup():
        B, S, D, F = 1, 2048, 640, 1728
        return {
            "x": _w((lambda *s: torch.randn(*s, dtype=torch.bfloat16) * 0.05)(B, S, D)),
            "w_gate": _w((lambda *s: torch.randn(*s, dtype=torch.bfloat16) * 0.05)(D, F)),
            "w_up": _w((lambda *s: torch.randn(*s, dtype=torch.bfloat16) * 0.05)(D, F)),
            "w_down": _w((lambda *s: torch.randn(*s, dtype=torch.bfloat16) * 0.05)(F, D)),
        }
    _B_in = _B_setup()

    return {
        "A_x": _A_in["x"],
        "A_Lambda_re": _A_in["Lambda_re"],
        "A_Lambda_im": _A_in["Lambda_im"],
        "A_B_re": _A_in["B_re"],
        "A_B_im": _A_in["B_im"],
        "A_C_re": _A_in["C_re"],
        "A_C_im": _A_in["C_im"],
        "A_log_dt": _A_in["log_dt"],
        "A_Dskip": _A_in["Dskip"],
        "B_x": _B_in["x"],
        "B_w_gate": _B_in["w_gate"],
        "B_w_up": _B_in["w_up"],
        "B_w_down": _B_in["w_down"],
    }

def reference(A_x, A_Lambda_re, A_Lambda_im, A_B_re, A_B_im, A_C_re, A_C_im, A_log_dt, A_Dskip, B_x, B_w_gate, B_w_up, B_w_down):
    def _A_ref(x, Lambda_re, Lambda_im, B_re, B_im, C_re, C_im, log_dt, Dskip):
        Bsz, L, H = x.shape
        Lam = Lambda_re + 1j * Lambda_im
        Bmat = B_re + 1j * B_im
        Cmat = C_re + 1j * C_im
        dt = torch.exp(log_dt)
        Lam_bar = torch.exp(dt * Lam)
        B_bar = ((Lam_bar - 1.0) / Lam)[:, None] * Bmat
        Bu = torch.einsum("bld,pd->blp", x + 0j, B_bar)
        h = torch.zeros_like(Bu[:, 0, :])
        hs = []
        for t in range(L):
            h = Lam_bar[None, :] * h + Bu[:, t, :]
            hs.append(h)
        hseq = torch.stack(hs, 1)
        y = 2.0 * torch.einsum("blp,dp->bld", hseq, Cmat).real + x * Dskip[None, None, :]
        return y

    def _B_ref(x, w_gate, w_up, w_down):
        return (_gelu(x @ w_gate) * (x @ w_up)) @ w_down

    x = A_x
    xn = _layernorm(x, axis=-1)
    return x + _A_ref(xn, A_Lambda_re, A_Lambda_im, A_B_re, A_B_im, A_C_re, A_C_im, A_log_dt, A_Dskip) + _B_ref(xn, B_w_gate, B_w_up, B_w_down)
```

```asm
; @launch grid=(256,1,1) block=(256,1,1) lds=163840
.amdgcn_target "amdgcn-amd-amdhsa--gfx950"
.text
.globl parallel_sum__ssm_conv_s5__geglu_ffn__prompt_kernel
.p2align 12
.type parallel_sum__ssm_conv_s5__geglu_ffn__prompt_kernel,@function
parallel_sum__ssm_conv_s5__geglu_ffn__prompt_kernel:
  s_cmp_ge_u32 s2, 256
  s_cbranch_scc1 L_end
  s_load_dwordx16 s[8:23], s[0:1], 0
  s_load_dwordx16 s[24:39], s[0:1], 64
  v_and_b32 v1, 63, v0
  v_lshrrev_b32 v2, 6, v0
  v_lshlrev_b32 v35, 4, v1
  v_readfirstlane_b32 s82, v2
  s_getpc_b64 s[76:77]
L_pc0:
  s_lshr_b32 s83, s2, 3
  s_lshl_b32 s83, s83, 12
  s_min_u32 s83, s83, (L_end-L_pc0-4096)
  v_lshl_add_u32 v60, v0, 4, s83
  global_load_dword a255, v60, s[76:77]
  s_bfe_u32 s80, s2, 0x40003
  s_lshl_b32 s83, s2, 2
  s_mov_b32 s81, 0x76543210
  s_cmp_ge_u32 s2, 128
  s_cselect_b32 s81, 0x9fa8edcb, s81
  s_lshr_b32 s81, s81, s83
  s_and_b32 s81, s81, 15
  s_lshl2_add_u32 s62, s81, s82
  s_mul_i32 s62, s62, 5120
  s_mul_i32 s83, s80, 163840
  s_add_u32 s62, s62, s83
  s_lshl2_add_u32 s87, s80, s82
  s_mul_i32 s87, s87, 40960
  s_mul_i32 s89, s82, 20480
  s_add_u32 s89, s89, 65536
  s_lshl_b32 s90, s82, 12
  s_and_b32 s85, s82, 1
  v_and_b32 v104, 7, v1
  v_lshrrev_b32 v3, 4, v1
  v_xor_b32 v2, v104, v3
  v_lshlrev_b32 v2, 4, v2
  v_xor_b32 v3, 64, v2
  v_lshrrev_b32 v4, 3, v1
  v_mul_u32_u24 v5, 1280, v4
  v_lshlrev_b32 v112, 7, v1
  v_lshrrev_b32 v40, 4, v1
  v_lshl_add_u32 v36, v40, 10, v35
  s_cmp_ge_u32 s81, 8
  s_cselect_b32 s62, 2130706432, s62
  s_cmp_ge_u32 s81, 11
  s_cbranch_scc1 L_h_ssm
  v_add_u32 v6, v5, v2
  v_add_u32 v7, v5, v3
  v_add_u32 v7, 9216, v7
  v_add_u32 v8, v5, v2
  v_add_u32 v8, 18432, v8
  v_add_u32 v9, v5, v3
  v_add_u32 v9, 27648, v9
  s_mul_i32 s83, s81, 320
  s_and_b32 s84, s81, 1
  s_lshl_b32 s86, s84, 6
  s_add_u32 s3, s83, s86
  s_add_u32 s4, s3, 128
  s_xor_b32 s84, s84, 1
  s_lshl_b32 s84, s84, 8
  s_add_u32 s5, s83, s84
  s_mov_b32 s63, s3
  s_and_b32 s84, s82, 2
  s_lshl_b32 s84, s84, 1
  v_bfe_u32 v105, v1, 4, 1
  v_lshlrev_b32 v105, 1, v105
  v_or_b32 v105, s84, v105
  v_xor_b32 v104, v104, v105
  v_lshlrev_b32 v104, 4, v104
  v_mul_u32_u24 v105, 3456, v4
  v_add_u32 v104, v104, v105
  s_mul_i32 s86, s85, 110592
  v_add_u32 v14, s86, v104
  v_add_u32 v15, 26624, v14
  v_add_u32 v16, 53248, v14
  v_add_u32 v17, 79872, v14
  s_lshl1_add_u32 s86, s80, s85
  s_mul_i32 s86, s86, 69120
  v_mul_u32_u24 v52, 3456, v1
  v_add_u32 v52, s86, v52
  s_mov_b32 s60, 221184
  s_mov_b32 s46, 2211840
  v_mov_b32 v127, 0
  v_mov_b32 v113, 0
  s_mov_b32 s95, 0
  s_waitcnt lgkmcnt(0)
  s_cmp_ge_u32 s82, 2
  s_cselect_b32 s44, s30, s28
  s_cselect_b32 s45, s31, s29
  s_branch L_h_join
L_h_ssm:
  s_sub_u32 s7, s81, 11
  v_lshrrev_b32 v104, 2, v4
  v_lshlrev_b32 v108, 4, v104
  v_and_b32 v105, 1, v4
  v_lshl_add_u32 v108, v105, 3, v108
  v_bfe_u32 v105, v4, 1, 1
  v_add_u32 v108, v108, v105
  v_mul_u32_u24 v108, 1280, v108
  v_add_u32 v6, v108, v2
  v_add_u32 v7, v108, v3
  v_add_u32 v7, 1536, v7
  v_add_u32 v8, v108, v2
  v_add_u32 v8, 3072, v8
  v_add_u32 v9, v108, v3
  v_add_u32 v9, 4608, v9
  s_mul_i32 s63, s7, 163840
  s_mul_i32 s86, s85, 40960
  s_add_u32 s3, s63, s86
  s_add_u32 s4, s3, 81920
  v_lshlrev_b32 v104, 3, v104
  v_and_b32 v105, 3, v4
  v_add_u32 v104, v104, v105
  v_mul_u32_u24 v104, 1280, v104
  v_add_u32 v14, v104, v2
  v_add_u32 v15, v104, v3
  v_add_u32 v15, 4096, v15
  v_add_u32 v16, v104, v2
  v_add_u32 v16, 18432, v16
  v_add_u32 v17, v104, v3
  v_add_u32 v17, 22528, v17
  s_lshl1_add_u32 s86, s80, s85
  s_mul_i32 s86, s86, 2560
  v_add_u32 v52, s86, v112
  s_lshr_b32 s86, s82, 1
  s_lshl1_add_u32 s86, s7, s86
  s_lshl_b32 s86, s86, 7
  v_lshl_add_u32 v113, v1, 1, s86
  s_and_b32 s84, s80, 7
  s_lshr_b32 s83, s80, 3
  s_mul_i32 s84, s84, 5
  s_mul_i32 s83, s83, 3
  s_add_u32 s83, s84, s83
  s_lshl1_add_u32 s95, s83, s85
  s_mul_i32 s95, s95, 10240
  s_add_u32 s95, s95, s86
  s_lshl_b32 s86, s85, 1
  v_lshrrev_b32 v120, 5, v1
  v_add_u32 v120, s86, v120
  v_sub_u32 v120, 0, v120
  v_and_b32 v120, 3, v120
  v_xor_b32 v120, v120, v1
  v_and_b32 v120, 7, v120
  v_lshl_add_u32 v127, v120, 4, v5
  s_mov_b32 s60, 128
  s_mov_b32 s46, 819200
  s_waitcnt lgkmcnt(0)
  s_cmp_ge_u32 s82, 2
  s_cselect_b32 s44, s16, s14
  s_cselect_b32 s45, s17, s15
L_h_join:
  s_and_b32 s45, s45, 0xffff
  s_mov_b32 s47, 0x20000
  s_mov_b32 s40, s8
  s_and_b32 s41, s9, 0xffff
  s_mov_b32 s42, 2621440
  s_mov_b32 s43, 0x20000
  s_cmp_ge_u32 s81, 11
  s_cbranch_scc1 L_j_ssm
  buffer_load_dwordx4 v[220:223], v36, s[40:43], s62 offen offset:0
  buffer_load_dwordx4 v[224:227], v36, s[40:43], s62 offen offset:256
  buffer_load_dwordx4 v[228:231], v36, s[40:43], s62 offen offset:512
  buffer_load_dwordx4 v[232:235], v36, s[40:43], s62 offen offset:768
  buffer_load_dwordx4 v[236:239], v36, s[40:43], s62 offen offset:1024
  s_bfm_b64 exec, 20, 0
  buffer_load_dword a255, v52, s[44:47], s63 offen
  s_mov_b64 exec, -1
  v_lshlrev_b32 v104, 21, v1
  s_bfm_b64 exec, 12, 0
  global_load_dword a255, v104, s[38:39]
  s_bfm_b64 exec, 3, 0
  global_load_dword a255, v104, s[34:35]
  s_bfm_b64 exec, 2, 0
  global_load_dword a255, v104, s[32:33]
  s_bfm_b64 exec, 10, 0
  global_load_dword a255, v112, s[24:25]
  s_mov_b64 exec, -1
  s_branch L_j2
L_j_ssm:
  global_load_ushort v216, v113, s[10:11]
  global_load_ushort v217, v113, s[12:13]
  global_load_ushort v218, v113, s[22:23]
  s_bfm_b64 exec, 20, 0
  buffer_load_dword a255, v52, s[44:47], s63 offen
  s_mov_b64 exec, -1
  s_mov_b32 s68, s18
  s_and_b32 s69, s19, 0xffff
  s_mov_b32 s70, 819200
  s_mov_b32 s71, 0x20000
  s_mov_b32 s72, s20
  s_and_b32 s73, s21, 0xffff
  s_mov_b32 s74, 819200
  s_mov_b32 s75, 0x20000
  buffer_load_dwordx4 v[192:195], v127, s[68:71], s95 offen
  buffer_load_dwordx4 v[196:199], v127, s[72:75], s95 offen
  s_add_u32 s95, s95, 20480
  buffer_load_dwordx4 v[200:203], v127, s[68:71], s95 offen
  buffer_load_dwordx4 v[204:207], v127, s[72:75], s95 offen
  s_add_u32 s95, s95, 20480
  buffer_load_dwordx4 v[208:211], v127, s[68:71], s95 offen
  buffer_load_dwordx4 v[212:215], v127, s[72:75], s95 offen
L_j2:
  s_add_u32 s83, s38, 16842752
  s_addc_u32 s84, s39, 0
  s_mov_b32 s85, s84
  s_mov_b32 s84, s83
  s_load_dword s61, s[84:85], 0
  v_cmp_gt_u32 vcc, 20, v1
  v_mov_b32 v104, 2130706432
  s_nop 0
  v_cndmask_b32 v52, v104, v52, vcc
  s_mov_b32 s100, 200000
  s_cmp_eq_u32 s82, 3
  s_cselect_b32 s6, 0, 2130706432
  v_and_b32 v34, 15, v1
  v_lshlrev_b32 v34, 4, v34
  v_bfe_u32 v104, v1, 4, 1
  v_lshl_add_u32 v34, v104, 10, v34
  v_lshrrev_b32 v104, 5, v1
  v_lshl_add_u32 v34, v104, 8, v34
  s_lshl_b32 s83, s80, 2
  s_add_u32 s83, s83, s82
  s_lshl_b32 s86, s83, 11
  s_lshr_b32 s83, s86, 15
  s_mul_i32 s83, s83, 3112960
  s_add_u32 s83, s83, s86
  v_add_u32 v34, s83, v34
  s_lshl_b32 s101, s81, 7
  s_add_u32 s101, s101, s86
  s_mov_b32 s48, s38
  s_and_b32 s49, s39, 0xffff
  s_mov_b32 s50, 12582912
  s_mov_b32 s51, 0x20000
  s_add_u32 s52, s38, 12582912
  s_addc_u32 s53, s39, 0
  s_and_b32 s53, s53, 0xffff
  s_mov_b32 s54, 3850240
  s_mov_b32 s55, 0x20000
  s_add_u32 s56, s38, 16515072
  s_addc_u32 s57, s39, 0
  s_and_b32 s57, s57, 0xffff
  s_mov_b32 s58, 6932480
  s_mov_b32 s59, 0x20000
  s_mov_b32 s64, s34
  s_and_b32 s65, s35, 0xffff
  s_mov_b32 s66, 5242880
  s_mov_b32 s67, 0x20000
  v_bfe_u32 v125, v35, 2, 7
  v_lshrrev_b32 v104, 2, v1
  v_lshrrev_b32 v105, 4, v1
  v_xor_b32 v104, v104, v105
  v_and_b32 v104, 1, v104
  v_cmp_eq_u32 vcc, 0, v104
  v_mov_b32 v105, 0x3f803f80
  s_nop 0
  v_cndmask_b32 v60, 0, v105, vcc
  v_mov_b32 v61, v60
  v_mov_b32 v62, v60
  v_mov_b32 v63, v60
  s_and_b32 s30, s2, 1
  s_bfe_u32 s83, s2, 0x10001
  s_lshl1_add_u32 s30, s30, s83
  s_bfe_u32 s83, s2, 0x10003
  s_lshr_b32 s84, s2, 7
  s_lshl1_add_u32 s83, s84, s83
  s_lshl2_add_u32 s30, s30, s83
  s_bfe_u32 s28, s2, 0x10002
  s_bfe_u32 s34, s2, 0x30004
  s_lshl3_add_u32 s34, s28, s34
  s_xor_b32 s83, s34, 8
  s_lshl_b32 s83, s83, 7
  v_and_b32 v104, 31, v1
  v_lshl_add_u32 v104, v104, 16, s83
  v_and_b32 v105, 32, v1
  v_lshlrev_b32 v105, 5, v105
  v_xor_b32 v124, v105, v104
  s_lshl2_add_u32 s86, s30, s82
  s_lshl_b32 s86, s86, 11
  v_and_b32 v85, 15, v1
  v_lshl_add_u32 v85, v85, 7, s86
  s_lshr_b32 s84, s86, 15
  s_mul_i32 s84, s84, 3112960
  s_add_u32 s86, s86, s84
  s_lshl_b32 s83, s28, 15
  s_add_u32 s35, s86, s83
  s_lshl_b32 s83, s28, 10
  v_add_u32 v90, s83, v35
  v_xor_b32 v91, 1024, v90
  s_and_b32 s85, s34, 7
  s_mul_i32 s99, s85, 5120
  s_lshl_b32 s83, s82, 1
  s_add_u32 s83, s83, s28
  s_mul_i32 s84, s83, 40960
  s_add_u32 s99, s99, s84
  s_mul_i32 s29, s82, 5120
  v_lshrrev_b32 v104, 1, v1
  v_min_u32 v104, 11, v104
  v_lshl_add_u32 v104, v104, 3, s83
  v_min_u32 v104, 93, v104
  v_subrev_u32 v105, 32, v104
  v_subrev_u32 v106, 52, v104
  v_min_u32 v105, v105, v106
  v_cmp_lt_u32 vcc, 19, v105
  v_and_b32 v105, -2, v104
  s_nop 0
  v_cndmask_b32 v104, v105, v104, vcc
  s_mul_i32 s83, s85, 5
  s_lshr_b32 s83, s83, 2
  s_lshl_b32 s85, s85, 1
  v_mov_b32 v105, s85
  v_mov_b32 v106, s83
  v_cndmask_b32 v105, v105, v106, vcc
  v_lshl_add_u32 v104, v104, 4, v105
  v_and_b32 v105, 1, v1
  v_add_u32 v104, v104, v105
  v_lshlrev_b32 v104, 7, v104
  v_add_u32 v89, 131072, v104
  s_cmp_ge_u32 s81, 11
  s_cbranch_scc1 L_ssm
  s_lshr_b32 s83, s82, 1
  v_and_b32 v106, 31, v1
  v_lshlrev_b32 v106, 7, v106
  v_bfe_u32 v104, v1, 1, 3
  v_lshrrev_b32 v105, 5, v1
  v_xor_b32 v104, v104, v105
  s_lshl_b32 s83, s83, 1
  v_xor_b32 v104, s83, v104
  v_xor_b32 v105, 0, v104
  v_lshl_add_u32 v10, v105, 4, v106
  v_xor_b32 v105, 2, v104
  v_lshl_add_u32 v11, v105, 4, v106
  v_xor_b32 v105, 4, v104
  v_lshl_add_u32 v12, v105, 4, v106
  v_xor_b32 v105, 6, v104
  v_lshl_add_u32 v13, v105, 4, v106
  v_add_u32 v10, s89, v10
  v_add_u32 v11, s89, v11
  v_add_u32 v12, s89, v12
  v_add_u32 v13, s89, v13
  v_bfe_u32 v104, v1, 4, 1
  v_lshrrev_b32 v105, 5, v1
  v_bfe_u32 v106, v1, 2, 2
  v_and_b32 v107, 1, v1
  v_lshlrev_b32 v107, 4, v107
  v_bfe_u32 v108, v1, 1, 1
  v_lshl_add_u32 v107, v108, 3, v107
  v_lshl_add_u32 v107, v104, 13, v107
  v_lshl_add_u32 v105, v105, 3, v106
  v_lshrrev_b32 v106, 1, v106
  v_lshl_add_u32 v106, v104, 1, v106
  v_lshl_add_u32 v108, v105, 7, v107
  v_lshl_add_u32 v109, v105, 6, v107
  s_lshr_b32 s84, s82, 1
  s_add_u32 s83, s82, 0
  s_and_b32 s83, s83, 3
  v_xor_b32 v110, s83, v106
  v_lshl_add_u32 v110, v110, 5, v108
  s_xor_b32 s85, s84, 0
  s_lshl_b32 s85, s85, 11
  v_add_u32 v18, s85, v110
  s_xor_b32 s85, s84, 1
  s_lshl_b32 s85, s85, 11
  v_add_u32 v19, s85, v110
  s_lshr_b32 s85, s83, 1
  s_lshl_b32 s86, s81, 1
  s_add_u32 s85, s85, s86
  s_lshl_b32 s85, s85, 15
  s_and_b32 s83, s83, 1
  s_lshl_b32 s83, s83, 9
  s_add_u32 s91, s85, s83
  s_add_u32 s83, s82, 1
  s_and_b32 s83, s83, 3
  v_xor_b32 v110, s83, v106
  v_lshl_add_u32 v110, v110, 5, v108
  s_xor_b32 s85, s84, 0
  s_lshl_b32 s85, s85, 11
  v_add_u32 v20, s85, v110
  s_xor_b32 s85, s84, 1
  s_lshl_b32 s85, s85, 11
  v_add_u32 v21, s85, v110
  s_lshr_b32 s85, s83, 1
  s_lshl_b32 s86, s81, 1
  s_add_u32 s85, s85, s86
  s_lshl_b32 s85, s85, 15
  s_and_b32 s83, s83, 1
  s_lshl_b32 s83, s83, 9
  s_add_u32 s92, s85, s83
  s_add_u32 s83, s82, 2
  s_and_b32 s83, s83, 3
  v_xor_b32 v110, s83, v106
  v_lshl_add_u32 v110, v110, 5, v108
  s_xor_b32 s85, s84, 0
  s_lshl_b32 s85, s85, 11
  v_add_u32 v22, s85, v110
  s_xor_b32 s85, s84, 1
  s_lshl_b32 s85, s85, 11
  v_add_u32 v23, s85, v110
  s_lshr_b32 s85, s83, 1
  s_lshl_b32 s86, s81, 1
  s_add_u32 s85, s85, s86
  s_lshl_b32 s85, s85, 15
  s_and_b32 s83, s83, 1
  s_lshl_b32 s83, s83, 9
  s_add_u32 s93, s85, s83
  s_add_u32 s83, s82, 3
  s_and_b32 s83, s83, 3
  v_xor_b32 v110, s83, v106
  v_lshl_add_u32 v110, v110, 5, v108
  s_xor_b32 s85, s84, 0
  s_lshl_b32 s85, s85, 11
  v_add_u32 v24, s85, v110
  s_xor_b32 s85, s84, 1
  s_lshl_b32 s85, s85, 11
  v_add_u32 v25, s85, v110
  s_lshr_b32 s85, s83, 1
  s_lshl_b32 s86, s81, 1
  s_add_u32 s85, s85, s86
  s_lshl_b32 s85, s85, 15
  s_and_b32 s83, s83, 1
  s_lshl_b32 s83, s83, 9
  s_add_u32 s94, s85, s83
  s_and_b32 s83, s82, 1
  s_xor_b32 s83, s83, 0
  v_xor_b32 v110, s83, v104
  v_lshl_add_u32 v110, v110, 5, v109
  s_xor_b32 s85, s84, 0
  s_lshl_b32 s85, s85, 10
  v_add_u32 v30, s85, v110
  s_xor_b32 s85, s84, 1
  s_lshl_b32 s85, s85, 10
  v_add_u32 v31, s85, v110
  s_and_b32 s83, s82, 1
  s_xor_b32 s83, s83, 1
  v_xor_b32 v110, s83, v104
  v_lshl_add_u32 v110, v110, 5, v109
  s_xor_b32 s85, s84, 0
  s_lshl_b32 s85, s85, 10
  v_add_u32 v32, s85, v110
  s_xor_b32 s85, s84, 1
  s_lshl_b32 s85, s85, 10
  v_add_u32 v33, s85, v110
  s_and_b32 s83, s82, 2
  v_and_b32 v104, 3, v1
  v_xor_b32 v104, s83, v104
  v_lshlrev_b32 v104, 4, v104
  v_lshrrev_b32 v105, 2, v1
  v_mul_u32_u24 v105, 3456, v105
  v_add_u32 v55, v104, v105
  s_and_b32 s85, s82, 1
  s_mul_i32 s85, s85, 221184
  v_add_u32 v26, s85, v55
  v_add_u32 v27, 54272, v26
  v_add_u32 v28, 108544, v26
  v_add_u32 v29, 162816, v26
  s_add_u32 s83, s81, 22
  s_lshl_b32 s83, s83, 15
  s_cmp_eq_u32 s81, 10
  s_cselect_b32 s83, 2130706432, s83
  s_and_b32 s84, s82, 1
  s_lshl_b32 s84, s84, 9
  s_add_u32 s10, s83, s84
  s_xor_b32 s11, s10, 512
  s_mov_b32 s68, s32
  s_and_b32 s69, s33, 0xffff
  s_mov_b32 s70, 2211840
  s_mov_b32 s71, 0x20000
  s_lshl_b32 s83, s80, 2
  s_add_u32 s83, s83, s82
  s_mul_i32 s84, s83, 205
  s_lshr_b32 s84, s84, 11
  s_mul_i32 s85, s84, 10
  s_sub_u32 s83, s83, s85
  s_lshl_b32 s85, s84, 6
  s_add_u32 s85, s85, s3
  s_cmp_eq_u32 s84, 4
  s_cselect_b32 s85, s5, s85
  s_mul_i32 s85, s85, 640
  s_lshl_b32 s86, s83, 7
  s_add_u32 s85, s85, s86
  s_lshl_b32 s86, s81, 1
  s_add_u32 s86, s86, s84
  s_cmp_ge_u32 s84, 2
  s_cselect_b32 s95, 70, 0
  s_add_u32 s86, s86, s95
  s_add_u32 s95, s81, 22
  s_cmp_eq_u32 s84, 4
  s_cselect_b32 s86, s95, s86
  s_lshl_b32 s16, s86, 4
  s_add_u32 s16, s16, s83
  s_lshl_b32 s16, s16, 7
  s_add_u32 s16, s16, 131072
  s_mul_i32 s86, s86, 40960
  s_lshl_b32 s83, s83, 12
  s_add_u32 s86, s86, s83
  s_cmp_eq_u32 s81, 10
  s_addc_u32 s84, s84, 0
  s_cmp_gt_u32 s84, 4
  s_cselect_b32 s14, 2130706432, s85
  s_cselect_b32 s7, 2130706432, s86
  s_cselect_b32 s16, 2130706432, s16
  s_cmp_eq_u32 s81, 10
  s_cselect_b32 s5, 2130706432, s5
  v_and_b32 v54, 7, v1
  v_lshl_add_u32 v54, v54, 4, v5
  v_lshrrev_b32 v104, 4, v1
  v_lshlrev_b32 v104, 3, v104
  v_bfe_u32 v105, v1, 2, 2
  v_add_u32 v104, v104, v105
  v_lshlrev_b32 v104, 7, v104
  v_and_b32 v105, 3, v1
  v_lshl_add_u32 v104, v105, 3, v104
  v_add_u32 v53, s89, v104
  s_add_u32 m0, s89, 0
  s_nop 0
  buffer_load_dwordx4 v6, s[40:43], s87 offen offset:0 lds
  buffer_load_dwordx4 v7, s[40:43], s87 offen offset:1024 lds
  buffer_load_dwordx4 v8, s[40:43], s87 offen offset:2048 lds
  buffer_load_dwordx4 v9, s[40:43], s87 offen offset:3072 lds
  s_add_u32 s87, s87, 128
  s_mov_b32 s88, s3
  s_add_u32 m0, s90, 49152
  s_nop 0
  buffer_load_dwordx4 v14, s[44:47], s88 offen offset:0 lds
  buffer_load_dwordx4 v15, s[44:47], s88 offen offset:1024 lds
  buffer_load_dwordx4 v16, s[44:47], s88 offen offset:2048 lds
  buffer_load_dwordx4 v17, s[44:47], s88 offen offset:3072 lds
  s_add_u32 s88, s88, 221184
  s_add_u32 m0, s89, 4096
  s_nop 0
  buffer_load_dwordx4 v6, s[40:43], s87 offen offset:0 lds
  buffer_load_dwordx4 v7, s[40:43], s87 offen offset:1024 lds
  buffer_load_dwordx4 v8, s[40:43], s87 offen offset:2048 lds
  buffer_load_dwordx4 v9, s[40:43], s87 offen offset:3072 lds
  s_add_u32 s87, s87, 128
  v_mov_b32 v36, 0
  v_mov_b32 v37, 0
  v_mov_b32 v38, 0
  v_mov_b32 v39, 0
  s_mov_b32 s83, 0x3f803f80
  s_lshl2_add_u32 s84, s81, s82
  s_lshl_b32 s84, s84, 6
  s_lshl_b32 s85, s80, 11
  s_add_u32 s84, s84, s85
  s_add_u32 s84, s84, 6899712
  s_cmp_ge_u32 s81, 8
  s_cselect_b32 s84, 2130706432, s84
  v_lshlrev_b32 v40, 4, v40
  s_waitcnt vmcnt(17)
  v_dot2c_f32_bf16 v36, s83, v220
  v_dot2c_f32_bf16 v37, v220, v220
  v_dot2c_f32_bf16 v38, s83, v221
  v_dot2c_f32_bf16 v39, v221, v221
  v_dot2c_f32_bf16 v36, s83, v222
  v_dot2c_f32_bf16 v37, v222, v222
  v_dot2c_f32_bf16 v38, s83, v223
  v_dot2c_f32_bf16 v39, v223, v223
  v_dot2c_f32_bf16 v36, s83, v224
  v_dot2c_f32_bf16 v37, v224, v224
  v_dot2c_f32_bf16 v38, s83, v225
  v_dot2c_f32_bf16 v39, v225, v225
  v_dot2c_f32_bf16 v36, s83, v226
  v_dot2c_f32_bf16 v37, v226, v226
  v_dot2c_f32_bf16 v38, s83, v227
  v_dot2c_f32_bf16 v39, v227, v227
  v_dot2c_f32_bf16 v36, s83, v228
  v_dot2c_f32_bf16 v37, v228, v228
  v_dot2c_f32_bf16 v38, s83, v229
  v_dot2c_f32_bf16 v39, v229, v229
  v_dot2c_f32_bf16 v36, s83, v230
  v_dot2c_f32_bf16 v37, v230, v230
  v_dot2c_f32_bf16 v38, s83, v231
  v_dot2c_f32_bf16 v39, v231, v231
  v_dot2c_f32_bf16 v36, s83, v232
  v_dot2c_f32_bf16 v37, v232, v232
  v_dot2c_f32_bf16 v38, s83, v233
  v_dot2c_f32_bf16 v39, v233, v233
  v_dot2c_f32_bf16 v36, s83, v234
  v_dot2c_f32_bf16 v37, v234, v234
  v_dot2c_f32_bf16 v38, s83, v235
  v_dot2c_f32_bf16 v39, v235, v235
  v_dot2c_f32_bf16 v36, s83, v236
  v_dot2c_f32_bf16 v37, v236, v236
  v_dot2c_f32_bf16 v38, s83, v237
  v_dot2c_f32_bf16 v39, v237, v237
  v_dot2c_f32_bf16 v36, s83, v238
  v_dot2c_f32_bf16 v37, v238, v238
  v_dot2c_f32_bf16 v38, s83, v239
  v_dot2c_f32_bf16 v39, v239, v239
  s_nop 1
  v_add_f32 v36, v36, v38
  v_add_f32 v37, v37, v39
  s_nop 0
  v_add_f32_dpp v36, v36, v36 quad_perm:[1,0,3,2] row_mask:0xf bank_mask:0xf
  v_add_f32_dpp v37, v37, v37 quad_perm:[1,0,3,2] row_mask:0xf bank_mask:0xf
  s_nop 0
  v_add_f32_dpp v36, v36, v36 quad_perm:[2,3,0,1] row_mask:0xf bank_mask:0xf
  v_add_f32_dpp v37, v37, v37 quad_perm:[2,3,0,1] row_mask:0xf bank_mask:0xf
  s_nop 0
  v_add_f32_dpp v36, v36, v36 row_half_mirror row_mask:0xf bank_mask:0xf
  v_add_f32_dpp v37, v37, v37 row_half_mirror row_mask:0xf bank_mask:0xf
  s_nop 0
  v_add_f32_dpp v36, v36, v36 row_mirror row_mask:0xf bank_mask:0xf
  v_add_f32_dpp v37, v37, v37 row_mirror row_mask:0xf bank_mask:0xf
  v_mul_f32 v36, 0x3acccccd, v36
  v_mul_f32 v37, 0x3acccccd, v37
  v_fma_f32 v37, -v36, v36, v37
  v_max_f32 v37, 0, v37
  v_cvt_pk_bf16_f32 v37, v37, v37
  v_and_b32 v37, 0xffff0000, v37
  v_add_f32 v37, 0x3727c5ac, v37
  v_cvt_pk_bf16_f32 v37, v37, v37
  v_and_b32 v37, 0xffff0000, v37
  v_sqrt_f32 v37, v37
  v_cvt_pk_bf16_f32 v220, v36, v36
  v_and_b32 v220, 0xffff0000, v220
  v_cvt_pk_bf16_f32 v222, v37, v37
  v_and_b32 v222, 0xffff0000, v222
  v_rcp_f32 v221, v222
  s_waitcnt lgkmcnt(0)
  s_mul_i32 s61, s61, 0x9E3779B1
  s_add_u32 s61, s61, 0x85EBCA6B
  s_or_b32 s61, s61, 0x101
  v_mov_b32 v223, s61
  s_mov_b64 exec, 0
  s_cmp_eq_u32 s82, 0
  s_cbranch_scc1 L_pgf0
  s_cmp_eq_u32 s82, 1
  s_cbranch_scc1 L_pgf1
  s_cmp_eq_u32 s82, 2
  s_cbranch_scc1 L_pgf2
  s_branch L_pgf3
L_pgfr:
  s_mov_b64 exec, -1
  s_add_u32 m0, s90, 0
  s_nop 0
  buffer_load_dwordx4 v14, s[44:47], s88 offen offset:0 lds
  buffer_load_dwordx4 v15, s[44:47], s88 offen offset:1024 lds
  buffer_load_dwordx4 v16, s[44:47], s88 offen offset:2048 lds
  buffer_load_dwordx4 v17, s[44:47], s88 offen offset:3072 lds
  s_add_u32 s88, s88, 221184
  s_mov_b32 exec_lo, 0x10001
  s_mov_b32 exec_hi, 0x10001
  buffer_store_dwordx4 v[220:223], v40, s[56:59], s84 offen sc1
  s_mov_b64 exec, -1
  s_waitcnt vmcnt(9)
  s_barrier
  ds_read_b128 a[0:3], v10 offset:0
  ds_read_b64_tr_b16 v[64:65], v18 offset:49152
  ds_read_b64_tr_b16 v[66:67], v18 offset:49664
  ds_read_b64_tr_b16 v[68:69], v20 offset:49152
  ds_read_b64_tr_b16 v[70:71], v20 offset:49664
  ds_read_b64_tr_b16 v[72:73], v22 offset:49152
  ds_read_b64_tr_b16 v[74:75], v22 offset:49664
  ds_read_b64_tr_b16 v[76:77], v24 offset:49152
  ds_read_b64_tr_b16 v[78:79], v24 offset:49664
  s_waitcnt lgkmcnt(4)
  v_mfma_f32_32x32x16_bf16 v[128:143], v[64:67], a[0:3], 0
  ds_read_b128 a[4:7], v11 offset:0
  ds_read_b64_tr_b16 v[80:81], v19 offset:49152
  ds_read_b64_tr_b16 v[82:83], v19 offset:49664
  v_mfma_f32_16x16x32_bf16 v[44:47], v[60:63], v[64:67], 0
  v_mfma_f32_32x32x16_bf16 v[144:159], v[68:71], a[0:3], 0
  s_add_u32 m0, s89, 8192
  s_nop 0
  buffer_load_dwordx4 v6, s[40:43], s87 offen offset:0 lds
  ds_read_b64_tr_b16 v[64:65], v21 offset:49152
  ds_read_b64_tr_b16 v[66:67], v21 offset:49664
  s_waitcnt lgkmcnt(5)
  v_mfma_f32_32x32x16_bf16 v[160:175], v[72:75], a[0:3], 0
  buffer_load_dwordx4 v7, s[40:43], s87 offen offset:1024 lds
  buffer_load_dwordx4 v8, s[40:43], s87 offen offset:2048 lds
  ds_read_b64_tr_b16 v[68:69], v23 offset:49152
  ds_read_b64_tr_b16 v[70:71], v23 offset:49664
  v_mfma_f32_32x32x16_bf16 v[176:191], v[76:79], a[0:3], 0
  buffer_load_dwordx4 v9, s[40:43], s87 offen offset:3072 lds
  s_add_u32 s87, s87, 128
  ds_read_b64_tr_b16 v[72:73], v25 offset:49152
  ds_read_b64_tr_b16 v[74:75], v25 offset:49664
  s_waitcnt lgkmcnt(4)
  v_mfma_f32_32x32x16_bf16 v[128:143], v[80:83], a[4:7], v[128:143]
  s_add_u32 m0, s90, 16384
  s_nop 0
  buffer_load_dwordx4 v14, s[44:47], s88 offen offset:0 lds
  ds_read_b128 a[8:11], v12 offset:0
  ds_read_b64_tr_b16 v[76:77], v18 offset:53248
  ds_read_b64_tr_b16 v[78:79], v18 offset:53760
  v_mfma_f32_16x16x32_bf16 v[44:47], v[60:63], v[80:83], v[44:47]
  v_mfma_f32_32x32x16_bf16 v[144:159], v[64:67], a[4:7], v[144:159]
  buffer_load_dwordx4 v15, s[44:47], s88 offen offset:1024 lds
  buffer_load_dwordx4 v16, s[44:47], s88 offen offset:2048 lds
  ds_read_b64_tr_b16 v[80:81], v20 offset:53248
  ds_read_b64_tr_b16 v[82:83], v20 offset:53760
  s_waitcnt lgkmcnt(5)
  v_mfma_f32_32x32x16_bf16 v[160:175], v[68:71], a[4:7], v[160:175]
  buffer_load_dwordx4 v17, s[44:47], s88 offen offset:3072 lds
  s_add_u32 s88, s88, 221184
  ds_read_b64_tr_b16 v[64:65], v22 offset:53248
  ds_read_b64_tr_b16 v[66:67], v22 offset:53760
  v_mfma_f32_32x32x16_bf16 v[176:191], v[72:75], a[4:7], v[176:191]
  s_add_u32 m0, s89, 12288
  s_nop 0
  buffer_load_dwordx4 v6, s[40:43], s87 offen offset:0 lds
  ds_read_b64_tr_b16 v[68:69], v24 offset:53248
  ds_read_b64_tr_b16 v[70:71], v24 offset:53760
  s_waitcnt lgkmcnt(4)
  v_mfma_f32_32x32x16_bf16 v[128:143], v[76:79], a[8:11], v[128:143]
  buffer_load_dwordx4 v7, s[40:43], s87 offen offset:1024 lds
  buffer_load_dwordx4 v8, s[40:43], s87 offen offset:2048 lds
  ds_read_b128 a[12:15], v13 offset:0
  ds_read_b64_tr_b16 v[72:73], v19 offset:53248
  ds_read_b64_tr_b16 v[74:75], v19 offset:53760
  v_mfma_f32_16x16x32_bf16 v[44:47], v[60:63], v[76:79], v[44:47]
  v_mfma_f32_32x32x16_bf16 v[144:159], v[80:83], a[8:11], v[144:159]
  buffer_load_dwordx4 v9, s[40:43], s87 offen offset:3072 lds
  s_add_u32 s87, s87, 128
  ds_read_b64_tr_b16 v[76:77], v21 offset:53248
  ds_read_b64_tr_b16 v[78:79], v21 offset:53760
  s_waitcnt lgkmcnt(5)
  v_mfma_f32_32x32x16_bf16 v[160:175], v[64:67], a[8:11], v[160:175]
  s_add_u32 m0, s90, 32768
  s_nop 0
  buffer_load_dwordx4 v14, s[44:47], s88 offen offset:0 lds
  ds_read_b64_tr_b16 v[80:81], v23 offset:53248
  ds_read_b64_tr_b16 v[82:83], v23 offset:53760
  v_mfma_f32_32x32x16_bf16 v[176:191], v[68:71], a[8:11], v[176:191]
  buffer_load_dwordx4 v15, s[44:47], s88 offen offset:1024 lds
  buffer_load_dwordx4 v16, s[44:47], s88 offen offset:2048 lds
  ds_read_b64_tr_b16 v[64:65], v25 offset:53248
  ds_read_b64_tr_b16 v[66:67], v25 offset:53760
  s_waitcnt lgkmcnt(4)
  v_mfma_f32_32x32x16_bf16 v[128:143], v[72:75], a[12:15], v[128:143]
  buffer_load_dwordx4 v17, s[44:47], s88 offen offset:3072 lds
  s_add_u32 s88, s88, 221184
  s_waitcnt vmcnt(17)
  s_barrier
  ds_read_b128 a[16:19], v10 offset:4096
L_pgf0:
  s_cbranch_execz L_pgf4
  ds_read_b64_tr_b16 v[68:69], v18 offset:0
  ds_read_b64_tr_b16 v[70:71], v18 offset:512
  v_mfma_f32_16x16x32_bf16 v[44:47], v[60:63], v[72:75], v[44:47]
  v_mfma_f32_32x32x16_bf16 v[144:159], v[76:79], a[12:15], v[144:159]
  ds_read_b64_tr_b16 v[72:73], v20 offset:0
  ds_read_b64_tr_b16 v[74:75], v20 offset:512
  s_waitcnt lgkmcnt(5)
  v_mfma_f32_32x32x16_bf16 v[160:175], v[80:83], a[12:15], v[160:175]
  s_add_u32 m0, s90, 49152
  ds_read_b64_tr_b16 v[76:77], v22 offset:0
  ds_read_b64_tr_b16 v[78:79], v22 offset:512
  v_mfma_f32_32x32x16_bf16 v[176:191], v[64:67], a[12:15], v[176:191]
  buffer_load_dwordx4 v14, s[44:47], s88 offen offset:0 lds
  ds_read_b64_tr_b16 v[80:81], v24 offset:0
  ds_read_b64_tr_b16 v[82:83], v24 offset:512
  s_waitcnt lgkmcnt(4)
  v_mfma_f32_32x32x16_bf16 v[128:143], v[68:71], a[16:19], v[128:143]
  buffer_load_dwordx4 v15, s[44:47], s88 offen offset:1024 lds
  ds_read_b128 a[20:23], v11 offset:4096
  ds_read_b64_tr_b16 v[64:65], v19 offset:0
  ds_read_b64_tr_b16 v[66:67], v19 offset:512
  v_mfma_f32_16x16x32_bf16 v[44:47], v[60:63], v[68:71], v[44:47]
  v_mfma_f32_32x32x16_bf16 v[144:159], v[72:75], a[16:19], v[144:159]
  buffer_load_dwordx4 v16, s[44:47], s88 offen offset:2048 lds
  ds_read_b64_tr_b16 v[68:69], v21 offset:0
  ds_read_b64_tr_b16 v[70:71], v21 offset:512
  s_waitcnt lgkmcnt(5)
  v_mfma_f32_32x32x16_bf16 v[160:175], v[76:79], a[16:19], v[160:175]
  buffer_load_dwordx4 v17, s[44:47], s88 offen offset:3072 lds
  ds_read_b64_tr_b16 v[72:73], v23 offset:0
  ds_read_b64_tr_b16 v[74:75], v23 offset:512
  v_mfma_f32_32x32x16_bf16 v[176:191], v[80:83], a[16:19], v[176:191]
  s_add_u32 s88, s88, 221184
  ds_read_b64_tr_b16 v[76:77], v25 offset:0
  ds_read_b64_tr_b16 v[78:79], v25 offset:512
  s_waitcnt lgkmcnt(4)
  v_mfma_f32_32x32x16_bf16 v[128:143], v[64:67], a[20:23], v[128:143]
  s_add_u32 m0, s89, 0
  ds_read_b128 a[24:27], v12 offset:4096
  ds_read_b64_tr_b16 v[80:81], v18 offset:4096
  ds_read_b64_tr_b16 v[82:83], v18 offset:4608
  v_mfma_f32_16x16x32_bf16 v[44:47], v[60:63], v[64:67], v[44:47]
  v_mfma_f32_32x32x16_bf16 v[144:159], v[68:71], a[20:23], v[144:159]
  buffer_load_dwordx4 v6, s[40:43], s87 offen offset:0 lds
  ds_read_b64_tr_b16 v[64:65], v20 offset:4096
  ds_read_b64_tr_b16 v[66:67], v20 offset:4608
  s_waitcnt lgkmcnt(5)
  v_mfma_f32_32x32x16_bf16 v[160:175], v[72:75], a[20:23], v[160:175]
  buffer_load_dwordx4 v7, s[40:43], s87 offen offset:1024 lds
  ds_read_b64_tr_b16 v[68:69], v22 offset:4096
  ds_read_b64_tr_b16 v[70:71], v22 offset:4608
  v_mfma_f32_32x32x16_bf16 v[176:191], v[76:79], a[20:23], v[176:191]
  buffer_load_dwordx4 v8, s[40:43], s87 offen offset:2048 lds
  ds_read_b64_tr_b16 v[72:73], v24 offset:4096
  ds_read_b64_tr_b16 v[74:75], v24 offset:4608
  s_waitcnt lgkmcnt(4)
  v_mfma_f32_32x32x16_bf16 v[128:143], v[80:83], a[24:27], v[128:143]
  buffer_load_dwordx4 v9, s[40:43], s87 offen offset:3072 lds
  ds_read_b128 a[28:31], v13 offset:4096
  ds_read_b64_tr_b16 v[76:77], v19 offset:4096
  ds_read_b64_tr_b16 v[78:79], v19 offset:4608
  v_mfma_f32_16x16x32_bf16 v[44:47], v[60:63], v[80:83], v[44:47]
  v_mfma_f32_32x32x16_bf16 v[144:159], v[64:67], a[24:27], v[144:159]
  s_add_u32 s87, s87, 128
  ds_read_b64_tr_b16 v[80:81], v21 offset:4096
  ds_read_b64_tr_b16 v[82:83], v21 offset:4608
  s_waitcnt lgkmcnt(5)
  v_mfma_f32_32x32x16_bf16 v[160:175], v[68:71], a[24:27], v[160:175]
  ds_read_b64_tr_b16 v[64:65], v23 offset:4096
  ds_read_b64_tr_b16 v[66:67], v23 offset:4608
  v_mfma_f32_32x32x16_bf16 v[176:191], v[72:75], a[24:27], v[176:191]
  ds_read_b64_tr_b16 v[68:69], v25 offset:4096
  ds_read_b64_tr_b16 v[70:71], v25 offset:4608
  s_waitcnt lgkmcnt(4)
  v_mfma_f32_32x32x16_bf16 v[128:143], v[76:79], a[28:31], v[128:143]
  s_waitcnt vmcnt(16)
  s_barrier
  ds_read_b128 a[32:35], v10 offset:8192
  ds_read_b64_tr_b16 v[72:73], v18 offset:16384
  ds_read_b64_tr_b16 v[74:75], v18 offset:16896
  v_mfma_f32_16x16x32_bf16 v[44:47], v[60:63], v[76:79], v[44:47]
  v_mfma_f32_32x32x16_bf16 v[144:159], v[80:83], a[28:31], v[144:159]
  ds_read_b64_tr_b16 v[76:77], v20 offset:16384
  ds_read_b64_tr_b16 v[78:79], v20 offset:16896
  s_waitcnt lgkmcnt(5)
  v_mfma_f32_32x32x16_bf16 v[160:175], v[64:67], a[28:31], v[160:175]
  s_add_u32 m0, s90, 0
  ds_read_b64_tr_b16 v[80:81], v22 offset:16384
  ds_read_b64_tr_b16 v[82:83], v22 offset:16896
  v_mfma_f32_32x32x16_bf16 v[176:191], v[68:71], a[28:31], v[176:191]
  buffer_load_dwordx4 v14, s[44:47], s88 offen offset:0 lds
  ds_read_b64_tr_b16 v[64:65], v24 offset:16384
  ds_read_b64_tr_b16 v[66:67], v24 offset:16896
  s_waitcnt lgkmcnt(4)
  v_mfma_f32_32x32x16_bf16 v[128:143], v[72:75], a[32:35], v[128:143]
  buffer_load_dwordx4 v15, s[44:47], s88 offen offset:1024 lds
  ds_read_b128 a[36:39], v11 offset:8192
  ds_read_b64_tr_b16 v[68:69], v19 offset:16384
  ds_read_b64_tr_b16 v[70:71], v19 offset:16896
  v_mfma_f32_16x16x32_bf16 v[44:47], v[60:63], v[72:75], v[44:47]
  v_mfma_f32_32x32x16_bf16 v[144:159], v[76:79], a[32:35], v[144:159]
  buffer_load_dwordx4 v16, s[44:47], s88 offen offset:2048 lds
  ds_read_b64_tr_b16 v[72:73], v21 offset:16384
  ds_read_b64_tr_b16 v[74:75], v21 offset:16896
  s_waitcnt lgkmcnt(5)
  v_mfma_f32_32x32x16_bf16 v[160:175], v[80:83], a[32:35], v[160:175]
  buffer_load_dwordx4 v17, s[44:47], s88 offen offset:3072 lds
  ds_read_b64_tr_b16 v[76:77], v23 offset:16384
  ds_read_b64_tr_b16 v[78:79], v23 offset:16896
  v_mfma_f32_32x32x16_bf16 v[176:191], v[64:67], a[32:35], v[176:191]
  s_add_u32 s88, s88, 221184
  ds_read_b64_tr_b16 v[80:81], v25 offset:16384
  ds_read_b64_tr_b16 v[82:83], v25 offset:16896
  s_waitcnt lgkmcnt(4)
  v_mfma_f32_32x32x16_bf16 v[128:143], v[68:71], a[36:39], v[128:143]
  s_add_u32 m0, s89, 4096
  ds_read_b128 a[40:43], v12 offset:8192
  ds_read_b64_tr_b16 v[64:65], v18 offset:20480
  ds_read_b64_tr_b16 v[66:67], v18 offset:20992
  v_mfma_f32_16x16x32_bf16 v[44:47], v[60:63], v[68:71], v[44:47]
  v_mfma_f32_32x32x16_bf16 v[144:159], v[72:75], a[36:39], v[144:159]
  buffer_load_dwordx4 v6, s[40:43], s87 offen offset:0 lds
  ds_read_b64_tr_b16 v[68:69], v20 offset:20480
  ds_read_b64_tr_b16 v[70:71], v20 offset:20992
  s_waitcnt lgkmcnt(5)
  v_mfma_f32_32x32x16_bf16 v[160:175], v[76:79], a[36:39], v[160:175]
  buffer_load_dwordx4 v7, s[40:43], s87 offen offset:1024 lds
  ds_read_b64_tr_b16 v[72:73], v22 offset:20480
  ds_read_b64_tr_b16 v[74:75], v22 offset:20992
  v_mfma_f32_32x32x16_bf16 v[176:191], v[80:83], a[36:39], v[176:191]
  buffer_load_dwordx4 v8, s[40:43], s87 offen offset:2048 lds
  ds_read_b64_tr_b16 v[76:77], v24 offset:20480
  ds_read_b64_tr_b16 v[78:79], v24 offset:20992
  s_waitcnt lgkmcnt(4)
  v_mfma_f32_32x32x16_bf16 v[128:143], v[64:67], a[40:43], v[128:143]
  buffer_load_dwordx4 v9, s[40:43], s87 offen offset:3072 lds
  ds_read_b128 a[44:47], v13 offset:8192
  ds_read_b64_tr_b16 v[80:81], v19 offset:20480
  ds_read_b64_tr_b16 v[82:83], v19 offset:20992
  v_mfma_f32_16x16x32_bf16 v[44:47], v[60:63], v[64:67], v[44:47]
  v_and_b32 v43, 31, v1
  v_lshl_add_u32 v43, s82, 5, v43
  v_mfma_f32_32x32x16_bf16 v[144:159], v[68:71], a[40:43], v[144:159]
  s_add_u32 s87, s87, 128
  ds_read_b64_tr_b16 v[64:65], v21 offset:20480
  ds_read_b64_tr_b16 v[66:67], v21 offset:20992
  v_lshl_add_u32 v42, s80, 7, v43
  v_lshlrev_b32 v42, 4, v42
  s_waitcnt lgkmcnt(5)
  v_mfma_f32_32x32x16_bf16 v[160:175], v[72:75], a[40:43], v[160:175]
  ds_read_b64_tr_b16 v[68:69], v23 offset:20480
  ds_read_b64_tr_b16 v[70:71], v23 offset:20992
  v_add_u32 v42, 6899712, v42
  v_mfma_f32_32x32x16_bf16 v[176:191], v[76:79], a[40:43], v[176:191]
  ds_read_b64_tr_b16 v[72:73], v25 offset:20480
  ds_read_b64_tr_b16 v[74:75], v25 offset:20992
  buffer_load_dword a255, v52, s[44:47], s5 offen
  s_waitcnt lgkmcnt(4)
  v_mfma_f32_32x32x16_bf16 v[128:143], v[80:83], a[44:47], v[128:143]
  s_waitcnt vmcnt(17)
  s_barrier
  ds_read_b128 a[48:51], v10 offset:12288
  ds_read_b64_tr_b16 v[76:77], v18 offset:32768
  ds_read_b64_tr_b16 v[78:79], v18 offset:33280
  v_mfma_f32_16x16x32_bf16 v[44:47], v[60:63], v[80:83], v[44:47]
  v_mfma_f32_32x32x16_bf16 v[144:159], v[64:67], a[44:47], v[144:159]
  ds_read_b64_tr_b16 v[80:81], v20 offset:32768
  ds_read_b64_tr_b16 v[82:83], v20 offset:33280
  s_waitcnt lgkmcnt(5)
  v_mfma_f32_32x32x16_bf16 v[160:175], v[68:71], a[44:47], v[160:175]
  s_add_u32 m0, s90, 16384
  ds_read_b64_tr_b16 v[64:65], v22 offset:32768
  ds_read_b64_tr_b16 v[66:67], v22 offset:33280
  v_mfma_f32_32x32x16_bf16 v[176:191], v[72:75], a[44:47], v[176:191]
  buffer_load_dwordx4 v14, s[44:47], s88 offen offset:0 lds
  ds_read_b64_tr_b16 v[68:69], v24 offset:32768
  ds_read_b64_tr_b16 v[70:71], v24 offset:33280
  s_waitcnt lgkmcnt(4)
  v_mfma_f32_32x32x16_bf16 v[128:143], v[76:79], a[48:51], v[128:143]
  buffer_load_dwordx4 v15, s[44:47], s88 offen offset:1024 lds
  ds_read_b128 a[52:55], v11 offset:12288
  ds_read_b64_tr_b16 v[72:73], v19 offset:32768
  ds_read_b64_tr_b16 v[74:75], v19 offset:33280
  v_mfma_f32_16x16x32_bf16 v[44:47], v[60:63], v[76:79], v[44:47]
  v_mfma_f32_32x32x16_bf16 v[144:159], v[80:83], a[48:51], v[144:159]
  buffer_load_dwordx4 v16, s[44:47], s88 offen offset:2048 lds
  ds_read_b64_tr_b16 v[76:77], v21 offset:32768
  ds_read_b64_tr_b16 v[78:79], v21 offset:33280
  s_waitcnt lgkmcnt(5)
  v_mfma_f32_32x32x16_bf16 v[160:175], v[64:67], a[48:51], v[160:175]
  buffer_load_dwordx4 v17, s[44:47], s88 offen offset:3072 lds
  ds_read_b64_tr_b16 v[80:81], v23 offset:32768
  ds_read_b64_tr_b16 v[82:83], v23 offset:33280
  v_mfma_f32_32x32x16_bf16 v[176:191], v[68:71], a[48:51], v[176:191]
  s_add_u32 s88, s88, 221184
  ds_read_b64_tr_b16 v[64:65], v25 offset:32768
  ds_read_b64_tr_b16 v[66:67], v25 offset:33280
  s_waitcnt lgkmcnt(4)
  v_mfma_f32_32x32x16_bf16 v[128:143], v[72:75], a[52:55], v[128:143]
  s_add_u32 m0, s89, 8192
  ds_read_b128 a[56:59], v12 offset:12288
  ds_read_b64_tr_b16 v[68:69], v18 offset:36864
  ds_read_b64_tr_b16 v[70:71], v18 offset:37376
  v_mfma_f32_16x16x32_bf16 v[44:47], v[60:63], v[72:75], v[44:47]
  v_mfma_f32_32x32x16_bf16 v[144:159], v[76:79], a[52:55], v[144:159]
  buffer_load_dwordx4 v6, s[40:43], s87 offen offset:0 lds
  ds_read_b64_tr_b16 v[72:73], v20 offset:36864
  ds_read_b64_tr_b16 v[74:75], v20 offset:37376
  s_waitcnt lgkmcnt(5)
  v_mfma_f32_32x32x16_bf16 v[160:175], v[80:83], a[52:55], v[160:175]
  buffer_load_dwordx4 v7, s[40:43], s87 offen offset:1024 lds
  ds_read_b64_tr_b16 v[76:77], v22 offset:36864
  ds_read_b64_tr_b16 v[78:79], v22 offset:37376
  v_mfma_f32_32x32x16_bf16 v[176:191], v[64:67], a[52:55], v[176:191]
  buffer_load_dwordx4 v8, s[40:43], s87 offen offset:2048 lds
  ds_read_b64_tr_b16 v[80:81], v24 offset:36864
  ds_read_b64_tr_b16 v[82:83], v24 offset:37376
  s_waitcnt lgkmcnt(4)
  v_mfma_f32_32x32x16_bf16 v[128:143], v[68:71], a[56:59], v[128:143]
  buffer_load_dwordx4 v9, s[40:43], s87 offen offset:3072 lds
  ds_read_b128 a[60:63], v13 offset:12288
  ds_read_b64_tr_b16 v[64:65], v19 offset:36864
  ds_read_b64_tr_b16 v[66:67], v19 offset:37376
  v_mfma_f32_16x16x32_bf16 v[44:47], v[60:63], v[68:71], v[44:47]
  v_mfma_f32_32x32x16_bf16 v[144:159], v[72:75], a[56:59], v[144:159]
  s_add_u32 s87, s87, 128
  ds_read_b64_tr_b16 v[68:69], v21 offset:36864
  ds_read_b64_tr_b16 v[70:71], v21 offset:37376
  s_waitcnt lgkmcnt(5)
  v_mfma_f32_32x32x16_bf16 v[160:175], v[76:79], a[56:59], v[160:175]
  ds_read_b64_tr_b16 v[72:73], v23 offset:36864
  ds_read_b64_tr_b16 v[74:75], v23 offset:37376
  s_add_u32 m0, s89, 16384
  s_nop 0
  buffer_load_dwordx4 v54, s[68:71], s14 offen offset:0 lds
  s_add_u32 s14, s14, 9216
  buffer_load_dwordx4 v54, s[68:71], s14 offen offset:1024 lds
  s_add_u32 s14, s14, 9216
  buffer_load_dwordx4 v54, s[68:71], s14 offen offset:2048 lds
  s_add_u32 s14, s14, 9216
  buffer_load_dwordx4 v54, s[68:71], s14 offen offset:3072 lds
  v_mfma_f32_32x32x16_bf16 v[176:191], v[80:83], a[56:59], v[176:191]
  ds_read_b64_tr_b16 v[76:77], v25 offset:36864
  ds_read_b64_tr_b16 v[78:79], v25 offset:37376
  s_waitcnt lgkmcnt(4)
  v_mfma_f32_32x32x16_bf16 v[128:143], v[64:67], a[60:63], v[128:143]
  s_waitcnt vmcnt(21)
  s_barrier
  ds_read_b128 a[64:67], v10 offset:0
  ds_read_b64_tr_b16 v[80:81], v18 offset:49152
  ds_read_b64_tr_b16 v[82:83], v18 offset:49664
  v_mfma_f32_16x16x32_bf16 v[44:47], v[60:63], v[64:67], v[44:47]
  v_mfma_f32_32x32x16_bf16 v[144:159], v[68:71], a[60:63], v[144:159]
  ds_read_b64_tr_b16 v[64:65], v20 offset:49152
  ds_read_b64_tr_b16 v[66:67], v20 offset:49664
  s_waitcnt lgkmcnt(5)
  v_mfma_f32_32x32x16_bf16 v[160:175], v[72:75], a[60:63], v[160:175]
  s_add_u32 m0, s90, 32768
  ds_read_b64_tr_b16 v[68:69], v22 offset:49152
  ds_read_b64_tr_b16 v[70:71], v22 offset:49664
  v_mfma_f32_32x32x16_bf16 v[176:191], v[76:79], a[60:63], v[176:191]
  buffer_load_dwordx4 v14, s[44:47], s88 offen offset:0 lds
  ds_read_b64_tr_b16 v[72:73], v24 offset:49152
  ds_read_b64_tr_b16 v[74:75], v24 offset:49664
  s_waitcnt lgkmcnt(4)
  v_mfma_f32_32x32x16_bf16 v[128:143], v[80:83], a[64:67], v[128:143]
  buffer_load_dwordx4 v15, s[44:47], s88 offen offset:1024 lds
  ds_read_b128 a[68:71], v11 offset:0
  ds_read_b64_tr_b16 v[76:77], v19 offset:49152
  ds_read_b64_tr_b16 v[78:79], v19 offset:49664
  v_mfma_f32_16x16x32_bf16 v[44:47], v[60:63], v[80:83], v[44:47]
  v_mfma_f32_32x32x16_bf16 v[144:159], v[64:67], a[64:67], v[144:159]
  buffer_load_dwordx4 v16, s[44:47], s88 offen offset:2048 lds
  ds_read_b64_tr_b16 v[80:81], v21 offset:49152
  ds_read_b64_tr_b16 v[82:83], v21 offset:49664
  s_waitcnt lgkmcnt(5)
  v_mfma_f32_32x32x16_bf16 v[160:175], v[68:71], a[64:67], v[160:175]
  buffer_load_dwordx4 v17, s[44:47], s88 offen offset:3072 lds
  ds_read_b64_tr_b16 v[64:65], v23 offset:49152
  ds_read_b64_tr_b16 v[66:67], v23 offset:49664
  v_mfma_f32_32x32x16_bf16 v[176:191], v[72:75], a[64:67], v[176:191]
  s_add_u32 s88, s88, 221184
  ds_read_b64_tr_b16 v[68:69], v25 offset:49152
  ds_read_b64_tr_b16 v[70:71], v25 offset:49664
  s_waitcnt lgkmcnt(4)
  v_mfma_f32_32x32x16_bf16 v[128:143], v[76:79], a[68:71], v[128:143]
  s_add_u32 m0, s89, 12288
  ds_read_b128 a[72:75], v12 offset:0
  ds_read_b64_tr_b16 v[72:73], v18 offset:53248
  ds_read_b64_tr_b16 v[74:75], v18 offset:53760
  v_mfma_f32_16x16x32_bf16 v[44:47], v[60:63], v[76:79], v[44:47]
  v_mfma_f32_32x32x16_bf16 v[144:159], v[80:83], a[68:71], v[144:159]
  buffer_load_dwordx4 v6, s[40:43], s87 offen offset:0 lds
  ds_read_b64_tr_b16 v[76:77], v20 offset:53248
  ds_read_b64_tr_b16 v[78:79], v20 offset:53760
  s_waitcnt lgkmcnt(5)
  v_mfma_f32_32x32x16_bf16 v[160:175], v[64:67], a[68:71], v[160:175]
  buffer_load_dwordx4 v7, s[40:43], s87 offen offset:1024 lds
  ds_read_b64_tr_b16 v[80:81], v22 offset:53248
  ds_read_b64_tr_b16 v[82:83], v22 offset:53760
  v_mfma_f32_32x32x16_bf16 v[176:191], v[68:71], a[68:71], v[176:191]
  buffer_load_dwordx4 v8, s[40:43], s87 offen offset:2048 lds
  ds_read_b64_tr_b16 v[64:65], v24 offset:53248
  ds_read_b64_tr_b16 v[66:67], v24 offset:53760
  s_waitcnt lgkmcnt(4)
  v_mfma_f32_32x32x16_bf16 v[128:143], v[72:75], a[72:75], v[128:143]
  buffer_load_dwordx4 v9, s[40:43], s87 offen offset:3072 lds
  ds_read_b128 a[76:79], v13 offset:0
  ds_read_b64_tr_b16 v[68:69], v19 offset:53248
  ds_read_b64_tr_b16 v[70:71], v19 offset:53760
  v_mfma_f32_16x16x32_bf16 v[44:47], v[60:63], v[72:75], v[44:47]
  v_mfma_f32_32x32x16_bf16 v[144:159], v[76:79], a[72:75], v[144:159]
  s_add_u32 s87, s87, 128
  ds_read_b64_tr_b16 v[72:73], v21 offset:53248
  ds_read_b64_tr_b16 v[74:75], v21 offset:53760
  s_waitcnt lgkmcnt(5)
  v_mfma_f32_32x32x16_bf16 v[160:175], v[80:83], a[72:75], v[160:175]
  ds_read_b64_tr_b16 v[76:77], v23 offset:53248
  ds_read_b64_tr_b16 v[78:79], v23 offset:53760
  v_mfma_f32_32x32x16_bf16 v[176:191], v[64:67], a[72:75], v[176:191]
  ds_read_b64_tr_b16 v[80:81], v25 offset:53248
  ds_read_b64_tr_b16 v[82:83], v25 offset:53760
  s_waitcnt lgkmcnt(4)
  v_mfma_f32_32x32x16_bf16 v[128:143], v[68:71], a[76:79], v[128:143]
  s_waitcnt vmcnt(21)
  s_barrier
  ds_read_b128 a[80:83], v10 offset:4096
  ds_read_b64_tr_b16 v[64:65], v18 offset:0
  ds_read_b64_tr_b16 v[66:67], v18 offset:512
  v_mfma_f32_16x16x32_bf16 v[44:47], v[60:63], v[68:71], v[44:47]
  v_mfma_f32_32x32x16_bf16 v[144:159], v[72:75], a[76:79], v[144:159]
  ds_read_b64_tr_b16 v[68:69], v20 offset:0
  ds_read_b64_tr_b16 v[70:71], v20 offset:512
  s_waitcnt lgkmcnt(5)
  v_mfma_f32_32x32x16_bf16 v[160:175], v[76:79], a[76:79], v[160:175]
  s_add_u32 m0, s90, 49152
  ds_read_b64_tr_b16 v[72:73], v22 offset:0
  ds_read_b64_tr_b16 v[74:75], v22 offset:512
  v_mfma_f32_32x32x16_bf16 v[176:191], v[80:83], a[76:79], v[176:191]
  buffer_load_dwordx4 v14, s[44:47], s88 offen offset:0 lds
  ds_read_b64_tr_b16 v[76:77], v24 offset:0
  ds_read_b64_tr_b16 v[78:79], v24 offset:512
  s_waitcnt lgkmcnt(4)
  v_mfma_f32_32x32x16_bf16 v[128:143], v[64:67], a[80:83], v[128:143]
  buffer_load_dwordx4 v15, s[44:47], s88 offen offset:1024 lds
  ds_read_b128 a[84:87], v11 offset:4096
  ds_read_b64_tr_b16 v[80:81], v19 offset:0
  ds_read_b64_tr_b16 v[82:83], v19 offset:512
  v_mfma_f32_16x16x32_bf16 v[44:47], v[60:63], v[64:67], v[44:47]
  v_mfma_f32_32x32x16_bf16 v[144:159], v[68:71], a[80:83], v[144:159]
  buffer_load_dwordx4 v16, s[44:47], s88 offen offset:2048 lds
  ds_read_b64_tr_b16 v[64:65], v21 offset:0
  ds_read_b64_tr_b16 v[66:67], v21 offset:512
  s_waitcnt lgkmcnt(5)
  v_mfma_f32_32x32x16_bf16 v[160:175], v[72:75], a[80:83], v[160:175]
  buffer_load_dwordx4 v17, s[44:47], s88 offen offset:3072 lds
  ds_read_b64_tr_b16 v[68:69], v23 offset:0
  ds_read_b64_tr_b16 v[70:71], v23 offset:512
  v_mfma_f32_32x32x16_bf16 v[176:191], v[76:79], a[80:83], v[176:191]
  s_add_u32 s88, s88, 221184
  ds_read_b64_tr_b16 v[72:73], v25 offset:0
  ds_read_b64_tr_b16 v[74:75], v25 offset:512
  s_waitcnt lgkmcnt(4)
  v_mfma_f32_32x32x16_bf16 v[128:143], v[80:83], a[84:87], v[128:143]
  s_add_u32 m0, s89, 0
  ds_read_b128 a[88:91], v12 offset:4096
  ds_read_b64_tr_b16 v[76:77], v18 offset:4096
  ds_read_b64_tr_b16 v[78:79], v18 offset:4608
  v_mfma_f32_16x16x32_bf16 v[44:47], v[60:63], v[80:83], v[44:47]
  v_mfma_f32_32x32x16_bf16 v[144:159], v[64:67], a[84:87], v[144:159]
  buffer_load_dwordx4 v6, s[40:43], s87 offen offset:0 lds
  ds_read_b64_tr_b16 v[80:81], v20 offset:4096
  ds_read_b64_tr_b16 v[82:83], v20 offset:4608
  s_waitcnt lgkmcnt(5)
  v_mfma_f32_32x32x16_bf16 v[160:175], v[68:71], a[84:87], v[160:175]
  buffer_load_dwordx4 v7, s[40:43], s87 offen offset:1024 lds
  ds_read_b64_tr_b16 v[64:65], v22 offset:4096
  ds_read_b64_tr_b16 v[66:67], v22 offset:4608
  v_mfma_f32_32x32x16_bf16 v[176:191], v[72:75], a[84:87], v[176:191]
  buffer_load_dwordx4 v8, s[40:43], s87 offen offset:2048 lds
  ds_read_b64_tr_b16 v[68:69], v24 offset:4096
  ds_read_b64_tr_b16 v[70:71], v24 offset:4608
  s_waitcnt lgkmcnt(4)
  v_mfma_f32_32x32x16_bf16 v[128:143], v[76:79], a[88:91], v[128:143]
  buffer_load_dwordx4 v9, s[40:43], s87 offen offset:3072 lds
  ds_read_b128 a[92:95], v13 offset:4096
  ds_read_b64_tr_b16 v[72:73], v19 offset:4096
  ds_read_b64_tr_b16 v[74:75], v19 offset:4608
  v_mfma_f32_16x16x32_bf16 v[44:47], v[60:63], v[76:79], v[44:47]
  v_mfma_f32_32x32x16_bf16 v[144:159], v[80:83], a[88:91], v[144:159]
  s_add_u32 s87, s87, 128
  ds_read_b64_tr_b16 v[76:77], v21 offset:4096
  ds_read_b64_tr_b16 v[78:79], v21 offset:4608
  s_waitcnt lgkmcnt(5)
  v_mfma_f32_32x32x16_bf16 v[160:175], v[64:67], a[88:91], v[160:175]
  ds_read_b64_tr_b16 v[80:81], v23 offset:4096
  ds_read_b64_tr_b16 v[82:83], v23 offset:4608
  v_mfma_f32_32x32x16_bf16 v[176:191], v[68:71], a[88:91], v[176:191]
  ds_read_b64_tr_b16 v[64:65], v25 offset:4096
  ds_read_b64_tr_b16 v[66:67], v25 offset:4608
  s_waitcnt lgkmcnt(4)
  v_mfma_f32_32x32x16_bf16 v[128:143], v[72:75], a[92:95], v[128:143]
  s_waitcnt vmcnt(20)
  s_barrier
  ds_read_b128 a[96:99], v10 offset:8192
  ds_read_b64_tr_b16 v[68:69], v18 offset:16384
  ds_read_b64_tr_b16 v[70:71], v18 offset:16896
  v_mfma_f32_16x16x32_bf16 v[44:47], v[60:63], v[72:75], v[44:47]
  v_mfma_f32_32x32x16_bf16 v[144:159], v[76:79], a[92:95], v[144:159]
  ds_read_b64_tr_b16 v[72:73], v20 offset:16384
  ds_read_b64_tr_b16 v[74:75], v20 offset:16896
  s_waitcnt lgkmcnt(5)
  v_mfma_f32_32x32x16_bf16 v[160:175], v[80:83], a[92:95], v[160:175]
  s_add_u32 m0, s90, 0
  ds_read_b64_tr_b16 v[76:77], v22 offset:16384
  ds_read_b64_tr_b16 v[78:79], v22 offset:16896
  v_mfma_f32_32x32x16_bf16 v[176:191], v[64:67], a[92:95], v[176:191]
  buffer_load_dwordx4 v14, s[44:47], s88 offen offset:0 lds
  ds_read_b64_tr_b16 v[80:81], v24 offset:16384
  ds_read_b64_tr_b16 v[82:83], v24 offset:16896
  s_waitcnt lgkmcnt(4)
  v_mfma_f32_32x32x16_bf16 v[128:143], v[68:71], a[96:99], v[128:143]
  buffer_load_dwordx4 v15, s[44:47], s88 offen offset:1024 lds
  ds_read_b128 a[100:103], v11 offset:8192
  ds_read_b64_tr_b16 v[64:65], v19 offset:16384
  ds_read_b64_tr_b16 v[66:67], v19 offset:16896
  buffer_load_dwordx4 v[104:107], v42, s[56:59], 0 offen sc1
  v_mfma_f32_16x16x32_bf16 v[44:47], v[60:63], v[68:71], v[44:47]
  v_mfma_f32_32x32x16_bf16 v[144:159], v[72:75], a[96:99], v[144:159]
  buffer_load_dwordx4 v16, s[44:47], s88 offen offset:2048 lds
  ds_read_b64_tr_b16 v[68:69], v21 offset:16384
  ds_read_b64_tr_b16 v[70:71], v21 offset:16896
  s_waitcnt lgkmcnt(5)
  v_mfma_f32_32x32x16_bf16 v[160:175], v[76:79], a[96:99], v[160:175]
  buffer_load_dwordx4 v17, s[44:47], s88 offen offset:3072 lds
  ds_read_b64_tr_b16 v[72:73], v23 offset:16384
  ds_read_b64_tr_b16 v[74:75], v23 offset:16896
  v_mfma_f32_32x32x16_bf16 v[176:191], v[80:83], a[96:99], v[176:191]
  s_add_u32 s88, s88, 221184
  ds_read_b64_tr_b16 v[76:77], v25 offset:16384
  ds_read_b64_tr_b16 v[78:79], v25 offset:16896
  s_waitcnt lgkmcnt(4)
  v_mfma_f32_32x32x16_bf16 v[128:143], v[64:67], a[100:103], v[128:143]
  s_add_u32 m0, s89, 4096
  ds_read_b128 a[104:107], v12 offset:8192
  ds_read_b64_tr_b16 v[80:81], v18 offset:20480
  ds_read_b64_tr_b16 v[82:83], v18 offset:20992
  v_mfma_f32_16x16x32_bf16 v[44:47], v[60:63], v[64:67], v[44:47]
  v_mfma_f32_32x32x16_bf16 v[144:159], v[68:71], a[100:103], v[144:159]
  buffer_load_dwordx4 v6, s[40:43], s87 offen offset:0 lds
  ds_read_b64_tr_b16 v[64:65], v20 offset:20480
  ds_read_b64_tr_b16 v[66:67], v20 offset:20992
  s_waitcnt lgkmcnt(5)
  v_mfma_f32_32x32x16_bf16 v[160:175], v[72:75], a[100:103], v[160:175]
  buffer_load_dwordx4 v7, s[40:43], s87 offen offset:1024 lds
  ds_read_b64_tr_b16 v[68:69], v22 offset:20480
  ds_read_b64_tr_b16 v[70:71], v22 offset:20992
  v_mfma_f32_32x32x16_bf16 v[176:191], v[76:79], a[100:103], v[176:191]
  buffer_load_dwordx4 v8, s[40:43], s87 offen offset:2048 lds
  ds_read_b64_tr_b16 v[72:73], v24 offset:20480
  ds_read_b64_tr_b16 v[74:75], v24 offset:20992
  s_waitcnt lgkmcnt(4)
  v_mfma_f32_32x32x16_bf16 v[128:143], v[80:83], a[104:107], v[128:143]
  buffer_load_dwordx4 v9, s[40:43], s87 offen offset:3072 lds
  ds_read_b128 a[108:111], v13 offset:8192
  ds_read_b64_tr_b16 v[76:77], v19 offset:20480
  ds_read_b64_tr_b16 v[78:79], v19 offset:20992
  v_mfma_f32_16x16x32_bf16 v[44:47], v[60:63], v[80:83], v[44:47]
  v_mfma_f32_32x32x16_bf16 v[144:159], v[64:67], a[104:107], v[144:159]
  s_add_u32 s87, s87, 128
  ds_read_b64_tr_b16 v[80:81], v21 offset:20480
  ds_read_b64_tr_b16 v[82:83], v21 offset:20992
  s_waitcnt lgkmcnt(5)
  v_mfma_f32_32x32x16_bf16 v[160:175], v[68:71], a[104:107], v[160:175]
  ds_read_b64_tr_b16 v[64:65], v23 offset:20480
  ds_read_b64_tr_b16 v[66:67], v23 offset:20992
  v_mfma_f32_32x32x16_bf16 v[176:191], v[72:75], a[104:107], v[176:191]
  ds_read_b64_tr_b16 v[68:69], v25 offset:20480
  ds_read_b64_tr_b16 v[70:71], v25 offset:20992
  s_waitcnt lgkmcnt(4)
  v_mfma_f32_32x32x16_bf16 v[128:143], v[76:79], a[108:111], v[128:143]
  s_waitcnt vmcnt(17)
  s_barrier
  ds_read_b128 a[112:115], v10 offset:12288
  ds_read_b64_tr_b16 v[72:73], v18 offset:32768
  ds_read_b64_tr_b16 v[74:75], v18 offset:33280
  v_mfma_f32_16x16x32_bf16 v[44:47], v[60:63], v[76:79], v[44:47]
  v_mfma_f32_32x32x16_bf16 v[144:159], v[80:83], a[108:111], v[144:159]
  ds_read_b64_tr_b16 v[76:77], v20 offset:32768
  ds_read_b64_tr_b16 v[78:79], v20 offset:33280
  s_waitcnt lgkmcnt(5)
  v_mfma_f32_32x32x16_bf16 v[160:175], v[64:67], a[108:111], v[160:175]
  s_mov_b32 s88, s5
  ds_read_b64_tr_b16 v[80:81], v22 offset:32768
  ds_read_b64_tr_b16 v[82:83], v22 offset:33280
  v_mfma_f32_32x32x16_bf16 v[176:191], v[68:71], a[108:111], v[176:191]
  s_add_u32 m0, s90, 16384
  ds_read_b64_tr_b16 v[64:65], v24 offset:32768
  ds_read_b64_tr_b16 v[66:67], v24 offset:33280
  s_waitcnt lgkmcnt(4)
  v_mfma_f32_32x32x16_bf16 v[128:143], v[72:75], a[112:115], v[128:143]
  buffer_load_dwordx4 v26, s[44:47], s88 offen offset:0 lds
  ds_read_b128 a[116:119], v11 offset:12288
  ds_read_b64_tr_b16 v[68:69], v19 offset:32768
  ds_read_b64_tr_b16 v[70:71], v19 offset:33280
  v_mfma_f32_16x16x32_bf16 v[44:47], v[60:63], v[72:75], v[44:47]
  v_mfma_f32_32x32x16_bf16 v[144:159], v[76:79], a[112:115], v[144:159]
  buffer_load_dwordx4 v27, s[44:47], s88 offen offset:1024 lds
  ds_read_b64_tr_b16 v[72:73], v21 offset:32768
  ds_read_b64_tr_b16 v[74:75], v21 offset:33280
  s_waitcnt lgkmcnt(5)
  v_mfma_f32_32x32x16_bf16 v[160:175], v[80:83], a[112:115], v[160:175]
  buffer_load_dwordx4 v28, s[44:47], s88 offen offset:2048 lds
  ds_read_b64_tr_b16 v[76:77], v23 offset:32768
  ds_read_b64_tr_b16 v[78:79], v23 offset:33280
  v_mfma_f32_32x32x16_bf16 v[176:191], v[64:67], a[112:115], v[176:191]
  buffer_load_dwordx4 v29, s[44:47], s88 offen offset:3072 lds
  ds_read_b64_tr_b16 v[80:81], v25 offset:32768
  ds_read_b64_tr_b16 v[82:83], v25 offset:33280
  s_waitcnt lgkmcnt(4)
  v_mfma_f32_32x32x16_bf16 v[128:143], v[68:71], a[116:119], v[128:143]
  s_add_u32 s88, s88, 442368
  ds_read_b128 a[120:123], v12 offset:12288
  ds_read_b64_tr_b16 v[64:65], v18 offset:36864
  ds_read_b64_tr_b16 v[66:67], v18 offset:37376
  v_mfma_f32_16x16x32_bf16 v[44:47], v[60:63], v[68:71], v[44:47]
  v_mfma_f32_32x32x16_bf16 v[144:159], v[72:75], a[116:119], v[144:159]
  ds_read_b64_tr_b16 v[68:69], v20 offset:36864
  ds_read_b64_tr_b16 v[70:71], v20 offset:37376
  s_waitcnt lgkmcnt(5)
  v_mfma_f32_32x32x16_bf16 v[160:175], v[76:79], a[116:119], v[160:175]
  ds_read_b64_tr_b16 v[72:73], v22 offset:36864
  ds_read_b64_tr_b16 v[74:75], v22 offset:37376
  v_mfma_f32_32x32x16_bf16 v[176:191], v[80:83], a[116:119], v[176:191]
  ds_read_b64_tr_b16 v[76:77], v24 offset:36864
  ds_read_b64_tr_b16 v[78:79], v24 offset:37376
  s_waitcnt lgkmcnt(4)
  v_mfma_f32_32x32x16_bf16 v[128:143], v[64:67], a[120:123], v[128:143]
  ds_read_b128 a[124:127], v13 offset:12288
  ds_read_b64_tr_b16 v[80:81], v19 offset:36864
  ds_read_b64_tr_b16 v[82:83], v19 offset:37376
  v_mfma_f32_16x16x32_bf16 v[44:47], v[60:63], v[64:67], v[44:47]
  v_mfma_f32_32x32x16_bf16 v[144:159], v[68:71], a[120:123], v[144:159]
  ds_read_b64_tr_b16 v[64:65], v21 offset:36864
  ds_read_b64_tr_b16 v[66:67], v21 offset:37376
  s_waitcnt lgkmcnt(5)
  v_mfma_f32_32x32x16_bf16 v[160:175], v[72:75], a[120:123], v[160:175]
  ds_read_b64_tr_b16 v[68:69], v23 offset:36864
  ds_read_b64_tr_b16 v[70:71], v23 offset:37376
L_pgf1:
  s_cbranch_execz L_pgf5
  v_mfma_f32_32x32x16_bf16 v[176:191], v[76:79], a[120:123], v[176:191]
  ds_read_b64_tr_b16 v[72:73], v25 offset:36864
  ds_read_b64_tr_b16 v[74:75], v25 offset:37376
  s_waitcnt lgkmcnt(4)
  v_mfma_f32_32x32x16_bf16 v[128:143], v[80:83], a[124:127], v[128:143]
  s_waitcnt vmcnt(13)
  s_barrier
  ds_read_b128 a[128:131], v10 offset:0
  ds_read_b64_tr_b16 v[76:77], v18 offset:49152
  ds_read_b64_tr_b16 v[78:79], v18 offset:49664
  v_mfma_f32_16x16x32_bf16 v[44:47], v[60:63], v[80:83], v[44:47]
  v_mfma_f32_32x32x16_bf16 v[144:159], v[64:67], a[124:127], v[144:159]
  ds_read_b64_tr_b16 v[80:81], v20 offset:49152
  ds_read_b64_tr_b16 v[82:83], v20 offset:49664
  s_waitcnt lgkmcnt(5)
  v_mfma_f32_32x32x16_bf16 v[160:175], v[68:71], a[124:127], v[160:175]
  s_add_u32 m0, s90, 32768
  ds_read_b64_tr_b16 v[64:65], v22 offset:49152
  ds_read_b64_tr_b16 v[66:67], v22 offset:49664
  v_mfma_f32_32x32x16_bf16 v[176:191], v[72:75], a[124:127], v[176:191]
  buffer_load_dwordx4 v26, s[44:47], s88 offen offset:0 lds
  ds_read_b64_tr_b16 v[68:69], v24 offset:49152
  ds_read_b64_tr_b16 v[70:71], v24 offset:49664
  s_waitcnt lgkmcnt(4)
  v_mfma_f32_32x32x16_bf16 v[128:143], v[76:79], a[128:131], v[128:143]
  buffer_load_dwordx4 v27, s[44:47], s88 offen offset:1024 lds
  ds_read_b128 a[132:135], v11 offset:0
  ds_read_b64_tr_b16 v[72:73], v19 offset:49152
  ds_read_b64_tr_b16 v[74:75], v19 offset:49664
  v_mfma_f32_16x16x32_bf16 v[44:47], v[60:63], v[76:79], v[44:47]
  v_mfma_f32_32x32x16_bf16 v[144:159], v[80:83], a[128:131], v[144:159]
  buffer_load_dwordx4 v28, s[44:47], s88 offen offset:2048 lds
  ds_read_b64_tr_b16 v[76:77], v21 offset:49152
  ds_read_b64_tr_b16 v[78:79], v21 offset:49664
  s_waitcnt lgkmcnt(5)
  v_mfma_f32_32x32x16_bf16 v[160:175], v[64:67], a[128:131], v[160:175]
  buffer_load_dwordx4 v29, s[44:47], s88 offen offset:3072 lds
  ds_read_b64_tr_b16 v[80:81], v23 offset:49152
  ds_read_b64_tr_b16 v[82:83], v23 offset:49664
  v_mfma_f32_32x32x16_bf16 v[176:191], v[68:71], a[128:131], v[176:191]
  s_add_u32 s88, s88, 442368
  ds_read_b64_tr_b16 v[64:65], v25 offset:49152
  ds_read_b64_tr_b16 v[66:67], v25 offset:49664
  s_waitcnt lgkmcnt(4)
  v_mfma_f32_32x32x16_bf16 v[128:143], v[72:75], a[132:135], v[128:143]
  ds_read_b128 a[136:139], v12 offset:0
  ds_read_b64_tr_b16 v[68:69], v18 offset:53248
  ds_read_b64_tr_b16 v[70:71], v18 offset:53760
  v_mfma_f32_16x16x32_bf16 v[44:47], v[60:63], v[72:75], v[44:47]
  v_mfma_f32_32x32x16_bf16 v[144:159], v[76:79], a[132:135], v[144:159]
  ds_read_b64_tr_b16 v[72:73], v20 offset:53248
  ds_read_b64_tr_b16 v[74:75], v20 offset:53760
  s_waitcnt lgkmcnt(5)
  v_mfma_f32_32x32x16_bf16 v[160:175], v[80:83], a[132:135], v[160:175]
  ds_read_b64_tr_b16 v[76:77], v22 offset:53248
  ds_read_b64_tr_b16 v[78:79], v22 offset:53760
  v_mfma_f32_32x32x16_bf16 v[176:191], v[64:67], a[132:135], v[176:191]
  ds_read_b64_tr_b16 v[80:81], v24 offset:53248
  ds_read_b64_tr_b16 v[82:83], v24 offset:53760
  s_waitcnt lgkmcnt(4)
  v_mfma_f32_32x32x16_bf16 v[128:143], v[68:71], a[136:139], v[128:143]
  ds_read_b128 a[140:143], v13 offset:0
  ds_read_b64_tr_b16 v[64:65], v19 offset:53248
  ds_read_b64_tr_b16 v[66:67], v19 offset:53760
  v_mfma_f32_16x16x32_bf16 v[44:47], v[60:63], v[68:71], v[44:47]
  v_mfma_f32_32x32x16_bf16 v[144:159], v[72:75], a[136:139], v[144:159]
  ds_read_b64_tr_b16 v[68:69], v21 offset:53248
  ds_read_b64_tr_b16 v[70:71], v21 offset:53760
  s_waitcnt lgkmcnt(5)
  v_mfma_f32_32x32x16_bf16 v[160:175], v[76:79], a[136:139], v[160:175]
  ds_read_b64_tr_b16 v[72:73], v23 offset:53248
  ds_read_b64_tr_b16 v[74:75], v23 offset:53760
  v_mfma_f32_32x32x16_bf16 v[176:191], v[80:83], a[136:139], v[176:191]
  ds_read_b64_tr_b16 v[76:77], v25 offset:53248
  ds_read_b64_tr_b16 v[78:79], v25 offset:53760
  s_waitcnt lgkmcnt(4)
  v_mfma_f32_32x32x16_bf16 v[128:143], v[64:67], a[140:143], v[128:143]
  s_waitcnt vmcnt(8)
  s_barrier
  ds_read_b128 a[144:147], v10 offset:4096
  ds_read_b64_tr_b16 v[80:81], v18 offset:0
  ds_read_b64_tr_b16 v[82:83], v18 offset:512
  v_mfma_f32_16x16x32_bf16 v[44:47], v[60:63], v[64:67], v[44:47]
  v_mfma_f32_32x32x16_bf16 v[144:159], v[68:71], a[140:143], v[144:159]
  ds_read_b64_tr_b16 v[64:65], v20 offset:0
  ds_read_b64_tr_b16 v[66:67], v20 offset:512
  s_waitcnt lgkmcnt(5)
  v_mfma_f32_32x32x16_bf16 v[160:175], v[72:75], a[140:143], v[160:175]
  s_add_u32 m0, s90, 49152
  ds_read_b64_tr_b16 v[68:69], v22 offset:0
  ds_read_b64_tr_b16 v[70:71], v22 offset:512
  v_mfma_f32_32x32x16_bf16 v[176:191], v[76:79], a[140:143], v[176:191]
  buffer_load_dwordx4 v26, s[44:47], s88 offen offset:0 lds
  ds_read_b64_tr_b16 v[72:73], v24 offset:0
  ds_read_b64_tr_b16 v[74:75], v24 offset:512
  s_waitcnt lgkmcnt(4)
  v_mfma_f32_32x32x16_bf16 v[128:143], v[80:83], a[144:147], v[128:143]
  buffer_load_dwordx4 v27, s[44:47], s88 offen offset:1024 lds
  ds_read_b128 a[148:151], v11 offset:4096
  ds_read_b64_tr_b16 v[76:77], v19 offset:0
  ds_read_b64_tr_b16 v[78:79], v19 offset:512
  v_mfma_f32_16x16x32_bf16 v[44:47], v[60:63], v[80:83], v[44:47]
  v_mfma_f32_32x32x16_bf16 v[144:159], v[64:67], a[144:147], v[144:159]
  buffer_load_dwordx4 v28, s[44:47], s88 offen offset:2048 lds
  ds_read_b64_tr_b16 v[80:81], v21 offset:0
  ds_read_b64_tr_b16 v[82:83], v21 offset:512
  s_waitcnt lgkmcnt(5)
  v_mfma_f32_32x32x16_bf16 v[160:175], v[68:71], a[144:147], v[160:175]
  buffer_load_dwordx4 v29, s[44:47], s88 offen offset:3072 lds
  ds_read_b64_tr_b16 v[64:65], v23 offset:0
  ds_read_b64_tr_b16 v[66:67], v23 offset:512
  v_cmp_ne_u32 vcc, s61, v107
  s_nop 1
  s_cmp_lg_u64 vcc, 0
  s_cbranch_scc1 L_slow4
L_back4:
  v_mfma_f32_32x32x16_bf16 v[176:191], v[72:75], a[144:147], v[176:191]
  s_add_u32 s88, s88, 442368
  ds_read_b64_tr_b16 v[68:69], v25 offset:0
  ds_read_b64_tr_b16 v[70:71], v25 offset:512
  v_cmp_gt_u32 s[18:19], 32, v1
  v_cvt_pk_bf16_f32 v107, -v104, -v104
  s_waitcnt lgkmcnt(4)
  v_mfma_f32_32x32x16_bf16 v[128:143], v[76:79], a[148:151], v[128:143]
  ds_read_b128 a[152:155], v12 offset:4096
  ds_read_b64_tr_b16 v[72:73], v18 offset:4096
  ds_read_b64_tr_b16 v[74:75], v18 offset:4608
  v_cndmask_b32 v107, 0, v107, s[18:19]
  v_mul_f32 v86, 0xc0135761, v105
  v_mfma_f32_16x16x32_bf16 v[44:47], v[60:63], v[76:79], v[44:47]
  v_mul_f32 v87, v105, v105
  v_mul_f32 v87, v87, v105
  v_mfma_f32_32x32x16_bf16 v[144:159], v[80:83], a[148:151], v[144:159]
  ds_read_b64_tr_b16 v[76:77], v20 offset:4096
  ds_read_b64_tr_b16 v[78:79], v20 offset:4608
  v_mul_f32 v87, 0xbdd2d3e8, v87
  v_mul_f32 v88, v106, v106
  v_mov_b32 v36, v107
  s_waitcnt lgkmcnt(5)
  v_mfma_f32_32x32x16_bf16 v[160:175], v[64:67], a[148:151], v[160:175]
  ds_read_b64_tr_b16 v[80:81], v22 offset:4096
  ds_read_b64_tr_b16 v[82:83], v22 offset:4608
  v_mov_b32 v92, v36
  v_mov_b32 v93, 0
  v_mov_b32 v94, 0
  v_mfma_f32_32x32x16_bf16 v[176:191], v[68:71], a[148:151], v[176:191]
  ds_read_b64_tr_b16 v[64:65], v24 offset:4096
  ds_read_b64_tr_b16 v[66:67], v24 offset:4608
  v_mov_b32 v95, 0
  v_mov_b32 v96, 0
  v_mov_b32 v97, v36
  s_waitcnt lgkmcnt(4)
  v_mfma_f32_32x32x16_bf16 v[128:143], v[72:75], a[152:155], v[128:143]
  ds_read_b128 a[156:159], v13 offset:4096
  ds_read_b64_tr_b16 v[68:69], v19 offset:4096
  ds_read_b64_tr_b16 v[70:71], v19 offset:4608
  v_mov_b32 v98, 0
  v_mov_b32 v99, 0
  v_mfma_f32_16x16x32_bf16 v[44:47], v[60:63], v[72:75], v[44:47]
  v_mfma_f32_32x32x16_bf16 v[144:159], v[76:79], a[152:155], v[144:159]
  ds_read_b64_tr_b16 v[72:73], v21 offset:4096
  ds_read_b64_tr_b16 v[74:75], v21 offset:4608
  s_waitcnt lgkmcnt(5)
  v_mfma_f32_32x32x16_bf16 v[160:175], v[80:83], a[152:155], v[160:175]
  ds_read_b64_tr_b16 v[76:77], v23 offset:4096
  ds_read_b64_tr_b16 v[78:79], v23 offset:4608
  v_mfma_f32_32x32x16_bf16 v[176:191], v[64:67], a[152:155], v[176:191]
  ds_read_b64_tr_b16 v[80:81], v25 offset:4096
  ds_read_b64_tr_b16 v[82:83], v25 offset:4608
  s_waitcnt lgkmcnt(4)
  v_mfma_f32_32x32x16_bf16 v[128:143], v[68:71], a[156:159], v[128:143]
  s_waitcnt vmcnt(8)
  s_barrier
  ds_read_b64_tr_b16 v[64:65], v30 offset:16384
  ds_read_b64_tr_b16 v[66:67], v30 offset:16640
  v_mfma_f32_16x16x32_bf16 v[44:47], v[60:63], v[68:71], v[44:47]
  v_mfma_f32_32x32x16_bf16 v[144:159], v[72:75], a[156:159], v[144:159]
  ds_read_b64_tr_b16 v[68:69], v32 offset:16384
  ds_read_b64_tr_b16 v[70:71], v32 offset:16640
  s_waitcnt lgkmcnt(4)
  v_mfma_f32_32x32x16_bf16 v[160:175], v[76:79], a[156:159], v[160:175]
  s_add_u32 m0, s90, 0
  ds_read_b64_tr_b16 v[72:73], v31 offset:16384
  ds_read_b64_tr_b16 v[74:75], v31 offset:16640
  v_mfma_f32_32x32x16_bf16 v[176:191], v[80:83], a[156:159], v[176:191]
  buffer_load_dwordx4 v26, s[44:47], s88 offen offset:0 lds
  ds_read_b64_tr_b16 v[76:77], v33 offset:16384
  ds_read_b64_tr_b16 v[78:79], v33 offset:16640
  s_waitcnt lgkmcnt(4)
  v_mfma_f32_32x32x16_bf16 v[192:207], v[64:67], a[0:3], 0
  buffer_load_dwordx4 v27, s[44:47], s88 offen offset:1024 lds
  ds_read_b64_tr_b16 v[80:81], v30 offset:18432
  ds_read_b64_tr_b16 v[82:83], v30 offset:18688
  v_mfma_f32_16x16x32_bf16 v[48:51], v[60:63], v[64:67], 0
  s_lshl_b32 s85, s82, 8
  s_add_u32 s85, s85, 148480
  v_mfma_f32_32x32x16_bf16 v[208:223], v[68:71], a[0:3], 0
  buffer_load_dwordx4 v28, s[44:47], s88 offen offset:2048 lds
  ds_read_b64_tr_b16 v[64:65], v32 offset:18432
  ds_read_b64_tr_b16 v[66:67], v32 offset:18688
  s_waitcnt lgkmcnt(4)
  v_mfma_f32_32x32x16_bf16 v[192:207], v[72:75], a[4:7], v[192:207]
  buffer_load_dwordx4 v29, s[44:47], s88 offen offset:3072 lds
  ds_read_b64_tr_b16 v[68:69], v31 offset:18432
  ds_read_b64_tr_b16 v[70:71], v31 offset:18688
  v_mfma_f32_32x32x16_bf16 v[208:223], v[76:79], a[4:7], v[208:223]
  s_add_u32 s88, s88, 442368
  ds_read_b64_tr_b16 v[72:73], v33 offset:18432
  ds_read_b64_tr_b16 v[74:75], v33 offset:18688
  v_lshl_add_u32 v4, v1, 2, s85
  s_waitcnt lgkmcnt(4)
  v_mfma_f32_32x32x16_bf16 v[192:207], v[80:83], a[8:11], v[192:207]
  ds_read_b64_tr_b16 v[76:77], v30 offset:20480
  ds_read_b64_tr_b16 v[78:79], v30 offset:20736
  ds_read_b64_tr_b16 a[160:161], v53 offset:16384
  v_cvt_pk_bf16_f32 v3, v44, v44
  v_and_b32 v3, 0xffff0000, v3
  v_mfma_f32_16x16x32_bf16 v[48:51], v[60:63], v[80:83], v[48:51]
  ds_read_b64_tr_b16 a[162:163], v53 offset:16896
  v_sub_f32 v5, v44, v3
  v_mfma_f32_32x32x16_bf16 v[208:223], v[64:67], a[8:11], v[208:223]
  ds_read_b64_tr_b16 v[80:81], v32 offset:20480
  ds_read_b64_tr_b16 v[82:83], v32 offset:20736
  ds_read_b64_tr_b16 a[164:165], v53 offset:16416
  v_cvt_pk_bf16_f32 v5, v3, v5
  ds_write2st64_b32 v4, v5, v5 offset0:0 offset1:4
  s_waitcnt lgkmcnt(8)
  v_mfma_f32_32x32x16_bf16 v[192:207], v[68:71], a[12:15], v[192:207]
  ds_read_b64_tr_b16 v[64:65], v31 offset:20480
  ds_read_b64_tr_b16 v[66:67], v31 offset:20736
  ds_read_b64_tr_b16 a[166:167], v53 offset:16928
  v_mfma_f32_32x32x16_bf16 v[208:223], v[72:75], a[12:15], v[208:223]
  ds_read_b64_tr_b16 v[68:69], v33 offset:20480
  ds_read_b64_tr_b16 v[70:71], v33 offset:20736
  ds_read_b64_tr_b16 a[168:169], v53 offset:16448
  s_waitcnt lgkmcnt(8)
  v_mfma_f32_32x32x16_bf16 v[192:207], v[76:79], a[16:19], v[192:207]
  ds_read_b64_tr_b16 v[72:73], v30 offset:22528
  ds_read_b64_tr_b16 v[74:75], v30 offset:22784
  ds_read_b64_tr_b16 a[170:171], v53 offset:16960
  v_mfma_f32_16x16x32_bf16 v[48:51], v[60:63], v[76:79], v[48:51]
  ds_read_b64_tr_b16 a[172:173], v53 offset:16480
  v_mfma_f32_32x32x16_bf16 v[208:223], v[80:83], a[16:19], v[208:223]
  ds_read_b64_tr_b16 v[76:77], v32 offset:22528
  ds_read_b64_tr_b16 v[78:79], v32 offset:22784
  s_waitcnt lgkmcnt(11)
  ds_read_b64_tr_b16 a[174:175], v53 offset:16992
  s_waitcnt lgkmcnt(8)
  v_mfma_f32_32x32x16_bf16 v[192:207], v[64:67], a[20:23], v[192:207]
  ds_read_b64_tr_b16 v[80:81], v31 offset:22528
  ds_read_b64_tr_b16 v[82:83], v31 offset:22784
  v_mfma_f32_32x32x16_bf16 v[208:223], v[68:71], a[20:23], v[208:223]
  ds_read_b64_tr_b16 v[64:65], v33 offset:22528
  ds_read_b64_tr_b16 v[66:67], v33 offset:22784
  s_waitcnt lgkmcnt(5)
  v_mfma_f32_32x32x16_bf16 v[192:207], v[72:75], a[24:27], v[192:207]
  s_waitcnt vmcnt(8)
  s_barrier
  ds_read_b64_tr_b16 v[68:69], v30 offset:32768
  ds_read_b64_tr_b16 v[70:71], v30 offset:33024
  buffer_store_dwordx4 a[160:163], v35, s[52:55], s7 offen offset:0 sc1
  v_mfma_f32_16x16x32_bf16 v[48:51], v[60:63], v[72:75], v[48:51]
  v_mfma_f32_32x32x16_bf16 v[208:223], v[76:79], a[24:27], v[208:223]
  ds_read2st64_b32 v[100:101], v4 offset0:0 offset1:1
  ds_read2st64_b32 v[102:103], v4 offset0:2 offset1:3
  ds_read_b64_tr_b16 v[72:73], v32 offset:32768
  ds_read_b64_tr_b16 v[74:75], v32 offset:33024
  buffer_store_dwordx4 a[164:167], v35, s[52:55], s7 offen offset:1024 sc1
  s_waitcnt lgkmcnt(6)
  v_mfma_f32_32x32x16_bf16 v[192:207], v[80:83], a[28:31], v[192:207]
  s_add_u32 m0, s90, 16384
  ds_read_b64_tr_b16 v[76:77], v31 offset:32768
  ds_read_b64_tr_b16 v[78:79], v31 offset:33024
  buffer_store_dwordx4 a[168:171], v35, s[52:55], s7 offen offset:2048 sc1
  v_mfma_f32_32x32x16_bf16 v[208:223], v[64:67], a[28:31], v[208:223]
  buffer_load_dwordx4 v26, s[44:47], s88 offen offset:0 lds
  ds_read_b64_tr_b16 v[80:81], v33 offset:32768
  ds_read_b64_tr_b16 v[82:83], v33 offset:33024
  buffer_store_dwordx4 a[172:175], v35, s[52:55], s7 offen offset:3072 sc1
  s_waitcnt lgkmcnt(4)
  v_mfma_f32_32x32x16_bf16 v[192:207], v[68:71], a[32:35], v[192:207]
  buffer_load_dwordx4 v27, s[44:47], s88 offen offset:1024 lds
  ds_read_b64_tr_b16 v[64:65], v30 offset:34816
  ds_read_b64_tr_b16 v[66:67], v30 offset:35072
  v_mfma_f32_16x16x32_bf16 v[48:51], v[60:63], v[68:71], v[48:51]
  v_mfma_f32_32x32x16_bf16 v[208:223], v[72:75], a[32:35], v[208:223]
  buffer_load_dwordx4 v28, s[44:47], s88 offen offset:2048 lds
  ds_read_b64_tr_b16 v[68:69], v32 offset:34816
  ds_read_b64_tr_b16 v[70:71], v32 offset:35072
  s_waitcnt lgkmcnt(4)
  v_mfma_f32_32x32x16_bf16 v[192:207], v[76:79], a[36:39], v[192:207]
  buffer_load_dwordx4 v29, s[44:47], s88 offen offset:3072 lds
  ds_read_b64_tr_b16 v[72:73], v31 offset:34816
  ds_read_b64_tr_b16 v[74:75], v31 offset:35072
  v_mfma_f32_32x32x16_bf16 v[208:223], v[80:83], a[36:39], v[208:223]
  s_add_u32 s88, s88, 442368
  ds_read_b64_tr_b16 v[76:77], v33 offset:34816
  ds_read_b64_tr_b16 v[78:79], v33 offset:35072
  v_mfma_f32_32x32x16_bf16 v[128:143], v[100:103], v[92:95], v[128:143]
  v_mov_b32 v92, 0
  v_mov_b32 v94, v36
  v_mfma_f32_32x32x16_bf16 v[144:159], v[100:103], v[96:99], v[144:159]
  v_mov_b32 v97, 0
  v_mov_b32 v99, v36
  v_mfma_f32_32x32x16_bf16 v[160:175], v[100:103], v[92:95], v[160:175]
  s_nop 0
  v_mfma_f32_32x32x16_bf16 v[176:191], v[100:103], v[96:99], v[176:191]
  s_waitcnt lgkmcnt(4)
  v_mfma_f32_32x32x16_bf16 v[192:207], v[64:67], a[40:43], v[192:207]
  ds_read_b64_tr_b16 v[80:81], v30 offset:36864
  ds_read_b64_tr_b16 v[82:83], v30 offset:37120
  v_mul_f32 v108, v128, v128
  v_mul_f32 v109, v129, v129
  v_fma_f32 v108, v108, v87, v86
  v_mfma_f32_16x16x32_bf16 v[48:51], v[60:63], v[64:67], v[48:51]
  v_fma_f32 v109, v109, v87, v86
  v_mul_f32 v108, v128, v108
  v_mul_f32 v109, v129, v109
  v_mfma_f32_32x32x16_bf16 v[208:223], v[68:71], a[40:43], v[208:223]
  ds_read_b64_tr_b16 v[64:65], v32 offset:36864
  ds_read_b64_tr_b16 v[66:67], v32 offset:37120
  v_exp_f32 v108, v108
  v_exp_f32 v109, v109
  v_mul_f32 v136, v128, v136
  s_waitcnt lgkmcnt(4)
  v_mfma_f32_32x32x16_bf16 v[192:207], v[72:75], a[44:47], v[192:207]
  ds_read_b64_tr_b16 v[68:69], v31 offset:36864
  ds_read_b64_tr_b16 v[70:71], v31 offset:37120
  v_mul_f32 v137, v129, v137
  v_fma_f32 v108, v108, v88, v88
  v_fma_f32 v109, v109, v88, v88
  v_mfma_f32_32x32x16_bf16 v[208:223], v[76:79], a[44:47], v[208:223]
  ds_read_b64_tr_b16 v[72:73], v33 offset:36864
  ds_read_b64_tr_b16 v[74:75], v33 offset:37120
  v_rcp_f32 v108, v108
  v_rcp_f32 v109, v109
  v_mul_f32 v136, v136, v108
  s_waitcnt lgkmcnt(4)
  v_mfma_f32_32x32x16_bf16 v[192:207], v[80:83], a[48:51], v[192:207]
  ds_read_b64_tr_b16 v[76:77], v30 offset:38912
  ds_read_b64_tr_b16 v[78:79], v30 offset:39168
  v_mul_f32 v137, v137, v109
  v_cvt_pk_bf16_f32 v6, v136, v137
  v_mul_f32 v110, v130, v130
  v_mfma_f32_16x16x32_bf16 v[48:51], v[60:63], v[80:83], v[48:51]
  v_mul_f32 v111, v131, v131
  v_fma_f32 v110, v110, v87, v86
  v_fma_f32 v111, v111, v87, v86
  v_mfma_f32_32x32x16_bf16 v[208:223], v[64:67], a[48:51], v[208:223]
  ds_read_b64_tr_b16 v[80:81], v32 offset:38912
  ds_read_b64_tr_b16 v[82:83], v32 offset:39168
  v_mul_f32 v110, v130, v110
  v_mul_f32 v111, v131, v111
  v_exp_f32 v110, v110
  s_waitcnt lgkmcnt(4)
  v_mfma_f32_32x32x16_bf16 v[192:207], v[68:71], a[52:55], v[192:207]
  ds_read_b64_tr_b16 v[64:65], v31 offset:38912
  ds_read_b64_tr_b16 v[66:67], v31 offset:39168
  buffer_load_dword a255, v52, s[44:47], s4 offen
  v_exp_f32 v111, v111
  v_mul_f32 v138, v130, v138
  v_mul_f32 v139, v131, v139
  v_mfma_f32_32x32x16_bf16 v[208:223], v[72:75], a[52:55], v[208:223]
  ds_read_b64_tr_b16 v[68:69], v33 offset:38912
  ds_read_b64_tr_b16 v[70:71], v33 offset:39168
  v_fma_f32 v110, v110, v88, v88
  v_fma_f32 v111, v111, v88, v88
  v_rcp_f32 v110, v110
  s_waitcnt lgkmcnt(4)
  v_mfma_f32_32x32x16_bf16 v[192:207], v[76:79], a[56:59], v[192:207]
  s_waitcnt vmcnt(13)
  s_barrier
  ds_read_b64_tr_b16 v[72:73], v30 offset:49152
  ds_read_b64_tr_b16 v[74:75], v30 offset:49408
  v_rcp_f32 v111, v111
  v_mul_f32 v138, v138, v110
  v_mul_f32 v139, v139, v111
  v_mfma_f32_16x16x32_bf16 v[48:51], v[60:63], v[76:79], v[48:51]
  v_cvt_pk_bf16_f32 v7, v138, v139
  v_mul_f32 v108, v132, v132
  v_mul_f32 v109, v133, v133
  v_mfma_f32_32x32x16_bf16 v[208:223], v[80:83], a[56:59], v[208:223]
  ds_read_b64_tr_b16 v[76:77], v32 offset:49152
  ds_read_b64_tr_b16 v[78:79], v32 offset:49408
  v_fma_f32 v108, v108, v87, v86
  v_fma_f32 v109, v109, v87, v86
  v_mul_f32 v108, v132, v108
  s_waitcnt lgkmcnt(4)
  v_mfma_f32_32x32x16_bf16 v[192:207], v[64:67], a[60:63], v[192:207]
  s_mov_b32 s88, s4
  ds_read_b64_tr_b16 v[80:81], v31 offset:49152
  ds_read_b64_tr_b16 v[82:83], v31 offset:49408
  v_mul_f32 v109, v133, v109
  v_exp_f32 v108, v108
  v_exp_f32 v109, v109
  v_mfma_f32_32x32x16_bf16 v[208:223], v[68:71], a[60:63], v[208:223]
  s_add_u32 m0, s90, 32768
  ds_read_b64_tr_b16 v[64:65], v33 offset:49152
  ds_read_b64_tr_b16 v[66:67], v33 offset:49408
  v_mul_f32 v140, v132, v140
  v_mul_f32 v141, v133, v141
  s_waitcnt lgkmcnt(4)
  v_mfma_f32_32x32x16_bf16 v[192:207], v[72:75], a[64:67], v[192:207]
  buffer_load_dwordx4 v14, s[44:47], s88 offen offset:0 lds
  ds_read_b64_tr_b16 v[68:69], v30 offset:51200
  ds_read_b64_tr_b16 v[70:71], v30 offset:51456
  v_fma_f32 v108, v108, v88, v88
  v_fma_f32 v109, v109, v88, v88
  v_mfma_f32_16x16x32_bf16 v[48:51], v[60:63], v[72:75], v[48:51]
  v_rcp_f32 v108, v108
  v_rcp_f32 v109, v109
  v_mfma_f32_32x32x16_bf16 v[208:223], v[76:79], a[64:67], v[208:223]
  buffer_load_dwordx4 v15, s[44:47], s88 offen offset:1024 lds
  ds_read_b64_tr_b16 v[72:73], v32 offset:51200
  ds_read_b64_tr_b16 v[74:75], v32 offset:51456
  v_mul_f32 v140, v140, v108
  v_mul_f32 v141, v141, v109
  s_waitcnt lgkmcnt(4)
  v_mfma_f32_32x32x16_bf16 v[192:207], v[80:83], a[68:71], v[192:207]
  buffer_load_dwordx4 v16, s[44:47], s88 offen offset:2048 lds
  ds_read_b64_tr_b16 v[76:77], v31 offset:51200
  ds_read_b64_tr_b16 v[78:79], v31 offset:51456
  v_cvt_pk_bf16_f32 v8, v140, v141
  v_mul_f32 v110, v134, v134
  v_mfma_f32_32x32x16_bf16 v[208:223], v[64:67], a[68:71], v[208:223]
  buffer_load_dwordx4 v17, s[44:47], s88 offen offset:3072 lds
  ds_read_b64_tr_b16 v[80:81], v33 offset:51200
  ds_read_b64_tr_b16 v[82:83], v33 offset:51456
  v_mul_f32 v111, v135, v135
  v_fma_f32 v110, v110, v87, v86
  s_waitcnt lgkmcnt(4)
  v_mfma_f32_32x32x16_bf16 v[192:207], v[68:71], a[72:75], v[192:207]
  s_add_u32 s88, s88, 221184
  ds_read_b64_tr_b16 v[64:65], v30 offset:53248
  ds_read_b64_tr_b16 v[66:67], v30 offset:53504
  v_fma_f32 v111, v111, v87, v86
  v_mul_f32 v110, v134, v110
  v_mfma_f32_16x16x32_bf16 v[48:51], v[60:63], v[68:71], v[48:51]
  v_mul_f32 v111, v135, v111
  v_exp_f32 v110, v110
  v_mfma_f32_32x32x16_bf16 v[208:223], v[72:75], a[72:75], v[208:223]
  ds_read_b64_tr_b16 v[68:69], v32 offset:53248
  ds_read_b64_tr_b16 v[70:71], v32 offset:53504
  v_exp_f32 v111, v111
  v_mul_f32 v142, v134, v142
  s_waitcnt lgkmcnt(4)
  v_mfma_f32_32x32x16_bf16 v[192:207], v[76:79], a[76:79], v[192:207]
  ds_read_b64_tr_b16 v[72:73], v31 offset:53248
  ds_read_b64_tr_b16 v[74:75], v31 offset:53504
  v_mul_f32 v143, v135, v143
  v_fma_f32 v110, v110, v88, v88
  v_fma_f32 v111, v111, v88, v88
  v_mfma_f32_32x32x16_bf16 v[208:223], v[80:83], a[76:79], v[208:223]
  ds_read_b64_tr_b16 v[76:77], v33 offset:53248
  ds_read_b64_tr_b16 v[78:79], v33 offset:53504
  v_rcp_f32 v110, v110
  v_rcp_f32 v111, v111
  s_waitcnt lgkmcnt(4)
  v_mfma_f32_32x32x16_bf16 v[192:207], v[64:67], a[80:83], v[192:207]
  ds_read_b64_tr_b16 v[80:81], v30 offset:55296
  ds_read_b64_tr_b16 v[82:83], v30 offset:55552
  s_waitcnt vmcnt(8)
  v_mov_b32 v2, s61
  buffer_store_dword v2, off, s[56:59], s16 sc1
  v_mul_f32 v142, v142, v110
  v_mul_f32 v143, v143, v111
  v_mfma_f32_16x16x32_bf16 v[48:51], v[60:63], v[64:67], v[48:51]
  v_cvt_pk_bf16_f32 v9, v142, v143
  v_mul_f32 v118, v144, v144
  v_mfma_f32_32x32x16_bf16 v[208:223], v[68:71], a[80:83], v[208:223]
  ds_read_b64_tr_b16 v[64:65], v32 offset:55296
  ds_read_b64_tr_b16 v[66:67], v32 offset:55552
  v_mul_f32 v119, v145, v145
  v_fma_f32 v118, v118, v87, v86
  v_fma_f32 v119, v119, v87, v86
  s_waitcnt lgkmcnt(4)
  v_mfma_f32_32x32x16_bf16 v[192:207], v[72:75], a[84:87], v[192:207]
  ds_read_b64_tr_b16 v[68:69], v31 offset:55296
  ds_read_b64_tr_b16 v[70:71], v31 offset:55552
  v_mul_f32 v118, v144, v118
  v_mul_f32 v119, v145, v119
  v_mfma_f32_32x32x16_bf16 v[208:223], v[76:79], a[84:87], v[208:223]
  ds_read_b64_tr_b16 v[72:73], v33 offset:55296
  ds_read_b64_tr_b16 v[74:75], v33 offset:55552
  v_exp_f32 v118, v118
  v_exp_f32 v119, v119
  s_waitcnt lgkmcnt(4)
  v_mfma_f32_32x32x16_bf16 v[192:207], v[80:83], a[88:91], v[192:207]
  s_barrier
  ds_read_b64_tr_b16 v[76:77], v30 offset:0
  ds_read_b64_tr_b16 v[78:79], v30 offset:256
  v_mul_f32 v152, v144, v152
  v_mul_f32 v153, v145, v153
  v_mfma_f32_16x16x32_bf16 v[48:51], v[60:63], v[80:83], v[48:51]
  v_fma_f32 v118, v118, v88, v88
  v_fma_f32 v119, v119, v88, v88
  v_mfma_f32_32x32x16_bf16 v[208:223], v[64:67], a[88:91], v[208:223]
  ds_read_b64_tr_b16 v[80:81], v32 offset:0
  ds_read_b64_tr_b16 v[82:83], v32 offset:256
  v_rcp_f32 v118, v118
  v_rcp_f32 v119, v119
  s_waitcnt lgkmcnt(4)
  v_mfma_f32_32x32x16_bf16 v[192:207], v[68:71], a[92:95], v[192:207]
  s_add_u32 m0, s90, 49152
  ds_read_b64_tr_b16 v[64:65], v31 offset:0
  ds_read_b64_tr_b16 v[66:67], v31 offset:256
  v_mul_f32 v152, v152, v118
  v_mul_f32 v153, v153, v119
  v_mfma_f32_32x32x16_bf16 v[208:223], v[72:75], a[92:95], v[208:223]
  buffer_load_dwordx4 v14, s[44:47], s88 offen offset:0 lds
  ds_read_b64_tr_b16 v[68:69], v33 offset:0
  ds_read_b64_tr_b16 v[70:71], v33 offset:256
  v_cvt_pk_bf16_f32 v10, v152, v153
  v_mul_f32 v120, v146, v146
  s_waitcnt lgkmcnt(4)
  v_mfma_f32_32x32x16_bf16 v[192:207], v[76:79], a[96:99], v[192:207]
  buffer_load_dwordx4 v15, s[44:47], s88 offen offset:1024 lds
  ds_read_b64_tr_b16 v[72:73], v30 offset:2048
  ds_read_b64_tr_b16 v[74:75], v30 offset:2304
  v_mul_f32 v121, v147, v147
  v_fma_f32 v120, v120, v87, v86
  v_mfma_f32_16x16x32_bf16 v[48:51], v[60:63], v[76:79], v[48:51]
  v_fma_f32 v121, v121, v87, v86
  v_mul_f32 v120, v146, v120
  v_mfma_f32_32x32x16_bf16 v[208:223], v[80:83], a[96:99], v[208:223]
  buffer_load_dwordx4 v16, s[44:47], s88 offen offset:2048 lds
  ds_read_b64_tr_b16 v[76:77], v32 offset:2048
  ds_read_b64_tr_b16 v[78:79], v32 offset:2304
  v_mul_f32 v121, v147, v121
  v_exp_f32 v120, v120
  s_waitcnt lgkmcnt(4)
  v_mfma_f32_32x32x16_bf16 v[192:207], v[64:67], a[100:103], v[192:207]
  buffer_load_dwordx4 v17, s[44:47], s88 offen offset:3072 lds
  ds_read_b64_tr_b16 v[80:81], v31 offset:2048
  ds_read_b64_tr_b16 v[82:83], v31 offset:2304
  v_exp_f32 v121, v121
  v_mul_f32 v154, v146, v154
  v_mfma_f32_32x32x16_bf16 v[208:223], v[68:71], a[100:103], v[208:223]
  s_add_u32 s88, s88, 221184
  ds_read_b64_tr_b16 v[64:65], v33 offset:2048
  ds_read_b64_tr_b16 v[66:67], v33 offset:2304
  v_mul_f32 v155, v147, v155
  v_fma_f32 v120, v120, v88, v88
  s_waitcnt lgkmcnt(4)
  v_mfma_f32_32x32x16_bf16 v[192:207], v[72:75], a[104:107], v[192:207]
  ds_read_b64_tr_b16 v[68:69], v30 offset:4096
  ds_read_b64_tr_b16 v[70:71], v30 offset:4352
  v_fma_f32 v121, v121, v88, v88
  v_rcp_f32 v120, v120
  v_mfma_f32_16x16x32_bf16 v[48:51], v[60:63], v[72:75], v[48:51]
  v_rcp_f32 v121, v121
  v_mul_f32 v154, v154, v120
  v_mfma_f32_32x32x16_bf16 v[208:223], v[76:79], a[104:107], v[208:223]
  ds_read_b64_tr_b16 v[72:73], v32 offset:4096
  ds_read_b64_tr_b16 v[74:75], v32 offset:4352
  v_mul_f32 v155, v155, v121
  v_cvt_pk_bf16_f32 v11, v154, v155
  v_mul_f32 v118, v148, v148
  s_waitcnt lgkmcnt(4)
  v_mfma_f32_32x32x16_bf16 v[192:207], v[80:83], a[108:111], v[192:207]
  ds_read_b64_tr_b16 v[76:77], v31 offset:4096
  ds_read_b64_tr_b16 v[78:79], v31 offset:4352
  v_mul_f32 v119, v149, v149
  v_fma_f32 v118, v118, v87, v86
  v_fma_f32 v119, v119, v87, v86
  v_mfma_f32_32x32x16_bf16 v[208:223], v[64:67], a[108:111], v[208:223]
  ds_read_b64_tr_b16 v[80:81], v33 offset:4096
  ds_read_b64_tr_b16 v[82:83], v33 offset:4352
  v_mul_f32 v118, v148, v118
  v_mul_f32 v119, v149, v119
  s_waitcnt lgkmcnt(4)
  v_mfma_f32_32x32x16_bf16 v[192:207], v[68:71], a[112:115], v[192:207]
  ds_read_b64_tr_b16 v[64:65], v30 offset:6144
  ds_read_b64_tr_b16 v[66:67], v30 offset:6400
  v_exp_f32 v118, v118
  v_exp_f32 v119, v119
  v_mfma_f32_16x16x32_bf16 v[48:51], v[60:63], v[68:71], v[48:51]
  v_mul_f32 v156, v148, v156
  v_mul_f32 v157, v149, v157
  v_mfma_f32_32x32x16_bf16 v[208:223], v[72:75], a[112:115], v[208:223]
  ds_read_b64_tr_b16 v[68:69], v32 offset:6144
  ds_read_b64_tr_b16 v[70:71], v32 offset:6400
  v_fma_f32 v118, v118, v88, v88
  v_fma_f32 v119, v119, v88, v88
  s_waitcnt lgkmcnt(4)
  v_mfma_f32_32x32x16_bf16 v[192:207], v[76:79], a[116:119], v[192:207]
  ds_read_b64_tr_b16 v[72:73], v31 offset:6144
  ds_read_b64_tr_b16 v[74:75], v31 offset:6400
  v_rcp_f32 v118, v118
  v_rcp_f32 v119, v119
  v_mfma_f32_32x32x16_bf16 v[208:223], v[80:83], a[116:119], v[208:223]
  ds_read_b64_tr_b16 v[76:77], v33 offset:6144
  ds_read_b64_tr_b16 v[78:79], v33 offset:6400
  v_mul_f32 v156, v156, v118
  v_mul_f32 v157, v157, v119
  v_cvt_pk_bf16_f32 v12, v156, v157
  s_waitcnt lgkmcnt(4)
  v_mfma_f32_32x32x16_bf16 v[192:207], v[64:67], a[120:123], v[192:207]
L_pgf2:
  s_cbranch_execz L_pgf6
  s_waitcnt vmcnt(10)
  s_barrier
  ds_read_b64_tr_b16 v[80:81], v30 offset:16384
  ds_read_b64_tr_b16 v[82:83], v30 offset:16640
  v_mul_f32 v120, v150, v150
  v_mul_f32 v121, v151, v151
  v_mfma_f32_16x16x32_bf16 v[48:51], v[60:63], v[64:67], v[48:51]
  v_fma_f32 v120, v120, v87, v86
  v_fma_f32 v121, v121, v87, v86
  v_mfma_f32_32x32x16_bf16 v[208:223], v[68:71], a[120:123], v[208:223]
  ds_read_b64_tr_b16 v[64:65], v32 offset:16384
  ds_read_b64_tr_b16 v[66:67], v32 offset:16640
  v_mul_f32 v120, v150, v120
  v_mul_f32 v121, v151, v121
  s_waitcnt lgkmcnt(4)
  v_mfma_f32_32x32x16_bf16 v[192:207], v[72:75], a[124:127], v[192:207]
  s_add_u32 m0, s90, 0
  ds_read_b64_tr_b16 v[68:69], v31 offset:16384
  ds_read_b64_tr_b16 v[70:71], v31 offset:16640
  v_exp_f32 v120, v120
  v_exp_f32 v121, v121
  v_mfma_f32_32x32x16_bf16 v[208:223], v[76:79], a[124:127], v[208:223]
  buffer_load_dwordx4 v14, s[44:47], s88 offen offset:0 lds
  ds_read_b64_tr_b16 v[72:73], v33 offset:16384
  ds_read_b64_tr_b16 v[74:75], v33 offset:16640
  v_mul_f32 v158, v150, v158
  v_mul_f32 v159, v151, v159
  s_waitcnt lgkmcnt(4)
  v_mfma_f32_32x32x16_bf16 v[192:207], v[80:83], a[128:131], v[192:207]
  buffer_load_dwordx4 v15, s[44:47], s88 offen offset:1024 lds
  ds_read_b64_tr_b16 v[76:77], v30 offset:18432
  ds_read_b64_tr_b16 v[78:79], v30 offset:18688
  v_fma_f32 v120, v120, v88, v88
  v_fma_f32 v121, v121, v88, v88
  v_mfma_f32_16x16x32_bf16 v[48:51], v[60:63], v[80:83], v[48:51]
  v_rcp_f32 v120, v120
  v_mfma_f32_32x32x16_bf16 v[208:223], v[64:67], a[128:131], v[208:223]
  buffer_load_dwordx4 v16, s[44:47], s88 offen offset:2048 lds
  ds_read_b64_tr_b16 v[80:81], v32 offset:18432
  ds_read_b64_tr_b16 v[82:83], v32 offset:18688
  v_rcp_f32 v121, v121
  s_waitcnt lgkmcnt(4)
  v_mfma_f32_32x32x16_bf16 v[192:207], v[68:71], a[132:135], v[192:207]
  buffer_load_dwordx4 v17, s[44:47], s88 offen offset:3072 lds
  ds_read_b64_tr_b16 v[64:65], v31 offset:18432
  ds_read_b64_tr_b16 v[66:67], v31 offset:18688
  v_mul_f32 v158, v158, v120
  v_mfma_f32_32x32x16_bf16 v[208:223], v[72:75], a[132:135], v[208:223]
  s_add_u32 s88, s88, 221184
  ds_read_b64_tr_b16 v[68:69], v33 offset:18432
  ds_read_b64_tr_b16 v[70:71], v33 offset:18688
  v_mul_f32 v159, v159, v121
  v_cvt_pk_bf16_f32 v13, v158, v159
  v_mul_f32 v108, v160, v160
  v_mul_f32 v109, v161, v161
  v_fma_f32 v108, v108, v87, v86
  s_waitcnt lgkmcnt(4)
  v_mfma_f32_32x32x16_bf16 v[192:207], v[76:79], a[136:139], v[192:207]
  ds_read_b64_tr_b16 v[72:73], v30 offset:20480
  ds_read_b64_tr_b16 v[74:75], v30 offset:20736
  v_fma_f32 v109, v109, v87, v86
  v_mul_f32 v108, v160, v108
  v_mul_f32 v109, v161, v109
  v_mfma_f32_16x16x32_bf16 v[48:51], v[60:63], v[76:79], v[48:51]
  v_exp_f32 v108, v108
  v_exp_f32 v109, v109
  v_mul_f32 v168, v160, v168
  v_mfma_f32_32x32x16_bf16 v[208:223], v[80:83], a[136:139], v[208:223]
  ds_read_b64_tr_b16 v[76:77], v32 offset:20480
  ds_read_b64_tr_b16 v[78:79], v32 offset:20736
  v_mul_f32 v169, v161, v169
  v_fma_f32 v108, v108, v88, v88
  v_fma_f32 v109, v109, v88, v88
  s_waitcnt lgkmcnt(4)
  v_mfma_f32_32x32x16_bf16 v[192:207], v[64:67], a[140:143], v[192:207]
  ds_read_b64_tr_b16 v[80:81], v31 offset:20480
  ds_read_b64_tr_b16 v[82:83], v31 offset:20736
  v_rcp_f32 v108, v108
  v_rcp_f32 v109, v109
  v_mul_f32 v168, v168, v108
  v_mfma_f32_32x32x16_bf16 v[208:223], v[68:71], a[140:143], v[208:223]
  ds_read_b64_tr_b16 v[64:65], v33 offset:20480
  ds_read_b64_tr_b16 v[66:67], v33 offset:20736
  v_mul_f32 v169, v169, v109
  v_cvt_pk_bf16_f32 v160, v168, v169
  v_mul_f32 v110, v162, v162
  s_waitcnt lgkmcnt(4)
  v_mfma_f32_32x32x16_bf16 v[192:207], v[72:75], a[144:147], v[192:207]
  ds_read_b64_tr_b16 v[68:69], v30 offset:22528
  ds_read_b64_tr_b16 v[70:71], v30 offset:22784
  v_mul_f32 v111, v163, v163
  v_fma_f32 v110, v110, v87, v86
  v_fma_f32 v111, v111, v87, v86
  v_mfma_f32_16x16x32_bf16 v[48:51], v[60:63], v[72:75], v[48:51]
  v_mul_f32 v110, v162, v110
  v_mul_f32 v111, v163, v111
  v_exp_f32 v110, v110
  v_mfma_f32_32x32x16_bf16 v[208:223], v[76:79], a[144:147], v[208:223]
  ds_read_b64_tr_b16 v[72:73], v32 offset:22528
  ds_read_b64_tr_b16 v[74:75], v32 offset:22784
  v_exp_f32 v111, v111
  v_mul_f32 v170, v162, v170
  v_mul_f32 v171, v163, v171
  s_waitcnt lgkmcnt(4)
  v_mfma_f32_32x32x16_bf16 v[192:207], v[80:83], a[148:151], v[192:207]
  ds_read_b64_tr_b16 v[76:77], v31 offset:22528
  ds_read_b64_tr_b16 v[78:79], v31 offset:22784
  v_fma_f32 v110, v110, v88, v88
  v_fma_f32 v111, v111, v88, v88
  v_rcp_f32 v110, v110
  v_mfma_f32_32x32x16_bf16 v[208:223], v[64:67], a[148:151], v[208:223]
  ds_read_b64_tr_b16 v[80:81], v33 offset:22528
  ds_read_b64_tr_b16 v[82:83], v33 offset:22784
  v_rcp_f32 v111, v111
  v_mul_f32 v170, v170, v110
  v_mul_f32 v171, v171, v111
  s_waitcnt lgkmcnt(4)
  v_mfma_f32_32x32x16_bf16 v[192:207], v[68:71], a[152:155], v[192:207]
  s_waitcnt vmcnt(9)
  s_barrier
  ds_read_b64_tr_b16 v[64:65], v18 offset:32768
  ds_read_b64_tr_b16 v[66:67], v18 offset:33280
  v_cvt_pk_bf16_f32 v161, v170, v171
  v_mul_f32 v108, v164, v164
  v_mul_f32 v109, v165, v165
  v_mfma_f32_16x16x32_bf16 v[48:51], v[60:63], v[68:71], v[48:51]
  v_fma_f32 v108, v108, v87, v86
  v_fma_f32 v109, v109, v87, v86
  v_mul_f32 v108, v164, v108
  v_mfma_f32_32x32x16_bf16 v[208:223], v[72:75], a[152:155], v[208:223]
  ds_read_b64_tr_b16 v[68:69], v20 offset:32768
  ds_read_b64_tr_b16 v[70:71], v20 offset:33280
  v_mul_f32 v109, v165, v109
  v_exp_f32 v108, v108
  v_exp_f32 v109, v109
  s_waitcnt lgkmcnt(4)
  v_mfma_f32_32x32x16_bf16 v[192:207], v[76:79], a[156:159], v[192:207]
  s_add_u32 m0, s90, 16384
  ds_read_b64_tr_b16 v[72:73], v22 offset:32768
  ds_read_b64_tr_b16 v[74:75], v22 offset:33280
  v_mul_f32 v172, v164, v172
  v_mul_f32 v173, v165, v173
  v_fma_f32 v108, v108, v88, v88
  v_mfma_f32_32x32x16_bf16 v[208:223], v[80:83], a[156:159], v[208:223]
  buffer_load_dwordx4 v14, s[44:47], s88 offen offset:0 lds
  ds_read_b64_tr_b16 v[76:77], v24 offset:32768
  ds_read_b64_tr_b16 v[78:79], v24 offset:33280
  v_fma_f32 v109, v109, v88, v88
  v_rcp_f32 v108, v108
  v_rcp_f32 v109, v109
  s_waitcnt lgkmcnt(4)
  v_mfma_f32_32x32x16_bf16 v[224:239], v[64:67], a[0:3], 0
  buffer_load_dwordx4 v15, s[44:47], s88 offen offset:1024 lds
  ds_read_b64_tr_b16 v[80:81], v19 offset:32768
  ds_read_b64_tr_b16 v[82:83], v19 offset:33280
  v_mul_f32 v172, v172, v108
  v_mul_f32 v173, v173, v109
  v_cvt_pk_bf16_f32 v162, v172, v173
  v_mfma_f32_16x16x32_bf16 v[44:47], v[60:63], v[64:67], 0
  s_lshl_b32 s85, s82, 8
  s_add_u32 s85, s85, 148480
  v_mul_f32 v110, v166, v166
  v_mul_f32 v111, v167, v167
  v_fma_f32 v110, v110, v87, v86
  v_mfma_f32_32x32x16_bf16 v[240:255], v[68:71], a[0:3], 0
  buffer_load_dwordx4 v16, s[44:47], s88 offen offset:2048 lds
  ds_read_b64_tr_b16 v[64:65], v21 offset:32768
  ds_read_b64_tr_b16 v[66:67], v21 offset:33280
  v_fma_f32 v111, v111, v87, v86
  v_mul_f32 v110, v166, v110
  v_mul_f32 v111, v167, v111
  s_waitcnt lgkmcnt(4)
  v_mfma_f32_32x32x16_bf16 v[128:143], v[72:75], a[0:3], 0
  buffer_load_dwordx4 v17, s[44:47], s88 offen offset:3072 lds
  ds_read_b64_tr_b16 v[68:69], v23 offset:32768
  ds_read_b64_tr_b16 v[70:71], v23 offset:33280
  v_exp_f32 v110, v110
  v_exp_f32 v111, v111
  v_mul_f32 v174, v166, v174
  v_mfma_f32_32x32x16_bf16 v[144:159], v[76:79], a[0:3], 0
  s_add_u32 s88, s88, 221184
  ds_read_b64_tr_b16 v[72:73], v25 offset:32768
  ds_read_b64_tr_b16 v[74:75], v25 offset:33280
  v_lshl_add_u32 v4, v1, 2, s85
  v_cvt_pk_bf16_f32 v3, v48, v48
  v_mul_f32 v175, v167, v175
  v_fma_f32 v110, v110, v88, v88
  v_fma_f32 v111, v111, v88, v88
  s_waitcnt lgkmcnt(4)
  v_mfma_f32_32x32x16_bf16 v[224:239], v[80:83], a[4:7], v[224:239]
  ds_read_b64_tr_b16 v[76:77], v18 offset:36864
  ds_read_b64_tr_b16 v[78:79], v18 offset:37376
  s_mov_b64 exec, 0xffffff
  buffer_load_dword v84, v89, s[56:59], 0 offen sc1
  s_mov_b64 exec, -1
  v_rcp_f32 v110, v110
  v_rcp_f32 v111, v111
  v_mul_f32 v174, v174, v110
  v_mfma_f32_16x16x32_bf16 v[44:47], v[60:63], v[80:83], v[44:47]
  v_and_b32 v3, 0xffff0000, v3
  v_sub_f32 v5, v48, v3
  v_mul_f32 v175, v175, v111
  v_cvt_pk_bf16_f32 v163, v174, v175
  v_mul_f32 v118, v176, v176
  v_mfma_f32_32x32x16_bf16 v[240:255], v[64:67], a[4:7], v[240:255]
  ds_read_b64_tr_b16 v[80:81], v20 offset:36864
  ds_read_b64_tr_b16 v[82:83], v20 offset:37376
  v_cvt_pk_bf16_f32 v5, v3, v5
  ds_write2st64_b32 v4, v5, v5 offset0:0 offset1:4
  v_mov_b32 v92, v36
  v_mul_f32 v119, v177, v177
  v_fma_f32 v118, v118, v87, v86
  v_fma_f32 v119, v119, v87, v86
  s_waitcnt lgkmcnt(5)
  v_mfma_f32_32x32x16_bf16 v[128:143], v[68:71], a[4:7], v[128:143]
  ds_read_b64_tr_b16 v[64:65], v22 offset:36864
  ds_read_b64_tr_b16 v[66:67], v22 offset:37376
  v_mov_b32 v93, 0
  v_mov_b32 v94, v36
  v_mov_b32 v95, 0
  v_mul_f32 v118, v176, v118
  v_mul_f32 v119, v177, v119
  v_exp_f32 v118, v118
  v_mfma_f32_32x32x16_bf16 v[144:159], v[72:75], a[4:7], v[144:159]
  ds_read_b64_tr_b16 v[68:69], v24 offset:36864
  ds_read_b64_tr_b16 v[70:71], v24 offset:37376
  v_mov_b32 v96, 0
  v_mov_b32 v97, v36
  v_mov_b32 v98, 0
  v_exp_f32 v119, v119
  v_mul_f32 v184, v176, v184
  v_mul_f32 v185, v177, v185
  s_waitcnt lgkmcnt(5)
  v_mfma_f32_32x32x16_bf16 v[224:239], v[76:79], a[8:11], v[224:239]
  ds_read_b64_tr_b16 v[72:73], v19 offset:36864
  ds_read_b64_tr_b16 v[74:75], v19 offset:37376
  v_mov_b32 v99, v36
  v_fma_f32 v118, v118, v88, v88
  v_fma_f32 v119, v119, v88, v88
  v_rcp_f32 v118, v118
  v_mfma_f32_16x16x32_bf16 v[44:47], v[60:63], v[76:79], v[44:47]
  v_rcp_f32 v119, v119
  v_mul_f32 v184, v184, v118
  v_mul_f32 v185, v185, v119
  v_mfma_f32_32x32x16_bf16 v[240:255], v[80:83], a[8:11], v[240:255]
  ds_read_b64_tr_b16 v[76:77], v21 offset:36864
  ds_read_b64_tr_b16 v[78:79], v21 offset:37376
  v_cvt_pk_bf16_f32 v176, v184, v185
  v_mul_f32 v120, v178, v178
  v_mul_f32 v121, v179, v179
  s_waitcnt lgkmcnt(4)
  v_mfma_f32_32x32x16_bf16 v[128:143], v[64:67], a[8:11], v[128:143]
  ds_read_b64_tr_b16 v[80:81], v23 offset:36864
  ds_read_b64_tr_b16 v[82:83], v23 offset:37376
  v_fma_f32 v120, v120, v87, v86
  v_fma_f32 v121, v121, v87, v86
  v_mul_f32 v120, v178, v120
  v_mfma_f32_32x32x16_bf16 v[144:159], v[68:71], a[8:11], v[144:159]
  ds_read_b64_tr_b16 v[64:65], v25 offset:36864
  ds_read_b64_tr_b16 v[66:67], v25 offset:37376
  v_mul_f32 v121, v179, v121
  v_exp_f32 v120, v120
  v_exp_f32 v121, v121
  s_waitcnt lgkmcnt(4)
  v_mfma_f32_32x32x16_bf16 v[224:239], v[72:75], a[12:15], v[224:239]
  s_waitcnt vmcnt(9)
  s_barrier
  ds_read_b64_tr_b16 v[68:69], v18 offset:49152
  ds_read_b64_tr_b16 v[70:71], v18 offset:49664
  v_mul_f32 v186, v178, v186
  v_mul_f32 v187, v179, v187
  v_fma_f32 v120, v120, v88, v88
  v_mfma_f32_16x16x32_bf16 v[44:47], v[60:63], v[72:75], v[44:47]
  v_fma_f32 v121, v121, v88, v88
  v_rcp_f32 v120, v120
  v_mfma_f32_32x32x16_bf16 v[240:255], v[76:79], a[12:15], v[240:255]
  ds_read2st64_b32 v[100:101], v4 offset0:0 offset1:1
  ds_read2st64_b32 v[102:103], v4 offset0:2 offset1:3
  ds_read_b64_tr_b16 v[72:73], v20 offset:49152
  ds_read_b64_tr_b16 v[74:75], v20 offset:49664
  v_rcp_f32 v121, v121
  v_mul_f32 v186, v186, v120
  s_waitcnt lgkmcnt(6)
  v_mfma_f32_32x32x16_bf16 v[128:143], v[80:83], a[12:15], v[128:143]
  s_add_u32 m0, s90, 32768
  ds_read_b64_tr_b16 v[76:77], v22 offset:49152
  ds_read_b64_tr_b16 v[78:79], v22 offset:49664
  v_mul_f32 v187, v187, v121
  v_cvt_pk_bf16_f32 v177, v186, v187
  v_mfma_f32_32x32x16_bf16 v[144:159], v[64:67], a[12:15], v[144:159]
  buffer_load_dwordx4 v14, s[44:47], s88 offen offset:0 lds
  ds_read_b64_tr_b16 v[80:81], v24 offset:49152
  ds_read_b64_tr_b16 v[82:83], v24 offset:49664
  v_mul_f32 v118, v180, v180
  v_mul_f32 v119, v181, v181
  s_waitcnt lgkmcnt(4)
  v_mfma_f32_32x32x16_bf16 v[224:239], v[68:71], a[16:19], v[224:239]
  buffer_load_dwordx4 v15, s[44:47], s88 offen offset:1024 lds
  ds_read_b64_tr_b16 v[64:65], v19 offset:49152
  ds_read_b64_tr_b16 v[66:67], v19 offset:49664
  v_fma_f32 v118, v118, v87, v86
  v_fma_f32 v119, v119, v87, v86
  v_mfma_f32_16x16x32_bf16 v[44:47], v[60:63], v[68:71], v[44:47]
  v_mul_f32 v118, v180, v118
  v_mul_f32 v119, v181, v119
  v_mfma_f32_32x32x16_bf16 v[240:255], v[72:75], a[16:19], v[240:255]
  buffer_load_dwordx4 v16, s[44:47], s88 offen offset:2048 lds
  ds_read_b64_tr_b16 v[68:69], v21 offset:49152
  ds_read_b64_tr_b16 v[70:71], v21 offset:49664
  v_exp_f32 v118, v118
  v_exp_f32 v119, v119
  s_waitcnt lgkmcnt(4)
  v_mfma_f32_32x32x16_bf16 v[128:143], v[76:79], a[16:19], v[128:143]
  buffer_load_dwordx4 v17, s[44:47], s88 offen offset:3072 lds
  ds_read_b64_tr_b16 v[72:73], v23 offset:49152
  ds_read_b64_tr_b16 v[74:75], v23 offset:49664
  v_mul_f32 v188, v180, v188
  v_mul_f32 v189, v181, v189
  v_mfma_f32_32x32x16_bf16 v[144:159], v[80:83], a[16:19], v[144:159]
  s_add_u32 s88, s88, 221184
  ds_read_b64_tr_b16 v[76:77], v25 offset:49152
  ds_read_b64_tr_b16 v[78:79], v25 offset:49664
  v_fma_f32 v118, v118, v88, v88
  v_fma_f32 v119, v119, v88, v88
  v_mfma_f32_32x32x16_bf16 v[192:207], v[100:103], v[92:95], v[192:207]
  v_rcp_f32 v118, v118
  v_rcp_f32 v119, v119
  v_mul_f32 v188, v188, v118
  v_mfma_f32_32x32x16_bf16 v[208:223], v[100:103], v[96:99], v[208:223]
  v_mul_f32 v189, v189, v119
  v_cvt_pk_bf16_f32 v178, v188, v189
  v_mul_f32 v120, v182, v182
  v_mul_f32 v121, v183, v183
  v_fma_f32 v120, v120, v87, v86
  s_waitcnt lgkmcnt(4)
  v_mfma_f32_32x32x16_bf16 v[224:239], v[64:67], a[20:23], v[224:239]
  ds_read_b64_tr_b16 v[80:81], v18 offset:53248
  ds_read_b64_tr_b16 v[82:83], v18 offset:53760
  s_waitcnt vmcnt(4)
  v_cmp_ne_u32 vcc, s61, v84
  s_nop 1
  s_and_b32 vcc_lo, vcc_lo, 0xffffff
  s_cbranch_scc1 L_slow0
L_back0:
  v_fma_f32 v121, v121, v87, v86
  v_mul_f32 v120, v182, v120
  v_mfma_f32_16x16x32_bf16 v[44:47], v[60:63], v[64:67], v[44:47]
  v_mul_f32 v121, v183, v121
  v_exp_f32 v120, v120
  v_mfma_f32_32x32x16_bf16 v[240:255], v[68:71], a[20:23], v[240:255]
  ds_read_b64_tr_b16 v[64:65], v20 offset:53248
  ds_read_b64_tr_b16 v[66:67], v20 offset:53760
  v_exp_f32 v121, v121
  v_mul_f32 v190, v182, v190
  s_waitcnt lgkmcnt(4)
  v_mfma_f32_32x32x16_bf16 v[128:143], v[72:75], a[20:23], v[128:143]
  ds_read_b64_tr_b16 v[68:69], v22 offset:53248
  ds_read_b64_tr_b16 v[70:71], v22 offset:53760
  v_mul_f32 v191, v183, v191
  v_fma_f32 v120, v120, v88, v88
  v_fma_f32 v121, v121, v88, v88
  v_mfma_f32_32x32x16_bf16 v[144:159], v[76:79], a[20:23], v[144:159]
  ds_read_b64_tr_b16 v[72:73], v24 offset:53248
  ds_read_b64_tr_b16 v[74:75], v24 offset:53760
  v_rcp_f32 v120, v120
  v_rcp_f32 v121, v121
  s_waitcnt lgkmcnt(4)
  v_mfma_f32_32x32x16_bf16 v[224:239], v[80:83], a[24:27], v[224:239]
  ds_read_b64_tr_b16 v[76:77], v19 offset:53248
  ds_read_b64_tr_b16 v[78:79], v19 offset:53760
  v_mul_f32 v190, v190, v120
  v_mul_f32 v191, v191, v121
  v_cvt_pk_bf16_f32 v179, v190, v191
  v_mfma_f32_16x16x32_bf16 v[44:47], v[60:63], v[80:83], v[44:47]
  buffer_store_dwordx4 v[6:9], v34, s[48:51], s91 offen sc1
  v_mfma_f32_32x32x16_bf16 v[240:255], v[64:67], a[24:27], v[240:255]
  ds_read_b64_tr_b16 v[80:81], v21 offset:53248
  ds_read_b64_tr_b16 v[82:83], v21 offset:53760
  buffer_store_dwordx4 v[10:13], v34, s[48:51], s92 offen sc1
  s_waitcnt lgkmcnt(4)
  v_mfma_f32_32x32x16_bf16 v[128:143], v[68:71], a[24:27], v[128:143]
  ds_read_b64_tr_b16 v[64:65], v23 offset:53248
  ds_read_b64_tr_b16 v[66:67], v23 offset:53760
  buffer_store_dwordx4 v[160:163], v34, s[48:51], s93 offen sc1
  v_mfma_f32_32x32x16_bf16 v[144:159], v[72:75], a[24:27], v[144:159]
  ds_read_b64_tr_b16 v[68:69], v25 offset:53248
  ds_read_b64_tr_b16 v[70:71], v25 offset:53760
  buffer_store_dwordx4 v[176:179], v34, s[48:51], s94 offen sc1
  v_mul_f32 v108, v192, v192
  v_mul_f32 v109, v193, v193
  v_fma_f32 v108, v108, v87, v86
  s_waitcnt lgkmcnt(4)
  v_mfma_f32_32x32x16_bf16 v[224:239], v[76:79], a[28:31], v[224:239]
  s_barrier
  ds_read_b64_tr_b16 v[72:73], v18 offset:0
  ds_read_b64_tr_b16 v[74:75], v18 offset:512
  v_fma_f32 v109, v109, v87, v86
  v_mul_f32 v108, v192, v108
  v_mul_f32 v109, v193, v109
  v_mfma_f32_16x16x32_bf16 v[44:47], v[60:63], v[76:79], v[44:47]
  v_exp_f32 v108, v108
  v_exp_f32 v109, v109
  v_mul_f32 v200, v192, v200
  v_mfma_f32_32x32x16_bf16 v[240:255], v[80:83], a[28:31], v[240:255]
  ds_read_b64_tr_b16 v[76:77], v20 offset:0
  ds_read_b64_tr_b16 v[78:79], v20 offset:512
  v_mul_f32 v201, v193, v201
  v_fma_f32 v108, v108, v88, v88
  v_fma_f32 v109, v109, v88, v88
  s_waitcnt lgkmcnt(4)
  v_mfma_f32_32x32x16_bf16 v[128:143], v[64:67], a[28:31], v[128:143]
  s_add_u32 m0, s90, 49152
  ds_read_b64_tr_b16 v[80:81], v22 offset:0
  ds_read_b64_tr_b16 v[82:83], v22 offset:512
  v_rcp_f32 v108, v108
  v_rcp_f32 v109, v109
  v_mul_f32 v200, v200, v108
  v_mfma_f32_32x32x16_bf16 v[144:159], v[68:71], a[28:31], v[144:159]
  buffer_load_dwordx4 v14, s[44:47], s88 offen offset:0 lds
  ds_read_b64_tr_b16 v[64:65], v24 offset:0
  ds_read_b64_tr_b16 v[66:67], v24 offset:512
  v_mul_f32 v201, v201, v109
  v_cvt_pk_bf16_f32 v192, v200, v201
  v_mul_f32 v110, v194, v194
  s_waitcnt lgkmcnt(4)
  v_mfma_f32_32x32x16_bf16 v[224:239], v[72:75], a[32:35], v[224:239]
  buffer_load_dwordx4 v15, s[44:47], s88 offen offset:1024 lds
  ds_read_b64_tr_b16 v[68:69], v19 offset:0
  ds_read_b64_tr_b16 v[70:71], v19 offset:512
  v_mul_f32 v111, v195, v195
  v_fma_f32 v110, v110, v87, v86
  v_fma_f32 v111, v111, v87, v86
  v_mfma_f32_16x16x32_bf16 v[44:47], v[60:63], v[72:75], v[44:47]
  v_mul_f32 v110, v194, v110
  v_mul_f32 v111, v195, v111
  v_exp_f32 v110, v110
  v_mfma_f32_32x32x16_bf16 v[240:255], v[76:79], a[32:35], v[240:255]
  buffer_load_dwordx4 v16, s[44:47], s88 offen offset:2048 lds
  ds_read_b64_tr_b16 v[72:73], v21 offset:0
  ds_read_b64_tr_b16 v[74:75], v21 offset:512
  v_exp_f32 v111, v111
  v_mul_f32 v202, v194, v202
  v_mul_f32 v203, v195, v203
  s_waitcnt lgkmcnt(4)
  v_mfma_f32_32x32x16_bf16 v[128:143], v[80:83], a[32:35], v[128:143]
  buffer_load_dwordx4 v17, s[44:47], s88 offen offset:3072 lds
  ds_read_b64_tr_b16 v[76:77], v23 offset:0
  ds_read_b64_tr_b16 v[78:79], v23 offset:512
  v_fma_f32 v110, v110, v88, v88
  v_fma_f32 v111, v111, v88, v88
  v_rcp_f32 v110, v110
  v_mfma_f32_32x32x16_bf16 v[144:159], v[64:67], a[32:35], v[144:159]
  s_add_u32 s88, s88, 221184
  ds_read_b64_tr_b16 v[80:81], v25 offset:0
  ds_read_b64_tr_b16 v[82:83], v25 offset:512
  v_rcp_f32 v111, v111
  v_mul_f32 v202, v202, v110
  v_mul_f32 v203, v203, v111
  s_waitcnt lgkmcnt(4)
  v_mfma_f32_32x32x16_bf16 v[224:239], v[68:71], a[36:39], v[224:239]
  ds_read_b64_tr_b16 v[64:65], v18 offset:4096
  ds_read_b64_tr_b16 v[66:67], v18 offset:4608
  v_cvt_pk_bf16_f32 v193, v202, v203
  v_mul_f32 v108, v196, v196
  v_mul_f32 v109, v197, v197
  v_mfma_f32_16x16x32_bf16 v[44:47], v[60:63], v[68:71], v[44:47]
  v_fma_f32 v108, v108, v87, v86
  v_fma_f32 v109, v109, v87, v86
  v_mul_f32 v108, v196, v108
  v_mfma_f32_32x32x16_bf16 v[240:255], v[72:75], a[36:39], v[240:255]
  s_add_u32 m0, s29, 65536
  s_add_u32 s15, s99, 983040
  buffer_load_dwordx4 v35, s[52:55], s15 offen offset:0 sc1 lds
  ds_read_b64_tr_b16 v[68:69], v20 offset:4096
  ds_read_b64_tr_b16 v[70:71], v20 offset:4608
  v_mul_f32 v109, v197, v109
  v_exp_f32 v108, v108
  v_exp_f32 v109, v109
  s_waitcnt lgkmcnt(4)
  v_mfma_f32_32x32x16_bf16 v[128:143], v[76:79], a[36:39], v[128:143]
  ds_read_b64_tr_b16 v[72:73], v22 offset:4096
  ds_read_b64_tr_b16 v[74:75], v22 offset:4608
  v_mul_f32 v204, v196, v204
  v_mul_f32 v205, v197, v205
  v_fma_f32 v108, v108, v88, v88
  v_mfma_f32_32x32x16_bf16 v[144:159], v[80:83], a[36:39], v[144:159]
  s_add_u32 m0, s29, 65536
  s_nop 0
  buffer_load_dwordx4 v35, s[52:55], s15 offen offset:1024 sc1 lds
  ds_read_b64_tr_b16 v[76:77], v24 offset:4096
  ds_read_b64_tr_b16 v[78:79], v24 offset:4608
  v_fma_f32 v109, v109, v88, v88
  v_rcp_f32 v108, v108
  s_waitcnt lgkmcnt(4)
  v_mfma_f32_32x32x16_bf16 v[224:239], v[64:67], a[40:43], v[224:239]
  ds_read_b64_tr_b16 v[80:81], v19 offset:4096
  ds_read_b64_tr_b16 v[82:83], v19 offset:4608
  v_rcp_f32 v109, v109
  v_mul_f32 v204, v204, v108
  v_mfma_f32_16x16x32_bf16 v[44:47], v[60:63], v[64:67], v[44:47]
  v_mul_f32 v205, v205, v109
  v_cvt_pk_bf16_f32 v194, v204, v205
  v_mfma_f32_32x32x16_bf16 v[240:255], v[68:71], a[40:43], v[240:255]
  s_add_u32 m0, s29, 65536
  s_nop 0
  buffer_load_dwordx4 v35, s[52:55], s15 offen offset:2048 sc1 lds
  ds_read_b64_tr_b16 v[64:65], v21 offset:4096
  ds_read_b64_tr_b16 v[66:67], v21 offset:4608
  v_mul_f32 v110, v198, v198
  v_mul_f32 v111, v199, v199
  s_waitcnt lgkmcnt(4)
  v_mfma_f32_32x32x16_bf16 v[128:143], v[72:75], a[40:43], v[128:143]
  ds_read_b64_tr_b16 v[68:69], v23 offset:4096
  ds_read_b64_tr_b16 v[70:71], v23 offset:4608
  v_fma_f32 v110, v110, v87, v86
  v_fma_f32 v111, v111, v87, v86
  v_mul_f32 v110, v198, v110
  v_mfma_f32_32x32x16_bf16 v[144:159], v[76:79], a[40:43], v[144:159]
  s_add_u32 m0, s29, 65536
  s_nop 0
  buffer_load_dwordx4 v35, s[52:55], s15 offen offset:3072 sc1 lds
  ds_read_b64_tr_b16 v[72:73], v25 offset:4096
  ds_read_b64_tr_b16 v[74:75], v25 offset:4608
  v_mul_f32 v111, v199, v111
  v_exp_f32 v110, v110
  s_waitcnt lgkmcnt(4)
  v_mfma_f32_32x32x16_bf16 v[224:239], v[80:83], a[44:47], v[224:239]
  s_barrier
  ds_read_b64_tr_b16 v[76:77], v18 offset:16384
  ds_read_b64_tr_b16 v[78:79], v18 offset:16896
  v_exp_f32 v111, v111
  v_mul_f32 v206, v198, v206
  v_mfma_f32_16x16x32_bf16 v[44:47], v[60:63], v[80:83], v[44:47]
  v_mul_f32 v207, v199, v207
  v_fma_f32 v110, v110, v88, v88
  v_mfma_f32_32x32x16_bf16 v[240:255], v[64:67], a[44:47], v[240:255]
  ds_read_b64_tr_b16 v[80:81], v20 offset:16384
  ds_read_b64_tr_b16 v[82:83], v20 offset:16896
  v_fma_f32 v111, v111, v88, v88
  v_rcp_f32 v110, v110
  s_waitcnt lgkmcnt(4)
  v_mfma_f32_32x32x16_bf16 v[128:143], v[68:71], a[44:47], v[128:143]
  s_add_u32 m0, s90, 0
  ds_read_b64_tr_b16 v[64:65], v22 offset:16384
  ds_read_b64_tr_b16 v[66:67], v22 offset:16896
  v_rcp_f32 v111, v111
  v_mul_f32 v206, v206, v110
  v_mfma_f32_32x32x16_bf16 v[144:159], v[72:75], a[44:47], v[144:159]
  buffer_load_dwordx4 v14, s[44:47], s88 offen offset:0 lds
  ds_read_b64_tr_b16 v[68:69], v24 offset:16384
  ds_read_b64_tr_b16 v[70:71], v24 offset:16896
  v_mul_f32 v207, v207, v111
  v_cvt_pk_bf16_f32 v195, v206, v207
  s_waitcnt lgkmcnt(4)
  v_mfma_f32_32x32x16_bf16 v[224:239], v[76:79], a[48:51], v[224:239]
  buffer_load_dwordx4 v15, s[44:47], s88 offen offset:1024 lds
  ds_read_b64_tr_b16 v[72:73], v19 offset:16384
  ds_read_b64_tr_b16 v[74:75], v19 offset:16896
  s_waitcnt vmcnt(10)
  v_add_u32 v2, s61, v125
  buffer_store_dword v2, v125, s[56:59], s101 offen sc1
  v_mul_f32 v118, v208, v208
  v_mul_f32 v119, v209, v209
  v_mfma_f32_16x16x32_bf16 v[44:47], v[60:63], v[76:79], v[44:47]
  v_fma_f32 v118, v118, v87, v86
  v_fma_f32 v119, v119, v87, v86
  v_mfma_f32_32x32x16_bf16 v[240:255], v[80:83], a[48:51], v[240:255]
  buffer_load_dwordx4 v16, s[44:47], s88 offen offset:2048 lds
  ds_read_b64_tr_b16 v[76:77], v21 offset:16384
  ds_read_b64_tr_b16 v[78:79], v21 offset:16896
  v_mul_f32 v118, v208, v118
  v_mul_f32 v119, v209, v119
  s_waitcnt lgkmcnt(4)
  v_mfma_f32_32x32x16_bf16 v[128:143], v[64:67], a[48:51], v[128:143]
  buffer_load_dwordx4 v17, s[44:47], s88 offen offset:3072 lds
  ds_read_b64_tr_b16 v[80:81], v23 offset:16384
  ds_read_b64_tr_b16 v[82:83], v23 offset:16896
  v_exp_f32 v118, v118
  v_exp_f32 v119, v119
  v_mfma_f32_32x32x16_bf16 v[144:159], v[68:71], a[48:51], v[144:159]
  s_add_u32 s88, s88, 221184
  ds_read_b64_tr_b16 v[64:65], v25 offset:16384
  ds_read_b64_tr_b16 v[66:67], v25 offset:16896
  v_mul_f32 v216, v208, v216
  v_mul_f32 v217, v209, v217
  s_waitcnt lgkmcnt(4)
  v_mfma_f32_32x32x16_bf16 v[224:239], v[72:75], a[52:55], v[224:239]
  ds_read_b64_tr_b16 v[68:69], v18 offset:20480
  ds_read_b64_tr_b16 v[70:71], v18 offset:20992
  v_fma_f32 v118, v118, v88, v88
  v_fma_f32 v119, v119, v88, v88
  v_mfma_f32_16x16x32_bf16 v[44:47], v[60:63], v[72:75], v[44:47]
  v_rcp_f32 v118, v118
  v_rcp_f32 v119, v119
  v_mfma_f32_32x32x16_bf16 v[240:255], v[76:79], a[52:55], v[240:255]
  s_add_u32 m0, s29, 69632
  s_add_u32 s15, s99, 987136
  buffer_load_dwordx4 v35, s[52:55], s15 offen offset:0 sc1 lds
  ds_read_b64_tr_b16 v[72:73], v20 offset:20480
  ds_read_b64_tr_b16 v[74:75], v20 offset:20992
  v_mul_f32 v216, v216, v118
  v_mul_f32 v217, v217, v119
  s_waitcnt lgkmcnt(4)
  v_mfma_f32_32x32x16_bf16 v[128:143], v[80:83], a[52:55], v[128:143]
  ds_read_b64_tr_b16 v[76:77], v22 offset:20480
  ds_read_b64_tr_b16 v[78:79], v22 offset:20992
  v_cvt_pk_bf16_f32 v208, v216, v217
  v_mul_f32 v120, v210, v210
  v_mul_f32 v121, v211, v211
  v_mfma_f32_32x32x16_bf16 v[144:159], v[64:67], a[52:55], v[144:159]
  s_add_u32 m0, s29, 86016
  s_add_u32 s15, s99, 1310720
  buffer_load_dwordx4 v35, s[52:55], s15 offen offset:0 sc1 lds
  ds_read_b64_tr_b16 v[80:81], v24 offset:20480
  ds_read_b64_tr_b16 v[82:83], v24 offset:20992
  v_fma_f32 v120, v120, v87, v86
  v_fma_f32 v121, v121, v87, v86
  s_waitcnt lgkmcnt(4)
  v_mfma_f32_32x32x16_bf16 v[224:239], v[68:71], a[56:59], v[224:239]
  ds_read_b64_tr_b16 v[64:65], v19 offset:20480
  ds_read_b64_tr_b16 v[66:67], v19 offset:20992
  v_mul_f32 v120, v210, v120
  v_mul_f32 v121, v211, v121
  v_mfma_f32_16x16x32_bf16 v[44:47], v[60:63], v[68:71], v[44:47]
  v_exp_f32 v120, v120
  v_exp_f32 v121, v121
  v_mfma_f32_32x32x16_bf16 v[240:255], v[72:75], a[56:59], v[240:255]
  s_add_u32 m0, s29, 86016
  s_nop 0
  buffer_load_dwordx4 v35, s[52:55], s15 offen offset:1024 sc1 lds
  ds_read_b64_tr_b16 v[68:69], v21 offset:20480
  ds_read_b64_tr_b16 v[70:71], v21 offset:20992
  v_mul_f32 v218, v210, v218
  v_mul_f32 v219, v211, v219
  s_waitcnt lgkmcnt(4)
  v_mfma_f32_32x32x16_bf16 v[128:143], v[76:79], a[56:59], v[128:143]
L_pgf3:
  s_cbranch_execz L_pgf7
  ds_read_b64_tr_b16 v[72:73], v23 offset:20480
  ds_read_b64_tr_b16 v[74:75], v23 offset:20992
  v_fma_f32 v120, v120, v88, v88
  v_fma_f32 v121, v121, v88, v88
  v_mfma_f32_32x32x16_bf16 v[144:159], v[80:83], a[56:59], v[144:159]
  s_add_u32 m0, s29, 86016
  s_nop 0
  buffer_load_dwordx4 v35, s[52:55], s15 offen offset:2048 sc1 lds
  ds_read_b64_tr_b16 v[76:77], v25 offset:20480
  ds_read_b64_tr_b16 v[78:79], v25 offset:20992
  v_rcp_f32 v120, v120
  v_rcp_f32 v121, v121
  s_waitcnt lgkmcnt(4)
  v_mfma_f32_32x32x16_bf16 v[224:239], v[64:67], a[60:63], v[224:239]
  s_barrier
  ds_read_b64_tr_b16 v[80:81], v18 offset:32768
  ds_read_b64_tr_b16 v[82:83], v18 offset:33280
  v_mul_f32 v218, v218, v120
  v_mul_f32 v219, v219, v121
  v_mfma_f32_16x16x32_bf16 v[44:47], v[60:63], v[64:67], v[44:47]
  v_cvt_pk_bf16_f32 v209, v218, v219
  v_mul_f32 v118, v212, v212
  v_mfma_f32_32x32x16_bf16 v[240:255], v[68:71], a[60:63], v[240:255]
  ds_read_b64_tr_b16 v[64:65], v20 offset:32768
  ds_read_b64_tr_b16 v[66:67], v20 offset:33280
  v_mul_f32 v119, v213, v213
  v_fma_f32 v118, v118, v87, v86
  v_fma_f32 v119, v119, v87, v86
  s_waitcnt lgkmcnt(4)
  v_mfma_f32_32x32x16_bf16 v[128:143], v[72:75], a[60:63], v[128:143]
  s_add_u32 m0, s90, 16384
  ds_read_b64_tr_b16 v[68:69], v22 offset:32768
  ds_read_b64_tr_b16 v[70:71], v22 offset:33280
  v_mul_f32 v118, v212, v118
  v_mul_f32 v119, v213, v119
  v_mfma_f32_32x32x16_bf16 v[144:159], v[76:79], a[60:63], v[144:159]
  buffer_load_dwordx4 v14, s[44:47], s88 offen offset:0 lds
  ds_read_b64_tr_b16 v[72:73], v24 offset:32768
  ds_read_b64_tr_b16 v[74:75], v24 offset:33280
  v_exp_f32 v118, v118
  v_exp_f32 v119, v119
  s_waitcnt lgkmcnt(4)
  v_mfma_f32_32x32x16_bf16 v[224:239], v[80:83], a[64:67], v[224:239]
  buffer_load_dwordx4 v15, s[44:47], s88 offen offset:1024 lds
  ds_read_b64_tr_b16 v[76:77], v19 offset:32768
  ds_read_b64_tr_b16 v[78:79], v19 offset:33280
  v_mul_f32 v220, v212, v220
  v_mul_f32 v221, v213, v221
  v_mfma_f32_16x16x32_bf16 v[44:47], v[60:63], v[80:83], v[44:47]
  v_fma_f32 v118, v118, v88, v88
  v_fma_f32 v119, v119, v88, v88
  v_mfma_f32_32x32x16_bf16 v[240:255], v[64:67], a[64:67], v[240:255]
  buffer_load_dwordx4 v16, s[44:47], s88 offen offset:2048 lds
  ds_read_b64_tr_b16 v[80:81], v21 offset:32768
  ds_read_b64_tr_b16 v[82:83], v21 offset:33280
  v_rcp_f32 v118, v118
  v_rcp_f32 v119, v119
  s_waitcnt lgkmcnt(4)
  v_mfma_f32_32x32x16_bf16 v[128:143], v[68:71], a[64:67], v[128:143]
  buffer_load_dwordx4 v17, s[44:47], s88 offen offset:3072 lds
  ds_read_b64_tr_b16 v[64:65], v23 offset:32768
  ds_read_b64_tr_b16 v[66:67], v23 offset:33280
  v_mul_f32 v220, v220, v118
  v_mul_f32 v221, v221, v119
  v_mfma_f32_32x32x16_bf16 v[144:159], v[72:75], a[64:67], v[144:159]
  s_add_u32 s88, s88, 221184
  ds_read_b64_tr_b16 v[68:69], v25 offset:32768
  ds_read_b64_tr_b16 v[70:71], v25 offset:33280
  v_cvt_pk_bf16_f32 v210, v220, v221
  v_mul_f32 v120, v214, v214
  s_waitcnt lgkmcnt(4)
  v_mfma_f32_32x32x16_bf16 v[224:239], v[76:79], a[68:71], v[224:239]
  ds_read_b64_tr_b16 v[72:73], v18 offset:36864
  ds_read_b64_tr_b16 v[74:75], v18 offset:37376
  v_mul_f32 v121, v215, v215
  v_fma_f32 v120, v120, v87, v86
  v_fma_f32 v121, v121, v87, v86
  v_mfma_f32_16x16x32_bf16 v[44:47], v[60:63], v[76:79], v[44:47]
  v_mul_f32 v120, v214, v120
  v_mul_f32 v121, v215, v121
  v_mfma_f32_32x32x16_bf16 v[240:255], v[80:83], a[68:71], v[240:255]
  s_add_u32 m0, s29, 86016
  s_nop 0
  buffer_load_dwordx4 v35, s[52:55], s15 offen offset:3072 sc1 lds
  ds_read_b64_tr_b16 v[76:77], v20 offset:36864
  ds_read_b64_tr_b16 v[78:79], v20 offset:37376
  v_exp_f32 v120, v120
  v_exp_f32 v121, v121
  s_waitcnt lgkmcnt(4)
  v_mfma_f32_32x32x16_bf16 v[128:143], v[64:67], a[68:71], v[128:143]
  ds_read_b64_tr_b16 v[80:81], v22 offset:36864
  ds_read_b64_tr_b16 v[82:83], v22 offset:37376
  v_mul_f32 v222, v214, v222
  v_mul_f32 v223, v215, v223
  v_fma_f32 v120, v120, v88, v88
  v_mfma_f32_32x32x16_bf16 v[144:159], v[68:71], a[68:71], v[144:159]
  s_add_u32 m0, s29, 90112
  s_add_u32 s15, s99, 1314816
  buffer_load_dwordx4 v35, s[52:55], s15 offen offset:0 sc1 lds
  ds_read_b64_tr_b16 v[64:65], v24 offset:36864
  ds_read_b64_tr_b16 v[66:67], v24 offset:37376
  v_fma_f32 v121, v121, v88, v88
  v_rcp_f32 v120, v120
  s_waitcnt lgkmcnt(4)
  v_mfma_f32_32x32x16_bf16 v[224:239], v[72:75], a[72:75], v[224:239]
  ds_read_b64_tr_b16 v[68:69], v19 offset:36864
  ds_read_b64_tr_b16 v[70:71], v19 offset:37376
  v_rcp_f32 v121, v121
  v_mul_f32 v222, v222, v120
  v_mfma_f32_16x16x32_bf16 v[44:47], v[60:63], v[72:75], v[44:47]
  v_mul_f32 v223, v223, v121
  v_cvt_pk_bf16_f32 v211, v222, v223
  v_mfma_f32_32x32x16_bf16 v[240:255], v[76:79], a[72:75], v[240:255]
  s_add_u32 m0, s29, 106496
  s_add_u32 s15, s99, 1638400
  buffer_load_dwordx4 v35, s[52:55], s15 offen offset:0 sc1 lds
  ds_read_b64_tr_b16 v[72:73], v21 offset:36864
  ds_read_b64_tr_b16 v[74:75], v21 offset:37376
  s_waitcnt lgkmcnt(4)
  v_mfma_f32_32x32x16_bf16 v[128:143], v[80:83], a[72:75], v[128:143]
  ds_read_b64_tr_b16 v[76:77], v23 offset:36864
  ds_read_b64_tr_b16 v[78:79], v23 offset:37376
  buffer_store_dwordx4 v[192:195], v34, s[48:51], s10 offen sc1
  v_mfma_f32_32x32x16_bf16 v[144:159], v[64:67], a[72:75], v[144:159]
  s_add_u32 m0, s29, 106496
  s_nop 0
  buffer_load_dwordx4 v35, s[52:55], s15 offen offset:1024 sc1 lds
  ds_read_b64_tr_b16 v[80:81], v25 offset:36864
  ds_read_b64_tr_b16 v[82:83], v25 offset:37376
  s_waitcnt lgkmcnt(4)
  v_mfma_f32_32x32x16_bf16 v[224:239], v[68:71], a[76:79], v[224:239]
  s_waitcnt vmcnt(22)
  s_barrier
  ds_read_b64_tr_b16 v[64:65], v18 offset:49152
  ds_read_b64_tr_b16 v[66:67], v18 offset:49664
  buffer_store_dwordx4 v[208:211], v34, s[48:51], s11 offen sc1
  v_mfma_f32_16x16x32_bf16 v[44:47], v[60:63], v[68:71], v[44:47]
  v_mfma_f32_32x32x16_bf16 v[240:255], v[72:75], a[76:79], v[240:255]
  ds_read_b64_tr_b16 v[68:69], v20 offset:49152
  ds_read_b64_tr_b16 v[70:71], v20 offset:49664
  s_waitcnt lgkmcnt(4)
  v_mfma_f32_32x32x16_bf16 v[128:143], v[76:79], a[76:79], v[128:143]
  s_add_u32 m0, s90, 32768
  ds_read_b64_tr_b16 v[72:73], v22 offset:49152
  ds_read_b64_tr_b16 v[74:75], v22 offset:49664
  v_mfma_f32_32x32x16_bf16 v[144:159], v[80:83], a[76:79], v[144:159]
  buffer_load_dwordx4 v14, s[44:47], s88 offen offset:0 lds
  ds_read_b64_tr_b16 v[76:77], v24 offset:49152
  ds_read_b64_tr_b16 v[78:79], v24 offset:49664
  s_waitcnt lgkmcnt(4)
  v_mfma_f32_32x32x16_bf16 v[224:239], v[64:67], a[80:83], v[224:239]
  buffer_load_dwordx4 v15, s[44:47], s88 offen offset:1024 lds
  ds_read_b64_tr_b16 v[80:81], v19 offset:49152
  ds_read_b64_tr_b16 v[82:83], v19 offset:49664
  v_mfma_f32_16x16x32_bf16 v[44:47], v[60:63], v[64:67], v[44:47]
  v_mfma_f32_32x32x16_bf16 v[240:255], v[68:71], a[80:83], v[240:255]
  buffer_load_dwordx4 v16, s[44:47], s88 offen offset:2048 lds
  ds_read_b64_tr_b16 v[64:65], v21 offset:49152
  ds_read_b64_tr_b16 v[66:67], v21 offset:49664
  s_waitcnt lgkmcnt(4)
  v_mfma_f32_32x32x16_bf16 v[128:143], v[72:75], a[80:83], v[128:143]
  buffer_load_dwordx4 v17, s[44:47], s88 offen offset:3072 lds
  ds_read_b64_tr_b16 v[68:69], v23 offset:49152
  ds_read_b64_tr_b16 v[70:71], v23 offset:49664
  v_mfma_f32_32x32x16_bf16 v[144:159], v[76:79], a[80:83], v[144:159]
  s_add_u32 s88, s88, 221184
  ds_read_b64_tr_b16 v[72:73], v25 offset:49152
  ds_read_b64_tr_b16 v[74:75], v25 offset:49664
  s_waitcnt lgkmcnt(4)
  v_mfma_f32_32x32x16_bf16 v[224:239], v[80:83], a[84:87], v[224:239]
  ds_read_b64_tr_b16 v[76:77], v18 offset:53248
  ds_read_b64_tr_b16 v[78:79], v18 offset:53760
  v_mfma_f32_16x16x32_bf16 v[44:47], v[60:63], v[80:83], v[44:47]
  v_mfma_f32_32x32x16_bf16 v[240:255], v[64:67], a[84:87], v[240:255]
  s_add_u32 m0, s29, 106496
  s_nop 0
  buffer_load_dwordx4 v35, s[52:55], s15 offen offset:2048 sc1 lds
  ds_read_b64_tr_b16 v[80:81], v20 offset:53248
  ds_read_b64_tr_b16 v[82:83], v20 offset:53760
  s_waitcnt lgkmcnt(4)
  v_mfma_f32_32x32x16_bf16 v[128:143], v[68:71], a[84:87], v[128:143]
  ds_read_b64_tr_b16 v[64:65], v22 offset:53248
  ds_read_b64_tr_b16 v[66:67], v22 offset:53760
  v_mfma_f32_32x32x16_bf16 v[144:159], v[72:75], a[84:87], v[144:159]
  s_add_u32 m0, s29, 106496
  s_nop 0
  buffer_load_dwordx4 v35, s[52:55], s15 offen offset:3072 sc1 lds
  ds_read_b64_tr_b16 v[68:69], v24 offset:53248
  ds_read_b64_tr_b16 v[70:71], v24 offset:53760
  s_waitcnt lgkmcnt(4)
  v_mfma_f32_32x32x16_bf16 v[224:239], v[76:79], a[88:91], v[224:239]
  ds_read_b64_tr_b16 v[72:73], v19 offset:53248
  ds_read_b64_tr_b16 v[74:75], v19 offset:53760
  v_mfma_f32_16x16x32_bf16 v[44:47], v[60:63], v[76:79], v[44:47]
  v_mfma_f32_32x32x16_bf16 v[240:255], v[80:83], a[88:91], v[240:255]
  s_add_u32 m0, s29, 110592
  s_add_u32 s15, s99, 1642496
  buffer_load_dwordx4 v35, s[52:55], s15 offen offset:0 sc1 lds
  ds_read_b64_tr_b16 v[76:77], v21 offset:53248
  ds_read_b64_tr_b16 v[78:79], v21 offset:53760
  s_waitcnt lgkmcnt(4)
  v_mfma_f32_32x32x16_bf16 v[128:143], v[64:67], a[88:91], v[128:143]
  ds_read_b64_tr_b16 v[80:81], v23 offset:53248
  ds_read_b64_tr_b16 v[82:83], v23 offset:53760
  v_mfma_f32_32x32x16_bf16 v[144:159], v[68:71], a[88:91], v[144:159]
  s_add_u32 m0, s29, 126976
  s_add_u32 s15, s99, 1966080
  buffer_load_dwordx4 v35, s[52:55], s15 offen offset:0 sc1 lds
  ds_read_b64_tr_b16 v[64:65], v25 offset:53248
  ds_read_b64_tr_b16 v[66:67], v25 offset:53760
  s_waitcnt lgkmcnt(4)
  v_mfma_f32_32x32x16_bf16 v[224:239], v[72:75], a[92:95], v[224:239]
  s_waitcnt vmcnt(22)
  s_barrier
  ds_read_b64_tr_b16 v[68:69], v18 offset:0
  ds_read_b64_tr_b16 v[70:71], v18 offset:512
  s_mov_b64 exec, 0xffff
  buffer_load_dword v84, v85, s[56:59], 0 offen offset:0 sc1
  s_mov_b64 exec, -1
  v_mfma_f32_16x16x32_bf16 v[44:47], v[60:63], v[72:75], v[44:47]
  v_mfma_f32_32x32x16_bf16 v[240:255], v[76:79], a[92:95], v[240:255]
  ds_read_b64_tr_b16 v[72:73], v20 offset:0
  ds_read_b64_tr_b16 v[74:75], v20 offset:512
  s_waitcnt lgkmcnt(4)
  v_mfma_f32_32x32x16_bf16 v[128:143], v[80:83], a[92:95], v[128:143]
  s_add_u32 m0, s90, 49152
  ds_read_b64_tr_b16 v[76:77], v22 offset:0
  ds_read_b64_tr_b16 v[78:79], v22 offset:512
  v_mfma_f32_32x32x16_bf16 v[144:159], v[64:67], a[92:95], v[144:159]
  buffer_load_dwordx4 v14, s[44:47], s88 offen offset:0 lds
  ds_read_b64_tr_b16 v[80:81], v24 offset:0
  ds_read_b64_tr_b16 v[82:83], v24 offset:512
  s_waitcnt lgkmcnt(4)
  v_mfma_f32_32x32x16_bf16 v[224:239], v[68:71], a[96:99], v[224:239]
  buffer_load_dwordx4 v15, s[44:47], s88 offen offset:1024 lds
  ds_read_b64_tr_b16 v[64:65], v19 offset:0
  ds_read_b64_tr_b16 v[66:67], v19 offset:512
  v_mfma_f32_16x16x32_bf16 v[44:47], v[60:63], v[68:71], v[44:47]
  v_mfma_f32_32x32x16_bf16 v[240:255], v[72:75], a[96:99], v[240:255]
  buffer_load_dwordx4 v16, s[44:47], s88 offen offset:2048 lds
  ds_read_b64_tr_b16 v[68:69], v21 offset:0
  ds_read_b64_tr_b16 v[70:71], v21 offset:512
  s_waitcnt lgkmcnt(4)
  v_mfma_f32_32x32x16_bf16 v[128:143], v[76:79], a[96:99], v[128:143]
  buffer_load_dwordx4 v17, s[44:47], s88 offen offset:3072 lds
  ds_read_b64_tr_b16 v[72:73], v23 offset:0
  ds_read_b64_tr_b16 v[74:75], v23 offset:512
  v_mfma_f32_32x32x16_bf16 v[144:159], v[80:83], a[96:99], v[144:159]
  s_add_u32 s88, s88, 221184
  ds_read_b64_tr_b16 v[76:77], v25 offset:0
  ds_read_b64_tr_b16 v[78:79], v25 offset:512
  s_waitcnt lgkmcnt(4)
  v_mfma_f32_32x32x16_bf16 v[224:239], v[64:67], a[100:103], v[224:239]
  ds_read_b64_tr_b16 v[80:81], v18 offset:4096
  ds_read_b64_tr_b16 v[82:83], v18 offset:4608
  v_mfma_f32_16x16x32_bf16 v[44:47], v[60:63], v[64:67], v[44:47]
  v_mfma_f32_32x32x16_bf16 v[240:255], v[68:71], a[100:103], v[240:255]
  s_add_u32 m0, s29, 126976
  s_nop 0
  buffer_load_dwordx4 v35, s[52:55], s15 offen offset:1024 sc1 lds
  ds_read_b64_tr_b16 v[64:65], v20 offset:4096
  ds_read_b64_tr_b16 v[66:67], v20 offset:4608
  s_waitcnt lgkmcnt(4)
  v_mfma_f32_32x32x16_bf16 v[128:143], v[72:75], a[100:103], v[128:143]
  ds_read_b64_tr_b16 v[68:69], v22 offset:4096
  ds_read_b64_tr_b16 v[70:71], v22 offset:4608
  v_mfma_f32_32x32x16_bf16 v[144:159], v[76:79], a[100:103], v[144:159]
  s_add_u32 m0, s29, 126976
  s_nop 0
  buffer_load_dwordx4 v35, s[52:55], s15 offen offset:2048 sc1 lds
  ds_read_b64_tr_b16 v[72:73], v24 offset:4096
  ds_read_b64_tr_b16 v[74:75], v24 offset:4608
  s_waitcnt lgkmcnt(4)
  v_mfma_f32_32x32x16_bf16 v[224:239], v[80:83], a[104:107], v[224:239]
  ds_read_b64_tr_b16 v[76:77], v19 offset:4096
  ds_read_b64_tr_b16 v[78:79], v19 offset:4608
  v_mfma_f32_16x16x32_bf16 v[44:47], v[60:63], v[80:83], v[44:47]
  v_mfma_f32_32x32x16_bf16 v[240:255], v[64:67], a[104:107], v[240:255]
  s_add_u32 m0, s29, 126976
  s_nop 0
  buffer_load_dwordx4 v35, s[52:55], s15 offen offset:3072 sc1 lds
  ds_read_b64_tr_b16 v[80:81], v21 offset:4096
  ds_read_b64_tr_b16 v[82:83], v21 offset:4608
  s_waitcnt lgkmcnt(4)
  v_mfma_f32_32x32x16_bf16 v[128:143], v[68:71], a[104:107], v[128:143]
  ds_read_b64_tr_b16 v[64:65], v23 offset:4096
  ds_read_b64_tr_b16 v[66:67], v23 offset:4608
  v_mfma_f32_32x32x16_bf16 v[144:159], v[72:75], a[104:107], v[144:159]
  s_add_u32 m0, s29, 131072
  s_add_u32 s15, s99, 1970176
  buffer_load_dwordx4 v35, s[52:55], s15 offen offset:0 sc1 lds
  ds_read_b64_tr_b16 v[68:69], v25 offset:4096
  ds_read_b64_tr_b16 v[70:71], v25 offset:4608
  s_waitcnt lgkmcnt(4)
  v_mfma_f32_32x32x16_bf16 v[224:239], v[76:79], a[108:111], v[224:239]
  s_waitcnt vmcnt(23)
  s_barrier
  ds_read_b64_tr_b16 v[72:73], v18 offset:16384
  ds_read_b64_tr_b16 v[74:75], v18 offset:16896
  v_mfma_f32_16x16x32_bf16 v[44:47], v[60:63], v[76:79], v[44:47]
  v_mfma_f32_32x32x16_bf16 v[240:255], v[80:83], a[108:111], v[240:255]
  ds_read_b64_tr_b16 v[76:77], v20 offset:16384
  ds_read_b64_tr_b16 v[78:79], v20 offset:16896
  s_waitcnt lgkmcnt(4)
  v_mfma_f32_32x32x16_bf16 v[128:143], v[64:67], a[108:111], v[128:143]
  ds_read_b64_tr_b16 v[80:81], v22 offset:16384
  ds_read_b64_tr_b16 v[82:83], v22 offset:16896
  v_mfma_f32_32x32x16_bf16 v[144:159], v[68:71], a[108:111], v[144:159]
  ds_read_b64_tr_b16 v[64:65], v24 offset:16384
  ds_read_b64_tr_b16 v[66:67], v24 offset:16896
  s_waitcnt lgkmcnt(4)
  v_mfma_f32_32x32x16_bf16 v[224:239], v[72:75], a[112:115], v[224:239]
  ds_read_b64_tr_b16 v[68:69], v19 offset:16384
  ds_read_b64_tr_b16 v[70:71], v19 offset:16896
  v_mfma_f32_16x16x32_bf16 v[44:47], v[60:63], v[72:75], v[44:47]
  v_mfma_f32_32x32x16_bf16 v[240:255], v[76:79], a[112:115], v[240:255]
  ds_read_b64_tr_b16 v[72:73], v21 offset:16384
  ds_read_b64_tr_b16 v[74:75], v21 offset:16896
  s_waitcnt lgkmcnt(4)
  v_mfma_f32_32x32x16_bf16 v[128:143], v[80:83], a[112:115], v[128:143]
  ds_read_b64_tr_b16 v[76:77], v23 offset:16384
  ds_read_b64_tr_b16 v[78:79], v23 offset:16896
  s_waitcnt vmcnt(8)
  v_cmp_ne_u32 vcc, s61, v84
  s_nop 1
  s_and_b32 vcc_lo, vcc_lo, 0x7ff
  s_cbranch_scc1 L_slow1
L_back1:
  v_mfma_f32_32x32x16_bf16 v[144:159], v[64:67], a[112:115], v[144:159]
  ds_read_b64_tr_b16 v[80:81], v25 offset:16384
  ds_read_b64_tr_b16 v[82:83], v25 offset:16896
  v_bitop3_b32 v2, v125, 8, s61 bitop3:0x6a
  buffer_store_dword v2, v125, s[56:59], s101 offen sc1
  s_waitcnt lgkmcnt(4)
  v_mfma_f32_32x32x16_bf16 v[224:239], v[68:71], a[116:119], v[224:239]
  s_add_u32 s98, s35, 0
  buffer_load_dwordx4 a[160:163], v90, s[48:51], s98 offen sc1
  ds_read_b64_tr_b16 v[64:65], v18 offset:20480
  ds_read_b64_tr_b16 v[66:67], v18 offset:20992
  v_mfma_f32_16x16x32_bf16 v[44:47], v[60:63], v[68:71], v[44:47]
  v_mfma_f32_32x32x16_bf16 v[240:255], v[72:75], a[116:119], v[240:255]
  ds_read_b64_tr_b16 v[68:69], v20 offset:20480
  ds_read_b64_tr_b16 v[70:71], v20 offset:20992
  s_waitcnt lgkmcnt(4)
  v_mfma_f32_32x32x16_bf16 v[128:143], v[76:79], a[116:119], v[128:143]
  buffer_load_dwordx4 a[164:167], v91, s[48:51], s98 offen sc1
  ds_read_b64_tr_b16 v[72:73], v22 offset:20480
  ds_read_b64_tr_b16 v[74:75], v22 offset:20992
  v_mfma_f32_32x32x16_bf16 v[144:159], v[80:83], a[116:119], v[144:159]
  ds_read_b64_tr_b16 v[76:77], v24 offset:20480
  ds_read_b64_tr_b16 v[78:79], v24 offset:20992
  s_waitcnt lgkmcnt(4)
  v_mfma_f32_32x32x16_bf16 v[224:239], v[64:67], a[120:123], v[224:239]
  s_add_u32 s98, s35, 65536
  buffer_load_dwordx4 a[168:171], v90, s[48:51], s98 offen sc1
  ds_read_b64_tr_b16 v[80:81], v19 offset:20480
  ds_read_b64_tr_b16 v[82:83], v19 offset:20992
  v_mfma_f32_16x16x32_bf16 v[44:47], v[60:63], v[64:67], v[44:47]
  v_mfma_f32_32x32x16_bf16 v[240:255], v[68:71], a[120:123], v[240:255]
  ds_read_b64_tr_b16 v[64:65], v21 offset:20480
  ds_read_b64_tr_b16 v[66:67], v21 offset:20992
  s_waitcnt lgkmcnt(4)
  v_mfma_f32_32x32x16_bf16 v[128:143], v[72:75], a[120:123], v[128:143]
  buffer_load_dwordx4 a[172:175], v91, s[48:51], s98 offen sc1
  ds_read_b64_tr_b16 v[68:69], v23 offset:20480
  ds_read_b64_tr_b16 v[70:71], v23 offset:20992
  v_mfma_f32_32x32x16_bf16 v[144:159], v[76:79], a[120:123], v[144:159]
  ds_read_b64_tr_b16 v[72:73], v25 offset:20480
  ds_read_b64_tr_b16 v[74:75], v25 offset:20992
  s_waitcnt lgkmcnt(4)
  v_mfma_f32_32x32x16_bf16 v[224:239], v[80:83], a[124:127], v[224:239]
  s_add_u32 s98, s35, 131072
  buffer_load_dwordx4 a[176:179], v90, s[48:51], s98 offen sc1
  s_barrier
  ds_read_b64_tr_b16 v[76:77], v18 offset:32768
  ds_read_b64_tr_b16 v[78:79], v18 offset:33280
  v_mfma_f32_16x16x32_bf16 v[44:47], v[60:63], v[80:83], v[44:47]
  v_mfma_f32_32x32x16_bf16 v[240:255], v[64:67], a[124:127], v[240:255]
  ds_read_b64_tr_b16 v[80:81], v20 offset:32768
  ds_read_b64_tr_b16 v[82:83], v20 offset:33280
  s_waitcnt lgkmcnt(4)
  v_mfma_f32_32x32x16_bf16 v[128:143], v[68:71], a[124:127], v[128:143]
  buffer_load_dwordx4 a[180:183], v91, s[48:51], s98 offen sc1
  ds_read_b64_tr_b16 v[64:65], v22 offset:32768
  ds_read_b64_tr_b16 v[66:67], v22 offset:33280
  v_mfma_f32_32x32x16_bf16 v[144:159], v[72:75], a[124:127], v[144:159]
  s_add_u32 m0, s29, 0
  s_add_u32 s15, s99, 0
  buffer_load_dwordx4 v35, s[52:55], s15 offen offset:0 sc1 lds
  ds_read_b64_tr_b16 v[68:69], v24 offset:32768
  ds_read_b64_tr_b16 v[70:71], v24 offset:33280
  s_waitcnt lgkmcnt(4)
  v_mfma_f32_32x32x16_bf16 v[224:239], v[76:79], a[128:131], v[224:239]
  s_add_u32 s98, s35, 196608
  buffer_load_dwordx4 a[184:187], v90, s[48:51], s98 offen sc1
  ds_read_b64_tr_b16 v[72:73], v19 offset:32768
  ds_read_b64_tr_b16 v[74:75], v19 offset:33280
  v_mfma_f32_16x16x32_bf16 v[44:47], v[60:63], v[76:79], v[44:47]
  v_mfma_f32_32x32x16_bf16 v[240:255], v[80:83], a[128:131], v[240:255]
  s_add_u32 m0, s29, 0
  s_nop 0
  buffer_load_dwordx4 v35, s[52:55], s15 offen offset:1024 sc1 lds
  ds_read_b64_tr_b16 v[76:77], v21 offset:32768
  ds_read_b64_tr_b16 v[78:79], v21 offset:33280
  s_waitcnt lgkmcnt(4)
  v_mfma_f32_32x32x16_bf16 v[128:143], v[64:67], a[128:131], v[128:143]
  buffer_load_dwordx4 a[188:191], v91, s[48:51], s98 offen sc1
  ds_read_b64_tr_b16 v[80:81], v23 offset:32768
  ds_read_b64_tr_b16 v[82:83], v23 offset:33280
  v_mfma_f32_32x32x16_bf16 v[144:159], v[68:71], a[128:131], v[144:159]
  s_add_u32 m0, s29, 0
  s_nop 0
  buffer_load_dwordx4 v35, s[52:55], s15 offen offset:2048 sc1 lds
  ds_read_b64_tr_b16 v[64:65], v25 offset:32768
  ds_read_b64_tr_b16 v[66:67], v25 offset:33280
  s_waitcnt lgkmcnt(4)
  v_mfma_f32_32x32x16_bf16 v[224:239], v[72:75], a[132:135], v[224:239]
  s_add_u32 s98, s35, 262144
  buffer_load_dwordx4 a[192:195], v90, s[48:51], s98 offen sc1
  ds_read_b64_tr_b16 v[68:69], v18 offset:36864
  ds_read_b64_tr_b16 v[70:71], v18 offset:37376
  v_mfma_f32_16x16x32_bf16 v[44:47], v[60:63], v[72:75], v[44:47]
  v_mfma_f32_32x32x16_bf16 v[240:255], v[76:79], a[132:135], v[240:255]
  s_add_u32 m0, s29, 0
  s_nop 0
  buffer_load_dwordx4 v35, s[52:55], s15 offen offset:3072 sc1 lds
  ds_read_b64_tr_b16 v[72:73], v20 offset:36864
  ds_read_b64_tr_b16 v[74:75], v20 offset:37376
  s_waitcnt lgkmcnt(4)
  v_mfma_f32_32x32x16_bf16 v[128:143], v[80:83], a[132:135], v[128:143]
  buffer_load_dwordx4 a[196:199], v91, s[48:51], s98 offen sc1
  ds_read_b64_tr_b16 v[76:77], v22 offset:36864
  ds_read_b64_tr_b16 v[78:79], v22 offset:37376
  v_mfma_f32_32x32x16_bf16 v[144:159], v[64:67], a[132:135], v[144:159]
  s_add_u32 m0, s29, 4096
  s_add_u32 s15, s99, 4096
  buffer_load_dwordx4 v35, s[52:55], s15 offen offset:0 sc1 lds
  ds_read_b64_tr_b16 v[80:81], v24 offset:36864
  ds_read_b64_tr_b16 v[82:83], v24 offset:37376
  s_waitcnt lgkmcnt(4)
  v_mfma_f32_32x32x16_bf16 v[224:239], v[68:71], a[136:139], v[224:239]
  s_add_u32 s98, s35, 327680
  buffer_load_dwordx4 a[200:203], v90, s[48:51], s98 offen sc1
  ds_read_b64_tr_b16 v[64:65], v19 offset:36864
  ds_read_b64_tr_b16 v[66:67], v19 offset:37376
  v_mfma_f32_16x16x32_bf16 v[44:47], v[60:63], v[68:71], v[44:47]
  v_mfma_f32_32x32x16_bf16 v[240:255], v[72:75], a[136:139], v[240:255]
  ds_read_b64_tr_b16 v[68:69], v21 offset:36864
  ds_read_b64_tr_b16 v[70:71], v21 offset:37376
  s_waitcnt lgkmcnt(4)
  v_mfma_f32_32x32x16_bf16 v[128:143], v[76:79], a[136:139], v[128:143]
  buffer_load_dwordx4 a[204:207], v91, s[48:51], s98 offen sc1
  ds_read_b64_tr_b16 v[72:73], v23 offset:36864
  ds_read_b64_tr_b16 v[74:75], v23 offset:37376
  v_mfma_f32_32x32x16_bf16 v[144:159], v[80:83], a[136:139], v[144:159]
  ds_read_b64_tr_b16 v[76:77], v25 offset:36864
  ds_read_b64_tr_b16 v[78:79], v25 offset:37376
  s_waitcnt lgkmcnt(4)
  v_mfma_f32_32x32x16_bf16 v[224:239], v[64:67], a[140:143], v[224:239]
  s_add_u32 s98, s35, 393216
  buffer_load_dwordx4 a[208:211], v90, s[48:51], s98 offen sc1
  s_waitcnt vmcnt(23)
  s_barrier
  ds_read_b64_tr_b16 v[80:81], v18 offset:49152
  ds_read_b64_tr_b16 v[82:83], v18 offset:49664
  v_mfma_f32_16x16x32_bf16 v[44:47], v[60:63], v[64:67], v[44:47]
  v_mfma_f32_32x32x16_bf16 v[240:255], v[68:71], a[140:143], v[240:255]
  ds_read_b64_tr_b16 v[64:65], v20 offset:49152
  ds_read_b64_tr_b16 v[66:67], v20 offset:49664
  s_waitcnt lgkmcnt(4)
  v_mfma_f32_32x32x16_bf16 v[128:143], v[72:75], a[140:143], v[128:143]
  buffer_load_dwordx4 a[212:215], v91, s[48:51], s98 offen sc1
  ds_read_b64_tr_b16 v[68:69], v22 offset:49152
  ds_read_b64_tr_b16 v[70:71], v22 offset:49664
  v_mfma_f32_32x32x16_bf16 v[144:159], v[76:79], a[140:143], v[144:159]
  s_add_u32 m0, s29, 20480
  s_add_u32 s15, s99, 327680
  buffer_load_dwordx4 v35, s[52:55], s15 offen offset:0 sc1 lds
  ds_read_b64_tr_b16 v[72:73], v24 offset:49152
  ds_read_b64_tr_b16 v[74:75], v24 offset:49664
  s_waitcnt lgkmcnt(4)
  v_mfma_f32_32x32x16_bf16 v[224:239], v[80:83], a[144:147], v[224:239]
  s_add_u32 s98, s35, 458752
  buffer_load_dwordx4 a[216:219], v90, s[48:51], s98 offen sc1
  ds_read_b64_tr_b16 v[76:77], v19 offset:49152
  ds_read_b64_tr_b16 v[78:79], v19 offset:49664
  v_mfma_f32_16x16x32_bf16 v[44:47], v[60:63], v[80:83], v[44:47]
  v_mfma_f32_32x32x16_bf16 v[240:255], v[64:67], a[144:147], v[240:255]
  s_add_u32 m0, s29, 20480
  s_nop 0
  buffer_load_dwordx4 v35, s[52:55], s15 offen offset:1024 sc1 lds
  ds_read_b64_tr_b16 v[80:81], v21 offset:49152
  ds_read_b64_tr_b16 v[82:83], v21 offset:49664
  s_waitcnt lgkmcnt(4)
  v_mfma_f32_32x32x16_bf16 v[128:143], v[68:71], a[144:147], v[128:143]
  buffer_load_dwordx4 a[220:223], v91, s[48:51], s98 offen sc1
  ds_read_b64_tr_b16 v[64:65], v23 offset:49152
  ds_read_b64_tr_b16 v[66:67], v23 offset:49664
  v_mfma_f32_32x32x16_bf16 v[144:159], v[72:75], a[144:147], v[144:159]
  s_add_u32 m0, s29, 20480
  s_nop 0
  buffer_load_dwordx4 v35, s[52:55], s15 offen offset:2048 sc1 lds
  ds_read_b64_tr_b16 v[68:69], v25 offset:49152
  ds_read_b64_tr_b16 v[70:71], v25 offset:49664
  s_waitcnt lgkmcnt(4)
  v_mfma_f32_32x32x16_bf16 v[224:239], v[76:79], a[148:151], v[224:239]
  s_add_u32 s98, s35, 524288
  buffer_load_dwordx4 a[224:227], v90, s[48:51], s98 offen sc1
  ds_read_b64_tr_b16 v[72:73], v18 offset:53248
  ds_read_b64_tr_b16 v[74:75], v18 offset:53760
  v_mfma_f32_16x16x32_bf16 v[44:47], v[60:63], v[76:79], v[44:47]
  v_mfma_f32_32x32x16_bf16 v[240:255], v[80:83], a[148:151], v[240:255]
  s_add_u32 m0, s29, 20480
  s_nop 0
  buffer_load_dwordx4 v35, s[52:55], s15 offen offset:3072 sc1 lds
  ds_read_b64_tr_b16 v[76:77], v20 offset:53248
  ds_read_b64_tr_b16 v[78:79], v20 offset:53760
  s_waitcnt lgkmcnt(4)
  v_mfma_f32_32x32x16_bf16 v[128:143], v[64:67], a[148:151], v[128:143]
  buffer_load_dwordx4 a[228:231], v91, s[48:51], s98 offen sc1
  ds_read_b64_tr_b16 v[80:81], v22 offset:53248
  ds_read_b64_tr_b16 v[82:83], v22 offset:53760
  v_mfma_f32_32x32x16_bf16 v[144:159], v[68:71], a[148:151], v[144:159]
  s_add_u32 m0, s29, 24576
  s_add_u32 s15, s99, 331776
  buffer_load_dwordx4 v35, s[52:55], s15 offen offset:0 sc1 lds
  ds_read_b64_tr_b16 v[64:65], v24 offset:53248
  ds_read_b64_tr_b16 v[66:67], v24 offset:53760
  s_waitcnt lgkmcnt(4)
  v_mfma_f32_32x32x16_bf16 v[224:239], v[72:75], a[152:155], v[224:239]
  s_add_u32 s98, s35, 589824
  buffer_load_dwordx4 a[232:235], v90, s[48:51], s98 offen sc1
  ds_read_b64_tr_b16 v[68:69], v19 offset:53248
  ds_read_b64_tr_b16 v[70:71], v19 offset:53760
  v_mfma_f32_16x16x32_bf16 v[44:47], v[60:63], v[72:75], v[44:47]
  v_mfma_f32_32x32x16_bf16 v[240:255], v[76:79], a[152:155], v[240:255]
  ds_read_b64_tr_b16 v[72:73], v21 offset:53248
  ds_read_b64_tr_b16 v[74:75], v21 offset:53760
  s_waitcnt lgkmcnt(4)
  v_mfma_f32_32x32x16_bf16 v[128:143], v[80:83], a[152:155], v[128:143]
  buffer_load_dwordx4 a[236:239], v91, s[48:51], s98 offen sc1
  ds_read_b64_tr_b16 v[76:77], v23 offset:53248
  ds_read_b64_tr_b16 v[78:79], v23 offset:53760
  v_mfma_f32_32x32x16_bf16 v[144:159], v[64:67], a[152:155], v[144:159]
  ds_read_b64_tr_b16 v[80:81], v25 offset:53248
  ds_read_b64_tr_b16 v[82:83], v25 offset:53760
  s_waitcnt lgkmcnt(4)
  v_mfma_f32_32x32x16_bf16 v[224:239], v[68:71], a[156:159], v[224:239]
  s_add_u32 s98, s35, 655360
  buffer_load_dwordx4 a[240:243], v90, s[48:51], s98 offen sc1
  v_mfma_f32_16x16x32_bf16 v[44:47], v[60:63], v[68:71], v[44:47]
  v_mfma_f32_32x32x16_bf16 v[240:255], v[72:75], a[156:159], v[240:255]
  s_waitcnt lgkmcnt(0)
  v_mfma_f32_32x32x16_bf16 v[128:143], v[76:79], a[156:159], v[128:143]
  buffer_load_dwordx4 a[244:247], v91, s[48:51], s98 offen sc1
  v_mfma_f32_32x32x16_bf16 v[144:159], v[80:83], a[156:159], v[144:159]
  s_nop 2
  v_cvt_pk_bf16_f32 v3, v44, v44
  v_and_b32 v3, 0xffff0000, v3
  v_sub_f32 v5, v44, v3
  v_cvt_pk_bf16_f32 v5, v3, v5
  ds_write2st64_b32 v4, v5, v5 offset0:0 offset1:4
  v_mov_b32 v94, 0
  v_mov_b32 v99, 0
  v_mov_b32 v6, 0
  v_mov_b32 v7, 0
  v_mov_b32 v8, v36
  v_mov_b32 v9, 0
  v_mov_b32 v10, 0
  v_mov_b32 v11, 0
  v_mov_b32 v12, 0
  v_mov_b32 v13, v36
  s_add_u32 s91, s91, 2359296
  s_add_u32 s92, s92, 2359296
  s_add_u32 s93, s93, 2359296
L_pgf4:
  s_cbranch_execz L_pgfr
  s_add_u32 s94, s94, 2359296
  s_waitcnt vmcnt(17)
  s_waitcnt lgkmcnt(0)
  s_barrier
  ds_read2st64_b32 v[100:101], v4 offset0:0 offset1:1
  ds_read2st64_b32 v[102:103], v4 offset0:2 offset1:3
  s_waitcnt lgkmcnt(0)
  v_mfma_f32_32x32x16_bf16 v[224:239], v[100:103], v[92:95], v[224:239]
  v_mfma_f32_32x32x16_bf16 v[240:255], v[100:103], v[96:99], v[240:255]
  v_mfma_f32_32x32x16_bf16 v[128:143], v[100:103], v[6:9], v[128:143]
  v_mfma_f32_32x32x16_bf16 v[144:159], v[100:103], v[10:13], v[144:159]
  s_nop 8
  v_pk_mul_f32 v[108:109], v[224:225], v[224:225]
  v_pk_mul_f32 v[110:111], v[226:227], v[226:227]
  v_pk_fma_f32 v[108:109], v[108:109], v[86:87], v[86:87] op_sel:[0,1,0] op_sel_hi:[1,1,0]
  v_pk_fma_f32 v[110:111], v[110:111], v[86:87], v[86:87] op_sel:[0,1,0] op_sel_hi:[1,1,0]
  v_pk_mul_f32 v[108:109], v[224:225], v[108:109]
  v_pk_mul_f32 v[110:111], v[226:227], v[110:111]
  v_exp_f32 v108, v108
  v_exp_f32 v109, v109
  s_add_u32 m0, s29, 40960
  s_add_u32 s15, s99, 655360
  buffer_load_dwordx4 v35, s[52:55], s15 offen offset:0 sc1 lds
  v_exp_f32 v110, v110
  v_exp_f32 v111, v111
  v_pk_mul_f32 v[232:233], v[224:225], v[232:233]
  v_pk_mul_f32 v[234:235], v[226:227], v[234:235]
  v_pk_fma_f32 v[108:109], v[108:109], v[88:89], v[88:89] op_sel_hi:[1,0,0]
  v_pk_fma_f32 v[110:111], v[110:111], v[88:89], v[88:89] op_sel_hi:[1,0,0]
  v_rcp_f32 v108, v108
  v_rcp_f32 v109, v109
  s_add_u32 m0, s29, 40960
  s_nop 0
  buffer_load_dwordx4 v35, s[52:55], s15 offen offset:1024 sc1 lds
  v_rcp_f32 v110, v110
  v_rcp_f32 v111, v111
  v_pk_mul_f32 v[232:233], v[232:233], v[108:109]
  v_pk_mul_f32 v[234:235], v[234:235], v[110:111]
  v_cvt_pk_bf16_f32 v14, v232, v233
  v_cvt_pk_bf16_f32 v15, v234, v235
  v_pk_mul_f32 v[108:109], v[228:229], v[228:229]
  v_pk_mul_f32 v[110:111], v[230:231], v[230:231]
  s_add_u32 m0, s29, 40960
  s_nop 0
  buffer_load_dwordx4 v35, s[52:55], s15 offen offset:2048 sc1 lds
  v_pk_fma_f32 v[108:109], v[108:109], v[86:87], v[86:87] op_sel:[0,1,0] op_sel_hi:[1,1,0]
  v_pk_fma_f32 v[110:111], v[110:111], v[86:87], v[86:87] op_sel:[0,1,0] op_sel_hi:[1,1,0]
  v_pk_mul_f32 v[108:109], v[228:229], v[108:109]
  v_pk_mul_f32 v[110:111], v[230:231], v[110:111]
  v_exp_f32 v108, v108
  v_exp_f32 v109, v109
  v_exp_f32 v110, v110
  v_exp_f32 v111, v111
  s_add_u32 m0, s29, 40960
  s_nop 0
  buffer_load_dwordx4 v35, s[52:55], s15 offen offset:3072 sc1 lds
  v_pk_mul_f32 v[236:237], v[228:229], v[236:237]
  v_pk_mul_f32 v[238:239], v[230:231], v[238:239]
  v_pk_fma_f32 v[108:109], v[108:109], v[88:89], v[88:89] op_sel_hi:[1,0,0]
  v_pk_fma_f32 v[110:111], v[110:111], v[88:89], v[88:89] op_sel_hi:[1,0,0]
  v_rcp_f32 v108, v108
  v_rcp_f32 v109, v109
  v_rcp_f32 v110, v110
  v_rcp_f32 v111, v111
  s_add_u32 m0, s29, 45056
  s_add_u32 s15, s99, 659456
  buffer_load_dwordx4 v35, s[52:55], s15 offen offset:0 sc1 lds
  v_pk_mul_f32 v[236:237], v[236:237], v[108:109]
  v_pk_mul_f32 v[238:239], v[238:239], v[110:111]
  v_cvt_pk_bf16_f32 v16, v236, v237
  v_cvt_pk_bf16_f32 v17, v238, v239
  v_pk_mul_f32 v[118:119], v[240:241], v[240:241]
  v_pk_mul_f32 v[120:121], v[242:243], v[242:243]
  v_pk_fma_f32 v[118:119], v[118:119], v[86:87], v[86:87] op_sel:[0,1,0] op_sel_hi:[1,1,0]
  v_pk_fma_f32 v[120:121], v[120:121], v[86:87], v[86:87] op_sel:[0,1,0] op_sel_hi:[1,1,0]
  s_mov_b64 exec, 0xffff
  buffer_load_dword v84, v85, s[56:59], 0 offen offset:4 sc1
  s_mov_b64 exec, -1
  v_pk_mul_f32 v[118:119], v[240:241], v[118:119]
  v_pk_mul_f32 v[120:121], v[242:243], v[120:121]
  v_exp_f32 v118, v118
  v_exp_f32 v119, v119
  v_exp_f32 v120, v120
  v_exp_f32 v121, v121
  v_pk_mul_f32 v[248:249], v[240:241], v[248:249]
  v_pk_mul_f32 v[250:251], v[242:243], v[250:251]
  v_pk_fma_f32 v[118:119], v[118:119], v[88:89], v[88:89] op_sel_hi:[1,0,0]
  v_pk_fma_f32 v[120:121], v[120:121], v[88:89], v[88:89] op_sel_hi:[1,0,0]
  v_rcp_f32 v118, v118
  v_rcp_f32 v119, v119
  v_rcp_f32 v120, v120
  v_rcp_f32 v121, v121
  v_pk_mul_f32 v[248:249], v[248:249], v[118:119]
  v_pk_mul_f32 v[250:251], v[250:251], v[120:121]
  v_cvt_pk_bf16_f32 v18, v248, v249
  v_cvt_pk_bf16_f32 v19, v250, v251
  v_pk_mul_f32 v[118:119], v[244:245], v[244:245]
  v_pk_mul_f32 v[120:121], v[246:247], v[246:247]
  v_pk_fma_f32 v[118:119], v[118:119], v[86:87], v[86:87] op_sel:[0,1,0] op_sel_hi:[1,1,0]
  v_pk_fma_f32 v[120:121], v[120:121], v[86:87], v[86:87] op_sel:[0,1,0] op_sel_hi:[1,1,0]
  v_pk_mul_f32 v[118:119], v[244:245], v[118:119]
  v_pk_mul_f32 v[120:121], v[246:247], v[120:121]
  v_exp_f32 v118, v118
  v_exp_f32 v119, v119
  v_exp_f32 v120, v120
  v_exp_f32 v121, v121
  v_pk_mul_f32 v[252:253], v[244:245], v[252:253]
  v_pk_mul_f32 v[254:255], v[246:247], v[254:255]
  v_pk_fma_f32 v[118:119], v[118:119], v[88:89], v[88:89] op_sel_hi:[1,0,0]
  v_pk_fma_f32 v[120:121], v[120:121], v[88:89], v[88:89] op_sel_hi:[1,0,0]
  v_rcp_f32 v118, v118
  v_rcp_f32 v119, v119
  v_rcp_f32 v120, v120
  v_rcp_f32 v121, v121
  v_pk_mul_f32 v[252:253], v[252:253], v[118:119]
  v_pk_mul_f32 v[254:255], v[254:255], v[120:121]
  v_cvt_pk_bf16_f32 v20, v252, v253
  v_cvt_pk_bf16_f32 v21, v254, v255
  v_pk_mul_f32 v[108:109], v[128:129], v[128:129]
  v_pk_mul_f32 v[110:111], v[130:131], v[130:131]
  v_pk_fma_f32 v[108:109], v[108:109], v[86:87], v[86:87] op_sel:[0,1,0] op_sel_hi:[1,1,0]
  v_pk_fma_f32 v[110:111], v[110:111], v[86:87], v[86:87] op_sel:[0,1,0] op_sel_hi:[1,1,0]
  v_pk_mul_f32 v[108:109], v[128:129], v[108:109]
  v_pk_mul_f32 v[110:111], v[130:131], v[110:111]
  v_exp_f32 v108, v108
  v_exp_f32 v109, v109
  v_exp_f32 v110, v110
  v_exp_f32 v111, v111
  v_pk_mul_f32 v[136:137], v[128:129], v[136:137]
  v_pk_mul_f32 v[138:139], v[130:131], v[138:139]
  v_pk_fma_f32 v[108:109], v[108:109], v[88:89], v[88:89] op_sel_hi:[1,0,0]
  v_pk_fma_f32 v[110:111], v[110:111], v[88:89], v[88:89] op_sel_hi:[1,0,0]
  v_rcp_f32 v108, v108
  v_rcp_f32 v109, v109
  v_rcp_f32 v110, v110
  v_rcp_f32 v111, v111
  v_pk_mul_f32 v[136:137], v[136:137], v[108:109]
  v_pk_mul_f32 v[138:139], v[138:139], v[110:111]
  v_cvt_pk_bf16_f32 v22, v136, v137
  v_cvt_pk_bf16_f32 v23, v138, v139
  v_pk_mul_f32 v[108:109], v[132:133], v[132:133]
  v_pk_mul_f32 v[110:111], v[134:135], v[134:135]
  v_pk_fma_f32 v[108:109], v[108:109], v[86:87], v[86:87] op_sel:[0,1,0] op_sel_hi:[1,1,0]
  v_pk_fma_f32 v[110:111], v[110:111], v[86:87], v[86:87] op_sel:[0,1,0] op_sel_hi:[1,1,0]
  v_pk_mul_f32 v[108:109], v[132:133], v[108:109]
  v_pk_mul_f32 v[110:111], v[134:135], v[110:111]
  v_exp_f32 v108, v108
  v_exp_f32 v109, v109
  v_exp_f32 v110, v110
  v_exp_f32 v111, v111
  v_pk_mul_f32 v[140:141], v[132:133], v[140:141]
  v_pk_mul_f32 v[142:143], v[134:135], v[142:143]
  v_pk_fma_f32 v[108:109], v[108:109], v[88:89], v[88:89] op_sel_hi:[1,0,0]
  v_pk_fma_f32 v[110:111], v[110:111], v[88:89], v[88:89] op_sel_hi:[1,0,0]
  v_rcp_f32 v108, v108
  v_rcp_f32 v109, v109
  v_rcp_f32 v110, v110
  v_rcp_f32 v111, v111
  v_pk_mul_f32 v[140:141], v[140:141], v[108:109]
  v_pk_mul_f32 v[142:143], v[142:143], v[110:111]
  v_cvt_pk_bf16_f32 v24, v140, v141
  v_cvt_pk_bf16_f32 v25, v142, v143
  v_pk_mul_f32 v[118:119], v[144:145], v[144:145]
  v_pk_mul_f32 v[120:121], v[146:147], v[146:147]
  v_pk_fma_f32 v[118:119], v[118:119], v[86:87], v[86:87] op_sel:[0,1,0] op_sel_hi:[1,1,0]
  v_pk_fma_f32 v[120:121], v[120:121], v[86:87], v[86:87] op_sel:[0,1,0] op_sel_hi:[1,1,0]
  v_pk_mul_f32 v[118:119], v[144:145], v[118:119]
  v_pk_mul_f32 v[120:121], v[146:147], v[120:121]
  v_exp_f32 v118, v118
  v_exp_f32 v119, v119
  v_exp_f32 v120, v120
  v_exp_f32 v121, v121
  v_pk_mul_f32 v[152:153], v[144:145], v[152:153]
  v_pk_mul_f32 v[154:155], v[146:147], v[154:155]
  v_pk_fma_f32 v[118:119], v[118:119], v[88:89], v[88:89] op_sel_hi:[1,0,0]
  v_pk_fma_f32 v[120:121], v[120:121], v[88:89], v[88:89] op_sel_hi:[1,0,0]
  v_rcp_f32 v118, v118
  v_rcp_f32 v119, v119
  v_rcp_f32 v120, v120
  v_rcp_f32 v121, v121
  v_pk_mul_f32 v[152:153], v[152:153], v[118:119]
  v_pk_mul_f32 v[154:155], v[154:155], v[120:121]
  v_cvt_pk_bf16_f32 v26, v152, v153
  v_cvt_pk_bf16_f32 v27, v154, v155
  v_pk_mul_f32 v[118:119], v[148:149], v[148:149]
  v_pk_mul_f32 v[120:121], v[150:151], v[150:151]
  v_pk_fma_f32 v[118:119], v[118:119], v[86:87], v[86:87] op_sel:[0,1,0] op_sel_hi:[1,1,0]
  v_pk_fma_f32 v[120:121], v[120:121], v[86:87], v[86:87] op_sel:[0,1,0] op_sel_hi:[1,1,0]
  v_pk_mul_f32 v[118:119], v[148:149], v[118:119]
  v_pk_mul_f32 v[120:121], v[150:151], v[120:121]
  v_exp_f32 v118, v118
  v_exp_f32 v119, v119
  v_exp_f32 v120, v120
  v_exp_f32 v121, v121
  v_pk_mul_f32 v[156:157], v[148:149], v[156:157]
  v_pk_mul_f32 v[158:159], v[150:151], v[158:159]
  v_pk_fma_f32 v[118:119], v[118:119], v[88:89], v[88:89] op_sel_hi:[1,0,0]
  v_pk_fma_f32 v[120:121], v[120:121], v[88:89], v[88:89] op_sel_hi:[1,0,0]
  v_rcp_f32 v118, v118
  v_rcp_f32 v119, v119
  v_rcp_f32 v120, v120
  v_rcp_f32 v121, v121
  v_pk_mul_f32 v[156:157], v[156:157], v[118:119]
  v_pk_mul_f32 v[158:159], v[158:159], v[120:121]
  v_cvt_pk_bf16_f32 v28, v156, v157
  v_cvt_pk_bf16_f32 v29, v158, v159
  buffer_store_dwordx4 v[14:17], v34, s[48:51], s91 offen sc1
  buffer_store_dwordx4 v[18:21], v34, s[48:51], s92 offen sc1
  buffer_store_dwordx4 v[22:25], v34, s[48:51], s93 offen sc1
  buffer_store_dwordx4 v[26:29], v34, s[48:51], s94 offen sc1
  v_add_u32 v37, 65536, v35
  v_add_u32 v38, 131072, v35
  ds_read_b128 v[128:131], v35 offset:0
  ds_read_b128 v[132:135], v35 offset:1024
  ds_read_b128 v[136:139], v35 offset:2048
  ds_read_b128 v[140:143], v35 offset:3072
  ds_read_b128 v[144:147], v35 offset:4096
  s_waitcnt lgkmcnt(4)
  v_mfma_f32_16x16x32_bf16 v[216:219], v[128:131], a[160:163], 0
  ds_read_b128 v[148:151], v35 offset:5120
  v_mfma_f32_16x16x32_bf16 v[220:223], v[128:131], a[164:167], 0
  v_bfe_u32 v40, v1, 2, 2
  s_waitcnt lgkmcnt(4)
  v_mfma_f32_16x16x32_bf16 v[224:227], v[132:135], a[160:163], 0
  ds_read_b128 v[152:155], v35 offset:6144
  v_sub_u32 v40, 0, v40
  s_lshl2_add_u32 s83, s30, s82
  s_lshl1_add_u32 s83, s83, s28
  s_lshl_b32 s5, s83, 8
  v_mfma_f32_16x16x32_bf16 v[228:231], v[132:135], a[164:167], 0
  v_lshrrev_b32 v41, 4, v1
  s_add_u32 s5, s5, 6899712
  s_mul_i32 s3, s83, 20480
  s_and_b32 s4, s34, 7
  s_waitcnt lgkmcnt(4)
  v_mfma_f32_16x16x32_bf16 v[232:235], v[136:139], a[160:163], 0
  ds_read_b128 v[156:159], v35 offset:7168
  v_xor_b32 v40, v40, v41
  s_mul_i32 s4, s4, 160
  s_add_u32 s3, s3, s4
  v_lshrrev_b32 v73, 2, v1
  v_mfma_f32_16x16x32_bf16 v[236:239], v[136:139], a[164:167], 0
  s_waitcnt vmcnt(4)
  v_cmp_ne_u32 vcc, s61, v84
  s_nop 1
  s_and_b32 vcc_lo, vcc_lo, 0x7ff
  s_cbranch_scc1 L_slow3
L_back3:
  v_and_b32 v74, 3, v1
  v_lshlrev_b32 v46, 4, v73
  v_mul_u32_u24 v36, 1280, v73
  s_waitcnt lgkmcnt(4)
  v_mfma_f32_16x16x32_bf16 v[240:243], v[140:143], a[160:163], 0
  ds_read_b128 v[160:163], v35 offset:8192
  v_and_b32 v40, 3, v40
  v_lshl_add_u32 v36, v74, 3, v36
  v_add_lshl_u32 v36, v36, s3, 1
  v_mfma_f32_16x16x32_bf16 v[244:247], v[140:143], a[164:167], 0
  s_add_u32 s98, s35, 720896
  buffer_load_dwordx4 a[248:251], v90, s[48:51], s98 offen sc1
  s_lshl_b32 s84, s82, 12
  s_add_u32 s89, s84, 147456
  s_waitcnt lgkmcnt(4)
  v_mfma_f32_16x16x32_bf16 v[248:251], v[144:147], a[160:163], 0
  ds_read_b128 v[164:167], v35 offset:9216
  v_and_b32 v41, 15, v1
  v_lshl_add_u32 v72, v74, 3, s89
  v_mul_u32_u24 v71, 160, v73
  v_mfma_f32_16x16x32_bf16 v[252:255], v[144:147], a[164:167], 0
  buffer_load_dwordx4 a[0:3], v91, s[48:51], s98 offen sc1
  v_add_u32 v71, v71, v72
  v_add_u32 v68, 0, v1
  s_waitcnt lgkmcnt(4)
  v_mfma_f32_16x16x32_bf16 v[216:219], v[148:151], a[168:171], v[216:219]
  ds_read_b128 v[128:131], v35 offset:10240
  v_lshl_add_u32 v40, v41, 2, v40
  v_mul_u32_u24 v68, 205, v68
  v_lshrrev_b32 v68, 11, v68
  v_mfma_f32_16x16x32_bf16 v[220:223], v[148:151], a[172:175], v[220:223]
  s_add_u32 s98, s35, 786432
  buffer_load_dwordx4 a[4:7], v90, s[48:51], s98 offen sc1
  v_mul_u32_u24 v68, 1120, v68
  v_add_u32 v68, v68, v35
  s_waitcnt lgkmcnt(4)
  v_mfma_f32_16x16x32_bf16 v[224:227], v[152:155], a[168:171], v[224:227]
  ds_read_b128 v[132:135], v35 offset:11264
  v_lshlrev_b32 v40, 4, v40
  v_add_u32 v69, 64, v1
  v_mul_u32_u24 v69, 205, v69
  v_mfma_f32_16x16x32_bf16 v[228:231], v[152:155], a[172:175], v[228:231]
  buffer_load_dwordx4 a[8:11], v91, s[48:51], s98 offen sc1
  v_lshrrev_b32 v69, 11, v69
  v_mul_u32_u24 v69, 1120, v69
  s_waitcnt lgkmcnt(4)
  v_mfma_f32_16x16x32_bf16 v[232:235], v[156:159], a[168:171], v[232:235]
  ds_read_b128 v[136:139], v35 offset:12288
  v_add_u32 v41, 65536, v40
  v_add_u32 v69, v69, v35
  v_add_u32 v70, 128, v1
  v_mfma_f32_16x16x32_bf16 v[236:239], v[156:159], a[172:175], v[236:239]
  s_add_u32 s98, s35, 851968
  buffer_load_dwordx4 a[12:15], v90, s[48:51], s98 offen sc1
  v_mul_u32_u24 v70, 205, v70
  v_lshrrev_b32 v70, 11, v70
  s_waitcnt lgkmcnt(4)
  v_mfma_f32_16x16x32_bf16 v[240:243], v[160:163], a[168:171], v[240:243]
  ds_read_b128 v[140:143], v35 offset:13312
  v_add_u32 v42, 131072, v40
  v_mul_u32_u24 v70, 1120, v70
  v_add_u32 v70, v70, v35
  v_mfma_f32_16x16x32_bf16 v[244:247], v[160:163], a[172:175], v[244:247]
  buffer_load_dwordx4 a[16:19], v91, s[48:51], s98 offen sc1
  s_mov_b32 s72, s24
  s_and_b32 s73, s25, 0xffff
  s_waitcnt lgkmcnt(4)
  v_mfma_f32_16x16x32_bf16 v[248:251], v[164:167], a[168:171], v[248:251]
  ds_read_b128 v[144:147], v35 offset:14336
  s_mov_b32 s74, 1280
  s_mov_b32 s75, 0x20000
  v_mfma_f32_16x16x32_bf16 v[252:255], v[164:167], a[172:175], v[252:255]
  s_add_u32 s98, s35, 917504
  buffer_load_dwordx4 a[20:23], v90, s[48:51], s98 offen sc1
  s_mul_i32 s12, s82, 10240
  s_add_u32 s12, s12, 106496
  s_waitcnt lgkmcnt(4)
  v_mfma_f32_16x16x32_bf16 v[216:219], v[128:131], a[176:179], v[216:219]
  ds_read_b128 v[148:151], v35 offset:15360
  v_lshrrev_b32 v45, 4, v1
  v_and_b32 v44, 3, v73
  v_mfma_f32_16x16x32_bf16 v[220:223], v[128:131], a[180:183], v[220:223]
  v_xor_b32 v43, v45, v44
  v_lshl_add_u32 v43, v44, 2, v43
  s_waitcnt lgkmcnt(4)
  v_mfma_f32_16x16x32_bf16 v[224:227], v[132:135], a[176:179], v[224:227]
  ds_read_b128 v[152:155], v35 offset:16384
  v_lshl_add_u32 v43, v43, 2, v74
  v_xor_b32 v73, v45, v74
  v_mfma_f32_16x16x32_bf16 v[228:231], v[132:135], a[180:183], v[228:231]
  buffer_load_dwordx4 a[24:27], v91, s[48:51], s98 offen sc1
  v_lshl_add_u32 v45, v45, 2, v73
  v_lshl_add_u32 v45, v45, 2, v44
  s_waitcnt lgkmcnt(4)
  v_mfma_f32_16x16x32_bf16 v[232:235], v[136:139], a[176:179], v[232:235]
  ds_read_b128 v[156:159], v35 offset:17408
  v_lshlrev_b32 v43, 4, v43
  v_add_u32 v44, s12, v43
  v_mfma_f32_16x16x32_bf16 v[236:239], v[136:139], a[180:183], v[236:239]
  v_lshl_add_u32 v45, v45, 4, s12
  s_lshl_b32 s83, s30, 4
  s_waitcnt lgkmcnt(4)
  v_mfma_f32_16x16x32_bf16 v[240:243], v[140:143], a[176:179], v[240:243]
  ds_read_b128 v[160:163], v35 offset:18432
  s_add_u32 s83, s83, s34
  s_lshl_b32 s83, s83, 2
  v_mfma_f32_16x16x32_bf16 v[244:247], v[140:143], a[180:183], v[244:247]
  s_add_u32 s83, s83, s82
  s_mul_i32 s87, s83, 5120
  s_waitcnt lgkmcnt(4)
  v_mfma_f32_16x16x32_bf16 v[248:251], v[144:147], a[176:179], v[248:251]
  ds_read_b128 v[164:167], v35 offset:19456
  s_add_u32 s87, s87, 786432
  s_xor_b32 s83, s83, 32
  v_mfma_f32_16x16x32_bf16 v[252:255], v[144:147], a[180:183], v[252:255]
  s_add_u32 s98, s35, 983040
  buffer_load_dwordx4 a[28:31], v90, s[48:51], s98 offen sc1
  s_mul_i32 s88, s83, 5120
  s_add_u32 s88, s88, 786432
  s_waitcnt lgkmcnt(4)
  v_mfma_f32_16x16x32_bf16 v[216:219], v[148:151], a[184:187], v[216:219]
  s_barrier
  ds_read_b128 v[128:131], v35 offset:20480
  s_add_u32 s62, s87, 4096
  s_add_u32 s63, s88, 4096
  v_mfma_f32_16x16x32_bf16 v[220:223], v[148:151], a[188:191], v[220:223]
  s_lshr_b32 s69, s61, 8
  s_lshr_b32 s70, s61, 16
  s_waitcnt lgkmcnt(4)
  v_mfma_f32_16x16x32_bf16 v[224:227], v[152:155], a[184:187], v[224:227]
  ds_read_b128 v[132:135], v35 offset:21504
  s_lshr_b32 s71, s61, 24
  s_mov_b32 s68, s61
  v_mfma_f32_16x16x32_bf16 v[228:231], v[152:155], a[188:191], v[228:231]
  buffer_load_dwordx4 a[32:35], v91, s[48:51], s98 offen sc1
  v_mov_b32 v39, 0xff
  s_min_u32 s7, s2, 1
  s_waitcnt lgkmcnt(4)
  v_mfma_f32_16x16x32_bf16 v[232:235], v[156:159], a[184:187], v[232:235]
  ds_read_b128 v[136:139], v35 offset:22528
  s_mul_i32 s7, s7, 2130706432
  s_or_b32 s7, s7, s6
  v_mfma_f32_16x16x32_bf16 v[236:239], v[156:159], a[188:191], v[236:239]
  v_and_b32 v208, 15, v1
  v_lshlrev_b32 v208, 7, v208
  s_waitcnt lgkmcnt(4)
  v_mfma_f32_16x16x32_bf16 v[240:243], v[160:163], a[184:187], v[240:243]
  ds_read_b128 v[140:143], v35 offset:23552
  v_lshrrev_b32 v209, 4, v1
  v_lshl_add_u32 v208, v209, 13, v208
  v_mfma_f32_16x16x32_bf16 v[244:247], v[160:163], a[188:191], v[244:247]
  s_waitcnt lgkmcnt(4)
  v_mfma_f32_16x16x32_bf16 v[248:251], v[164:167], a[184:187], v[248:251]
  ds_read_b128 v[144:147], v35 offset:24576
  v_mfma_f32_16x16x32_bf16 v[252:255], v[164:167], a[188:191], v[252:255]
  s_add_u32 m0, s29, 0
  s_add_u32 s15, s99, 2293760
  buffer_load_dwordx4 v35, s[52:55], s15 offen offset:0 sc1 lds
  s_waitcnt lgkmcnt(4)
  v_mfma_f32_16x16x32_bf16 v[216:219], v[128:131], a[192:195], v[216:219]
  ds_read_b128 v[148:151], v35 offset:25600
  s_mov_b32 m0, s89
  s_nop 0
  buffer_load_dwordx4 v68, s[40:43], s3 offen offset:0 lds
  v_mfma_f32_16x16x32_bf16 v[220:223], v[128:131], a[196:199], v[220:223]
  s_mov_b64 exec, 0xffff
  buffer_load_dword v84, v85, s[56:59], 0 offen offset:4 sc1
  s_mov_b64 exec, -1
  s_waitcnt lgkmcnt(4)
  v_mfma_f32_16x16x32_bf16 v[224:227], v[132:135], a[192:195], v[224:227]
  ds_read_b128 v[152:155], v35 offset:26624
  s_mov_b32 m0, s89
  s_nop 0
  buffer_load_dwordx4 v69, s[40:43], s3 offen offset:1024 lds
  v_mfma_f32_16x16x32_bf16 v[228:231], v[132:135], a[196:199], v[228:231]
  s_waitcnt lgkmcnt(4)
  v_mfma_f32_16x16x32_bf16 v[232:235], v[136:139], a[192:195], v[232:235]
  ds_read_b128 v[156:159], v35 offset:27648
  s_mov_b32 m0, s89
  s_mov_b32 exec_hi, 0
  buffer_load_dwordx4 v70, s[40:43], s3 offen offset:2048 lds
  s_mov_b32 exec_hi, -1
  v_mfma_f32_16x16x32_bf16 v[236:239], v[136:139], a[196:199], v[236:239]
  s_add_u32 m0, s29, 0
  s_nop 0
  buffer_load_dwordx4 v35, s[52:55], s15 offen offset:1024 sc1 lds
  s_waitcnt lgkmcnt(4)
  v_mfma_f32_16x16x32_bf16 v[240:243], v[140:143], a[192:195], v[240:243]
  ds_read_b128 v[160:163], v35 offset:28672
  s_add_u32 m0, s89, 3072
  s_mov_b64 exec, 0x3ff
  buffer_load_dwordx4 v35, s[72:75], s4 offen lds
  s_mov_b64 exec, -1
  v_mfma_f32_16x16x32_bf16 v[244:247], v[140:143], a[196:199], v[244:247]
  s_waitcnt lgkmcnt(4)
  v_mfma_f32_16x16x32_bf16 v[248:251], v[144:147], a[192:195], v[248:251]
  ds_read_b128 v[164:167], v35 offset:29696
  buffer_load_dwordx2 v[46:47], v46, s[56:59], s5 offen sc1
  v_mfma_f32_16x16x32_bf16 v[252:255], v[144:147], a[196:199], v[252:255]
  s_waitcnt lgkmcnt(4)
  v_mfma_f32_16x16x32_bf16 v[216:219], v[148:151], a[200:203], v[216:219]
  ds_read_b128 v[128:131], v35 offset:30720
  v_mfma_f32_16x16x32_bf16 v[220:223], v[148:151], a[204:207], v[220:223]
  s_add_u32 m0, s29, 0
  s_nop 0
  buffer_load_dwordx4 v35, s[52:55], s15 offen offset:2048 sc1 lds
  s_waitcnt lgkmcnt(4)
  v_mfma_f32_16x16x32_bf16 v[224:227], v[152:155], a[200:203], v[224:227]
  ds_read_b128 v[132:135], v35 offset:31744
  v_mfma_f32_16x16x32_bf16 v[228:231], v[152:155], a[204:207], v[228:231]
  s_waitcnt lgkmcnt(4)
  v_mfma_f32_16x16x32_bf16 v[232:235], v[156:159], a[200:203], v[232:235]
  ds_read_b128 v[136:139], v35 offset:32768
  v_mfma_f32_16x16x32_bf16 v[236:239], v[156:159], a[204:207], v[236:239]
  s_add_u32 m0, s29, 0
  s_nop 0
  buffer_load_dwordx4 v35, s[52:55], s15 offen offset:3072 sc1 lds
  s_waitcnt lgkmcnt(4)
  v_mfma_f32_16x16x32_bf16 v[240:243], v[160:163], a[200:203], v[240:243]
  ds_read_b128 v[140:143], v35 offset:33792
  v_mfma_f32_16x16x32_bf16 v[244:247], v[160:163], a[204:207], v[244:247]
  s_waitcnt lgkmcnt(4)
  v_mfma_f32_16x16x32_bf16 v[248:251], v[164:167], a[200:203], v[248:251]
  ds_read_b128 v[144:147], v35 offset:34816
  v_mfma_f32_16x16x32_bf16 v[252:255], v[164:167], a[204:207], v[252:255]
  s_add_u32 m0, s29, 4096
  s_add_u32 s15, s99, 2297856
  buffer_load_dwordx4 v35, s[52:55], s15 offen offset:0 sc1 lds
  s_waitcnt lgkmcnt(4)
  v_mfma_f32_16x16x32_bf16 v[216:219], v[128:131], a[208:211], v[216:219]
  ds_read_b128 v[148:151], v35 offset:35840
  v_mfma_f32_16x16x32_bf16 v[220:223], v[128:131], a[212:215], v[220:223]
  s_waitcnt lgkmcnt(4)
  v_mfma_f32_16x16x32_bf16 v[224:227], v[132:135], a[208:211], v[224:227]
  ds_read_b128 v[152:155], v35 offset:36864
  v_mfma_f32_16x16x32_bf16 v[228:231], v[132:135], a[212:215], v[228:231]
  s_waitcnt lgkmcnt(4)
  v_mfma_f32_16x16x32_bf16 v[232:235], v[136:139], a[208:211], v[232:235]
  ds_read_b128 v[156:159], v35 offset:37888
  v_mfma_f32_16x16x32_bf16 v[236:239], v[136:139], a[212:215], v[236:239]
  s_waitcnt lgkmcnt(4)
  v_mfma_f32_16x16x32_bf16 v[240:243], v[140:143], a[208:211], v[240:243]
  ds_read_b128 v[160:163], v35 offset:38912
  v_mfma_f32_16x16x32_bf16 v[244:247], v[140:143], a[212:215], v[244:247]
  s_waitcnt lgkmcnt(4)
  v_mfma_f32_16x16x32_bf16 v[248:251], v[144:147], a[208:211], v[248:251]
  ds_read_b128 v[164:167], v35 offset:39936
  v_mfma_f32_16x16x32_bf16 v[252:255], v[144:147], a[212:215], v[252:255]
  s_waitcnt lgkmcnt(4)
  v_mfma_f32_16x16x32_bf16 v[216:219], v[148:151], a[216:219], v[216:219]
  s_barrier
  ds_read_b128 v[128:131], v35 offset:40960
  v_mfma_f32_16x16x32_bf16 v[220:223], v[148:151], a[220:223], v[220:223]
  s_waitcnt lgkmcnt(4)
  v_mfma_f32_16x16x32_bf16 v[224:227], v[152:155], a[216:219], v[224:227]
  ds_read_b128 v[132:135], v35 offset:41984
  v_mfma_f32_16x16x32_bf16 v[228:231], v[152:155], a[220:223], v[228:231]
  s_add_u32 m0, s29, 20480
  s_add_u32 s15, s99, 2621440
  buffer_load_dwordx4 v35, s[52:55], s15 offen offset:0 sc1 lds
  s_waitcnt lgkmcnt(4)
  v_mfma_f32_16x16x32_bf16 v[232:235], v[156:159], a[216:219], v[232:235]
  ds_read_b128 v[136:139], v35 offset:43008
  v_mfma_f32_16x16x32_bf16 v[236:239], v[156:159], a[220:223], v[236:239]
  s_add_u32 m0, s29, 20480
  s_nop 0
  buffer_load_dwordx4 v35, s[52:55], s15 offen offset:1024 sc1 lds
  s_waitcnt lgkmcnt(4)
  v_mfma_f32_16x16x32_bf16 v[240:243], v[160:163], a[216:219], v[240:243]
  ds_read_b128 v[140:143], v35 offset:44032
  v_mfma_f32_16x16x32_bf16 v[244:247], v[160:163], a[220:223], v[244:247]
  s_add_u32 m0, s29, 20480
  s_nop 0
  buffer_load_dwordx4 v35, s[52:55], s15 offen offset:2048 sc1 lds
  s_waitcnt lgkmcnt(4)
  v_mfma_f32_16x16x32_bf16 v[248:251], v[164:167], a[216:219], v[248:251]
  ds_read_b128 v[144:147], v35 offset:45056
  v_mfma_f32_16x16x32_bf16 v[252:255], v[164:167], a[220:223], v[252:255]
  s_add_u32 m0, s29, 20480
  s_nop 0
  buffer_load_dwordx4 v35, s[52:55], s15 offen offset:3072 sc1 lds
  s_waitcnt lgkmcnt(4)
  v_mfma_f32_16x16x32_bf16 v[216:219], v[128:131], a[224:227], v[216:219]
  ds_read_b128 v[148:151], v35 offset:46080
  v_mfma_f32_16x16x32_bf16 v[220:223], v[128:131], a[228:231], v[220:223]
  s_waitcnt vmcnt(12)
  v_cmp_ne_u32 vcc, s61, v84
  s_nop 1
  s_and_b32 vcc_lo, vcc_lo, 0xf800
  s_cbranch_scc1 L_slow2
L_back2:
  s_waitcnt lgkmcnt(4)
  v_mfma_f32_16x16x32_bf16 v[224:227], v[132:135], a[224:227], v[224:227]
  ds_read_b128 v[152:155], v35 offset:47104
  v_mfma_f32_16x16x32_bf16 v[228:231], v[132:135], a[228:231], v[228:231]
  s_add_u32 s98, s35, 1048576
  buffer_load_dwordx4 a[36:39], v90, s[48:51], s98 offen sc1
  s_waitcnt lgkmcnt(4)
  v_mfma_f32_16x16x32_bf16 v[232:235], v[136:139], a[224:227], v[232:235]
  ds_read_b128 v[156:159], v35 offset:48128
  v_mfma_f32_16x16x32_bf16 v[236:239], v[136:139], a[228:231], v[236:239]
  v_mov_b32 v2, s61
  buffer_store_dword v2, v125, s[56:59], s101 offen sc1
  s_waitcnt lgkmcnt(4)
  v_mfma_f32_16x16x32_bf16 v[240:243], v[140:143], a[224:227], v[240:243]
  ds_read_b128 v[160:163], v35 offset:49152
  v_mfma_f32_16x16x32_bf16 v[244:247], v[140:143], a[228:231], v[244:247]
  s_waitcnt lgkmcnt(4)
  v_mfma_f32_16x16x32_bf16 v[248:251], v[144:147], a[224:227], v[248:251]
  ds_read_b128 v[164:167], v35 offset:50176
  v_mfma_f32_16x16x32_bf16 v[252:255], v[144:147], a[228:231], v[252:255]
  buffer_load_dwordx4 a[40:43], v91, s[48:51], s98 offen sc1
  s_waitcnt lgkmcnt(4)
  v_mfma_f32_16x16x32_bf16 v[216:219], v[148:151], a[232:235], v[216:219]
  ds_read_b128 v[128:131], v35 offset:51200
  v_mfma_f32_16x16x32_bf16 v[220:223], v[148:151], a[236:239], v[220:223]
  s_waitcnt lgkmcnt(4)
  v_mfma_f32_16x16x32_bf16 v[224:227], v[152:155], a[232:235], v[224:227]
  ds_read_b128 v[132:135], v35 offset:52224
  v_mfma_f32_16x16x32_bf16 v[228:231], v[152:155], a[236:239], v[228:231]
  s_add_u32 s98, s35, 1114112
  buffer_load_dwordx4 a[44:47], v90, s[48:51], s98 offen sc1
  s_waitcnt lgkmcnt(4)
  v_mfma_f32_16x16x32_bf16 v[232:235], v[156:159], a[232:235], v[232:235]
  ds_read_b128 v[136:139], v35 offset:53248
  v_mfma_f32_16x16x32_bf16 v[236:239], v[156:159], a[236:239], v[236:239]
  s_waitcnt lgkmcnt(4)
  v_mfma_f32_16x16x32_bf16 v[240:243], v[160:163], a[232:235], v[240:243]
  ds_read_b128 v[140:143], v35 offset:54272
  v_mfma_f32_16x16x32_bf16 v[244:247], v[160:163], a[236:239], v[244:247]
  buffer_load_dwordx4 a[48:51], v91, s[48:51], s98 offen sc1
  s_waitcnt lgkmcnt(4)
  v_mfma_f32_16x16x32_bf16 v[248:251], v[164:167], a[232:235], v[248:251]
  ds_read_b128 v[144:147], v35 offset:55296
  v_mfma_f32_16x16x32_bf16 v[252:255], v[164:167], a[236:239], v[252:255]
  s_waitcnt lgkmcnt(4)
  v_mfma_f32_16x16x32_bf16 v[216:219], v[128:131], a[240:243], v[216:219]
  ds_read_b128 v[148:151], v35 offset:56320
  v_mfma_f32_16x16x32_bf16 v[220:223], v[128:131], a[244:247], v[220:223]
  s_add_u32 s98, s35, 1179648
  buffer_load_dwordx4 a[52:55], v90, s[48:51], s98 offen sc1
  s_waitcnt lgkmcnt(4)
  v_mfma_f32_16x16x32_bf16 v[224:227], v[132:135], a[240:243], v[224:227]
  ds_read_b128 v[152:155], v35 offset:57344
  v_mfma_f32_16x16x32_bf16 v[228:231], v[132:135], a[244:247], v[228:231]
  s_waitcnt lgkmcnt(4)
  v_mfma_f32_16x16x32_bf16 v[232:235], v[136:139], a[240:243], v[232:235]
  ds_read_b128 v[156:159], v35 offset:58368
  v_mfma_f32_16x16x32_bf16 v[236:239], v[136:139], a[244:247], v[236:239]
  s_waitcnt lgkmcnt(4)
  v_mfma_f32_16x16x32_bf16 v[240:243], v[140:143], a[240:243], v[240:243]
  ds_read_b128 v[160:163], v35 offset:59392
  v_mfma_f32_16x16x32_bf16 v[244:247], v[140:143], a[244:247], v[244:247]
  buffer_load_dwordx4 a[56:59], v91, s[48:51], s98 offen sc1
  s_waitcnt lgkmcnt(4)
  v_mfma_f32_16x16x32_bf16 v[248:251], v[144:147], a[240:243], v[248:251]
  ds_read_b128 v[164:167], v35 offset:60416
  v_mfma_f32_16x16x32_bf16 v[252:255], v[144:147], a[244:247], v[252:255]
  s_waitcnt lgkmcnt(4)
  v_mfma_f32_16x16x32_bf16 v[216:219], v[148:151], a[248:251], v[216:219]
  s_barrier
  ds_read_b128 v[128:131], v37 offset:0
  v_mfma_f32_16x16x32_bf16 v[220:223], v[148:151], a[0:3], v[220:223]
  s_add_u32 s98, s35, 1245184
  buffer_load_dwordx4 a[60:63], v90, s[48:51], s98 offen sc1
  s_waitcnt lgkmcnt(4)
  v_mfma_f32_16x16x32_bf16 v[224:227], v[152:155], a[248:251], v[224:227]
  ds_read_b128 v[132:135], v37 offset:1024
L_pgf5:
  s_cbranch_execz L_pgfr
  v_mfma_f32_16x16x32_bf16 v[228:231], v[152:155], a[0:3], v[228:231]
  s_waitcnt lgkmcnt(4)
  v_mfma_f32_16x16x32_bf16 v[232:235], v[156:159], a[248:251], v[232:235]
  ds_read_b128 v[136:139], v37 offset:2048
  v_mfma_f32_16x16x32_bf16 v[236:239], v[156:159], a[0:3], v[236:239]
  buffer_load_dwordx4 a[64:67], v91, s[48:51], s98 offen sc1
  s_waitcnt lgkmcnt(4)
  v_mfma_f32_16x16x32_bf16 v[240:243], v[160:163], a[248:251], v[240:243]
  ds_read_b128 v[140:143], v37 offset:3072
  v_mfma_f32_16x16x32_bf16 v[244:247], v[160:163], a[0:3], v[244:247]
  s_waitcnt lgkmcnt(4)
  v_mfma_f32_16x16x32_bf16 v[248:251], v[164:167], a[248:251], v[248:251]
  ds_read_b128 v[144:147], v37 offset:4096
  v_mfma_f32_16x16x32_bf16 v[252:255], v[164:167], a[0:3], v[252:255]
  s_add_u32 s98, s35, 1310720
  buffer_load_dwordx4 a[68:71], v90, s[48:51], s98 offen sc1
  s_waitcnt lgkmcnt(4)
  v_mfma_f32_16x16x32_bf16 v[216:219], v[128:131], a[4:7], v[216:219]
  ds_read_b128 v[148:151], v37 offset:5120
  v_mfma_f32_16x16x32_bf16 v[220:223], v[128:131], a[8:11], v[220:223]
  s_waitcnt lgkmcnt(4)
  v_mfma_f32_16x16x32_bf16 v[224:227], v[132:135], a[4:7], v[224:227]
  ds_read_b128 v[152:155], v37 offset:6144
  v_mfma_f32_16x16x32_bf16 v[228:231], v[132:135], a[8:11], v[228:231]
  s_waitcnt lgkmcnt(4)
  v_mfma_f32_16x16x32_bf16 v[232:235], v[136:139], a[4:7], v[232:235]
  ds_read_b128 v[156:159], v37 offset:7168
  v_mfma_f32_16x16x32_bf16 v[236:239], v[136:139], a[8:11], v[236:239]
  buffer_load_dwordx4 a[72:75], v91, s[48:51], s98 offen sc1
  s_waitcnt lgkmcnt(4)
  v_mfma_f32_16x16x32_bf16 v[240:243], v[140:143], a[4:7], v[240:243]
  ds_read_b128 v[160:163], v37 offset:8192
  v_mfma_f32_16x16x32_bf16 v[244:247], v[140:143], a[8:11], v[244:247]
  s_waitcnt lgkmcnt(4)
  v_mfma_f32_16x16x32_bf16 v[248:251], v[144:147], a[4:7], v[248:251]
  ds_read_b128 v[164:167], v37 offset:9216
  v_mfma_f32_16x16x32_bf16 v[252:255], v[144:147], a[8:11], v[252:255]
  s_add_u32 s98, s35, 1376256
  buffer_load_dwordx4 a[76:79], v90, s[48:51], s98 offen sc1
  s_waitcnt lgkmcnt(4)
  v_mfma_f32_16x16x32_bf16 v[216:219], v[148:151], a[12:15], v[216:219]
  ds_read_b128 v[128:131], v37 offset:10240
  v_mfma_f32_16x16x32_bf16 v[220:223], v[148:151], a[16:19], v[220:223]
  s_waitcnt lgkmcnt(4)
  v_mfma_f32_16x16x32_bf16 v[224:227], v[152:155], a[12:15], v[224:227]
  ds_read_b128 v[132:135], v37 offset:11264
  v_mfma_f32_16x16x32_bf16 v[228:231], v[152:155], a[16:19], v[228:231]
  buffer_load_dwordx4 a[80:83], v91, s[48:51], s98 offen sc1
  s_waitcnt lgkmcnt(4)
  v_mfma_f32_16x16x32_bf16 v[232:235], v[156:159], a[12:15], v[232:235]
  ds_read_b128 v[136:139], v37 offset:12288
  v_mfma_f32_16x16x32_bf16 v[236:239], v[156:159], a[16:19], v[236:239]
  s_waitcnt lgkmcnt(4)
  v_mfma_f32_16x16x32_bf16 v[240:243], v[160:163], a[12:15], v[240:243]
  ds_read_b128 v[140:143], v37 offset:13312
  v_mfma_f32_16x16x32_bf16 v[244:247], v[160:163], a[16:19], v[244:247]
  s_add_u32 s98, s35, 1441792
  buffer_load_dwordx4 a[84:87], v90, s[48:51], s98 offen sc1
  s_waitcnt lgkmcnt(4)
  v_mfma_f32_16x16x32_bf16 v[248:251], v[164:167], a[12:15], v[248:251]
  ds_read_b128 v[144:147], v37 offset:14336
  v_mfma_f32_16x16x32_bf16 v[252:255], v[164:167], a[16:19], v[252:255]
  s_waitcnt lgkmcnt(4)
  v_mfma_f32_16x16x32_bf16 v[216:219], v[128:131], a[20:23], v[216:219]
  ds_read_b128 v[148:151], v37 offset:15360
  v_mfma_f32_16x16x32_bf16 v[220:223], v[128:131], a[24:27], v[220:223]
  s_waitcnt lgkmcnt(4)
  v_mfma_f32_16x16x32_bf16 v[224:227], v[132:135], a[20:23], v[224:227]
  ds_read_b128 v[152:155], v37 offset:16384
  v_mfma_f32_16x16x32_bf16 v[228:231], v[132:135], a[24:27], v[228:231]
  buffer_load_dwordx4 a[88:91], v91, s[48:51], s98 offen sc1
  s_waitcnt lgkmcnt(4)
  v_mfma_f32_16x16x32_bf16 v[232:235], v[136:139], a[20:23], v[232:235]
  ds_read_b128 v[156:159], v37 offset:17408
  v_mfma_f32_16x16x32_bf16 v[236:239], v[136:139], a[24:27], v[236:239]
  s_waitcnt lgkmcnt(4)
  v_mfma_f32_16x16x32_bf16 v[240:243], v[140:143], a[20:23], v[240:243]
  ds_read_b128 v[160:163], v37 offset:18432
  v_mfma_f32_16x16x32_bf16 v[244:247], v[140:143], a[24:27], v[244:247]
  s_add_u32 s98, s35, 1507328
  buffer_load_dwordx4 a[92:95], v90, s[48:51], s98 offen sc1
  s_waitcnt lgkmcnt(4)
  v_mfma_f32_16x16x32_bf16 v[248:251], v[144:147], a[20:23], v[248:251]
  ds_read_b128 v[164:167], v37 offset:19456
  v_mfma_f32_16x16x32_bf16 v[252:255], v[144:147], a[24:27], v[252:255]
  s_waitcnt lgkmcnt(4)
  v_mfma_f32_16x16x32_bf16 v[216:219], v[148:151], a[28:31], v[216:219]
  s_barrier
  ds_read_b128 v[128:131], v41 offset:20480
  v_mfma_f32_16x16x32_bf16 v[220:223], v[148:151], a[32:35], v[220:223]
  buffer_load_dwordx4 a[96:99], v91, s[48:51], s98 offen sc1
  s_waitcnt lgkmcnt(4)
  v_mfma_f32_16x16x32_bf16 v[224:227], v[152:155], a[28:31], v[224:227]
  ds_read_b128 v[132:135], v41 offset:21504
  v_mfma_f32_16x16x32_bf16 v[228:231], v[152:155], a[32:35], v[228:231]
  s_waitcnt lgkmcnt(4)
  v_mfma_f32_16x16x32_bf16 v[232:235], v[156:159], a[28:31], v[232:235]
  ds_read_b128 v[136:139], v41 offset:22528
  v_mfma_f32_16x16x32_bf16 v[236:239], v[156:159], a[32:35], v[236:239]
  s_add_u32 s98, s35, 1572864
  buffer_load_dwordx4 a[100:103], v90, s[48:51], s98 offen sc1
  s_waitcnt lgkmcnt(4)
  v_mfma_f32_16x16x32_bf16 v[240:243], v[160:163], a[28:31], v[240:243]
  ds_read_b128 v[140:143], v41 offset:23552
  v_mfma_f32_16x16x32_bf16 v[244:247], v[160:163], a[32:35], v[244:247]
  s_waitcnt lgkmcnt(4)
  v_mfma_f32_16x16x32_bf16 v[248:251], v[164:167], a[28:31], v[248:251]
  ds_read_b128 v[144:147], v41 offset:24576
  v_mfma_f32_16x16x32_bf16 v[252:255], v[164:167], a[32:35], v[252:255]
  s_waitcnt vmcnt(17) lgkmcnt(4)
  v_mfma_f32_16x16x32_bf16 v[216:219], v[128:131], a[36:39], v[216:219]
  ds_read_b128 v[148:151], v41 offset:25600
  s_waitcnt vmcnt(15)
  v_mfma_f32_16x16x32_bf16 v[220:223], v[128:131], a[40:43], v[220:223]
  buffer_load_dwordx4 a[104:107], v91, s[48:51], s98 offen sc1
  s_waitcnt lgkmcnt(4)
  v_mfma_f32_16x16x32_bf16 v[224:227], v[132:135], a[36:39], v[224:227]
  ds_read_b128 v[152:155], v41 offset:26624
  v_mfma_f32_16x16x32_bf16 v[228:231], v[132:135], a[40:43], v[228:231]
  s_waitcnt lgkmcnt(4)
  v_mfma_f32_16x16x32_bf16 v[232:235], v[136:139], a[36:39], v[232:235]
  ds_read_b128 v[156:159], v41 offset:27648
  v_mfma_f32_16x16x32_bf16 v[236:239], v[136:139], a[40:43], v[236:239]
  s_add_u32 s98, s35, 1638400
  buffer_load_dwordx4 a[108:111], v90, s[48:51], s98 offen sc1
  s_waitcnt lgkmcnt(4)
  v_mfma_f32_16x16x32_bf16 v[240:243], v[140:143], a[36:39], v[240:243]
  ds_read_b128 v[160:163], v41 offset:28672
  v_mfma_f32_16x16x32_bf16 v[244:247], v[140:143], a[40:43], v[244:247]
  s_waitcnt lgkmcnt(4)
  v_mfma_f32_16x16x32_bf16 v[248:251], v[144:147], a[36:39], v[248:251]
  ds_read_b128 v[164:167], v41 offset:29696
  v_mfma_f32_16x16x32_bf16 v[252:255], v[144:147], a[40:43], v[252:255]
  buffer_load_dwordx4 a[112:115], v91, s[48:51], s98 offen sc1
  s_waitcnt vmcnt(17) lgkmcnt(4)
  v_mfma_f32_16x16x32_bf16 v[216:219], v[148:151], a[44:47], v[216:219]
  ds_read_b128 v[128:131], v41 offset:30720
  s_waitcnt vmcnt(16)
  v_mfma_f32_16x16x32_bf16 v[220:223], v[148:151], a[48:51], v[220:223]
  s_waitcnt lgkmcnt(4)
  v_mfma_f32_16x16x32_bf16 v[224:227], v[152:155], a[44:47], v[224:227]
  ds_read_b128 v[132:135], v41 offset:31744
  v_mfma_f32_16x16x32_bf16 v[228:231], v[152:155], a[48:51], v[228:231]
  s_add_u32 m0, s29, 24576
  s_add_u32 s15, s99, 2625536
  buffer_load_dwordx4 v35, s[52:55], s15 offen offset:0 sc1 lds
  s_waitcnt lgkmcnt(4)
  v_mfma_f32_16x16x32_bf16 v[232:235], v[156:159], a[44:47], v[232:235]
  ds_read_b128 v[136:139], v41 offset:32768
  v_mfma_f32_16x16x32_bf16 v[236:239], v[156:159], a[48:51], v[236:239]
  s_waitcnt lgkmcnt(4)
  v_mfma_f32_16x16x32_bf16 v[240:243], v[160:163], a[44:47], v[240:243]
  ds_read_b128 v[140:143], v41 offset:33792
  v_mfma_f32_16x16x32_bf16 v[244:247], v[160:163], a[48:51], v[244:247]
  s_waitcnt lgkmcnt(4)
  v_mfma_f32_16x16x32_bf16 v[248:251], v[164:167], a[44:47], v[248:251]
  ds_read_b128 v[144:147], v41 offset:34816
  v_mfma_f32_16x16x32_bf16 v[252:255], v[164:167], a[48:51], v[252:255]
  s_add_u32 m0, s29, 40960
  s_add_u32 s15, s99, 2949120
  buffer_load_dwordx4 v35, s[52:55], s15 offen offset:0 sc1 lds
  s_waitcnt vmcnt(17) lgkmcnt(4)
  v_mfma_f32_16x16x32_bf16 v[216:219], v[128:131], a[52:55], v[216:219]
  ds_read_b128 v[148:151], v41 offset:35840
  s_waitcnt vmcnt(16)
  v_mfma_f32_16x16x32_bf16 v[220:223], v[128:131], a[56:59], v[220:223]
  s_waitcnt lgkmcnt(4)
  v_mfma_f32_16x16x32_bf16 v[224:227], v[132:135], a[52:55], v[224:227]
  ds_read_b128 v[152:155], v41 offset:36864
  v_mfma_f32_16x16x32_bf16 v[228:231], v[132:135], a[56:59], v[228:231]
  s_add_u32 m0, s29, 40960
  s_nop 0
  buffer_load_dwordx4 v35, s[52:55], s15 offen offset:1024 sc1 lds
  s_waitcnt lgkmcnt(4)
  v_mfma_f32_16x16x32_bf16 v[232:235], v[136:139], a[52:55], v[232:235]
  ds_read_b128 v[156:159], v41 offset:37888
  v_mfma_f32_16x16x32_bf16 v[236:239], v[136:139], a[56:59], v[236:239]
  s_waitcnt lgkmcnt(4)
  v_mfma_f32_16x16x32_bf16 v[240:243], v[140:143], a[52:55], v[240:243]
  ds_read_b128 v[160:163], v41 offset:38912
  v_mfma_f32_16x16x32_bf16 v[244:247], v[140:143], a[56:59], v[244:247]
  s_add_u32 m0, s29, 40960
  s_nop 0
  buffer_load_dwordx4 v35, s[52:55], s15 offen offset:2048 sc1 lds
  s_waitcnt lgkmcnt(4)
  v_mfma_f32_16x16x32_bf16 v[248:251], v[144:147], a[52:55], v[248:251]
  ds_read_b128 v[164:167], v41 offset:39936
  ds_read_b64 v[48:49], v71 offset:0
  v_mfma_f32_16x16x32_bf16 v[252:255], v[144:147], a[56:59], v[252:255]
  ds_read_b64 v[50:51], v71 offset:32
  s_waitcnt vmcnt(17) lgkmcnt(6)
  v_mfma_f32_16x16x32_bf16 v[216:219], v[148:151], a[60:63], v[216:219]
  s_barrier
  ds_read_b128 v[128:131], v41 offset:40960
  s_waitcnt vmcnt(16)
  v_mfma_f32_16x16x32_bf16 v[220:223], v[148:151], a[64:67], v[220:223]
  s_add_u32 m0, s29, 40960
  s_nop 0
  buffer_load_dwordx4 v35, s[52:55], s15 offen offset:3072 sc1 lds
  ds_read_b64 v[52:53], v71 offset:64
  s_waitcnt lgkmcnt(7)
  v_mfma_f32_16x16x32_bf16 v[224:227], v[152:155], a[60:63], v[224:227]
  ds_read_b128 v[132:135], v41 offset:41984
  ds_read_b64 v[54:55], v71 offset:96
  v_mfma_f32_16x16x32_bf16 v[228:231], v[152:155], a[64:67], v[228:231]
  ds_read_b64 v[56:57], v71 offset:128
  s_waitcnt lgkmcnt(9)
  v_mfma_f32_16x16x32_bf16 v[232:235], v[156:159], a[60:63], v[232:235]
  ds_read_b128 v[136:139], v41 offset:43008
  ds_read_b64 v[58:59], v72 offset:3072
  v_mfma_f32_16x16x32_bf16 v[236:239], v[156:159], a[64:67], v[236:239]
  ds_read_b64 v[60:61], v72 offset:3104
  s_waitcnt lgkmcnt(11)
  v_mfma_f32_16x16x32_bf16 v[240:243], v[160:163], a[60:63], v[240:243]
  ds_read_b128 v[140:143], v41 offset:44032
  ds_read_b64 v[62:63], v72 offset:3136
  v_mfma_f32_16x16x32_bf16 v[244:247], v[160:163], a[64:67], v[244:247]
  s_add_u32 m0, s29, 45056
  s_add_u32 s15, s99, 2953216
  buffer_load_dwordx4 v35, s[52:55], s15 offen offset:0 sc1 lds
  ds_read_b64 v[64:65], v72 offset:3168
  s_waitcnt lgkmcnt(13)
  v_mfma_f32_16x16x32_bf16 v[248:251], v[164:167], a[60:63], v[248:251]
  ds_read_b128 v[144:147], v41 offset:45056
  s_waitcnt lgkmcnt(11)
  ds_read_b64 v[66:67], v72 offset:3200
  v_mfma_f32_16x16x32_bf16 v[252:255], v[164:167], a[64:67], v[252:255]
  s_waitcnt vmcnt(17)
  v_mfma_f32_16x16x32_bf16 v[216:219], v[128:131], a[68:71], v[216:219]
  ds_read_b128 v[148:151], v41 offset:46080
  s_waitcnt vmcnt(16)
  v_mfma_f32_16x16x32_bf16 v[220:223], v[128:131], a[72:75], v[220:223]
  s_add_u32 m0, s29, 65536
  s_add_u32 s15, s99, 3276800
  buffer_load_dwordx4 v35, s[52:55], s15 offen offset:0 sc1 lds
  s_waitcnt lgkmcnt(11)
  v_mfma_f32_16x16x32_bf16 v[224:227], v[132:135], a[68:71], v[224:227]
  ds_read_b128 v[152:155], v41 offset:47104
  v_mfma_f32_16x16x32_bf16 v[228:231], v[132:135], a[72:75], v[228:231]
  s_waitcnt lgkmcnt(9)
  v_mfma_f32_16x16x32_bf16 v[232:235], v[136:139], a[68:71], v[232:235]
  ds_read_b128 v[156:159], v41 offset:48128
  v_mfma_f32_16x16x32_bf16 v[236:239], v[136:139], a[72:75], v[236:239]
  s_add_u32 m0, s29, 65536
  s_nop 0
  buffer_load_dwordx4 v35, s[52:55], s15 offen offset:1024 sc1 lds
  s_waitcnt lgkmcnt(7)
  v_mfma_f32_16x16x32_bf16 v[240:243], v[140:143], a[68:71], v[240:243]
  ds_read_b128 v[160:163], v41 offset:49152
  v_mfma_f32_16x16x32_bf16 v[244:247], v[140:143], a[72:75], v[244:247]
  s_waitcnt lgkmcnt(5)
  v_mfma_f32_16x16x32_bf16 v[248:251], v[144:147], a[68:71], v[248:251]
  ds_read_b128 v[164:167], v41 offset:50176
  v_mfma_f32_16x16x32_bf16 v[252:255], v[144:147], a[72:75], v[252:255]
  s_add_u32 m0, s29, 65536
  s_nop 0
  buffer_load_dwordx4 v35, s[52:55], s15 offen offset:2048 sc1 lds
  s_waitcnt vmcnt(18) lgkmcnt(4)
  v_mfma_f32_16x16x32_bf16 v[216:219], v[148:151], a[76:79], v[216:219]
  ds_read_b128 v[128:131], v41 offset:51200
  s_waitcnt vmcnt(17)
  v_mfma_f32_16x16x32_bf16 v[220:223], v[148:151], a[80:83], v[220:223]
  s_waitcnt lgkmcnt(4)
  v_mfma_f32_16x16x32_bf16 v[224:227], v[152:155], a[76:79], v[224:227]
  ds_read_b128 v[132:135], v41 offset:52224
  v_mfma_f32_16x16x32_bf16 v[228:231], v[152:155], a[80:83], v[228:231]
  s_waitcnt lgkmcnt(4)
  v_mfma_f32_16x16x32_bf16 v[232:235], v[156:159], a[76:79], v[232:235]
  ds_read_b128 v[136:139], v41 offset:53248
  v_mfma_f32_16x16x32_bf16 v[236:239], v[156:159], a[80:83], v[236:239]
  s_mov_b64 exec, 0xffff
  buffer_load_dword v84, v85, s[56:59], 0 offen offset:8 sc1
  s_mov_b64 exec, -1
  s_waitcnt lgkmcnt(4)
  v_mfma_f32_16x16x32_bf16 v[240:243], v[160:163], a[76:79], v[240:243]
  ds_read_b128 v[140:143], v41 offset:54272
  v_mfma_f32_16x16x32_bf16 v[244:247], v[160:163], a[80:83], v[244:247]
  s_add_u32 m0, s29, 65536
  s_nop 0
  buffer_load_dwordx4 v35, s[52:55], s15 offen offset:3072 sc1 lds
  s_waitcnt lgkmcnt(4)
  v_mfma_f32_16x16x32_bf16 v[248:251], v[164:167], a[76:79], v[248:251]
  ds_read_b128 v[144:147], v41 offset:55296
  v_mfma_f32_16x16x32_bf16 v[252:255], v[164:167], a[80:83], v[252:255]
  s_waitcnt vmcnt(18) lgkmcnt(4)
  v_mfma_f32_16x16x32_bf16 v[216:219], v[128:131], a[84:87], v[216:219]
  ds_read_b128 v[148:151], v41 offset:56320
  s_waitcnt vmcnt(17)
  v_mfma_f32_16x16x32_bf16 v[220:223], v[128:131], a[88:91], v[220:223]
  s_add_u32 m0, s29, 69632
  s_add_u32 s15, s99, 3280896
  buffer_load_dwordx4 v35, s[52:55], s15 offen offset:0 sc1 lds
  s_waitcnt lgkmcnt(4)
  v_mfma_f32_16x16x32_bf16 v[224:227], v[132:135], a[84:87], v[224:227]
  ds_read_b128 v[152:155], v41 offset:57344
  v_mfma_f32_16x16x32_bf16 v[228:231], v[132:135], a[88:91], v[228:231]
  s_waitcnt lgkmcnt(4)
  v_mfma_f32_16x16x32_bf16 v[232:235], v[136:139], a[84:87], v[232:235]
  ds_read_b128 v[156:159], v41 offset:58368
  v_mfma_f32_16x16x32_bf16 v[236:239], v[136:139], a[88:91], v[236:239]
  s_add_u32 m0, s29, 86016
  s_add_u32 s15, s99, 3604480
  buffer_load_dwordx4 v35, s[52:55], s15 offen offset:0 sc1 lds
  s_waitcnt lgkmcnt(4)
  v_mfma_f32_16x16x32_bf16 v[240:243], v[140:143], a[84:87], v[240:243]
  ds_read_b128 v[160:163], v41 offset:59392
  v_mfma_f32_16x16x32_bf16 v[244:247], v[140:143], a[88:91], v[244:247]
  s_waitcnt lgkmcnt(4)
  v_mfma_f32_16x16x32_bf16 v[248:251], v[144:147], a[84:87], v[248:251]
  ds_read_b128 v[164:167], v41 offset:60416
  v_mfma_f32_16x16x32_bf16 v[252:255], v[144:147], a[88:91], v[252:255]
  s_add_u32 m0, s29, 86016
  s_nop 0
  buffer_load_dwordx4 v35, s[52:55], s15 offen offset:1024 sc1 lds
  s_waitcnt vmcnt(19) lgkmcnt(4)
  v_mfma_f32_16x16x32_bf16 v[216:219], v[148:151], a[92:95], v[216:219]
  ds_read_b128 v[128:131], v41 offset:61440
  s_waitcnt vmcnt(18)
  v_mfma_f32_16x16x32_bf16 v[220:223], v[148:151], a[96:99], v[220:223]
  s_waitcnt lgkmcnt(4)
  v_mfma_f32_16x16x32_bf16 v[224:227], v[152:155], a[92:95], v[224:227]
  ds_read_b128 v[132:135], v41 offset:62464
  v_mfma_f32_16x16x32_bf16 v[228:231], v[152:155], a[96:99], v[228:231]
  s_add_u32 m0, s29, 86016
  s_nop 0
  buffer_load_dwordx4 v35, s[52:55], s15 offen offset:2048 sc1 lds
  s_waitcnt lgkmcnt(4)
  v_mfma_f32_16x16x32_bf16 v[232:235], v[156:159], a[92:95], v[232:235]
  ds_read_b128 v[136:139], v41 offset:63488
  v_mfma_f32_16x16x32_bf16 v[236:239], v[156:159], a[96:99], v[236:239]
  s_waitcnt lgkmcnt(4)
  v_mfma_f32_16x16x32_bf16 v[240:243], v[160:163], a[92:95], v[240:243]
  ds_read_b128 v[140:143], v41 offset:64512
  v_mfma_f32_16x16x32_bf16 v[244:247], v[160:163], a[96:99], v[244:247]
  s_waitcnt lgkmcnt(4)
  v_mfma_f32_16x16x32_bf16 v[248:251], v[164:167], a[92:95], v[248:251]
  ds_read_b128 v[144:147], v42 offset:0
  v_mfma_f32_16x16x32_bf16 v[252:255], v[164:167], a[96:99], v[252:255]
  s_add_u32 m0, s29, 86016
  s_nop 0
  buffer_load_dwordx4 v35, s[52:55], s15 offen offset:3072 sc1 lds
  s_waitcnt vmcnt(19) lgkmcnt(4)
  v_mfma_f32_16x16x32_bf16 v[216:219], v[128:131], a[100:103], v[216:219]
  ds_read_b128 v[148:151], v42 offset:1024
  s_waitcnt vmcnt(18)
  v_mfma_f32_16x16x32_bf16 v[220:223], v[128:131], a[104:107], v[220:223]
  s_waitcnt lgkmcnt(4)
  v_mfma_f32_16x16x32_bf16 v[224:227], v[132:135], a[100:103], v[224:227]
  ds_read_b128 v[152:155], v42 offset:2048
  v_mfma_f32_16x16x32_bf16 v[228:231], v[132:135], a[104:107], v[228:231]
  s_add_u32 m0, s29, 90112
  s_add_u32 s15, s99, 3608576
  buffer_load_dwordx4 v35, s[52:55], s15 offen offset:0 sc1 lds
  s_waitcnt lgkmcnt(4)
  v_mfma_f32_16x16x32_bf16 v[232:235], v[136:139], a[100:103], v[232:235]
  ds_read_b128 v[156:159], v42 offset:3072
  v_mfma_f32_16x16x32_bf16 v[236:239], v[136:139], a[104:107], v[236:239]
  s_waitcnt lgkmcnt(4)
  v_mfma_f32_16x16x32_bf16 v[240:243], v[140:143], a[100:103], v[240:243]
  ds_read_b128 v[160:163], v42 offset:4096
  v_mfma_f32_16x16x32_bf16 v[244:247], v[140:143], a[104:107], v[244:247]
  s_waitcnt lgkmcnt(4)
  v_mfma_f32_16x16x32_bf16 v[248:251], v[144:147], a[100:103], v[248:251]
  ds_read_b128 v[164:167], v42 offset:5120
  v_mfma_f32_16x16x32_bf16 v[252:255], v[144:147], a[104:107], v[252:255]
  s_waitcnt vmcnt(18) lgkmcnt(4)
  v_mfma_f32_16x16x32_bf16 v[216:219], v[148:151], a[108:111], v[216:219]
  ds_read_b128 v[128:131], v42 offset:6144
  s_waitcnt vmcnt(7)
  v_cmp_ne_u32 vcc, s61, v84
  s_nop 1
  s_and_b32 vcc_lo, vcc_lo, 0xffff
  s_cbranch_scc1 L_slow5
L_back5:
  v_mfma_f32_16x16x32_bf16 v[220:223], v[148:151], a[112:115], v[220:223]
  s_add_u32 s98, s35, 1703936
  buffer_load_dwordx4 a[116:119], v91, s[48:51], s98 offen sc1
  s_add_u32 s98, s35, 1769472
  buffer_load_dwordx4 a[120:123], v91, s[48:51], s98 offen sc1
  v_lshlrev_b32 v180, 16, v48
  v_and_b32 v181, 0xffff0000, v48
  v_lshlrev_b32 v182, 16, v49
  v_and_b32 v183, 0xffff0000, v49
  v_lshlrev_b32 v184, 16, v50
  v_and_b32 v185, 0xffff0000, v50
  v_lshlrev_b32 v186, 16, v51
  v_and_b32 v187, 0xffff0000, v51
  v_lshlrev_b32 v188, 16, v52
  v_and_b32 v189, 0xffff0000, v52
  v_lshlrev_b32 v190, 16, v53
  v_and_b32 v191, 0xffff0000, v53
  v_lshlrev_b32 v192, 16, v54
  v_and_b32 v193, 0xffff0000, v54
  v_lshlrev_b32 v194, 16, v55
  v_and_b32 v195, 0xffff0000, v55
  v_lshlrev_b32 v196, 16, v56
  v_and_b32 v197, 0xffff0000, v56
  v_lshlrev_b32 v198, 16, v57
  v_and_b32 v199, 0xffff0000, v57
  v_sub_f32 v104, v180, v46
  v_sub_f32 v105, v181, v46
  v_sub_f32 v106, v182, v46
  v_sub_f32 v107, v183, v46
  s_waitcnt lgkmcnt(4)
  v_mfma_f32_16x16x32_bf16 v[224:227], v[152:155], a[108:111], v[224:227]
  ds_read_b128 v[132:135], v42 offset:7168
  s_add_u32 s98, s35, 1835008
  buffer_load_dwordx4 a[124:127], v91, s[48:51], s98 offen sc1
  s_add_u32 s98, s35, 1900544
  buffer_load_dwordx4 a[128:131], v91, s[48:51], s98 offen sc1
  v_sub_f32 v108, v184, v46
  v_sub_f32 v109, v185, v46
  v_sub_f32 v110, v186, v46
  v_sub_f32 v111, v187, v46
  v_sub_f32 v112, v188, v46
  v_sub_f32 v113, v189, v46
  v_sub_f32 v114, v190, v46
  v_sub_f32 v115, v191, v46
  v_sub_f32 v116, v192, v46
  v_sub_f32 v117, v193, v46
  v_sub_f32 v118, v194, v46
  v_sub_f32 v119, v195, v46
  v_sub_f32 v120, v196, v46
  v_sub_f32 v121, v197, v46
  v_sub_f32 v122, v198, v46
  v_sub_f32 v123, v199, v46
  v_cvt_pk_bf16_f32 v105, v104, v105
  v_cvt_pk_bf16_f32 v107, v106, v107
  v_cvt_pk_bf16_f32 v109, v108, v109
  v_cvt_pk_bf16_f32 v111, v110, v111
  v_cvt_pk_bf16_f32 v113, v112, v113
  v_cvt_pk_bf16_f32 v115, v114, v115
  v_cvt_pk_bf16_f32 v117, v116, v117
  v_cvt_pk_bf16_f32 v119, v118, v119
  v_mfma_f32_16x16x32_bf16 v[228:231], v[152:155], a[112:115], v[228:231]
  s_add_u32 s98, s35, 1966080
  buffer_load_dwordx4 a[132:135], v91, s[48:51], s98 offen sc1
  s_add_u32 s98, s35, 2031616
  buffer_load_dwordx4 a[136:139], v91, s[48:51], s98 offen sc1
  v_cvt_pk_bf16_f32 v121, v120, v121
  v_cvt_pk_bf16_f32 v123, v122, v123
  v_lshlrev_b32 v104, 16, v105
  v_and_b32 v105, 0xffff0000, v105
  v_lshlrev_b32 v106, 16, v107
  v_and_b32 v107, 0xffff0000, v107
  v_lshlrev_b32 v108, 16, v109
  v_and_b32 v109, 0xffff0000, v109
  v_lshlrev_b32 v110, 16, v111
  v_and_b32 v111, 0xffff0000, v111
  v_lshlrev_b32 v112, 16, v113
  v_and_b32 v113, 0xffff0000, v113
  v_lshlrev_b32 v114, 16, v115
  v_and_b32 v115, 0xffff0000, v115
  v_lshlrev_b32 v116, 16, v117
  v_and_b32 v117, 0xffff0000, v117
  v_lshlrev_b32 v118, 16, v119
  v_and_b32 v119, 0xffff0000, v119
  v_lshlrev_b32 v120, 16, v121
  v_and_b32 v121, 0xffff0000, v121
  v_lshlrev_b32 v122, 16, v123
  v_and_b32 v123, 0xffff0000, v123
  v_mul_f32 v104, v104, v47
  v_mul_f32 v105, v105, v47
  s_waitcnt lgkmcnt(4)
  v_mfma_f32_16x16x32_bf16 v[232:235], v[156:159], a[108:111], v[232:235]
  ds_read_b128 v[136:139], v42 offset:8192
  s_add_u32 s98, s35, 2097152
  buffer_load_dwordx4 a[140:143], v91, s[48:51], s98 offen sc1
  s_add_u32 s98, s35, 2162688
  buffer_load_dwordx4 a[144:147], v91, s[48:51], s98 offen sc1
  v_mul_f32 v106, v106, v47
  v_mul_f32 v107, v107, v47
  v_mul_f32 v108, v108, v47
  v_mul_f32 v109, v109, v47
  v_mul_f32 v110, v110, v47
  v_mul_f32 v111, v111, v47
  v_mul_f32 v112, v112, v47
  v_mul_f32 v113, v113, v47
  v_mul_f32 v114, v114, v47
  v_mul_f32 v115, v115, v47
  v_mul_f32 v116, v116, v47
  v_mul_f32 v117, v117, v47
  v_mul_f32 v118, v118, v47
  v_mul_f32 v119, v119, v47
  v_mul_f32 v120, v120, v47
  v_mul_f32 v121, v121, v47
  v_mul_f32 v122, v122, v47
  v_mul_f32 v123, v123, v47
  v_cvt_pk_bf16_f32 v105, v104, v105
  v_cvt_pk_bf16_f32 v107, v106, v107
  v_cvt_pk_bf16_f32 v109, v108, v109
  v_cvt_pk_bf16_f32 v111, v110, v111
  v_cvt_pk_bf16_f32 v113, v112, v113
  v_mfma_f32_16x16x32_bf16 v[236:239], v[156:159], a[112:115], v[236:239]
  s_add_u32 s14, s35, 2228224
  s_mov_b32 exec_lo, 0x1fff
  s_mov_b32 exec_hi, 0
  buffer_load_dword a255, v124, s[48:51], s14 offen sc1
  s_mov_b64 exec, -1
  v_cvt_pk_bf16_f32 v115, v114, v115
  v_cvt_pk_bf16_f32 v117, v116, v117
  v_cvt_pk_bf16_f32 v119, v118, v119
  v_cvt_pk_bf16_f32 v121, v120, v121
  v_cvt_pk_bf16_f32 v123, v122, v123
  v_lshlrev_b32 v104, 16, v105
  v_and_b32 v105, 0xffff0000, v105
  v_lshlrev_b32 v106, 16, v107
  v_and_b32 v107, 0xffff0000, v107
  v_lshlrev_b32 v108, 16, v109
  v_and_b32 v109, 0xffff0000, v109
  v_lshlrev_b32 v110, 16, v111
  v_and_b32 v111, 0xffff0000, v111
  v_lshlrev_b32 v112, 16, v113
  v_and_b32 v113, 0xffff0000, v113
  v_lshlrev_b32 v114, 16, v115
  v_and_b32 v115, 0xffff0000, v115
  v_lshlrev_b32 v116, 16, v117
  v_and_b32 v117, 0xffff0000, v117
  v_lshlrev_b32 v118, 16, v119
  v_and_b32 v119, 0xffff0000, v119
  v_lshlrev_b32 v120, 16, v121
  v_and_b32 v121, 0xffff0000, v121
  s_waitcnt lgkmcnt(4)
  v_mfma_f32_16x16x32_bf16 v[240:243], v[160:163], a[108:111], v[240:243]
  ds_read_b128 v[140:143], v42 offset:9216
  s_add_u32 s98, s35, 2228224
  buffer_load_dwordx4 a[148:151], v91, s[48:51], s98 offen sc1
  s_add_u32 s98, s35, 2293760
  buffer_load_dwordx4 a[152:155], v91, s[48:51], s98 offen sc1
  v_lshlrev_b32 v122, 16, v123
  v_and_b32 v123, 0xffff0000, v123
  v_lshlrev_b32 v6, 16, v58
  v_and_b32 v7, 0xffff0000, v58
  v_lshlrev_b32 v8, 16, v59
  v_and_b32 v9, 0xffff0000, v59
  v_lshlrev_b32 v10, 16, v60
  v_and_b32 v11, 0xffff0000, v60
  v_lshlrev_b32 v12, 16, v61
  v_and_b32 v13, 0xffff0000, v61
  v_lshlrev_b32 v14, 16, v62
  v_and_b32 v15, 0xffff0000, v62
  v_lshlrev_b32 v16, 16, v63
  v_and_b32 v17, 0xffff0000, v63
  v_lshlrev_b32 v18, 16, v64
  v_and_b32 v19, 0xffff0000, v64
  v_lshlrev_b32 v20, 16, v65
  v_and_b32 v21, 0xffff0000, v65
  v_lshlrev_b32 v22, 16, v66
  v_and_b32 v23, 0xffff0000, v66
  v_lshlrev_b32 v24, 16, v67
  v_and_b32 v25, 0xffff0000, v67
  v_mul_f32 v104, v104, v6
  v_mfma_f32_16x16x32_bf16 v[244:247], v[160:163], a[112:115], v[244:247]
  ds_read_b128 v[144:147], v42 offset:10240
  s_add_u32 s98, s35, 2359296
  buffer_load_dwordx4 a[156:159], v91, s[48:51], s98 offen sc1
  s_add_u32 s98, s35, 2424832
  buffer_load_dwordx4 a[160:163], v91, s[48:51], s98 offen sc1
  v_mul_f32 v105, v105, v7
  v_mul_f32 v106, v106, v8
  v_mul_f32 v107, v107, v9
  v_mul_f32 v108, v108, v10
  v_mul_f32 v109, v109, v11
  v_mul_f32 v110, v110, v12
  v_mul_f32 v111, v111, v13
  v_mul_f32 v112, v112, v14
  v_mul_f32 v113, v113, v15
  v_mul_f32 v114, v114, v16
  v_mul_f32 v115, v115, v17
  v_mul_f32 v116, v116, v18
  v_mul_f32 v117, v117, v19
  v_mul_f32 v118, v118, v20
  v_mul_f32 v119, v119, v21
  v_mul_f32 v120, v120, v22
  v_mul_f32 v121, v121, v23
  v_mul_f32 v122, v122, v24
  v_mul_f32 v123, v123, v25
  v_cvt_pk_bf16_f32 v105, v104, v105
  v_cvt_pk_bf16_f32 v107, v106, v107
  v_cvt_pk_bf16_f32 v109, v108, v109
  v_cvt_pk_bf16_f32 v111, v110, v111
  s_waitcnt lgkmcnt(5)
  v_mfma_f32_16x16x32_bf16 v[248:251], v[164:167], a[108:111], v[248:251]
  ds_read_b128 v[148:151], v42 offset:11264
  s_add_u32 s14, s35, 1703936
  s_mov_b32 exec_lo, 0
  s_mov_b32 exec_hi, 0x1fffff
  buffer_load_dword a255, v124, s[48:51], s14 offen sc1
  s_mov_b64 exec, -1
  v_cvt_pk_bf16_f32 v113, v112, v113
  v_cvt_pk_bf16_f32 v115, v114, v115
  v_cvt_pk_bf16_f32 v117, v116, v117
  v_cvt_pk_bf16_f32 v119, v118, v119
  v_cvt_pk_bf16_f32 v121, v120, v121
  v_cvt_pk_bf16_f32 v123, v122, v123
  v_lshlrev_b32 v104, 16, v105
  v_and_b32 v105, 0xffff0000, v105
  v_lshlrev_b32 v106, 16, v107
  v_and_b32 v107, 0xffff0000, v107
  v_lshlrev_b32 v108, 16, v109
  v_and_b32 v109, 0xffff0000, v109
  v_lshlrev_b32 v110, 16, v111
  v_and_b32 v111, 0xffff0000, v111
  v_lshlrev_b32 v112, 16, v113
  v_and_b32 v113, 0xffff0000, v113
  v_lshlrev_b32 v114, 16, v115
  v_and_b32 v115, 0xffff0000, v115
  v_lshlrev_b32 v116, 16, v117
  v_and_b32 v117, 0xffff0000, v117
  v_lshlrev_b32 v118, 16, v119
  v_and_b32 v119, 0xffff0000, v119
  v_lshlrev_b32 v120, 16, v121
  v_mfma_f32_16x16x32_bf16 v[252:255], v[164:167], a[112:115], v[252:255]
  ds_read_b128 v[152:155], v42 offset:12288
  s_add_u32 s98, s35, 2490368
  buffer_load_dwordx4 a[164:167], v91, s[48:51], s98 offen sc1
  s_add_u32 s98, s35, 2555904
  buffer_load_dwordx4 a[168:171], v91, s[48:51], s98 offen sc1
  v_and_b32 v121, 0xffff0000, v121
L_pgf6:
  s_cbranch_execz L_pgfr
  v_lshlrev_b32 v122, 16, v123
  v_and_b32 v123, 0xffff0000, v123
  v_add_f32 v180, v180, v104
  v_add_f32 v181, v181, v105
  v_add_f32 v182, v182, v106
  v_add_f32 v183, v183, v107
  v_add_f32 v184, v184, v108
  v_add_f32 v185, v185, v109
  v_add_f32 v186, v186, v110
  v_add_f32 v187, v187, v111
  v_add_f32 v188, v188, v112
  v_add_f32 v189, v189, v113
  v_add_f32 v190, v190, v114
  v_add_f32 v191, v191, v115
  v_add_f32 v192, v192, v116
  v_add_f32 v193, v193, v117
  v_add_f32 v194, v194, v118
  v_add_f32 v195, v195, v119
  v_add_f32 v196, v196, v120
  v_add_f32 v197, v197, v121
  v_add_f32 v198, v198, v122
  v_add_f32 v199, v199, v123
  s_waitcnt vmcnt(15) lgkmcnt(6)
  v_mfma_f32_16x16x32_bf16 v[220:223], v[128:131], a[116:119], v[220:223]
  ds_read_b128 v[156:159], v42 offset:13312
  s_add_u32 s98, s35, 2621440
  buffer_load_dwordx4 a[172:175], v91, s[48:51], s98 offen sc1
  s_add_u32 s98, s35, 2686976
  buffer_load_dwordx4 a[176:179], v91, s[48:51], s98 offen sc1
  s_waitcnt lgkmcnt(6)
  v_mfma_f32_16x16x32_bf16 v[228:231], v[132:135], a[116:119], v[228:231]
  ds_read_b128 v[160:163], v42 offset:14336
  s_add_u32 s98, s35, 2752512
  buffer_load_dwordx4 a[180:183], v91, s[48:51], s98 offen sc1
  s_waitcnt lgkmcnt(6)
  v_mfma_f32_16x16x32_bf16 v[236:239], v[136:139], a[116:119], v[236:239]
  ds_read_b128 v[164:167], v42 offset:15360
  s_waitcnt lgkmcnt(6)
  v_mfma_f32_16x16x32_bf16 v[244:247], v[140:143], a[116:119], v[244:247]
  s_barrier
  ds_read_b128 v[128:131], v40 offset:0
  s_waitcnt lgkmcnt(6)
  v_mfma_f32_16x16x32_bf16 v[252:255], v[144:147], a[116:119], v[252:255]
  ds_read_b128 v[132:135], v40 offset:1024
  s_waitcnt vmcnt(17) lgkmcnt(6)
  v_mfma_f32_16x16x32_bf16 v[220:223], v[148:151], a[120:123], v[220:223]
  ds_read_b128 v[136:139], v40 offset:2048
  s_add_u32 s98, s35, 2818048
  buffer_load_dwordx4 a[184:187], v91, s[48:51], s98 offen sc1
  s_waitcnt lgkmcnt(6)
  v_mfma_f32_16x16x32_bf16 v[228:231], v[152:155], a[120:123], v[228:231]
  ds_read_b128 v[140:143], v40 offset:3072
  s_waitcnt lgkmcnt(6)
  v_mfma_f32_16x16x32_bf16 v[236:239], v[156:159], a[120:123], v[236:239]
  ds_read_b128 v[144:147], v40 offset:4096
  s_waitcnt lgkmcnt(6)
  v_mfma_f32_16x16x32_bf16 v[244:247], v[160:163], a[120:123], v[244:247]
  ds_read_b128 v[148:151], v40 offset:5120
  s_waitcnt lgkmcnt(6)
  v_mfma_f32_16x16x32_bf16 v[252:255], v[164:167], a[120:123], v[252:255]
  ds_read_b128 v[152:155], v40 offset:6144
  s_waitcnt vmcnt(17) lgkmcnt(6)
  v_mfma_f32_16x16x32_bf16 v[220:223], v[128:131], a[124:127], v[220:223]
  ds_read_b128 v[156:159], v40 offset:7168
  s_add_u32 s98, s35, 2883584
  buffer_load_dwordx4 a[188:191], v91, s[48:51], s98 offen sc1
  s_waitcnt lgkmcnt(6)
  v_mfma_f32_16x16x32_bf16 v[228:231], v[132:135], a[124:127], v[228:231]
  ds_read_b128 v[160:163], v40 offset:8192
  s_waitcnt lgkmcnt(6)
  v_mfma_f32_16x16x32_bf16 v[236:239], v[136:139], a[124:127], v[236:239]
  ds_read_b128 v[164:167], v40 offset:9216
  s_waitcnt lgkmcnt(6)
  v_mfma_f32_16x16x32_bf16 v[244:247], v[140:143], a[124:127], v[244:247]
  ds_read_b128 v[128:131], v40 offset:10240
  s_waitcnt lgkmcnt(6)
  v_mfma_f32_16x16x32_bf16 v[252:255], v[144:147], a[124:127], v[252:255]
  ds_read_b128 v[132:135], v40 offset:11264
  s_waitcnt vmcnt(17) lgkmcnt(6)
  v_mfma_f32_16x16x32_bf16 v[220:223], v[148:151], a[128:131], v[220:223]
  ds_read_b128 v[136:139], v40 offset:12288
  s_add_u32 s98, s35, 2949120
  buffer_load_dwordx4 a[192:195], v91, s[48:51], s98 offen sc1
  s_waitcnt lgkmcnt(6)
  v_mfma_f32_16x16x32_bf16 v[228:231], v[152:155], a[128:131], v[228:231]
  ds_read_b128 v[140:143], v40 offset:13312
  s_waitcnt lgkmcnt(6)
  v_mfma_f32_16x16x32_bf16 v[236:239], v[156:159], a[128:131], v[236:239]
  ds_read_b128 v[144:147], v40 offset:14336
  s_waitcnt lgkmcnt(6)
  v_mfma_f32_16x16x32_bf16 v[244:247], v[160:163], a[128:131], v[244:247]
  ds_read_b128 v[148:151], v40 offset:15360
  s_waitcnt lgkmcnt(6)
  v_mfma_f32_16x16x32_bf16 v[252:255], v[164:167], a[128:131], v[252:255]
  ds_read_b128 v[152:155], v40 offset:16384
  s_waitcnt vmcnt(17) lgkmcnt(6)
  v_mfma_f32_16x16x32_bf16 v[220:223], v[128:131], a[132:135], v[220:223]
  ds_read_b128 v[156:159], v40 offset:17408
  s_add_u32 s98, s35, 3014656
  buffer_load_dwordx4 a[196:199], v91, s[48:51], s98 offen sc1
  s_waitcnt lgkmcnt(6)
  v_mfma_f32_16x16x32_bf16 v[228:231], v[132:135], a[132:135], v[228:231]
  ds_read_b128 v[160:163], v40 offset:18432
  s_waitcnt lgkmcnt(6)
  v_mfma_f32_16x16x32_bf16 v[236:239], v[136:139], a[132:135], v[236:239]
  ds_read_b128 v[164:167], v40 offset:19456
  s_waitcnt lgkmcnt(6)
  v_mfma_f32_16x16x32_bf16 v[244:247], v[140:143], a[132:135], v[244:247]
  s_barrier
  ds_read_b128 v[128:131], v40 offset:20480
  s_waitcnt lgkmcnt(6)
  v_mfma_f32_16x16x32_bf16 v[252:255], v[144:147], a[132:135], v[252:255]
  ds_read_b128 v[132:135], v40 offset:21504
  s_waitcnt vmcnt(17) lgkmcnt(6)
  v_mfma_f32_16x16x32_bf16 v[220:223], v[148:151], a[136:139], v[220:223]
  ds_read_b128 v[136:139], v40 offset:22528
  s_add_u32 s98, s35, 1703936
  buffer_load_dwordx4 a[200:203], v90, s[48:51], s98 offen sc1
  s_waitcnt lgkmcnt(6)
  v_mfma_f32_16x16x32_bf16 v[228:231], v[152:155], a[136:139], v[228:231]
  ds_read_b128 v[140:143], v40 offset:23552
  s_waitcnt lgkmcnt(6)
  v_mfma_f32_16x16x32_bf16 v[236:239], v[156:159], a[136:139], v[236:239]
  ds_read_b128 v[144:147], v40 offset:24576
  s_waitcnt lgkmcnt(6)
  v_mfma_f32_16x16x32_bf16 v[244:247], v[160:163], a[136:139], v[244:247]
  ds_read_b128 v[148:151], v40 offset:25600
  s_waitcnt lgkmcnt(6)
  v_mfma_f32_16x16x32_bf16 v[252:255], v[164:167], a[136:139], v[252:255]
  ds_read_b128 v[152:155], v40 offset:26624
  s_waitcnt vmcnt(17) lgkmcnt(6)
  v_mfma_f32_16x16x32_bf16 v[220:223], v[128:131], a[140:143], v[220:223]
  ds_read_b128 v[156:159], v40 offset:27648
  s_add_u32 s98, s35, 1769472
  buffer_load_dwordx4 a[204:207], v90, s[48:51], s98 offen sc1
  s_waitcnt lgkmcnt(6)
  v_mfma_f32_16x16x32_bf16 v[228:231], v[132:135], a[140:143], v[228:231]
  ds_read_b128 v[160:163], v40 offset:28672
  s_waitcnt lgkmcnt(6)
  v_mfma_f32_16x16x32_bf16 v[236:239], v[136:139], a[140:143], v[236:239]
  ds_read_b128 v[164:167], v40 offset:29696
  s_waitcnt lgkmcnt(6)
  v_mfma_f32_16x16x32_bf16 v[244:247], v[140:143], a[140:143], v[244:247]
  ds_read_b128 v[128:131], v40 offset:30720
  s_waitcnt lgkmcnt(6)
  v_mfma_f32_16x16x32_bf16 v[252:255], v[144:147], a[140:143], v[252:255]
  ds_read_b128 v[132:135], v40 offset:31744
  s_waitcnt vmcnt(17) lgkmcnt(6)
  v_mfma_f32_16x16x32_bf16 v[220:223], v[148:151], a[144:147], v[220:223]
  ds_read_b128 v[136:139], v40 offset:32768
  s_add_u32 s98, s35, 1835008
  buffer_load_dwordx4 a[208:211], v90, s[48:51], s98 offen sc1
  s_waitcnt lgkmcnt(6)
  v_mfma_f32_16x16x32_bf16 v[228:231], v[152:155], a[144:147], v[228:231]
  ds_read_b128 v[140:143], v40 offset:33792
  s_waitcnt lgkmcnt(6)
  v_mfma_f32_16x16x32_bf16 v[236:239], v[156:159], a[144:147], v[236:239]
  ds_read_b128 v[144:147], v40 offset:34816
  s_waitcnt lgkmcnt(6)
  v_mfma_f32_16x16x32_bf16 v[244:247], v[160:163], a[144:147], v[244:247]
  ds_read_b128 v[148:151], v40 offset:35840
  s_waitcnt lgkmcnt(6)
  v_mfma_f32_16x16x32_bf16 v[252:255], v[164:167], a[144:147], v[252:255]
  ds_read_b128 v[152:155], v40 offset:36864
  s_waitcnt vmcnt(16) lgkmcnt(6)
  v_mfma_f32_16x16x32_bf16 v[220:223], v[128:131], a[148:151], v[220:223]
  ds_read_b128 v[156:159], v40 offset:37888
  s_add_u32 s98, s35, 1900544
  buffer_load_dwordx4 a[212:215], v90, s[48:51], s98 offen sc1
  s_waitcnt lgkmcnt(6)
  v_mfma_f32_16x16x32_bf16 v[228:231], v[132:135], a[148:151], v[228:231]
  ds_read_b128 v[160:163], v40 offset:38912
  s_waitcnt lgkmcnt(6)
  v_mfma_f32_16x16x32_bf16 v[236:239], v[136:139], a[148:151], v[236:239]
  ds_read_b128 v[164:167], v40 offset:39936
  s_waitcnt lgkmcnt(6)
  v_mfma_f32_16x16x32_bf16 v[244:247], v[140:143], a[148:151], v[244:247]
  s_barrier
  ds_read_b128 v[128:131], v35 offset:40960
  s_waitcnt lgkmcnt(6)
  v_mfma_f32_16x16x32_bf16 v[252:255], v[144:147], a[148:151], v[252:255]
  ds_read_b128 v[132:135], v35 offset:41984
  s_waitcnt vmcnt(16) lgkmcnt(6)
  v_mfma_f32_16x16x32_bf16 v[220:223], v[148:151], a[152:155], v[220:223]
  ds_read_b128 v[136:139], v35 offset:43008
  s_add_u32 s98, s35, 1966080
  buffer_load_dwordx4 a[216:219], v90, s[48:51], s98 offen sc1
  s_waitcnt lgkmcnt(6)
  v_mfma_f32_16x16x32_bf16 v[228:231], v[152:155], a[152:155], v[228:231]
  ds_read_b128 v[140:143], v35 offset:44032
  s_waitcnt lgkmcnt(6)
  v_mfma_f32_16x16x32_bf16 v[236:239], v[156:159], a[152:155], v[236:239]
  ds_read_b128 v[144:147], v35 offset:45056
  s_waitcnt lgkmcnt(6)
  v_mfma_f32_16x16x32_bf16 v[244:247], v[160:163], a[152:155], v[244:247]
  ds_read_b128 v[148:151], v35 offset:46080
  s_waitcnt lgkmcnt(6)
  v_mfma_f32_16x16x32_bf16 v[252:255], v[164:167], a[152:155], v[252:255]
  ds_read_b128 v[152:155], v35 offset:47104
  s_waitcnt vmcnt(16) lgkmcnt(6)
  v_mfma_f32_16x16x32_bf16 v[220:223], v[128:131], a[156:159], v[220:223]
  ds_read_b128 v[156:159], v35 offset:48128
  s_add_u32 s98, s35, 2031616
  buffer_load_dwordx4 a[220:223], v90, s[48:51], s98 offen sc1
  s_waitcnt lgkmcnt(6)
  v_mfma_f32_16x16x32_bf16 v[228:231], v[132:135], a[156:159], v[228:231]
  ds_read_b128 v[160:163], v35 offset:49152
  s_waitcnt lgkmcnt(6)
  v_mfma_f32_16x16x32_bf16 v[236:239], v[136:139], a[156:159], v[236:239]
  ds_read_b128 v[164:167], v35 offset:50176
  s_waitcnt lgkmcnt(6)
  v_mfma_f32_16x16x32_bf16 v[244:247], v[140:143], a[156:159], v[244:247]
  ds_read_b128 v[128:131], v35 offset:51200
  s_waitcnt lgkmcnt(6)
  v_mfma_f32_16x16x32_bf16 v[252:255], v[144:147], a[156:159], v[252:255]
  ds_read_b128 v[132:135], v35 offset:52224
  s_waitcnt vmcnt(16) lgkmcnt(6)
  v_mfma_f32_16x16x32_bf16 v[220:223], v[148:151], a[160:163], v[220:223]
  ds_read_b128 v[136:139], v35 offset:53248
  s_add_u32 s98, s35, 2097152
  buffer_load_dwordx4 a[224:227], v90, s[48:51], s98 offen sc1
  s_waitcnt lgkmcnt(6)
  v_mfma_f32_16x16x32_bf16 v[228:231], v[152:155], a[160:163], v[228:231]
  ds_read_b128 v[140:143], v35 offset:54272
  s_waitcnt lgkmcnt(6)
  v_mfma_f32_16x16x32_bf16 v[236:239], v[156:159], a[160:163], v[236:239]
  ds_read_b128 v[144:147], v35 offset:55296
  s_waitcnt lgkmcnt(6)
  v_mfma_f32_16x16x32_bf16 v[244:247], v[160:163], a[160:163], v[244:247]
  ds_read_b128 v[148:151], v35 offset:56320
  s_waitcnt lgkmcnt(6)
  v_mfma_f32_16x16x32_bf16 v[252:255], v[164:167], a[160:163], v[252:255]
  ds_read_b128 v[152:155], v35 offset:57344
  s_waitcnt vmcnt(15) lgkmcnt(6)
  v_mfma_f32_16x16x32_bf16 v[220:223], v[128:131], a[164:167], v[220:223]
  ds_read_b128 v[156:159], v35 offset:58368
  s_add_u32 s98, s35, 2162688
  buffer_load_dwordx4 a[228:231], v90, s[48:51], s98 offen sc1
  s_waitcnt lgkmcnt(6)
  v_mfma_f32_16x16x32_bf16 v[228:231], v[132:135], a[164:167], v[228:231]
  ds_read_b128 v[160:163], v35 offset:59392
  s_waitcnt lgkmcnt(6)
  v_mfma_f32_16x16x32_bf16 v[236:239], v[136:139], a[164:167], v[236:239]
  ds_read_b128 v[164:167], v35 offset:60416
  s_waitcnt lgkmcnt(6)
  v_mfma_f32_16x16x32_bf16 v[244:247], v[140:143], a[164:167], v[244:247]
  s_barrier
  ds_read_b128 v[128:131], v37 offset:0
  s_add_u32 s98, s35, 2228224
  buffer_load_dwordx4 a[232:235], v90, s[48:51], s98 offen sc1
  s_waitcnt lgkmcnt(6)
  v_mfma_f32_16x16x32_bf16 v[252:255], v[144:147], a[164:167], v[252:255]
  ds_read_b128 v[132:135], v37 offset:1024
  s_waitcnt vmcnt(16) lgkmcnt(6)
  v_mfma_f32_16x16x32_bf16 v[220:223], v[148:151], a[168:171], v[220:223]
  ds_read_b128 v[136:139], v37 offset:2048
  s_waitcnt lgkmcnt(6)
  v_mfma_f32_16x16x32_bf16 v[228:231], v[152:155], a[168:171], v[228:231]
  ds_read_b128 v[140:143], v37 offset:3072
  s_add_u32 s98, s35, 2293760
  buffer_load_dwordx4 a[236:239], v90, s[48:51], s98 offen sc1
  s_waitcnt lgkmcnt(6)
  v_mfma_f32_16x16x32_bf16 v[236:239], v[156:159], a[168:171], v[236:239]
  ds_read_b128 v[144:147], v37 offset:4096
  s_waitcnt lgkmcnt(6)
  v_mfma_f32_16x16x32_bf16 v[244:247], v[160:163], a[168:171], v[244:247]
  ds_read_b128 v[148:151], v37 offset:5120
  s_waitcnt lgkmcnt(6)
  v_mfma_f32_16x16x32_bf16 v[252:255], v[164:167], a[168:171], v[252:255]
  ds_read_b128 v[152:155], v37 offset:6144
  s_add_u32 s98, s35, 2359296
  buffer_load_dwordx4 a[240:243], v90, s[48:51], s98 offen sc1
  s_waitcnt vmcnt(17) lgkmcnt(6)
  v_mfma_f32_16x16x32_bf16 v[220:223], v[128:131], a[172:175], v[220:223]
  ds_read_b128 v[156:159], v37 offset:7168
  s_waitcnt lgkmcnt(6)
  v_mfma_f32_16x16x32_bf16 v[228:231], v[132:135], a[172:175], v[228:231]
  ds_read_b128 v[160:163], v37 offset:8192
  s_waitcnt lgkmcnt(6)
  v_mfma_f32_16x16x32_bf16 v[236:239], v[136:139], a[172:175], v[236:239]
  ds_read_b128 v[164:167], v37 offset:9216
  s_add_u32 s98, s35, 2424832
  buffer_load_dwordx4 a[244:247], v90, s[48:51], s98 offen sc1
  s_waitcnt lgkmcnt(6)
  v_mfma_f32_16x16x32_bf16 v[244:247], v[140:143], a[172:175], v[244:247]
  ds_read_b128 v[128:131], v37 offset:10240
  s_waitcnt lgkmcnt(6)
  v_mfma_f32_16x16x32_bf16 v[252:255], v[144:147], a[172:175], v[252:255]
  ds_read_b128 v[132:135], v37 offset:11264
  s_waitcnt vmcnt(17) lgkmcnt(6)
  v_mfma_f32_16x16x32_bf16 v[220:223], v[148:151], a[176:179], v[220:223]
  ds_read_b128 v[136:139], v37 offset:12288
  s_add_u32 s98, s35, 2490368
  buffer_load_dwordx4 a[248:251], v90, s[48:51], s98 offen sc1
  s_waitcnt lgkmcnt(6)
  v_mfma_f32_16x16x32_bf16 v[228:231], v[152:155], a[176:179], v[228:231]
  ds_read_b128 v[140:143], v37 offset:13312
  s_waitcnt lgkmcnt(6)
  v_mfma_f32_16x16x32_bf16 v[236:239], v[156:159], a[176:179], v[236:239]
  ds_read_b128 v[144:147], v37 offset:14336
  s_add_u32 s98, s35, 2555904
  buffer_load_dwordx4 a[0:3], v90, s[48:51], s98 offen sc1
  s_waitcnt lgkmcnt(6)
  v_mfma_f32_16x16x32_bf16 v[244:247], v[160:163], a[176:179], v[244:247]
  ds_read_b128 v[148:151], v37 offset:15360
  s_waitcnt lgkmcnt(6)
  v_mfma_f32_16x16x32_bf16 v[252:255], v[164:167], a[176:179], v[252:255]
  ds_read_b128 v[152:155], v37 offset:16384
  s_waitcnt vmcnt(18) lgkmcnt(6)
  v_mfma_f32_16x16x32_bf16 v[220:223], v[128:131], a[180:183], v[220:223]
  ds_read_b128 v[156:159], v37 offset:17408
  s_add_u32 s98, s35, 2621440
  buffer_load_dwordx4 a[4:7], v90, s[48:51], s98 offen sc1
  s_waitcnt lgkmcnt(6)
  v_mfma_f32_16x16x32_bf16 v[228:231], v[132:135], a[180:183], v[228:231]
  ds_read_b128 v[160:163], v37 offset:18432
  s_waitcnt lgkmcnt(6)
  v_mfma_f32_16x16x32_bf16 v[236:239], v[136:139], a[180:183], v[236:239]
  ds_read_b128 v[164:167], v37 offset:19456
  s_waitcnt lgkmcnt(6)
  v_mfma_f32_16x16x32_bf16 v[244:247], v[140:143], a[180:183], v[244:247]
  s_barrier
  ds_read_b128 v[128:131], v37 offset:20480
  s_add_u32 s98, s35, 2686976
  buffer_load_dwordx4 a[8:11], v90, s[48:51], s98 offen sc1
  s_waitcnt lgkmcnt(6)
  v_mfma_f32_16x16x32_bf16 v[252:255], v[144:147], a[180:183], v[252:255]
  ds_read_b128 v[132:135], v37 offset:21504
  s_waitcnt vmcnt(19) lgkmcnt(6)
  v_mfma_f32_16x16x32_bf16 v[220:223], v[148:151], a[184:187], v[220:223]
  ds_read_b128 v[136:139], v37 offset:22528
  s_waitcnt lgkmcnt(6)
  v_mfma_f32_16x16x32_bf16 v[228:231], v[152:155], a[184:187], v[228:231]
  ds_read_b128 v[140:143], v37 offset:23552
  s_add_u32 s98, s35, 2752512
  buffer_load_dwordx4 a[12:15], v90, s[48:51], s98 offen sc1
  s_waitcnt lgkmcnt(6)
  v_mfma_f32_16x16x32_bf16 v[236:239], v[156:159], a[184:187], v[236:239]
  ds_read_b128 v[144:147], v37 offset:24576
  s_waitcnt lgkmcnt(6)
  v_mfma_f32_16x16x32_bf16 v[244:247], v[160:163], a[184:187], v[244:247]
  ds_read_b128 v[148:151], v37 offset:25600
  s_waitcnt lgkmcnt(6)
  v_mfma_f32_16x16x32_bf16 v[252:255], v[164:167], a[184:187], v[252:255]
  ds_read_b128 v[152:155], v37 offset:26624
  s_add_u32 s98, s35, 2818048
  buffer_load_dwordx4 a[16:19], v90, s[48:51], s98 offen sc1
  s_waitcnt vmcnt(20) lgkmcnt(6)
  v_mfma_f32_16x16x32_bf16 v[220:223], v[128:131], a[188:191], v[220:223]
  ds_read_b128 v[156:159], v37 offset:27648
  s_waitcnt lgkmcnt(6)
  v_mfma_f32_16x16x32_bf16 v[228:231], v[132:135], a[188:191], v[228:231]
  ds_read_b128 v[160:163], v37 offset:28672
  s_waitcnt lgkmcnt(6)
  v_mfma_f32_16x16x32_bf16 v[236:239], v[136:139], a[188:191], v[236:239]
  ds_read_b128 v[164:167], v37 offset:29696
  s_add_u32 s98, s35, 2883584
  buffer_load_dwordx4 a[20:23], v90, s[48:51], s98 offen sc1
  s_waitcnt lgkmcnt(6)
  v_mfma_f32_16x16x32_bf16 v[244:247], v[140:143], a[188:191], v[244:247]
  ds_read_b128 v[128:131], v37 offset:30720
  s_waitcnt lgkmcnt(6)
  v_mfma_f32_16x16x32_bf16 v[252:255], v[144:147], a[188:191], v[252:255]
  ds_read_b128 v[132:135], v37 offset:31744
  s_waitcnt vmcnt(20) lgkmcnt(6)
  v_mfma_f32_16x16x32_bf16 v[220:223], v[148:151], a[192:195], v[220:223]
  ds_read_b128 v[136:139], v37 offset:32768
  s_add_u32 s98, s35, 2949120
  buffer_load_dwordx4 a[24:27], v90, s[48:51], s98 offen sc1
  s_waitcnt lgkmcnt(6)
  v_mfma_f32_16x16x32_bf16 v[228:231], v[152:155], a[192:195], v[228:231]
  ds_read_b128 v[140:143], v37 offset:33792
  s_waitcnt lgkmcnt(6)
  v_mfma_f32_16x16x32_bf16 v[236:239], v[156:159], a[192:195], v[236:239]
  ds_read_b128 v[144:147], v37 offset:34816
  s_waitcnt lgkmcnt(6)
  v_mfma_f32_16x16x32_bf16 v[244:247], v[160:163], a[192:195], v[244:247]
  ds_read_b128 v[148:151], v42 offset:6144
  s_add_u32 s98, s35, 3014656
  buffer_load_dwordx4 a[28:31], v90, s[48:51], s98 offen sc1
  s_waitcnt lgkmcnt(6)
  v_mfma_f32_16x16x32_bf16 v[252:255], v[164:167], a[192:195], v[252:255]
  ds_read_b128 v[152:155], v42 offset:7168
  s_waitcnt vmcnt(21) lgkmcnt(6)
  v_mfma_f32_16x16x32_bf16 v[220:223], v[128:131], a[196:199], v[220:223]
  ds_read_b128 v[156:159], v42 offset:8192
  s_waitcnt lgkmcnt(6)
  v_mfma_f32_16x16x32_bf16 v[228:231], v[132:135], a[196:199], v[228:231]
  ds_read_b128 v[160:163], v42 offset:9216
  s_waitcnt lgkmcnt(6)
  v_mfma_f32_16x16x32_bf16 v[236:239], v[136:139], a[196:199], v[236:239]
  ds_read_b128 v[164:167], v42 offset:10240
  s_waitcnt lgkmcnt(6)
  v_mfma_f32_16x16x32_bf16 v[244:247], v[140:143], a[196:199], v[244:247]
  ds_read_b128 v[128:131], v42 offset:11264
  s_waitcnt lgkmcnt(6)
  v_mfma_f32_16x16x32_bf16 v[252:255], v[144:147], a[196:199], v[252:255]
  ds_read_b128 v[132:135], v42 offset:12288
  s_waitcnt vmcnt(20) lgkmcnt(6)
  v_mfma_f32_16x16x32_bf16 v[216:219], v[148:151], a[200:203], v[216:219]
  ds_read_b128 v[136:139], v42 offset:13312
  s_waitcnt lgkmcnt(6)
  v_mfma_f32_16x16x32_bf16 v[224:227], v[152:155], a[200:203], v[224:227]
  ds_read_b128 v[140:143], v42 offset:14336
  v_bfi_b32 v220, v39, s68, v220
  v_bfi_b32 v221, v39, s69, v221
  v_bfi_b32 v222, v39, s70, v222
  s_waitcnt lgkmcnt(6)
  v_mfma_f32_16x16x32_bf16 v[232:235], v[156:159], a[200:203], v[232:235]
  ds_read_b128 v[144:147], v42 offset:15360
  v_bfi_b32 v223, v39, s71, v223
  buffer_store_dwordx4 v[220:223], v43, s[56:59], s87 offen offset:0 sc1
  v_bfi_b32 v228, v39, s68, v228
  s_waitcnt lgkmcnt(6)
  v_mfma_f32_16x16x32_bf16 v[240:243], v[160:163], a[200:203], v[240:243]
  ds_read_b128 v[148:151], v40 offset:0
  v_bfi_b32 v229, v39, s69, v229
  v_bfi_b32 v230, v39, s70, v230
  v_bfi_b32 v231, v39, s71, v231
  s_waitcnt lgkmcnt(6)
  v_mfma_f32_16x16x32_bf16 v[248:251], v[164:167], a[200:203], v[248:251]
  ds_read_b128 v[152:155], v40 offset:1024
  buffer_store_dwordx4 v[228:231], v43, s[56:59], s87 offen offset:1024 sc1
  v_bfi_b32 v236, v39, s68, v236
  s_waitcnt vmcnt(21) lgkmcnt(6)
  v_mfma_f32_16x16x32_bf16 v[216:219], v[128:131], a[204:207], v[216:219]
  ds_read_b128 v[156:159], v40 offset:2048
  v_bfi_b32 v237, v39, s69, v237
  v_bfi_b32 v238, v39, s70, v238
  s_waitcnt lgkmcnt(6)
  v_mfma_f32_16x16x32_bf16 v[224:227], v[132:135], a[204:207], v[224:227]
  ds_read_b128 v[160:163], v40 offset:3072
  v_bfi_b32 v239, v39, s71, v239
  buffer_store_dwordx4 v[236:239], v43, s[56:59], s87 offen offset:2048 sc1
  s_waitcnt lgkmcnt(6)
  v_mfma_f32_16x16x32_bf16 v[232:235], v[136:139], a[204:207], v[232:235]
  ds_read_b128 v[164:167], v40 offset:4096
  v_bfi_b32 v244, v39, s68, v244
  v_bfi_b32 v245, v39, s69, v245
  s_waitcnt lgkmcnt(6)
  v_mfma_f32_16x16x32_bf16 v[240:243], v[140:143], a[204:207], v[240:243]
  ds_read_b128 v[128:131], v40 offset:5120
  v_bfi_b32 v246, v39, s70, v246
  v_bfi_b32 v247, v39, s71, v247
  s_waitcnt lgkmcnt(6)
  v_mfma_f32_16x16x32_bf16 v[248:251], v[144:147], a[204:207], v[248:251]
  ds_read_b128 v[132:135], v40 offset:6144
  s_barrier
  buffer_store_dwordx4 v[244:247], v43, s[56:59], s87 offen offset:3072 sc1
  v_bfi_b32 v252, v39, s68, v252
  s_waitcnt vmcnt(22) lgkmcnt(6)
  v_mfma_f32_16x16x32_bf16 v[216:219], v[148:151], a[208:211], v[216:219]
  ds_read_b128 v[136:139], v40 offset:7168
  v_bfi_b32 v253, v39, s69, v253
  v_bfi_b32 v254, v39, s70, v254
  s_waitcnt lgkmcnt(6)
  v_mfma_f32_16x16x32_bf16 v[224:227], v[152:155], a[208:211], v[224:227]
  ds_read_b128 v[140:143], v40 offset:8192
  v_bfi_b32 v255, v39, s71, v255
  buffer_store_dwordx4 v[252:255], v43, s[56:59], s62 offen offset:0 sc1
  s_waitcnt lgkmcnt(6)
  v_mfma_f32_16x16x32_bf16 v[232:235], v[156:159], a[208:211], v[232:235]
  ds_read_b128 v[144:147], v40 offset:9216
  s_waitcnt lgkmcnt(6)
  v_mfma_f32_16x16x32_bf16 v[240:243], v[160:163], a[208:211], v[240:243]
  ds_read_b128 v[148:151], v40 offset:10240
  s_waitcnt lgkmcnt(6)
  v_mfma_f32_16x16x32_bf16 v[248:251], v[164:167], a[208:211], v[248:251]
  ds_read_b128 v[152:155], v40 offset:11264
  s_waitcnt vmcnt(22) lgkmcnt(6)
  v_mfma_f32_16x16x32_bf16 v[216:219], v[128:131], a[212:215], v[216:219]
  ds_read_b128 v[156:159], v40 offset:12288
  s_waitcnt lgkmcnt(6)
  v_mfma_f32_16x16x32_bf16 v[224:227], v[132:135], a[212:215], v[224:227]
  ds_read_b128 v[160:163], v40 offset:13312
  s_waitcnt lgkmcnt(6)
  v_mfma_f32_16x16x32_bf16 v[232:235], v[136:139], a[212:215], v[232:235]
  ds_read_b128 v[164:167], v40 offset:14336
  s_waitcnt lgkmcnt(6)
  v_mfma_f32_16x16x32_bf16 v[240:243], v[140:143], a[212:215], v[240:243]
  ds_read_b128 v[128:131], v40 offset:15360
  s_waitcnt lgkmcnt(6)
  v_mfma_f32_16x16x32_bf16 v[248:251], v[144:147], a[212:215], v[248:251]
  ds_read_b128 v[132:135], v40 offset:16384
  s_waitcnt vmcnt(21) lgkmcnt(6)
  v_mfma_f32_16x16x32_bf16 v[216:219], v[148:151], a[216:219], v[216:219]
  ds_read_b128 v[136:139], v40 offset:17408
  s_waitcnt lgkmcnt(6)
  v_mfma_f32_16x16x32_bf16 v[224:227], v[152:155], a[216:219], v[224:227]
  ds_read_b128 v[140:143], v40 offset:18432
  s_waitcnt lgkmcnt(6)
  v_mfma_f32_16x16x32_bf16 v[232:235], v[156:159], a[216:219], v[232:235]
  ds_read_b128 v[144:147], v40 offset:19456
  s_waitcnt lgkmcnt(6)
  v_mfma_f32_16x16x32_bf16 v[240:243], v[160:163], a[216:219], v[240:243]
  ds_read_b128 v[148:151], v40 offset:20480
  s_waitcnt lgkmcnt(6)
  v_mfma_f32_16x16x32_bf16 v[248:251], v[164:167], a[216:219], v[248:251]
  ds_read_b128 v[152:155], v40 offset:21504
  s_waitcnt vmcnt(20) lgkmcnt(6)
  v_mfma_f32_16x16x32_bf16 v[216:219], v[128:131], a[220:223], v[216:219]
  ds_read_b128 v[156:159], v40 offset:22528
  s_waitcnt lgkmcnt(6)
  v_mfma_f32_16x16x32_bf16 v[224:227], v[132:135], a[220:223], v[224:227]
  ds_read_b128 v[160:163], v40 offset:23552
  s_waitcnt lgkmcnt(6)
  v_mfma_f32_16x16x32_bf16 v[232:235], v[136:139], a[220:223], v[232:235]
  ds_read_b128 v[164:167], v40 offset:24576
  s_waitcnt lgkmcnt(6)
  v_mfma_f32_16x16x32_bf16 v[240:243], v[140:143], a[220:223], v[240:243]
  ds_read_b128 v[128:131], v40 offset:25600
  s_waitcnt lgkmcnt(6)
  v_mfma_f32_16x16x32_bf16 v[248:251], v[144:147], a[220:223], v[248:251]
  ds_read_b128 v[132:135], v40 offset:26624
  s_waitcnt vmcnt(19) lgkmcnt(6)
  v_mfma_f32_16x16x32_bf16 v[216:219], v[148:151], a[224:227], v[216:219]
  ds_read_b128 v[136:139], v40 offset:27648
  s_waitcnt lgkmcnt(6)
  v_mfma_f32_16x16x32_bf16 v[224:227], v[152:155], a[224:227], v[224:227]
  ds_read_b128 v[140:143], v40 offset:28672
  s_waitcnt lgkmcnt(6)
  v_mfma_f32_16x16x32_bf16 v[232:235], v[156:159], a[224:227], v[232:235]
  ds_read_b128 v[144:147], v40 offset:29696
  s_waitcnt lgkmcnt(6)
  v_mfma_f32_16x16x32_bf16 v[240:243], v[160:163], a[224:227], v[240:243]
  ds_read_b128 v[148:151], v40 offset:30720
  s_waitcnt lgkmcnt(6)
  v_mfma_f32_16x16x32_bf16 v[248:251], v[164:167], a[224:227], v[248:251]
  ds_read_b128 v[152:155], v40 offset:31744
  s_waitcnt vmcnt(18) lgkmcnt(6)
  v_mfma_f32_16x16x32_bf16 v[216:219], v[128:131], a[228:231], v[216:219]
  ds_read_b128 v[156:159], v40 offset:32768
  s_waitcnt lgkmcnt(6)
  v_mfma_f32_16x16x32_bf16 v[224:227], v[132:135], a[228:231], v[224:227]
  ds_read_b128 v[160:163], v40 offset:33792
  s_waitcnt lgkmcnt(6)
  v_mfma_f32_16x16x32_bf16 v[232:235], v[136:139], a[228:231], v[232:235]
  ds_read_b128 v[164:167], v40 offset:34816
  s_waitcnt lgkmcnt(6)
  v_mfma_f32_16x16x32_bf16 v[240:243], v[140:143], a[228:231], v[240:243]
  ds_read_b128 v[128:131], v40 offset:35840
  s_waitcnt lgkmcnt(6)
  v_mfma_f32_16x16x32_bf16 v[248:251], v[144:147], a[228:231], v[248:251]
  ds_read_b128 v[132:135], v40 offset:36864
  s_waitcnt vmcnt(17) lgkmcnt(6)
  v_mfma_f32_16x16x32_bf16 v[216:219], v[148:151], a[232:235], v[216:219]
  ds_read_b128 v[136:139], v40 offset:37888
  s_waitcnt lgkmcnt(6)
  v_mfma_f32_16x16x32_bf16 v[224:227], v[152:155], a[232:235], v[224:227]
  ds_read_b128 v[140:143], v40 offset:38912
  s_waitcnt lgkmcnt(6)
  v_mfma_f32_16x16x32_bf16 v[232:235], v[156:159], a[232:235], v[232:235]
  ds_read_b128 v[144:147], v40 offset:39936
  s_waitcnt lgkmcnt(6)
  v_mfma_f32_16x16x32_bf16 v[240:243], v[160:163], a[232:235], v[240:243]
  ds_read_b128 v[148:151], v35 offset:40960
  s_waitcnt lgkmcnt(6)
  v_mfma_f32_16x16x32_bf16 v[248:251], v[164:167], a[232:235], v[248:251]
  ds_read_b128 v[152:155], v35 offset:41984
  s_waitcnt vmcnt(16) lgkmcnt(6)
  v_mfma_f32_16x16x32_bf16 v[216:219], v[128:131], a[236:239], v[216:219]
  ds_read_b128 v[156:159], v35 offset:43008
  s_waitcnt lgkmcnt(6)
  v_mfma_f32_16x16x32_bf16 v[224:227], v[132:135], a[236:239], v[224:227]
  ds_read_b128 v[160:163], v35 offset:44032
  s_waitcnt lgkmcnt(6)
  v_mfma_f32_16x16x32_bf16 v[232:235], v[136:139], a[236:239], v[232:235]
  ds_read_b128 v[164:167], v35 offset:45056
  s_waitcnt lgkmcnt(6)
  v_mfma_f32_16x16x32_bf16 v[240:243], v[140:143], a[236:239], v[240:243]
  ds_read_b128 v[128:131], v35 offset:46080
  s_waitcnt lgkmcnt(6)
  v_mfma_f32_16x16x32_bf16 v[248:251], v[144:147], a[236:239], v[248:251]
  ds_read_b128 v[132:135], v35 offset:47104
  s_waitcnt vmcnt(15) lgkmcnt(6)
  v_mfma_f32_16x16x32_bf16 v[216:219], v[148:151], a[240:243], v[216:219]
  ds_read_b128 v[136:139], v35 offset:48128
  s_waitcnt lgkmcnt(6)
  v_mfma_f32_16x16x32_bf16 v[224:227], v[152:155], a[240:243], v[224:227]
  ds_read_b128 v[140:143], v35 offset:49152
  s_waitcnt lgkmcnt(6)
  v_mfma_f32_16x16x32_bf16 v[232:235], v[156:159], a[240:243], v[232:235]
  ds_read_b128 v[144:147], v35 offset:50176
  s_waitcnt lgkmcnt(6)
  v_mfma_f32_16x16x32_bf16 v[240:243], v[160:163], a[240:243], v[240:243]
  ds_read_b128 v[148:151], v35 offset:51200
  s_waitcnt lgkmcnt(6)
  v_mfma_f32_16x16x32_bf16 v[248:251], v[164:167], a[240:243], v[248:251]
  ds_read_b128 v[152:155], v35 offset:52224
  s_waitcnt vmcnt(14) lgkmcnt(6)
  v_mfma_f32_16x16x32_bf16 v[216:219], v[128:131], a[244:247], v[216:219]
  ds_read_b128 v[156:159], v35 offset:53248
  s_waitcnt lgkmcnt(6)
  v_mfma_f32_16x16x32_bf16 v[224:227], v[132:135], a[244:247], v[224:227]
  ds_read_b128 v[160:163], v35 offset:54272
  s_waitcnt lgkmcnt(6)
  v_mfma_f32_16x16x32_bf16 v[232:235], v[136:139], a[244:247], v[232:235]
  ds_read_b128 v[164:167], v35 offset:55296
  s_waitcnt lgkmcnt(6)
  v_mfma_f32_16x16x32_bf16 v[240:243], v[140:143], a[244:247], v[240:243]
  ds_read_b128 v[128:131], v35 offset:56320
  s_waitcnt lgkmcnt(6)
  v_mfma_f32_16x16x32_bf16 v[248:251], v[144:147], a[244:247], v[248:251]
  ds_read_b128 v[132:135], v35 offset:57344
  s_waitcnt vmcnt(13) lgkmcnt(6)
  v_mfma_f32_16x16x32_bf16 v[216:219], v[148:151], a[248:251], v[216:219]
  ds_read_b128 v[136:139], v35 offset:58368
  s_waitcnt lgkmcnt(6)
L_pgf7:
  s_cbranch_execz L_pgfr
  v_mfma_f32_16x16x32_bf16 v[224:227], v[152:155], a[248:251], v[224:227]
  ds_read_b128 v[140:143], v35 offset:59392
  s_waitcnt lgkmcnt(6)
  v_mfma_f32_16x16x32_bf16 v[232:235], v[156:159], a[248:251], v[232:235]
  ds_read_b128 v[144:147], v35 offset:60416
  s_waitcnt lgkmcnt(6)
  v_mfma_f32_16x16x32_bf16 v[240:243], v[160:163], a[248:251], v[240:243]
  ds_read_b128 v[148:151], v37 offset:0
  s_waitcnt lgkmcnt(6)
  v_mfma_f32_16x16x32_bf16 v[248:251], v[164:167], a[248:251], v[248:251]
  ds_read_b128 v[152:155], v37 offset:1024
  s_waitcnt vmcnt(12) lgkmcnt(6)
  v_mfma_f32_16x16x32_bf16 v[216:219], v[128:131], a[0:3], v[216:219]
  ds_read_b128 v[156:159], v37 offset:2048
  s_waitcnt lgkmcnt(6)
  v_mfma_f32_16x16x32_bf16 v[224:227], v[132:135], a[0:3], v[224:227]
  ds_read_b128 v[160:163], v37 offset:3072
  s_waitcnt lgkmcnt(6)
  v_mfma_f32_16x16x32_bf16 v[232:235], v[136:139], a[0:3], v[232:235]
  ds_read_b128 v[164:167], v37 offset:4096
  s_waitcnt lgkmcnt(6)
  v_mfma_f32_16x16x32_bf16 v[240:243], v[140:143], a[0:3], v[240:243]
  ds_read_b128 v[128:131], v37 offset:5120
  s_waitcnt lgkmcnt(6)
  v_mfma_f32_16x16x32_bf16 v[248:251], v[144:147], a[0:3], v[248:251]
  ds_read_b128 v[132:135], v37 offset:6144
  s_waitcnt vmcnt(11) lgkmcnt(6)
  v_mfma_f32_16x16x32_bf16 v[216:219], v[148:151], a[4:7], v[216:219]
  ds_read_b128 v[136:139], v37 offset:7168
  s_waitcnt lgkmcnt(6)
  v_mfma_f32_16x16x32_bf16 v[224:227], v[152:155], a[4:7], v[224:227]
  ds_read_b128 v[140:143], v37 offset:8192
  s_cmp_lg_u32 s7, 0
  s_cbranch_scc1 L_tka0
  s_add_u32 s95, s7, 0
  buffer_load_dword v204, v208, s[56:59], s95 offen sc1
  s_add_u32 s95, s7, 32768
  buffer_load_dword v205, v208, s[56:59], s95 offen sc1
  s_add_u32 s95, s7, 65536
  buffer_load_dword v206, v208, s[56:59], s95 offen sc1
  s_add_u32 s95, s7, 98304
  buffer_load_dword v207, v208, s[56:59], s95 offen sc1
L_tka0:
  s_add_u32 m0, s12, 5120
  s_nop 0
  buffer_load_dwordx4 v35, s[56:59], s88 offen offset:0 sc1 lds
  buffer_load_dwordx4 v35, s[56:59], s88 offen offset:1024 sc1 lds
  buffer_load_dwordx4 v35, s[56:59], s88 offen offset:2048 sc1 lds
  buffer_load_dwordx4 v35, s[56:59], s88 offen offset:3072 sc1 lds
  s_add_u32 m0, s12, 9216
  s_nop 0
  buffer_load_dwordx4 v35, s[56:59], s63 offen offset:0 sc1 lds
  s_waitcnt lgkmcnt(6)
  v_mfma_f32_16x16x32_bf16 v[232:235], v[156:159], a[4:7], v[232:235]
  ds_read_b128 v[144:147], v37 offset:9216
  s_waitcnt lgkmcnt(6)
  v_mfma_f32_16x16x32_bf16 v[240:243], v[160:163], a[4:7], v[240:243]
  ds_read_b128 v[148:151], v37 offset:10240
  s_waitcnt lgkmcnt(6)
  v_mfma_f32_16x16x32_bf16 v[248:251], v[164:167], a[4:7], v[248:251]
  ds_read_b128 v[152:155], v37 offset:11264
  s_waitcnt vmcnt(15) lgkmcnt(6)
  v_mfma_f32_16x16x32_bf16 v[216:219], v[128:131], a[8:11], v[216:219]
  ds_read_b128 v[156:159], v37 offset:12288
  s_waitcnt lgkmcnt(6)
  v_mfma_f32_16x16x32_bf16 v[224:227], v[132:135], a[8:11], v[224:227]
  ds_read_b128 v[160:163], v37 offset:13312
  s_waitcnt lgkmcnt(6)
  v_mfma_f32_16x16x32_bf16 v[232:235], v[136:139], a[8:11], v[232:235]
  ds_read_b128 v[164:167], v37 offset:14336
  s_waitcnt lgkmcnt(6)
  v_mfma_f32_16x16x32_bf16 v[240:243], v[140:143], a[8:11], v[240:243]
  ds_read_b128 v[128:131], v37 offset:15360
  s_waitcnt lgkmcnt(6)
  v_mfma_f32_16x16x32_bf16 v[248:251], v[144:147], a[8:11], v[248:251]
  ds_read_b128 v[132:135], v37 offset:16384
  s_waitcnt vmcnt(14) lgkmcnt(6)
  v_mfma_f32_16x16x32_bf16 v[216:219], v[148:151], a[12:15], v[216:219]
  ds_read_b128 v[136:139], v37 offset:17408
  s_waitcnt lgkmcnt(6)
  v_mfma_f32_16x16x32_bf16 v[224:227], v[152:155], a[12:15], v[224:227]
  ds_read_b128 v[140:143], v37 offset:18432
  s_waitcnt lgkmcnt(6)
  v_mfma_f32_16x16x32_bf16 v[232:235], v[156:159], a[12:15], v[232:235]
  ds_read_b128 v[144:147], v37 offset:19456
  s_waitcnt lgkmcnt(6)
  v_mfma_f32_16x16x32_bf16 v[240:243], v[160:163], a[12:15], v[240:243]
  ds_read_b128 v[148:151], v37 offset:20480
  s_waitcnt lgkmcnt(6)
  v_mfma_f32_16x16x32_bf16 v[248:251], v[164:167], a[12:15], v[248:251]
  ds_read_b128 v[152:155], v37 offset:21504
  s_waitcnt vmcnt(13) lgkmcnt(6)
  v_mfma_f32_16x16x32_bf16 v[216:219], v[128:131], a[16:19], v[216:219]
  ds_read_b128 v[156:159], v37 offset:22528
  s_waitcnt lgkmcnt(6)
  v_mfma_f32_16x16x32_bf16 v[224:227], v[132:135], a[16:19], v[224:227]
  ds_read_b128 v[160:163], v37 offset:23552
  s_waitcnt lgkmcnt(6)
  v_mfma_f32_16x16x32_bf16 v[232:235], v[136:139], a[16:19], v[232:235]
  ds_read_b128 v[164:167], v37 offset:24576
  s_waitcnt lgkmcnt(6)
  v_mfma_f32_16x16x32_bf16 v[240:243], v[140:143], a[16:19], v[240:243]
  ds_read_b128 v[128:131], v37 offset:25600
  s_waitcnt lgkmcnt(6)
  v_mfma_f32_16x16x32_bf16 v[248:251], v[144:147], a[16:19], v[248:251]
  ds_read_b128 v[132:135], v37 offset:26624
  s_waitcnt vmcnt(12) lgkmcnt(6)
  v_mfma_f32_16x16x32_bf16 v[216:219], v[148:151], a[20:23], v[216:219]
  ds_read_b128 v[136:139], v37 offset:27648
  s_waitcnt lgkmcnt(6)
  v_mfma_f32_16x16x32_bf16 v[224:227], v[152:155], a[20:23], v[224:227]
  ds_read_b128 v[140:143], v37 offset:28672
  s_waitcnt lgkmcnt(6)
  v_mfma_f32_16x16x32_bf16 v[232:235], v[156:159], a[20:23], v[232:235]
  ds_read_b128 v[144:147], v37 offset:29696
  s_waitcnt lgkmcnt(6)
  v_mfma_f32_16x16x32_bf16 v[240:243], v[160:163], a[20:23], v[240:243]
  ds_read_b128 v[148:151], v37 offset:30720
  s_waitcnt lgkmcnt(6)
  v_mfma_f32_16x16x32_bf16 v[248:251], v[164:167], a[20:23], v[248:251]
  ds_read_b128 v[152:155], v37 offset:31744
  s_waitcnt vmcnt(11) lgkmcnt(6)
  v_mfma_f32_16x16x32_bf16 v[216:219], v[128:131], a[24:27], v[216:219]
  ds_read_b128 v[156:159], v37 offset:32768
  s_waitcnt lgkmcnt(6)
  v_mfma_f32_16x16x32_bf16 v[224:227], v[132:135], a[24:27], v[224:227]
  ds_read_b128 v[160:163], v37 offset:33792
  s_waitcnt lgkmcnt(6)
  v_mfma_f32_16x16x32_bf16 v[232:235], v[136:139], a[24:27], v[232:235]
  ds_read_b128 v[164:167], v37 offset:34816
  s_waitcnt lgkmcnt(6)
  v_mfma_f32_16x16x32_bf16 v[240:243], v[140:143], a[24:27], v[240:243]
  s_waitcnt lgkmcnt(5)
  v_mfma_f32_16x16x32_bf16 v[248:251], v[144:147], a[24:27], v[248:251]
  s_waitcnt vmcnt(10) lgkmcnt(4)
  v_mfma_f32_16x16x32_bf16 v[216:219], v[148:151], a[28:31], v[216:219]
  s_waitcnt lgkmcnt(3)
  v_mfma_f32_16x16x32_bf16 v[224:227], v[152:155], a[28:31], v[224:227]
  s_waitcnt lgkmcnt(2)
  v_mfma_f32_16x16x32_bf16 v[232:235], v[156:159], a[28:31], v[232:235]
  s_waitcnt lgkmcnt(1)
  v_mfma_f32_16x16x32_bf16 v[240:243], v[160:163], a[28:31], v[240:243]
  s_waitcnt lgkmcnt(0)
  v_mfma_f32_16x16x32_bf16 v[248:251], v[164:167], a[28:31], v[248:251]
  ds_write_b128 v44, v[216:219] offset:0
  s_nop 0
  ds_write_b128 v44, v[224:227] offset:1024
  s_nop 0
  ds_write_b128 v44, v[232:235] offset:2048
  s_nop 0
  ds_write_b128 v44, v[240:243] offset:3072
  s_nop 0
  ds_write_b128 v44, v[248:251] offset:4096
  ds_read_b128 v[104:107], v45 offset:0
  ds_read_b128 v[108:111], v45 offset:1024
  ds_read_b128 v[112:115], v45 offset:2048
  ds_read_b128 v[116:119], v45 offset:3072
  ds_read_b128 v[120:123], v45 offset:4096
  s_waitcnt vmcnt(4)
  ds_read_b128 v[6:9], v45 offset:5120
  s_waitcnt vmcnt(3)
  ds_read_b128 v[10:13], v45 offset:6144
  s_waitcnt vmcnt(2)
  ds_read_b128 v[14:17], v45 offset:7168
  s_waitcnt vmcnt(1)
  ds_read_b128 v[18:21], v45 offset:8192
  s_waitcnt vmcnt(0)
  s_waitcnt lgkmcnt(11)
  ds_read_b128 v[22:25], v45 offset:9216
  s_waitcnt lgkmcnt(9)
  v_pk_add_f32 v[104:105], v[104:105], v[180:181]
  v_pk_add_f32 v[106:107], v[106:107], v[182:183]
  s_waitcnt lgkmcnt(8)
  v_pk_add_f32 v[108:109], v[108:109], v[184:185]
  v_pk_add_f32 v[110:111], v[110:111], v[186:187]
  s_waitcnt lgkmcnt(7)
  v_pk_add_f32 v[112:113], v[112:113], v[188:189]
  v_pk_add_f32 v[114:115], v[114:115], v[190:191]
  s_waitcnt lgkmcnt(6)
  v_pk_add_f32 v[116:117], v[116:117], v[192:193]
  v_pk_add_f32 v[118:119], v[118:119], v[194:195]
  s_waitcnt lgkmcnt(5)
  v_pk_add_f32 v[120:121], v[120:121], v[196:197]
  v_pk_add_f32 v[122:123], v[122:123], v[198:199]
  s_waitcnt lgkmcnt(4)
  v_xor_b32 v200, s68, v6
  v_xor_b32 v201, s69, v7
  v_xor_b32 v202, s70, v8
  v_xor_b32 v203, s71, v9
  s_waitcnt lgkmcnt(3)
  v_bitop3_b32 v200, v200, v10, s68 bitop3:0xf6
  v_bitop3_b32 v201, v201, v11, s69 bitop3:0xf6
  v_bitop3_b32 v202, v202, v12, s70 bitop3:0xf6
  v_bitop3_b32 v203, v203, v13, s71 bitop3:0xf6
  s_waitcnt lgkmcnt(2)
  v_bitop3_b32 v200, v200, v14, s68 bitop3:0xf6
  v_bitop3_b32 v201, v201, v15, s69 bitop3:0xf6
  v_bitop3_b32 v202, v202, v16, s70 bitop3:0xf6
  v_bitop3_b32 v203, v203, v17, s71 bitop3:0xf6
  s_waitcnt lgkmcnt(1)
  v_bitop3_b32 v200, v200, v18, s68 bitop3:0xf6
  v_bitop3_b32 v201, v201, v19, s69 bitop3:0xf6
  v_bitop3_b32 v202, v202, v20, s70 bitop3:0xf6
  v_bitop3_b32 v203, v203, v21, s71 bitop3:0xf6
  s_waitcnt lgkmcnt(0)
  v_bitop3_b32 v200, v200, v22, s68 bitop3:0xf6
  v_bitop3_b32 v201, v201, v23, s69 bitop3:0xf6
  v_bitop3_b32 v202, v202, v24, s70 bitop3:0xf6
  v_bitop3_b32 v203, v203, v25, s71 bitop3:0xf6
  v_or3_b32 v200, v200, v201, v202
  v_bitop3_b32 v200, v200, v203, v39 bitop3:0xa8
  v_cmp_ne_u32 vcc, 0, v200
  s_nop 1
  s_cmp_lg_u64 vcc, 0
  s_cbranch_scc1 L_slow6
L_back6:
  v_pk_add_f32 v[104:105], v[104:105], v[6:7]
  v_pk_add_f32 v[106:107], v[106:107], v[8:9]
  buffer_store_dwordx4 v[104:107], v36, s[64:67], 0 offen offset:0
  v_pk_add_f32 v[108:109], v[108:109], v[10:11]
  v_pk_add_f32 v[110:111], v[110:111], v[12:13]
  buffer_store_dwordx4 v[108:111], v36, s[64:67], 0 offen offset:64
  v_pk_add_f32 v[112:113], v[112:113], v[14:15]
  v_pk_add_f32 v[114:115], v[114:115], v[16:17]
  buffer_store_dwordx4 v[112:115], v36, s[64:67], 0 offen offset:128
  v_pk_add_f32 v[116:117], v[116:117], v[18:19]
  v_pk_add_f32 v[118:119], v[118:119], v[20:21]
  buffer_store_dwordx4 v[116:119], v36, s[64:67], 0 offen offset:192
  v_pk_add_f32 v[120:121], v[120:121], v[22:23]
  v_pk_add_f32 v[122:123], v[122:123], v[24:25]
  buffer_store_dwordx4 v[120:123], v36, s[64:67], 0 offen offset:256
  s_cmp_lg_u32 s7, 0
  s_cbranch_scc1 L_tkb0
  v_xor_b32 v204, s61, v204
  v_xor_b32 v205, s61, v205
  v_xor_b32 v206, s61, v206
  v_xor_b32 v207, s61, v207
  v_or3_b32 v204, v204, v205, v206
  v_or_b32 v204, v204, v207
  v_cmp_ne_u32 vcc, 0, v204
  s_nop 1
  s_cmp_lg_u64 vcc, 0
  s_cbranch_scc1 L_slow7
L_back7:
  s_add_u32 s83, s7, 327680
  v_mov_b32 v2, s61
  buffer_store_dword v2, off, s[56:59], s83 sc1
L_tkb0:
  s_endpgm
L_ssm:
  s_and_b32 s84, s80, 7
  s_lshr_b32 s85, s80, 3
  s_lshl1_add_u32 s16, s84, s85
  s_mul_i32 s84, s84, 5
  s_mul_i32 s85, s85, 3
  s_add_u32 s85, s84, s85
  v_lshl_add_u32 v120, v120, 6, s89
  v_bfe_u32 v127, v1, 2, 1
  v_mul_u32_u24 v127, 81856, v127
  v_lshl_add_u32 v127, v4, 6, v127
  v_and_b32 v121, 7, v1
  v_lshl_add_u32 v127, v121, 4, v127
  s_lshl_b32 s84, s7, 15
  s_add_u32 s84, s84, 16846848
  s_add_u32 s76, s38, s84
  s_addc_u32 s77, s39, 0
  s_and_b32 s77, s77, 0xffff
  s_mov_b32 s78, 16384
  s_mov_b32 s79, 0x20000
  s_sub_u32 s84, 15, s80
  s_lshl_b32 s94, s84, 10
  s_add_u32 s94, s94, s6
  s_lshl2_add_u32 s92, s82, s84
  s_lshl_b32 s92, s92, 10
  s_add_u32 s92, s92, 1024
  s_lshl_b32 s10, s82, 2
  s_sub_i32 s10, s80, s10
  s_max_i32 s10, s10, 0
  s_min_i32 s10, s10, 4
  s_lshr_b32 s84, s82, 1
  s_and_b32 s83, s82, 1
  s_lshl_b32 s13, s84, 11
  s_lshl_b32 s86, s83, 9
  s_add_u32 s13, s13, s86
  s_add_u32 s13, s13, 152576
  s_mul_i32 s86, s84, 20
  s_lshl1_add_u32 s86, s83, s86
  s_lshl_b32 s91, s7, 2
  s_add_u32 s91, s91, 32
  s_add_u32 s86, s86, s91
  s_lshl_b32 s91, s91, 15
  s_mul_i32 s93, s86, 40960
  s_lshl_b32 s84, s85, 10
  s_add_u32 s93, s93, s84
  s_mul_i32 s84, s83, 81408
  s_sub_u32 s93, s93, s84
  s_lshl4_add_u32 s16, s86, s16
  s_lshl_b32 s16, s16, 7
  s_add_u32 s16, s16, 131072
  s_add_u32 s63, s63, 81920
  s_lshl_b32 s12, s82, 11
  s_add_u32 s12, s12, 2048
  s_cmp_lg_u32 s82, 0
  s_cselect_b32 s11, 1, 0
  s_cselect_b32 s12, s12, 162816
  s_lshl_b32 s83, s82, 9
  v_lshl_add_u32 v126, v1, 3, s83
  v_and_b32 v87, 19, v1
  v_bfe_u32 v88, v1, 2, 1
  v_lshl_add_u32 v87, v88, 3, v87
  v_bfe_u32 v88, v1, 3, 1
  v_lshl_add_u32 v87, v88, 2, v87
  v_lshlrev_b32 v87, 4, v87
  v_add_u32 v87, 152576, v87
  v_lshrrev_b32 v88, 5, v1
  v_lshl_add_u32 v88, v88, 9, v87
  s_mov_b32 s83, s82
  v_and_b32 v106, 31, v1
  v_lshlrev_b32 v106, 7, v106
  v_bfe_u32 v104, v1, 1, 3
  v_lshrrev_b32 v105, 5, v1
  v_xor_b32 v104, v104, v105
  s_lshl_b32 s83, s83, 1
  v_xor_b32 v104, s83, v104
  v_xor_b32 v105, 0, v104
  v_lshl_add_u32 v10, v105, 4, v106
  v_xor_b32 v105, 2, v104
  v_lshl_add_u32 v11, v105, 4, v106
  v_xor_b32 v105, 4, v104
  v_lshl_add_u32 v12, v105, 4, v106
  v_xor_b32 v105, 6, v104
  v_lshl_add_u32 v13, v105, 4, v106
  v_mov_b32 v18, v10
  v_add_u32 v10, s89, v10
  v_mov_b32 v19, v11
  v_add_u32 v11, s89, v11
  v_mov_b32 v20, v12
  v_add_u32 v12, s89, v12
  v_mov_b32 v21, v13
  v_add_u32 v13, s89, v13
  s_add_u32 m0, s89, 0
  s_nop 0
  buffer_load_dwordx4 v6, s[40:43], s87 offen offset:0 lds
  buffer_load_dwordx4 v7, s[40:43], s87 offen offset:1024 lds
  buffer_load_dwordx4 v8, s[40:43], s87 offen offset:2048 lds
  buffer_load_dwordx4 v9, s[40:43], s87 offen offset:3072 lds
  s_add_u32 s87, s87, 128
  s_mov_b32 s88, s3
  s_add_u32 m0, s90, 0
  s_nop 0
  buffer_load_dwordx4 v14, s[44:47], s88 offen offset:0 lds
  buffer_load_dwordx4 v15, s[44:47], s88 offen offset:1024 lds
  buffer_load_dwordx4 v16, s[44:47], s88 offen offset:2048 lds
  buffer_load_dwordx4 v17, s[44:47], s88 offen offset:3072 lds
  s_add_u32 s88, s88, 128
  s_waitcnt vmcnt(17)
  v_lshlrev_b32 v216, 16, v216
  s_waitcnt vmcnt(16)
  v_lshlrev_b32 v217, 16, v217
  s_waitcnt vmcnt(15)
  v_lshlrev_b32 v218, 16, v218
  v_mul_f32 v218, 0x3fb8aa3b, v218
  v_exp_f32 v218, v218
  s_nop 0
  v_cvt_pk_bf16_f32 v218, v218, v218
  v_and_b32 v218, 0xffff0000, v218
  v_mul_f32 v219, v218, v216
  v_mul_f32 v220, v218, v217
  v_mul_f32 v219, 0x3fb8aa3b, v219
  v_exp_f32 v221, v219
  v_mul_f32 v220, 0.15915494, v220
  v_rndne_f32 v219, v220
  v_sub_f32 v220, v220, v219
  v_cos_f32 v228, v220
  v_sin_f32 v229, v220
  v_mul_f32 v228, v228, v221
  v_mul_f32 v229, v229, v221
  v_mul_f32 v219, v216, v216
  v_fma_f32 v219, v217, v217, v219
  v_rcp_f32 v219, v219
  v_add_f32 v220, -1.0, v228
  v_add_f32 v219, v219, v219
  v_mul_f32 v226, v220, v216
  v_fma_f32 v226, v229, v217, v226
  v_mul_f32 v227, v229, v216
  v_fma_f32 v227, -v220, v217, v227
  v_mul_f32 v226, v226, v219
  v_mul_f32 v227, v227, v219
  v_lshl_add_u32 v121, v1, 3, s89
  ds_write_b64 v121, v[226:227] offset:16384
  v_mul_f32 v222, v228, v228
  v_mul_f32 v223, v228, v229
  v_fma_f32 v222, -v229, v229, v222
  v_fma_f32 v223, v229, v228, v223
  v_mul_f32 v224, v222, v222
  v_mul_f32 v225, v222, v223
  v_fma_f32 v224, -v223, v223, v224
  v_fma_f32 v225, v223, v222, v225
  v_mul_f32 v230, v224, v224
  v_mul_f32 v231, v224, v225
  v_fma_f32 v230, -v225, v225, v230
  v_fma_f32 v231, v225, v224, v231
  s_mov_b32 s60, 152576
  v_and_b32 v123, 0x400, v126
  v_add3_u32 v122, v35, v123, s60
  v_add_u32 v126, 148480, v126
  ds_write_b128 v122, v[228:231]
  v_mul_f32 v232, v230, v230
  v_mul_f32 v233, v230, v231
  v_fma_f32 v232, -v231, v231, v232
  v_fma_f32 v233, v231, v230, v233
  v_mul_f32 v236, v232, v232
  v_mul_f32 v237, v232, v233
  v_fma_f32 v236, -v233, v233, v236
  v_fma_f32 v237, v233, v232, v237
  v_mul_f32 v240, v236, v236
  v_mul_f32 v241, v236, v237
  v_fma_f32 v240, -v237, v237, v240
  v_fma_f32 v241, v237, v236, v241
  v_mul_f32 v244, v240, v236
  v_mul_f32 v245, v240, v237
  v_fma_f32 v244, -v241, v237, v244
  v_fma_f32 v245, v241, v236, v245
  v_mul_f32 v234, v240, v240
  v_mul_f32 v235, v240, v241
  v_fma_f32 v234, -v241, v241, v234
  v_fma_f32 v235, v241, v240, v235
  ds_write_b128 v122, v[232:235] offset:2048
  v_mul_f32 v222, v234, v234
  v_mul_f32 v223, v234, v235
  v_fma_f32 v222, -v235, v235, v222
  v_fma_f32 v223, v235, v234, v223
  v_mul_f32 v238, v222, v222
  v_mul_f32 v239, v222, v223
  v_fma_f32 v238, -v223, v223, v238
  v_fma_f32 v239, v223, v222, v239
  ds_write_b128 v122, v[236:239] offset:4096
  v_mul_f32 v242, v238, v238
  v_mul_f32 v243, v238, v239
  v_fma_f32 v242, -v239, v239, v242
  v_fma_f32 v243, v239, v238, v243
  ds_write_b128 v122, v[240:243] offset:6144
  v_mul_f32 v246, v242, v238
  v_mul_f32 v247, v242, v239
  v_fma_f32 v246, -v243, v239, v246
  v_fma_f32 v247, v243, v238, v247
  ds_write_b128 v122, v[244:247] offset:8192
  v_mov_b32 v248, 1.0
  v_mov_b32 v249, 0
  v_mov_b32 v123, 162816
  ds_write2_b64 v123, v[248:249], v[248:249] offset0:0 offset1:1
  ds_read_b128 v[232:235], v120 offset:16384
  ds_read_b128 v[236:239], v120 offset:16400
  ds_read_b128 v[240:243], v120 offset:16416
  ds_read_b128 v[244:247], v120 offset:16432
  s_add_u32 m0, s89, 4096
  s_nop 0
  buffer_load_dwordx4 v6, s[40:43], s87 offen offset:0 lds
  buffer_load_dwordx4 v7, s[40:43], s87 offen offset:1024 lds
  buffer_load_dwordx4 v8, s[40:43], s87 offen offset:2048 lds
  buffer_load_dwordx4 v9, s[40:43], s87 offen offset:3072 lds
  s_add_u32 s87, s87, 128
  s_add_u32 m0, s90, 16384
  s_nop 0
  buffer_load_dwordx4 v14, s[44:47], s88 offen offset:0 lds
  buffer_load_dwordx4 v15, s[44:47], s88 offen offset:1024 lds
  buffer_load_dwordx4 v16, s[44:47], s88 offen offset:2048 lds
  buffer_load_dwordx4 v17, s[44:47], s88 offen offset:3072 lds
  s_add_u32 s88, s88, 128
  v_mov_b32 v22, v52
  s_mov_b64 exec, 0
  s_cmp_eq_u32 s82, 0
  s_cbranch_scc1 L_pgs0
  s_cmp_eq_u32 s82, 1
  s_cbranch_scc1 L_pgs1
  s_cmp_eq_u32 s82, 2
  s_cbranch_scc1 L_pgs2
  s_branch L_pgs3
L_pgsr:
  s_mov_b64 exec, -1
  s_waitcnt vmcnt(8)
  s_waitcnt lgkmcnt(0)
  s_mul_i32 s61, s61, 0x9E3779B1
  s_add_u32 s61, s61, 0x85EBCA6B
  s_or_b32 s61, s61, 0x101
  s_mul_i32 s10, s10, s61
  s_barrier
  ds_read_b128 a[0:3], v10 offset:0
  ds_read_b128 v[64:67], v18 offset:0
  ds_read_b128 v[68:71], v18 offset:4096
  ds_read_b128 v[72:75], v18 offset:8192
  ds_read_b128 v[76:79], v18 offset:12288
  s_waitcnt lgkmcnt(2)
  v_mfma_f32_32x32x16_bf16 v[128:143], a[0:3], v[64:67], 0
  ds_read_b128 a[4:7], v11 offset:0
  ds_read_b128 v[80:83], v19 offset:0
  v_lshlrev_b32 v216, 16, v192
  v_lshlrev_b32 v217, 16, v196
  v_and_b32 v218, 0xffff0000, v192
  v_mfma_f32_16x16x32_bf16 v[44:47], v[60:63], v[64:67], 0
  v_and_b32 v219, 0xffff0000, v196
  v_mul_f32 v220, v216, v232
  v_mfma_f32_32x32x16_bf16 v[144:159], a[0:3], v[68:71], 0
  s_add_u32 m0, s89, 8192
  s_nop 0
  buffer_load_dwordx4 v6, s[40:43], s87 offen offset:0 lds
  ds_read_b128 v[64:67], v19 offset:4096
  v_fma_f32 v220, -v217, v233, v220
  v_mul_f32 v222, v216, v233
  v_mfma_f32_16x16x32_bf16 v[48:51], v[60:63], v[68:71], 0
  v_fma_f32 v222, v217, v232, v222
  v_mul_f32 v221, v218, v234
  s_waitcnt lgkmcnt(3)
  v_mfma_f32_32x32x16_bf16 v[160:175], a[0:3], v[72:75], 0
  buffer_load_dwordx4 v7, s[40:43], s87 offen offset:1024 lds
  buffer_load_dwordx4 v8, s[40:43], s87 offen offset:2048 lds
  ds_read_b128 v[68:71], v19 offset:8192
  v_fma_f32 v221, -v219, v235, v221
  v_mul_f32 v223, v218, v235
  v_mfma_f32_16x16x32_bf16 v[52:55], v[60:63], v[72:75], 0
  v_fma_f32 v223, v219, v234, v223
  v_cvt_pk_bf16_f32 v104, v220, v221
  v_mfma_f32_32x32x16_bf16 v[176:191], a[0:3], v[76:79], 0
  buffer_load_dwordx4 v9, s[40:43], s87 offen offset:3072 lds
  s_add_u32 s87, s87, 128
  ds_read_b128 v[72:75], v19 offset:12288
  v_cvt_pk_bf16_f32 v108, -v222, -v223
  v_lshlrev_b32 v216, 16, v193
  v_mfma_f32_16x16x32_bf16 v[56:59], v[60:63], v[76:79], 0
  v_lshlrev_b32 v217, 16, v197
  v_and_b32 v218, 0xffff0000, v193
  s_waitcnt lgkmcnt(2)
  v_mfma_f32_32x32x16_bf16 v[128:143], a[4:7], v[80:83], v[128:143]
  s_add_u32 m0, s90, 32768
  s_nop 0
  buffer_load_dwordx4 v14, s[44:47], s88 offen offset:0 lds
  ds_read_b128 a[8:11], v12 offset:0
  ds_read_b128 v[76:79], v20 offset:0
  v_and_b32 v219, 0xffff0000, v197
  v_mul_f32 v220, v216, v236
  v_mfma_f32_32x32x16_bf16 v[144:159], a[4:7], v[64:67], v[144:159]
  buffer_load_dwordx4 v15, s[44:47], s88 offen offset:1024 lds
  buffer_load_dwordx4 v16, s[44:47], s88 offen offset:2048 lds
  ds_read_b128 v[80:83], v20 offset:4096
  v_fma_f32 v220, -v217, v237, v220
  s_waitcnt lgkmcnt(3)
  v_mfma_f32_32x32x16_bf16 v[160:175], a[4:7], v[68:71], v[160:175]
  buffer_load_dwordx4 v17, s[44:47], s88 offen offset:3072 lds
  s_add_u32 s88, s88, 128
  ds_read_b128 v[64:67], v20 offset:8192
  v_mul_f32 v222, v216, v237
  v_mfma_f32_32x32x16_bf16 v[176:191], a[4:7], v[72:75], v[176:191]
  s_add_u32 m0, s89, 12288
  s_nop 0
  buffer_load_dwordx4 v6, s[40:43], s87 offen offset:0 lds
  ds_read_b128 v[68:71], v20 offset:12288
  v_fma_f32 v222, v217, v236, v222
  s_waitcnt lgkmcnt(2)
  v_mfma_f32_32x32x16_bf16 v[128:143], a[8:11], v[76:79], v[128:143]
  buffer_load_dwordx4 v7, s[40:43], s87 offen offset:1024 lds
  buffer_load_dwordx4 v8, s[40:43], s87 offen offset:2048 lds
  ds_read_b128 a[12:15], v13 offset:0
  ds_read_b128 v[72:75], v21 offset:0
  v_mul_f32 v221, v218, v238
  v_mfma_f32_32x32x16_bf16 v[144:159], a[8:11], v[80:83], v[144:159]
  buffer_load_dwordx4 v9, s[40:43], s87 offen offset:3072 lds
  s_add_u32 s87, s87, 128
  ds_read_b128 v[76:79], v21 offset:4096
  v_fma_f32 v221, -v219, v239, v221
  s_waitcnt lgkmcnt(3)
  v_mfma_f32_32x32x16_bf16 v[160:175], a[8:11], v[64:67], v[160:175]
  s_add_u32 m0, s90, 49152
  s_nop 0
  buffer_load_dwordx4 v14, s[44:47], s88 offen offset:0 lds
  ds_read_b128 v[80:83], v21 offset:8192
  v_mul_f32 v223, v218, v239
  v_mfma_f32_32x32x16_bf16 v[176:191], a[8:11], v[68:71], v[176:191]
  buffer_load_dwordx4 v15, s[44:47], s88 offen offset:1024 lds
  buffer_load_dwordx4 v16, s[44:47], s88 offen offset:2048 lds
  ds_read_b128 v[64:67], v21 offset:12288
  v_fma_f32 v223, v219, v238, v223
  s_waitcnt lgkmcnt(2)
  v_mfma_f32_32x32x16_bf16 v[128:143], a[12:15], v[72:75], v[128:143]
  buffer_load_dwordx4 v17, s[44:47], s88 offen offset:3072 lds
  s_add_u32 s88, s88, 128
  s_waitcnt vmcnt(16)
  s_barrier
  ds_read_b128 a[16:19], v10 offset:4096
  ds_read_b128 v[68:71], v18 offset:16384
  v_cvt_pk_bf16_f32 v105, v220, v221
  v_mfma_f32_32x32x16_bf16 v[144:159], a[12:15], v[76:79], v[144:159]
  ds_read_b128 v[72:75], v18 offset:20480
  v_cvt_pk_bf16_f32 v109, -v222, -v223
  v_lshlrev_b32 v216, 16, v194
  v_lshlrev_b32 v217, 16, v198
  v_and_b32 v218, 0xffff0000, v194
  s_waitcnt lgkmcnt(3)
  v_mfma_f32_32x32x16_bf16 v[160:175], a[12:15], v[80:83], v[160:175]
  s_add_u32 m0, s90, 0
  ds_read_b128 v[76:79], v18 offset:24576
  v_and_b32 v219, 0xffff0000, v198
  v_mul_f32 v220, v216, v240
  v_fma_f32 v220, -v217, v241, v220
  v_mfma_f32_32x32x16_bf16 v[176:191], a[12:15], v[64:67], v[176:191]
  buffer_load_dwordx4 v14, s[44:47], s88 offen offset:0 lds
  ds_read_b128 v[80:83], v18 offset:28672
  s_waitcnt lgkmcnt(2)
  v_mfma_f32_32x32x16_bf16 v[128:143], a[16:19], v[68:71], v[128:143]
  buffer_load_dwordx4 v15, s[44:47], s88 offen offset:1024 lds
  ds_read_b128 a[20:23], v11 offset:4096
  ds_read_b128 v[64:67], v19 offset:16384
  v_mfma_f32_16x16x32_bf16 v[44:47], v[60:63], v[68:71], v[44:47]
  v_mul_f32 v222, v216, v241
  v_fma_f32 v222, v217, v240, v222
  v_mfma_f32_32x32x16_bf16 v[144:159], a[16:19], v[72:75], v[144:159]
  buffer_load_dwordx4 v16, s[44:47], s88 offen offset:2048 lds
  ds_read_b128 v[68:71], v19 offset:20480
  v_mfma_f32_16x16x32_bf16 v[48:51], v[60:63], v[72:75], v[48:51]
  v_mul_f32 v221, v218, v242
  v_fma_f32 v221, -v219, v243, v221
  s_waitcnt lgkmcnt(3)
  v_mfma_f32_32x32x16_bf16 v[160:175], a[16:19], v[76:79], v[160:175]
  buffer_load_dwordx4 v17, s[44:47], s88 offen offset:3072 lds
  ds_read_b128 v[72:75], v19 offset:24576
  v_mfma_f32_16x16x32_bf16 v[52:55], v[60:63], v[76:79], v[52:55]
  v_mul_f32 v223, v218, v243
  v_fma_f32 v223, v219, v242, v223
  v_mfma_f32_32x32x16_bf16 v[176:191], a[16:19], v[80:83], v[176:191]
  s_add_u32 s88, s88, 128
  ds_read_b128 v[76:79], v19 offset:28672
  v_cvt_pk_bf16_f32 v106, v220, v221
  v_cvt_pk_bf16_f32 v110, -v222, -v223
  v_lshlrev_b32 v216, 16, v195
  v_mfma_f32_16x16x32_bf16 v[56:59], v[60:63], v[80:83], v[56:59]
  v_lshlrev_b32 v217, 16, v199
  v_and_b32 v218, 0xffff0000, v195
  s_waitcnt lgkmcnt(2)
  v_mfma_f32_32x32x16_bf16 v[128:143], a[20:23], v[64:67], v[128:143]
  s_add_u32 m0, s89, 0
  ds_read_b128 a[24:27], v12 offset:4096
  ds_read_b128 v[80:83], v20 offset:16384
  v_and_b32 v219, 0xffff0000, v199
  v_mfma_f32_32x32x16_bf16 v[144:159], a[20:23], v[68:71], v[144:159]
  buffer_load_dwordx4 v6, s[40:43], s87 offen offset:0 lds
  ds_read_b128 v[64:67], v20 offset:20480
  s_waitcnt lgkmcnt(3)
  v_mfma_f32_32x32x16_bf16 v[160:175], a[20:23], v[72:75], v[160:175]
  buffer_load_dwordx4 v7, s[40:43], s87 offen offset:1024 lds
  ds_read_b128 v[68:71], v20 offset:24576
L_pgs0:
  s_cbranch_execz L_pgs4
  v_mfma_f32_32x32x16_bf16 v[176:191], a[20:23], v[76:79], v[176:191]
  buffer_load_dwordx4 v8, s[40:43], s87 offen offset:2048 lds
  ds_read_b128 v[72:75], v20 offset:28672
  s_waitcnt lgkmcnt(2)
  v_mfma_f32_32x32x16_bf16 v[128:143], a[24:27], v[80:83], v[128:143]
  buffer_load_dwordx4 v9, s[40:43], s87 offen offset:3072 lds
  ds_read_b128 a[28:31], v13 offset:4096
  ds_read_b128 v[76:79], v21 offset:16384
  v_mfma_f32_32x32x16_bf16 v[144:159], a[24:27], v[64:67], v[144:159]
  s_add_u32 s87, s87, 128
  ds_read_b128 v[80:83], v21 offset:20480
  v_mul_f32 v220, v216, v244
  v_fma_f32 v220, -v217, v245, v220
  v_mul_f32 v222, v216, v245
  s_waitcnt lgkmcnt(3)
  v_mfma_f32_32x32x16_bf16 v[160:175], a[24:27], v[68:71], v[160:175]
  ds_read_b128 v[64:67], v21 offset:24576
  v_fma_f32 v222, v217, v244, v222
  v_mul_f32 v221, v218, v246
  v_fma_f32 v221, -v219, v247, v221
  v_mul_f32 v223, v218, v247
  v_mfma_f32_32x32x16_bf16 v[176:191], a[24:27], v[72:75], v[176:191]
  ds_read_b128 v[68:71], v21 offset:28672
  v_fma_f32 v223, v219, v246, v223
  v_cvt_pk_bf16_f32 v107, v220, v221
  v_cvt_pk_bf16_f32 v111, -v222, -v223
  v_lshlrev_b32 v216, 16, v200
  s_waitcnt lgkmcnt(2)
  v_mfma_f32_32x32x16_bf16 v[128:143], a[28:31], v[76:79], v[128:143]
  s_waitcnt vmcnt(16)
  s_barrier
  ds_read_b128 a[32:35], v10 offset:8192
  ds_read_b128 v[72:75], v18 offset:32768
  v_lshlrev_b32 v217, 16, v204
  v_mfma_f32_32x32x16_bf16 v[144:159], a[28:31], v[80:83], v[144:159]
  ds_read_b128 v[76:79], v18 offset:36864
  v_and_b32 v218, 0xffff0000, v200
  v_and_b32 v219, 0xffff0000, v204
  v_mul_f32 v220, v216, v232
  v_fma_f32 v220, -v217, v233, v220
  s_waitcnt lgkmcnt(3)
  v_mfma_f32_32x32x16_bf16 v[160:175], a[28:31], v[64:67], v[160:175]
  s_add_u32 m0, s90, 16384
  ds_read_b128 v[80:83], v18 offset:40960
  v_mul_f32 v222, v216, v233
  v_fma_f32 v222, v217, v232, v222
  v_mul_f32 v221, v218, v234
  v_mfma_f32_32x32x16_bf16 v[176:191], a[28:31], v[68:71], v[176:191]
  buffer_load_dwordx4 v14, s[44:47], s88 offen offset:0 lds
  ds_read_b128 v[64:67], v18 offset:45056
  s_waitcnt lgkmcnt(2)
  v_mfma_f32_32x32x16_bf16 v[128:143], a[32:35], v[72:75], v[128:143]
  buffer_load_dwordx4 v15, s[44:47], s88 offen offset:1024 lds
  ds_read_b128 a[36:39], v11 offset:8192
  ds_read_b128 v[68:71], v19 offset:32768
  v_mfma_f32_16x16x32_bf16 v[44:47], v[60:63], v[72:75], v[44:47]
  v_fma_f32 v221, -v219, v235, v221
  v_mul_f32 v223, v218, v235
  v_mfma_f32_32x32x16_bf16 v[144:159], a[32:35], v[76:79], v[144:159]
  buffer_load_dwordx4 v16, s[44:47], s88 offen offset:2048 lds
  ds_read_b128 v[72:75], v19 offset:36864
  v_mfma_f32_16x16x32_bf16 v[48:51], v[60:63], v[76:79], v[48:51]
  v_fma_f32 v223, v219, v234, v223
  v_cvt_pk_bf16_f32 v112, v220, v221
  s_waitcnt lgkmcnt(3)
  v_mfma_f32_32x32x16_bf16 v[160:175], a[32:35], v[80:83], v[160:175]
  buffer_load_dwordx4 v17, s[44:47], s88 offen offset:3072 lds
  ds_read_b128 v[76:79], v19 offset:40960
  v_mfma_f32_16x16x32_bf16 v[52:55], v[60:63], v[80:83], v[52:55]
  v_cvt_pk_bf16_f32 v116, -v222, -v223
  v_lshlrev_b32 v216, 16, v201
  v_mfma_f32_32x32x16_bf16 v[176:191], a[32:35], v[64:67], v[176:191]
  s_add_u32 s88, s88, 128
  ds_read_b128 v[80:83], v19 offset:45056
  v_lshlrev_b32 v217, 16, v205
  v_and_b32 v218, 0xffff0000, v201
  v_and_b32 v219, 0xffff0000, v205
  v_mfma_f32_16x16x32_bf16 v[56:59], v[60:63], v[64:67], v[56:59]
  v_mul_f32 v220, v216, v236
  v_fma_f32 v220, -v217, v237, v220
  s_waitcnt lgkmcnt(2)
  v_mfma_f32_32x32x16_bf16 v[128:143], a[36:39], v[68:71], v[128:143]
  s_add_u32 m0, s89, 4096
  ds_read_b128 a[40:43], v12 offset:8192
  ds_read_b128 v[64:67], v20 offset:32768
  v_mul_f32 v222, v216, v237
  v_mfma_f32_32x32x16_bf16 v[144:159], a[36:39], v[72:75], v[144:159]
  buffer_load_dwordx4 v6, s[40:43], s87 offen offset:0 lds
  ds_read_b128 v[68:71], v20 offset:36864
  s_waitcnt lgkmcnt(3)
  v_mfma_f32_32x32x16_bf16 v[160:175], a[36:39], v[76:79], v[160:175]
  buffer_load_dwordx4 v7, s[40:43], s87 offen offset:1024 lds
  ds_read_b128 v[72:75], v20 offset:40960
  v_mfma_f32_32x32x16_bf16 v[176:191], a[36:39], v[80:83], v[176:191]
  buffer_load_dwordx4 v8, s[40:43], s87 offen offset:2048 lds
  ds_read_b128 v[76:79], v20 offset:45056
  s_waitcnt lgkmcnt(2)
  v_mfma_f32_32x32x16_bf16 v[128:143], a[40:43], v[64:67], v[128:143]
  buffer_load_dwordx4 v9, s[40:43], s87 offen offset:3072 lds
  ds_read_b128 a[44:47], v13 offset:8192
  ds_read_b128 v[80:83], v21 offset:32768
  buffer_load_dword a255, v22, s[44:47], s63 offen
  v_mfma_f32_32x32x16_bf16 v[144:159], a[40:43], v[68:71], v[144:159]
  s_add_u32 s87, s87, 128
  ds_read_b128 v[64:67], v21 offset:36864
  v_fma_f32 v222, v217, v236, v222
  v_mul_f32 v221, v218, v238
  v_fma_f32 v221, -v219, v239, v221
  s_waitcnt lgkmcnt(3)
  v_mfma_f32_32x32x16_bf16 v[160:175], a[40:43], v[72:75], v[160:175]
  ds_read_b128 v[68:71], v21 offset:40960
  v_mul_f32 v223, v218, v239
  v_fma_f32 v223, v219, v238, v223
  v_cvt_pk_bf16_f32 v113, v220, v221
  v_cvt_pk_bf16_f32 v117, -v222, -v223
  v_mfma_f32_32x32x16_bf16 v[176:191], a[40:43], v[76:79], v[176:191]
  ds_read_b128 v[72:75], v21 offset:45056
  v_lshlrev_b32 v216, 16, v202
  v_lshlrev_b32 v217, 16, v206
  v_and_b32 v218, 0xffff0000, v202
  v_and_b32 v219, 0xffff0000, v206
  s_waitcnt lgkmcnt(2)
  v_mfma_f32_32x32x16_bf16 v[128:143], a[44:47], v[80:83], v[128:143]
  s_waitcnt vmcnt(17)
  s_barrier
  ds_read_b128 a[48:51], v10 offset:12288
  ds_read_b128 v[76:79], v18 offset:49152
  v_mul_f32 v220, v216, v240
  v_mfma_f32_32x32x16_bf16 v[144:159], a[44:47], v[64:67], v[144:159]
  ds_read_b128 v[80:83], v18 offset:53248
  v_fma_f32 v220, -v217, v241, v220
  v_mul_f32 v222, v216, v241
  v_fma_f32 v222, v217, v240, v222
  v_mul_f32 v221, v218, v242
  s_waitcnt lgkmcnt(3)
  v_mfma_f32_32x32x16_bf16 v[160:175], a[44:47], v[68:71], v[160:175]
  s_add_u32 m0, s90, 32768
  ds_read_b128 v[64:67], v18 offset:57344
  v_fma_f32 v221, -v219, v243, v221
  v_mul_f32 v223, v218, v243
  v_fma_f32 v223, v219, v242, v223
  v_mfma_f32_32x32x16_bf16 v[176:191], a[44:47], v[72:75], v[176:191]
  buffer_load_dwordx4 v14, s[44:47], s88 offen offset:0 lds
  ds_read_b128 v[68:71], v18 offset:61440
  s_waitcnt lgkmcnt(2)
  v_mfma_f32_32x32x16_bf16 v[128:143], a[48:51], v[76:79], v[128:143]
  buffer_load_dwordx4 v15, s[44:47], s88 offen offset:1024 lds
  ds_read_b128 a[52:55], v11 offset:12288
  ds_read_b128 v[72:75], v19 offset:49152
  v_mfma_f32_16x16x32_bf16 v[44:47], v[60:63], v[76:79], v[44:47]
  v_cvt_pk_bf16_f32 v114, v220, v221
  v_cvt_pk_bf16_f32 v118, -v222, -v223
  v_mfma_f32_32x32x16_bf16 v[144:159], a[48:51], v[80:83], v[144:159]
  buffer_load_dwordx4 v16, s[44:47], s88 offen offset:2048 lds
  ds_read_b128 v[76:79], v19 offset:53248
  v_mfma_f32_16x16x32_bf16 v[48:51], v[60:63], v[80:83], v[48:51]
  v_lshlrev_b32 v216, 16, v203
  v_lshlrev_b32 v217, 16, v207
  s_waitcnt lgkmcnt(3)
  v_mfma_f32_32x32x16_bf16 v[160:175], a[48:51], v[64:67], v[160:175]
  buffer_load_dwordx4 v17, s[44:47], s88 offen offset:3072 lds
  ds_read_b128 v[80:83], v19 offset:57344
  v_mfma_f32_16x16x32_bf16 v[52:55], v[60:63], v[64:67], v[52:55]
  v_and_b32 v218, 0xffff0000, v203
  v_and_b32 v219, 0xffff0000, v207
  v_mfma_f32_32x32x16_bf16 v[176:191], a[48:51], v[68:71], v[176:191]
  s_add_u32 s88, s88, 128
  ds_read_b128 v[64:67], v19 offset:61440
  v_mul_f32 v220, v216, v244
  v_fma_f32 v220, -v217, v245, v220
  v_mul_f32 v222, v216, v245
  v_mfma_f32_16x16x32_bf16 v[56:59], v[60:63], v[68:71], v[56:59]
  v_fma_f32 v222, v217, v244, v222
  v_mul_f32 v221, v218, v246
  s_waitcnt lgkmcnt(2)
  v_mfma_f32_32x32x16_bf16 v[128:143], a[52:55], v[72:75], v[128:143]
  s_add_u32 m0, s89, 8192
  ds_read_b128 a[56:59], v12 offset:12288
  ds_read_b128 v[68:71], v20 offset:49152
  v_fma_f32 v221, -v219, v247, v221
  v_mfma_f32_32x32x16_bf16 v[144:159], a[52:55], v[76:79], v[144:159]
  buffer_load_dwordx4 v6, s[40:43], s87 offen offset:0 lds
  ds_read_b128 v[72:75], v20 offset:53248
  s_waitcnt lgkmcnt(3)
  v_mfma_f32_32x32x16_bf16 v[160:175], a[52:55], v[80:83], v[160:175]
  buffer_load_dwordx4 v7, s[40:43], s87 offen offset:1024 lds
  ds_read_b128 v[76:79], v20 offset:57344
  v_mfma_f32_32x32x16_bf16 v[176:191], a[52:55], v[64:67], v[176:191]
  buffer_load_dwordx4 v8, s[40:43], s87 offen offset:2048 lds
  ds_read_b128 v[80:83], v20 offset:61440
  s_waitcnt lgkmcnt(2)
  v_mfma_f32_32x32x16_bf16 v[128:143], a[56:59], v[68:71], v[128:143]
  buffer_load_dwordx4 v9, s[40:43], s87 offen offset:3072 lds
  ds_read_b128 a[60:63], v13 offset:12288
  ds_read_b128 v[64:67], v21 offset:49152
  v_mfma_f32_32x32x16_bf16 v[144:159], a[56:59], v[72:75], v[144:159]
  s_add_u32 s87, s87, 128
  ds_read_b128 v[68:71], v21 offset:53248
  v_mul_f32 v223, v218, v247
  v_fma_f32 v223, v219, v246, v223
  v_cvt_pk_bf16_f32 v115, v220, v221
  s_waitcnt lgkmcnt(3)
  v_mfma_f32_32x32x16_bf16 v[160:175], a[56:59], v[76:79], v[160:175]
  ds_read_b128 v[72:75], v21 offset:57344
  v_cvt_pk_bf16_f32 v119, -v222, -v223
  v_lshlrev_b32 v216, 16, v208
  v_lshlrev_b32 v217, 16, v212
  v_and_b32 v218, 0xffff0000, v208
  v_mfma_f32_32x32x16_bf16 v[176:191], a[56:59], v[80:83], v[176:191]
  ds_read_b128 v[76:79], v21 offset:61440
  v_and_b32 v219, 0xffff0000, v212
  v_mul_f32 v220, v216, v232
  v_fma_f32 v220, -v217, v233, v220
  v_mul_f32 v222, v216, v233
  s_waitcnt lgkmcnt(2)
  v_mfma_f32_32x32x16_bf16 v[128:143], a[60:63], v[64:67], v[128:143]
  s_waitcnt vmcnt(17)
  s_barrier
  ds_read_b128 a[64:67], v10 offset:0
  ds_read_b128 v[80:83], v18 offset:0
  v_fma_f32 v222, v217, v232, v222
  v_mfma_f32_32x32x16_bf16 v[144:159], a[60:63], v[68:71], v[144:159]
  ds_read_b128 v[64:67], v18 offset:4096
  v_mul_f32 v221, v218, v234
  v_fma_f32 v221, -v219, v235, v221
  v_mul_f32 v223, v218, v235
  v_fma_f32 v223, v219, v234, v223
  s_waitcnt lgkmcnt(3)
  v_mfma_f32_32x32x16_bf16 v[160:175], a[60:63], v[72:75], v[160:175]
  s_add_u32 m0, s90, 49152
  ds_read_b128 v[68:71], v18 offset:8192
  v_cvt_pk_bf16_f32 v192, v220, v221
  v_cvt_pk_bf16_f32 v196, -v222, -v223
  v_lshlrev_b32 v216, 16, v209
  v_mfma_f32_32x32x16_bf16 v[176:191], a[60:63], v[76:79], v[176:191]
  buffer_load_dwordx4 v14, s[44:47], s88 offen offset:0 lds
  ds_read_b128 v[72:75], v18 offset:12288
  s_waitcnt lgkmcnt(2)
  v_mfma_f32_32x32x16_bf16 v[128:143], a[64:67], v[80:83], v[128:143]
  buffer_load_dwordx4 v15, s[44:47], s88 offen offset:1024 lds
  ds_read_b128 a[68:71], v11 offset:0
  ds_read_b128 v[76:79], v19 offset:0
  v_mfma_f32_16x16x32_bf16 v[44:47], v[60:63], v[80:83], v[44:47]
  v_lshlrev_b32 v217, 16, v213
  v_and_b32 v218, 0xffff0000, v209
  v_mfma_f32_32x32x16_bf16 v[144:159], a[64:67], v[64:67], v[144:159]
  buffer_load_dwordx4 v16, s[44:47], s88 offen offset:2048 lds
  ds_read_b128 v[80:83], v19 offset:4096
  v_mfma_f32_16x16x32_bf16 v[48:51], v[60:63], v[64:67], v[48:51]
  v_and_b32 v219, 0xffff0000, v213
  v_mul_f32 v220, v216, v236
  s_waitcnt lgkmcnt(3)
  v_mfma_f32_32x32x16_bf16 v[160:175], a[64:67], v[68:71], v[160:175]
  buffer_load_dwordx4 v17, s[44:47], s88 offen offset:3072 lds
  ds_read_b128 v[64:67], v19 offset:8192
  v_mfma_f32_16x16x32_bf16 v[52:55], v[60:63], v[68:71], v[52:55]
  v_fma_f32 v220, -v217, v237, v220
  v_mul_f32 v222, v216, v237
  v_mfma_f32_32x32x16_bf16 v[176:191], a[64:67], v[72:75], v[176:191]
  s_add_u32 s88, s88, 128
  ds_read_b128 v[68:71], v19 offset:12288
  v_fma_f32 v222, v217, v236, v222
  v_mul_f32 v221, v218, v238
  v_fma_f32 v221, -v219, v239, v221
  v_mfma_f32_16x16x32_bf16 v[56:59], v[60:63], v[72:75], v[56:59]
  v_mul_f32 v223, v218, v239
  v_fma_f32 v223, v219, v238, v223
  s_waitcnt lgkmcnt(2)
  v_mfma_f32_32x32x16_bf16 v[128:143], a[68:71], v[76:79], v[128:143]
  s_add_u32 m0, s89, 12288
  ds_read_b128 a[72:75], v12 offset:0
  ds_read_b128 v[72:75], v20 offset:0
  v_cvt_pk_bf16_f32 v193, v220, v221
  v_mfma_f32_32x32x16_bf16 v[144:159], a[68:71], v[80:83], v[144:159]
  buffer_load_dwordx4 v6, s[40:43], s87 offen offset:0 lds
  ds_read_b128 v[76:79], v20 offset:4096
  s_waitcnt lgkmcnt(3)
  v_mfma_f32_32x32x16_bf16 v[160:175], a[68:71], v[64:67], v[160:175]
  buffer_load_dwordx4 v7, s[40:43], s87 offen offset:1024 lds
  ds_read_b128 v[80:83], v20 offset:8192
  v_mfma_f32_32x32x16_bf16 v[176:191], a[68:71], v[68:71], v[176:191]
  buffer_load_dwordx4 v8, s[40:43], s87 offen offset:2048 lds
  ds_read_b128 v[64:67], v20 offset:12288
  s_waitcnt lgkmcnt(2)
  v_mfma_f32_32x32x16_bf16 v[128:143], a[72:75], v[72:75], v[128:143]
  buffer_load_dwordx4 v9, s[40:43], s87 offen offset:3072 lds
  ds_read_b128 a[76:79], v13 offset:0
  ds_read_b128 v[68:71], v21 offset:0
  v_mfma_f32_32x32x16_bf16 v[144:159], a[72:75], v[76:79], v[144:159]
  s_add_u32 s87, s87, 128
  ds_read_b128 v[72:75], v21 offset:4096
  v_cvt_pk_bf16_f32 v197, -v222, -v223
  v_lshlrev_b32 v216, 16, v210
  v_lshlrev_b32 v217, 16, v214
  s_waitcnt lgkmcnt(3)
  v_mfma_f32_32x32x16_bf16 v[160:175], a[72:75], v[80:83], v[160:175]
  ds_read_b128 v[76:79], v21 offset:8192
  v_and_b32 v218, 0xffff0000, v210
  v_and_b32 v219, 0xffff0000, v214
  v_mul_f32 v220, v216, v240
  v_fma_f32 v220, -v217, v241, v220
  v_mfma_f32_32x32x16_bf16 v[176:191], a[72:75], v[64:67], v[176:191]
  ds_read_b128 v[80:83], v21 offset:12288
  v_mul_f32 v222, v216, v241
  v_fma_f32 v222, v217, v240, v222
  v_mul_f32 v221, v218, v242
  v_fma_f32 v221, -v219, v243, v221
  s_waitcnt lgkmcnt(2)
  v_mfma_f32_32x32x16_bf16 v[128:143], a[76:79], v[68:71], v[128:143]
  s_waitcnt vmcnt(17)
  s_barrier
  ds_read_b128 a[80:83], v10 offset:4096
  ds_read_b128 v[64:67], v18 offset:16384
  v_mul_f32 v223, v218, v243
  v_mfma_f32_32x32x16_bf16 v[144:159], a[76:79], v[72:75], v[144:159]
  ds_read_b128 v[68:71], v18 offset:20480
  v_fma_f32 v223, v219, v242, v223
  v_cvt_pk_bf16_f32 v194, v220, v221
  v_cvt_pk_bf16_f32 v198, -v222, -v223
  v_lshlrev_b32 v216, 16, v211
  s_waitcnt lgkmcnt(3)
  v_mfma_f32_32x32x16_bf16 v[160:175], a[76:79], v[76:79], v[160:175]
  s_add_u32 m0, s90, 0
  ds_read_b128 v[72:75], v18 offset:24576
  v_lshlrev_b32 v217, 16, v215
  v_and_b32 v218, 0xffff0000, v211
  v_and_b32 v219, 0xffff0000, v215
  v_mfma_f32_32x32x16_bf16 v[176:191], a[76:79], v[80:83], v[176:191]
  buffer_load_dwordx4 v14, s[44:47], s88 offen offset:0 lds
  ds_read_b128 v[76:79], v18 offset:28672
  s_waitcnt lgkmcnt(2)
  v_mfma_f32_32x32x16_bf16 v[128:143], a[80:83], v[64:67], v[128:143]
  buffer_load_dwordx4 v15, s[44:47], s88 offen offset:1024 lds
  ds_read_b128 a[84:87], v11 offset:4096
  ds_read_b128 v[80:83], v19 offset:16384
  v_mfma_f32_16x16x32_bf16 v[44:47], v[60:63], v[64:67], v[44:47]
  v_mul_f32 v220, v216, v244
  v_fma_f32 v220, -v217, v245, v220
  v_mfma_f32_32x32x16_bf16 v[144:159], a[80:83], v[68:71], v[144:159]
  buffer_load_dwordx4 v16, s[44:47], s88 offen offset:2048 lds
  ds_read_b128 v[64:67], v19 offset:20480
  v_bfe_u32 v40, v1, 2, 1
  v_mfma_f32_16x16x32_bf16 v[48:51], v[60:63], v[68:71], v[48:51]
  v_mul_f32 v222, v216, v245
  v_fma_f32 v222, v217, v244, v222
  v_lshlrev_b32 v40, 4, v40
  s_waitcnt lgkmcnt(3)
  v_mfma_f32_32x32x16_bf16 v[160:175], a[80:83], v[72:75], v[160:175]
  buffer_load_dwordx4 v17, s[44:47], s88 offen offset:3072 lds
  ds_read_b128 v[68:71], v19 offset:24576
  v_and_b32 v41, 1, v1
  v_mfma_f32_16x16x32_bf16 v[52:55], v[60:63], v[72:75], v[52:55]
  v_mul_f32 v221, v218, v246
  v_fma_f32 v221, -v219, v247, v221
  v_lshl_add_u32 v40, v41, 3, v40
  v_mfma_f32_32x32x16_bf16 v[176:191], a[80:83], v[76:79], v[176:191]
  s_add_u32 s88, s88, 128
  ds_read_b128 v[72:75], v19 offset:28672
  v_mul_f32 v223, v218, v247
  v_fma_f32 v223, v219, v246, v223
  v_cvt_pk_bf16_f32 v195, v220, v221
  v_bfe_u32 v41, v1, 3, 2
  v_mfma_f32_16x16x32_bf16 v[56:59], v[60:63], v[76:79], v[56:59]
  v_cvt_pk_bf16_f32 v199, -v222, -v223
  v_lshl_add_u32 v40, v41, 1, v40
  s_waitcnt lgkmcnt(2)
  v_mfma_f32_32x32x16_bf16 v[128:143], a[84:87], v[80:83], v[128:143]
  s_add_u32 m0, s89, 0
  ds_read_b128 a[88:91], v12 offset:4096
  ds_read_b128 v[76:79], v20 offset:16384
  v_bfe_u32 v41, v1, 1, 1
  v_mfma_f32_32x32x16_bf16 v[144:159], a[84:87], v[64:67], v[144:159]
  buffer_load_dwordx4 v6, s[40:43], s87 offen offset:0 lds
  ds_read_b128 v[80:83], v20 offset:20480
  v_add_u32 v40, v40, v41
  s_waitcnt lgkmcnt(3)
  v_mfma_f32_32x32x16_bf16 v[160:175], a[84:87], v[68:71], v[160:175]
  buffer_load_dwordx4 v7, s[40:43], s87 offen offset:1024 lds
  ds_read_b128 v[64:67], v20 offset:24576
  v_lshl_add_u32 v40, s82, 5, v40
  v_mfma_f32_32x32x16_bf16 v[176:191], a[84:87], v[72:75], v[176:191]
  buffer_load_dwordx4 v8, s[40:43], s87 offen offset:2048 lds
  ds_read_b128 v[68:71], v20 offset:28672
  v_lshlrev_b32 v40, 3, v40
  s_waitcnt lgkmcnt(2)
  v_mfma_f32_32x32x16_bf16 v[128:143], a[88:91], v[76:79], v[128:143]
  buffer_load_dwordx4 v9, s[40:43], s87 offen offset:3072 lds
  ds_read_b128 a[92:95], v13 offset:4096
  ds_read_b128 v[72:75], v21 offset:16384
  v_add_u32 v40, 147456, v40
  v_mfma_f32_32x32x16_bf16 v[144:159], a[88:91], v[80:83], v[144:159]
  s_add_u32 s87, s87, 128
  ds_read_b128 v[76:79], v21 offset:20480
  v_and_b32 v43, 31, v1
  v_lshl_add_u32 v43, s82, 5, v43
  v_lshl_add_u32 v42, s80, 7, v43
  s_waitcnt lgkmcnt(3)
  v_mfma_f32_32x32x16_bf16 v[160:175], a[88:91], v[64:67], v[160:175]
  ds_read_b128 v[80:83], v21 offset:24576
  v_lshlrev_b32 v42, 4, v42
  v_add_u32 v42, 6899712, v42
  v_lshlrev_b32 v43, 3, v43
  v_add_u32 v43, 147456, v43
  v_mfma_f32_32x32x16_bf16 v[176:191], a[88:91], v[68:71], v[176:191]
  ds_read_b128 v[64:67], v21 offset:28672
  s_waitcnt lgkmcnt(2)
  v_mfma_f32_32x32x16_bf16 v[128:143], a[92:95], v[72:75], v[128:143]
  s_waitcnt vmcnt(16)
  s_barrier
  ds_read_b128 a[96:99], v10 offset:8192
  ds_read_b128 v[68:71], v18 offset:32768
  v_mfma_f32_32x32x16_bf16 v[144:159], a[92:95], v[76:79], v[144:159]
  ds_read_b128 v[72:75], v18 offset:36864
  s_waitcnt lgkmcnt(3)
  v_mfma_f32_32x32x16_bf16 v[160:175], a[92:95], v[80:83], v[160:175]
  s_add_u32 m0, s90, 16384
  ds_read_b128 v[76:79], v18 offset:40960
  v_mfma_f32_32x32x16_bf16 v[176:191], a[92:95], v[64:67], v[176:191]
  buffer_load_dwordx4 v14, s[44:47], s88 offen offset:0 lds
  ds_read_b128 v[80:83], v18 offset:45056
  s_waitcnt lgkmcnt(2)
  v_mfma_f32_32x32x16_bf16 v[128:143], a[96:99], v[68:71], v[128:143]
  buffer_load_dwordx4 v15, s[44:47], s88 offen offset:1024 lds
  ds_read_b128 a[100:103], v11 offset:8192
  ds_read_b128 v[64:67], v19 offset:32768
  buffer_load_dwordx4 v[36:39], v42, s[56:59], 0 offen sc1
  v_mfma_f32_16x16x32_bf16 v[44:47], v[60:63], v[68:71], v[44:47]
  v_mfma_f32_32x32x16_bf16 v[144:159], a[96:99], v[72:75], v[144:159]
  buffer_load_dwordx4 v16, s[44:47], s88 offen offset:2048 lds
  ds_read_b128 v[68:71], v19 offset:36864
  v_mfma_f32_16x16x32_bf16 v[48:51], v[60:63], v[72:75], v[48:51]
  s_waitcnt lgkmcnt(3)
  v_mfma_f32_32x32x16_bf16 v[160:175], a[96:99], v[76:79], v[160:175]
  buffer_load_dwordx4 v17, s[44:47], s88 offen offset:3072 lds
  ds_read_b128 v[72:75], v19 offset:40960
  v_mfma_f32_16x16x32_bf16 v[52:55], v[60:63], v[76:79], v[52:55]
  v_mfma_f32_32x32x16_bf16 v[176:191], a[96:99], v[80:83], v[176:191]
  s_add_u32 s88, s88, 128
  ds_read_b128 v[76:79], v19 offset:45056
  v_mfma_f32_16x16x32_bf16 v[56:59], v[60:63], v[80:83], v[56:59]
  s_waitcnt lgkmcnt(2)
  v_mfma_f32_32x32x16_bf16 v[128:143], a[100:103], v[64:67], v[128:143]
  s_add_u32 m0, s89, 4096
  ds_read_b128 a[104:107], v12 offset:8192
  ds_read_b128 v[80:83], v20 offset:32768
  v_mfma_f32_32x32x16_bf16 v[144:159], a[100:103], v[68:71], v[144:159]
  buffer_load_dwordx4 v6, s[40:43], s87 offen offset:0 lds
  ds_read_b128 v[64:67], v20 offset:36864
  s_waitcnt lgkmcnt(3)
  v_mfma_f32_32x32x16_bf16 v[160:175], a[100:103], v[72:75], v[160:175]
  buffer_load_dwordx4 v7, s[40:43], s87 offen offset:1024 lds
  ds_read_b128 v[68:71], v20 offset:40960
  v_mfma_f32_32x32x16_bf16 v[176:191], a[100:103], v[76:79], v[176:191]
  buffer_load_dwordx4 v8, s[40:43], s87 offen offset:2048 lds
  ds_read_b128 v[72:75], v20 offset:45056
  s_waitcnt lgkmcnt(2)
  v_mfma_f32_32x32x16_bf16 v[128:143], a[104:107], v[80:83], v[128:143]
  buffer_load_dwordx4 v9, s[40:43], s87 offen offset:3072 lds
  ds_read_b128 a[108:111], v13 offset:8192
  ds_read_b128 v[76:79], v21 offset:32768
  v_mfma_f32_32x32x16_bf16 v[144:159], a[104:107], v[64:67], v[144:159]
  s_add_u32 s87, s87, 128
  ds_read_b128 v[80:83], v21 offset:36864
  s_waitcnt lgkmcnt(3)
  v_mfma_f32_32x32x16_bf16 v[160:175], a[104:107], v[68:71], v[160:175]
  ds_read_b128 v[64:67], v21 offset:40960
  v_mfma_f32_32x32x16_bf16 v[176:191], a[104:107], v[72:75], v[176:191]
  ds_read_b128 v[68:71], v21 offset:45056
  s_waitcnt lgkmcnt(2)
  v_mfma_f32_32x32x16_bf16 v[128:143], a[108:111], v[76:79], v[128:143]
  s_waitcnt vmcnt(17)
  s_barrier
  ds_read_b128 a[112:115], v10 offset:12288
  ds_read_b128 v[72:75], v18 offset:49152
  v_mfma_f32_32x32x16_bf16 v[144:159], a[108:111], v[80:83], v[144:159]
  ds_read_b128 v[76:79], v18 offset:53248
  s_waitcnt lgkmcnt(3)
  v_mfma_f32_32x32x16_bf16 v[160:175], a[108:111], v[64:67], v[160:175]
  s_mov_b32 s88, s4
  ds_read_b128 v[80:83], v18 offset:57344
  v_mfma_f32_32x32x16_bf16 v[176:191], a[108:111], v[68:71], v[176:191]
  s_add_u32 m0, s90, 32768
  ds_read_b128 v[64:67], v18 offset:61440
  s_waitcnt lgkmcnt(2)
  v_mfma_f32_32x32x16_bf16 v[128:143], a[112:115], v[72:75], v[128:143]
  buffer_load_dwordx4 v14, s[44:47], s88 offen offset:0 lds
  ds_read_b128 a[116:119], v11 offset:12288
  ds_read_b128 v[68:71], v19 offset:49152
  v_mfma_f32_16x16x32_bf16 v[44:47], v[60:63], v[72:75], v[44:47]
  v_mfma_f32_32x32x16_bf16 v[144:159], a[112:115], v[76:79], v[144:159]
  buffer_load_dwordx4 v15, s[44:47], s88 offen offset:1024 lds
  ds_read_b128 v[72:75], v19 offset:53248
  v_mfma_f32_16x16x32_bf16 v[48:51], v[60:63], v[76:79], v[48:51]
  s_waitcnt lgkmcnt(3)
  v_mfma_f32_32x32x16_bf16 v[160:175], a[112:115], v[80:83], v[160:175]
  buffer_load_dwordx4 v16, s[44:47], s88 offen offset:2048 lds
  ds_read_b128 v[76:79], v19 offset:57344
  v_mfma_f32_16x16x32_bf16 v[52:55], v[60:63], v[80:83], v[52:55]
  v_mfma_f32_32x32x16_bf16 v[176:191], a[112:115], v[64:67], v[176:191]
  buffer_load_dwordx4 v17, s[44:47], s88 offen offset:3072 lds
  ds_read_b128 v[80:83], v19 offset:61440
  v_mfma_f32_16x16x32_bf16 v[56:59], v[60:63], v[64:67], v[56:59]
  s_waitcnt lgkmcnt(2)
  v_mfma_f32_32x32x16_bf16 v[128:143], a[116:119], v[68:71], v[128:143]
  s_add_u32 s88, s88, 128
  ds_read_b128 a[120:123], v12 offset:12288
  ds_read_b128 v[64:67], v20 offset:49152
  v_mfma_f32_32x32x16_bf16 v[144:159], a[116:119], v[72:75], v[144:159]
  ds_read_b128 v[68:71], v20 offset:53248
  s_waitcnt lgkmcnt(3)
  v_mfma_f32_32x32x16_bf16 v[160:175], a[116:119], v[76:79], v[160:175]
  ds_read_b128 v[72:75], v20 offset:57344
  v_mfma_f32_32x32x16_bf16 v[176:191], a[116:119], v[80:83], v[176:191]
  ds_read_b128 v[76:79], v20 offset:61440
  s_waitcnt lgkmcnt(2)
  v_mfma_f32_32x32x16_bf16 v[128:143], a[120:123], v[64:67], v[128:143]
  ds_read_b128 a[124:127], v13 offset:12288
  ds_read_b128 v[80:83], v21 offset:49152
  v_mfma_f32_32x32x16_bf16 v[144:159], a[120:123], v[68:71], v[144:159]
  ds_read_b128 v[64:67], v21 offset:53248
  s_waitcnt lgkmcnt(3)
  v_mfma_f32_32x32x16_bf16 v[160:175], a[120:123], v[72:75], v[160:175]
  ds_read_b128 v[68:71], v21 offset:57344
  v_mfma_f32_32x32x16_bf16 v[176:191], a[120:123], v[76:79], v[176:191]
  ds_read_b128 v[72:75], v21 offset:61440
  s_waitcnt lgkmcnt(2)
  v_mfma_f32_32x32x16_bf16 v[128:143], a[124:127], v[80:83], v[128:143]
  s_waitcnt vmcnt(13)
  s_barrier
  ds_read_b128 a[128:131], v10 offset:0
  ds_read_b128 v[76:79], v18 offset:0
  v_mfma_f32_32x32x16_bf16 v[144:159], a[124:127], v[64:67], v[144:159]
  ds_read_b128 v[80:83], v18 offset:4096
  s_waitcnt lgkmcnt(3)
  v_mfma_f32_32x32x16_bf16 v[160:175], a[124:127], v[68:71], v[160:175]
  s_add_u32 m0, s90, 49152
  ds_read_b128 v[64:67], v18 offset:8192
  v_mfma_f32_32x32x16_bf16 v[176:191], a[124:127], v[72:75], v[176:191]
  buffer_load_dwordx4 v14, s[44:47], s88 offen offset:0 lds
  ds_read_b128 v[68:71], v18 offset:12288
  s_waitcnt lgkmcnt(2)
  v_mfma_f32_32x32x16_bf16 v[128:143], a[128:131], v[76:79], v[128:143]
  buffer_load_dwordx4 v15, s[44:47], s88 offen offset:1024 lds
  ds_read_b128 a[132:135], v11 offset:0
  ds_read_b128 v[72:75], v19 offset:0
  v_mfma_f32_16x16x32_bf16 v[44:47], v[60:63], v[76:79], v[44:47]
  v_mfma_f32_32x32x16_bf16 v[144:159], a[128:131], v[80:83], v[144:159]
  buffer_load_dwordx4 v16, s[44:47], s88 offen offset:2048 lds
  ds_read_b128 v[76:79], v19 offset:4096
  v_mfma_f32_16x16x32_bf16 v[48:51], v[60:63], v[80:83], v[48:51]
  s_waitcnt lgkmcnt(3)
  v_mfma_f32_32x32x16_bf16 v[160:175], a[128:131], v[64:67], v[160:175]
  buffer_load_dwordx4 v17, s[44:47], s88 offen offset:3072 lds
  ds_read_b128 v[80:83], v19 offset:8192
  v_mfma_f32_16x16x32_bf16 v[52:55], v[60:63], v[64:67], v[52:55]
  v_mfma_f32_32x32x16_bf16 v[176:191], a[128:131], v[68:71], v[176:191]
  s_add_u32 s88, s88, 128
  ds_read_b128 v[64:67], v19 offset:12288
  v_mfma_f32_16x16x32_bf16 v[56:59], v[60:63], v[68:71], v[56:59]
  s_waitcnt lgkmcnt(2)
  v_mfma_f32_32x32x16_bf16 v[128:143], a[132:135], v[72:75], v[128:143]
  ds_read_b128 a[136:139], v12 offset:0
  ds_read_b128 v[68:71], v20 offset:0
  v_mfma_f32_32x32x16_bf16 v[144:159], a[132:135], v[76:79], v[144:159]
  ds_read_b128 v[72:75], v20 offset:4096
  s_waitcnt lgkmcnt(3)
  v_mfma_f32_32x32x16_bf16 v[160:175], a[132:135], v[80:83], v[160:175]
  ds_read_b128 v[76:79], v20 offset:8192
  v_mfma_f32_32x32x16_bf16 v[176:191], a[132:135], v[64:67], v[176:191]
  ds_read_b128 v[80:83], v20 offset:12288
  s_add_u32 s95, s93, 40960
  s_waitcnt lgkmcnt(2)
  v_mfma_f32_32x32x16_bf16 v[128:143], a[136:139], v[68:71], v[128:143]
  ds_read_b128 a[140:143], v13 offset:0
  ds_read_b128 v[64:67], v21 offset:0
  buffer_store_dwordx4 v[104:107], v127, s[52:55], s93 offen offset:0 sc1
  v_mfma_f32_32x32x16_bf16 v[144:159], a[136:139], v[72:75], v[144:159]
  ds_read_b128 v[68:71], v21 offset:4096
L_pgs1:
  s_cbranch_execz L_pgs5
  buffer_store_dwordx4 v[108:111], v127, s[52:55], s95 offen offset:0 sc1
  s_waitcnt lgkmcnt(3)
  v_mfma_f32_32x32x16_bf16 v[160:175], a[136:139], v[76:79], v[160:175]
  ds_read_b128 v[72:75], v21 offset:8192
  s_add_u32 s95, s93, 40960
  v_mfma_f32_32x32x16_bf16 v[176:191], a[136:139], v[80:83], v[176:191]
  ds_read_b128 v[76:79], v21 offset:12288
  buffer_store_dwordx4 v[112:115], v127, s[52:55], s93 offen offset:1024 sc1
  s_waitcnt lgkmcnt(2)
  v_mfma_f32_32x32x16_bf16 v[128:143], a[140:143], v[64:67], v[128:143]
  s_waitcnt vmcnt(11)
  s_barrier
  ds_read_b128 a[144:147], v10 offset:4096
  ds_read_b128 v[80:83], v18 offset:16384
  v_mfma_f32_32x32x16_bf16 v[144:159], a[140:143], v[68:71], v[144:159]
  ds_read_b128 v[64:67], v18 offset:20480
  buffer_store_dwordx4 v[116:119], v127, s[52:55], s95 offen offset:1024 sc1
  s_waitcnt lgkmcnt(3)
  v_mfma_f32_32x32x16_bf16 v[160:175], a[140:143], v[72:75], v[160:175]
  s_add_u32 m0, s90, 0
  ds_read_b128 v[68:71], v18 offset:24576
  s_lshr_b32 s95, s80, 3
  v_mfma_f32_32x32x16_bf16 v[176:191], a[140:143], v[76:79], v[176:191]
  buffer_load_dwordx4 v14, s[44:47], s88 offen offset:0 lds
  ds_read_b128 v[72:75], v18 offset:28672
  s_waitcnt lgkmcnt(2)
  v_mfma_f32_32x32x16_bf16 v[128:143], a[144:147], v[80:83], v[128:143]
  buffer_load_dwordx4 v15, s[44:47], s88 offen offset:1024 lds
  ds_read_b128 a[148:151], v11 offset:4096
  ds_read_b128 v[76:79], v19 offset:16384
  v_mfma_f32_16x16x32_bf16 v[44:47], v[60:63], v[80:83], v[44:47]
  s_mul_i32 s95, s95, 2130706432
  v_mfma_f32_32x32x16_bf16 v[144:159], a[144:147], v[64:67], v[144:159]
  buffer_load_dwordx4 v16, s[44:47], s88 offen offset:2048 lds
  ds_read_b128 v[80:83], v19 offset:20480
  v_mfma_f32_16x16x32_bf16 v[48:51], v[60:63], v[64:67], v[48:51]
  s_add_u32 s93, s93, s95
  s_waitcnt lgkmcnt(3)
  v_mfma_f32_32x32x16_bf16 v[160:175], a[144:147], v[68:71], v[160:175]
  buffer_load_dwordx4 v17, s[44:47], s88 offen offset:3072 lds
  ds_read_b128 v[64:67], v19 offset:24576
  v_cmp_ne_u32 vcc, s61, v39
  s_nop 1
  s_cmp_lg_u64 vcc, 0
  s_cbranch_scc1 L_slow11
L_back11:
  ds_write_b64 v43, v[36:37]
  ds_read_b32 v36, v40
  v_mfma_f32_16x16x32_bf16 v[52:55], v[60:63], v[68:71], v[52:55]
  s_add_u32 s95, s93, 40960
  v_mfma_f32_32x32x16_bf16 v[176:191], a[144:147], v[72:75], v[176:191]
  s_add_u32 s88, s88, 128
  ds_read_b128 v[68:71], v19 offset:28672
  buffer_store_dwordx4 v[192:195], v127, s[52:55], s93 offen offset:2048 sc1
  v_mfma_f32_16x16x32_bf16 v[56:59], v[60:63], v[72:75], v[56:59]
  s_lshl_b32 s85, s82, 2
  s_add_u32 s85, s85, 148480
  s_waitcnt lgkmcnt(4)
  v_mfma_f32_32x32x16_bf16 v[128:143], a[148:151], v[76:79], v[128:143]
  ds_read_b128 a[152:155], v12 offset:4096
  ds_read_b128 v[72:75], v20 offset:16384
  v_add_u32 v4, s85, v35
  v_add_u32 v86, 148480, v35
  v_cvt_pk_bf16_f32 v3, v44, v44
  v_mfma_f32_32x32x16_bf16 v[144:159], a[148:151], v[80:83], v[144:159]
  ds_read_b128 v[76:79], v20 offset:20480
  v_and_b32 v3, 0xffff0000, v3
  v_sub_f32 v5, v44, v3
  v_cvt_pk_bf16_f32 v5, v3, v5
  ds_write_b32 v4, v5 offset:0
  s_waitcnt lgkmcnt(4)
  v_mfma_f32_32x32x16_bf16 v[160:175], a[148:151], v[64:67], v[160:175]
  ds_read_b128 v[80:83], v20 offset:24576
  v_cvt_pk_bf16_f32 v3, v48, v48
  v_and_b32 v3, 0xffff0000, v3
  v_sub_f32 v5, v48, v3
  v_cvt_pk_bf16_f32 v5, v3, v5
  v_mfma_f32_32x32x16_bf16 v[176:191], a[148:151], v[68:71], v[176:191]
  ds_read_b128 v[64:67], v20 offset:28672
  ds_write_b32 v4, v5 offset:1024
  v_cvt_pk_bf16_f32 v3, v52, v52
  v_and_b32 v3, 0xffff0000, v3
  v_sub_f32 v5, v52, v3
  s_waitcnt lgkmcnt(4)
  v_mfma_f32_32x32x16_bf16 v[128:143], a[152:155], v[72:75], v[128:143]
  ds_read_b128 a[156:159], v13 offset:4096
  ds_read_b128 v[68:71], v21 offset:16384
  v_cvt_pk_bf16_f32 v5, v3, v5
  ds_write_b32 v4, v5 offset:2048
  v_cvt_pk_bf16_f32 v3, v56, v56
  v_mfma_f32_32x32x16_bf16 v[144:159], a[152:155], v[76:79], v[144:159]
  ds_read_b128 v[72:75], v21 offset:20480
  v_and_b32 v3, 0xffff0000, v3
  v_sub_f32 v5, v56, v3
  v_cvt_pk_bf16_f32 v5, v3, v5
  ds_write_b32 v4, v5 offset:3072
  s_waitcnt lgkmcnt(6)
  v_mfma_f32_32x32x16_bf16 v[160:175], a[152:155], v[80:83], v[160:175]
  ds_read_b128 v[76:79], v21 offset:24576
  buffer_store_dwordx4 v[196:199], v127, s[52:55], s95 offen offset:2048 sc1
  v_mfma_f32_32x32x16_bf16 v[176:191], a[152:155], v[64:67], v[176:191]
  ds_read_b128 v[80:83], v21 offset:28672
  v_cmp_gt_u32 s[18:19], 32, v1
  v_cvt_pk_bf16_f32 v39, -v36, -v36
  s_nop 0
  v_cndmask_b32 v39, 0, v39, s[18:19]
  v_mov_b32 v92, v39
  s_waitcnt lgkmcnt(3)
  v_mfma_f32_32x32x16_bf16 v[128:143], a[156:159], v[68:71], v[128:143]
  s_waitcnt vmcnt(14)
  s_waitcnt lgkmcnt(2)
  s_barrier
  ds_read_b128 v[64:67], v18 offset:32768
  v_mov_b32 v93, v39
  v_mov_b32 v94, v39
  v_mfma_f32_32x32x16_bf16 v[144:159], a[156:159], v[72:75], v[144:159]
  ds_read_b128 v[68:71], v18 offset:36864
  v_mov_b32 v95, v39
  s_waitcnt lgkmcnt(2)
  v_mfma_f32_32x32x16_bf16 v[160:175], a[156:159], v[76:79], v[160:175]
  s_add_u32 m0, s90, 16384
  ds_read_b128 v[72:75], v18 offset:40960
  v_mfma_f32_32x32x16_bf16 v[176:191], a[156:159], v[80:83], v[176:191]
  buffer_load_dwordx4 v14, s[44:47], s88 offen offset:0 lds
  ds_read_b128 v[76:79], v18 offset:45056
  s_waitcnt lgkmcnt(2)
  v_mfma_f32_32x32x16_bf16 v[192:207], a[0:3], v[64:67], 0
  buffer_load_dwordx4 v15, s[44:47], s88 offen offset:1024 lds
  ds_read_b128 v[80:83], v19 offset:32768
  v_mfma_f32_16x16x32_bf16 v[104:107], v[60:63], v[64:67], 0
  v_mfma_f32_32x32x16_bf16 v[208:223], a[0:3], v[68:71], 0
  buffer_load_dwordx4 v16, s[44:47], s88 offen offset:2048 lds
  ds_read_b128 v[64:67], v19 offset:36864
  v_mfma_f32_16x16x32_bf16 v[108:111], v[60:63], v[68:71], 0
  s_waitcnt lgkmcnt(2)
  v_mfma_f32_32x32x16_bf16 v[224:239], a[0:3], v[72:75], 0
  buffer_load_dwordx4 v17, s[44:47], s88 offen offset:3072 lds
  ds_read_b128 v[68:71], v19 offset:40960
  v_mfma_f32_16x16x32_bf16 v[112:115], v[60:63], v[72:75], 0
  v_mfma_f32_32x32x16_bf16 v[240:255], a[0:3], v[76:79], 0
  s_add_u32 s88, s88, 128
  ds_read_b128 v[72:75], v19 offset:45056
  v_mfma_f32_16x16x32_bf16 v[116:119], v[60:63], v[76:79], 0
  s_waitcnt lgkmcnt(2)
  v_mfma_f32_32x32x16_bf16 v[192:207], a[4:7], v[80:83], v[192:207]
  ds_read_b128 v[76:79], v20 offset:32768
  v_mfma_f32_32x32x16_bf16 v[208:223], a[4:7], v[64:67], v[208:223]
  ds_read_b128 v[80:83], v20 offset:36864
  s_waitcnt lgkmcnt(2)
  v_mfma_f32_32x32x16_bf16 v[224:239], a[4:7], v[68:71], v[224:239]
  ds_read_b128 v[64:67], v20 offset:40960
  v_mfma_f32_32x32x16_bf16 v[240:255], a[4:7], v[72:75], v[240:255]
  ds_read_b128 v[68:71], v20 offset:45056
  s_waitcnt lgkmcnt(2)
  v_mfma_f32_32x32x16_bf16 v[192:207], a[8:11], v[76:79], v[192:207]
  ds_read_b128 v[72:75], v21 offset:32768
  v_mfma_f32_32x32x16_bf16 v[208:223], a[8:11], v[80:83], v[208:223]
  ds_read_b128 v[76:79], v21 offset:36864
  s_waitcnt lgkmcnt(2)
  v_mfma_f32_32x32x16_bf16 v[224:239], a[8:11], v[64:67], v[224:239]
  ds_read_b128 v[80:83], v21 offset:40960
  v_mfma_f32_32x32x16_bf16 v[240:255], a[8:11], v[68:71], v[240:255]
  ds_read_b128 v[64:67], v21 offset:45056
  s_waitcnt lgkmcnt(2)
  v_mfma_f32_32x32x16_bf16 v[192:207], a[12:15], v[72:75], v[192:207]
  s_waitcnt vmcnt(4)
  s_barrier
  ds_read_b128 v[68:71], v18 offset:49152
  v_mfma_f32_32x32x16_bf16 v[208:223], a[12:15], v[76:79], v[208:223]
  ds_read_b128 v[26:29], v86 offset:0
  v_mov_b32 v2, s61
  buffer_store_dword v2, off, s[56:59], s16 sc1
  v_add_u32 v2, s61, v125
  buffer_store_dword v2, v125, s[56:59], s101 offen sc1
  ds_read_b128 v[72:75], v18 offset:53248
  s_waitcnt lgkmcnt(3)
  v_mfma_f32_32x32x16_bf16 v[224:239], a[12:15], v[80:83], v[224:239]
  s_add_u32 m0, s90, 32768
  ds_read_b128 v[30:33], v86 offset:1024
  ds_read_b128 v[76:79], v18 offset:57344
  v_mfma_f32_32x32x16_bf16 v[240:255], a[12:15], v[64:67], v[240:255]
  buffer_load_dwordx4 v14, s[44:47], s88 offen offset:0 lds
  ds_read_b128 v[96:99], v86 offset:2048
  ds_read_b128 v[80:83], v18 offset:61440
  s_waitcnt lgkmcnt(4)
  v_mfma_f32_32x32x16_bf16 v[192:207], a[16:19], v[68:71], v[192:207]
  buffer_load_dwordx4 v15, s[44:47], s88 offen offset:1024 lds
  ds_read_b128 v[100:103], v86 offset:3072
  ds_read_b128 v[64:67], v19 offset:49152
  v_mfma_f32_16x16x32_bf16 v[104:107], v[60:63], v[68:71], v[104:107]
  v_mfma_f32_32x32x16_bf16 v[208:223], a[16:19], v[72:75], v[208:223]
  buffer_load_dwordx4 v16, s[44:47], s88 offen offset:2048 lds
  ds_read_b128 v[68:71], v19 offset:53248
  v_mfma_f32_16x16x32_bf16 v[108:111], v[60:63], v[72:75], v[108:111]
  s_waitcnt lgkmcnt(3)
  v_mfma_f32_32x32x16_bf16 v[224:239], a[16:19], v[76:79], v[224:239]
  buffer_load_dwordx4 v17, s[44:47], s88 offen offset:3072 lds
  ds_read_b128 v[72:75], v19 offset:57344
  v_mfma_f32_16x16x32_bf16 v[112:115], v[60:63], v[76:79], v[112:115]
  v_mfma_f32_32x32x16_bf16 v[240:255], a[16:19], v[80:83], v[240:255]
  s_add_u32 s88, s88, 128
  ds_read_b128 v[76:79], v19 offset:61440
  v_mfma_f32_16x16x32_bf16 v[116:119], v[60:63], v[80:83], v[116:119]
  s_waitcnt lgkmcnt(2)
  v_mfma_f32_32x32x16_bf16 v[192:207], a[20:23], v[64:67], v[192:207]
  ds_read_b128 v[80:83], v20 offset:49152
  v_mfma_f32_32x32x16_bf16 v[208:223], a[20:23], v[68:71], v[208:223]
  ds_read_b128 v[64:67], v20 offset:53248
  s_waitcnt lgkmcnt(2)
  v_mfma_f32_32x32x16_bf16 v[224:239], a[20:23], v[72:75], v[224:239]
  ds_read_b128 v[68:71], v20 offset:57344
  v_mfma_f32_32x32x16_bf16 v[240:255], a[20:23], v[76:79], v[240:255]
  ds_read_b128 v[72:75], v20 offset:61440
  v_mfma_f32_32x32x16_bf16 v[128:143], v[92:95], v[26:29], v[128:143]
  v_mfma_f32_32x32x16_bf16 v[144:159], v[92:95], v[30:33], v[144:159]
  v_mfma_f32_32x32x16_bf16 v[160:175], v[92:95], v[96:99], v[160:175]
  v_mfma_f32_32x32x16_bf16 v[176:191], v[92:95], v[100:103], v[176:191]
  s_waitcnt lgkmcnt(2)
  v_mfma_f32_32x32x16_bf16 v[192:207], a[24:27], v[80:83], v[192:207]
  ds_read_b128 v[76:79], v21 offset:49152
  v_lshrrev_b32 v127, 5, v1
  s_lshl_b32 s95, s82, 8
  s_add_u32 s95, s95, 147456
  v_lshl_add_u32 v127, v127, 7, s95
  v_mfma_f32_32x32x16_bf16 v[208:223], a[24:27], v[64:67], v[208:223]
  ds_read_b128 v[80:83], v21 offset:53248
  ds_read2_b32 v[26:27], v127 offset0:1 offset1:17
  ds_read2_b32 v[28:29], v127 offset0:3 offset1:19
  ds_read2_b32 v[30:31], v127 offset0:5 offset1:21
  ds_read2_b32 v[32:33], v127 offset0:7 offset1:23
  s_waitcnt lgkmcnt(6)
  v_mfma_f32_32x32x16_bf16 v[224:239], a[24:27], v[68:71], v[224:239]
  ds_read_b128 v[64:67], v21 offset:57344
  ds_read2_b32 v[96:97], v127 offset0:9 offset1:25
  ds_read2_b32 v[98:99], v127 offset0:11 offset1:27
  ds_read2_b32 v[100:101], v127 offset0:13 offset1:29
  ds_read2_b32 v[102:103], v127 offset0:15 offset1:31
  v_mfma_f32_32x32x16_bf16 v[240:255], a[24:27], v[72:75], v[240:255]
  ds_read_b128 v[68:71], v21 offset:61440
  ds_read_b128 v[6:9], v87 offset:0
  ds_read_b128 v[10:13], v87 offset:512
  s_waitcnt lgkmcnt(11)
  ds_read_b128 v[22:25], v88 offset:2048
  v_mul_u32_u24 v59, s11, v88
  v_mfma_f32_32x32x16_bf16 v[192:207], a[28:31], v[76:79], v[192:207]
  s_barrier
  ds_read_b128 v[72:75], v18 offset:0
  v_add_u32 v59, s12, v59
  ds_read_b128 v[120:123], v59
  v_mul_f32 v128, v128, v26
  v_mul_f32 v129, v129, v27
  v_mfma_f32_32x32x16_bf16 v[208:223], a[28:31], v[80:83], v[208:223]
  v_mov_b32 v2, 0
  v_mov_b32 v3, 0
  s_waitcnt lgkmcnt(11)
  ds_write_b64 v126, v[2:3]
  ds_read_b128 v[76:79], v18 offset:4096
  v_mul_f32 v130, v130, v28
  v_mul_f32 v131, v131, v29
  v_mul_f32 v132, v132, v30
  v_mul_f32 v133, v133, v31
  s_waitcnt lgkmcnt(7)
  v_mfma_f32_32x32x16_bf16 v[224:239], a[28:31], v[64:67], v[224:239]
  s_add_u32 m0, s90, 49152
  ds_read_b128 v[80:83], v18 offset:8192
  v_mul_f32 v134, v134, v32
  v_mul_f32 v135, v135, v33
  v_mul_f32 v136, v136, v96
  v_mul_f32 v137, v137, v97
  v_mfma_f32_32x32x16_bf16 v[240:255], a[28:31], v[68:71], v[240:255]
  buffer_load_dwordx4 v14, s[44:47], s88 offen offset:0 lds
  ds_read_b128 v[64:67], v18 offset:12288
  v_mul_f32 v138, v138, v98
  v_mul_f32 v139, v139, v99
  v_mul_f32 v140, v140, v100
  v_mul_f32 v141, v141, v101
  s_waitcnt lgkmcnt(2)
  v_mfma_f32_32x32x16_bf16 v[192:207], a[32:35], v[72:75], v[192:207]
  buffer_load_dwordx4 v15, s[44:47], s88 offen offset:1024 lds
  ds_read_b128 v[68:71], v19 offset:0
  v_mul_f32 v142, v142, v102
  v_mul_f32 v143, v143, v103
  v_mul_f32 v144, v144, v26
  v_mul_f32 v145, v145, v27
  v_mfma_f32_16x16x32_bf16 v[104:107], v[60:63], v[72:75], v[104:107]
  v_mul_f32 v146, v146, v28
  v_mul_f32 v147, v147, v29
  v_mul_f32 v148, v148, v30
  v_mul_f32 v149, v149, v31
  v_mfma_f32_32x32x16_bf16 v[208:223], a[32:35], v[76:79], v[208:223]
  buffer_load_dwordx4 v16, s[44:47], s88 offen offset:2048 lds
  ds_read_b128 v[72:75], v19 offset:4096
  v_mul_f32 v150, v150, v32
  v_mul_f32 v151, v151, v33
  v_mul_f32 v152, v152, v96
  v_mul_f32 v153, v153, v97
  v_mfma_f32_16x16x32_bf16 v[108:111], v[60:63], v[76:79], v[108:111]
  v_mul_f32 v154, v154, v98
  v_mul_f32 v155, v155, v99
  v_mul_f32 v156, v156, v100
  v_mul_f32 v157, v157, v101
  s_waitcnt lgkmcnt(2)
  v_mfma_f32_32x32x16_bf16 v[224:239], a[32:35], v[80:83], v[224:239]
  buffer_load_dwordx4 v17, s[44:47], s88 offen offset:3072 lds
  ds_read_b128 v[76:79], v19 offset:8192
  v_mul_f32 v158, v158, v102
  v_mul_f32 v159, v159, v103
  v_mul_f32 v160, v160, v26
  v_mul_f32 v161, v161, v27
  v_mfma_f32_16x16x32_bf16 v[112:115], v[60:63], v[80:83], v[112:115]
  v_mul_f32 v162, v162, v28
  v_mul_f32 v163, v163, v29
  v_mul_f32 v164, v164, v30
  v_mul_f32 v165, v165, v31
  v_mfma_f32_32x32x16_bf16 v[240:255], a[32:35], v[64:67], v[240:255]
  s_add_u32 s88, s88, 128
  ds_read_b128 v[80:83], v19 offset:12288
  v_mul_f32 v166, v166, v32
  v_mul_f32 v167, v167, v33
  v_mul_f32 v168, v168, v96
  v_mul_f32 v169, v169, v97
  v_mfma_f32_16x16x32_bf16 v[116:119], v[60:63], v[64:67], v[116:119]
  v_mul_f32 v170, v170, v98
  v_mul_f32 v171, v171, v99
  v_mul_f32 v172, v172, v100
  v_mul_f32 v173, v173, v101
  s_waitcnt lgkmcnt(2)
  v_mfma_f32_32x32x16_bf16 v[192:207], a[36:39], v[68:71], v[192:207]
  ds_read_b128 v[64:67], v20 offset:0
  v_mul_f32 v174, v174, v102
  v_mul_f32 v175, v175, v103
  v_mul_f32 v176, v176, v26
  v_mul_f32 v177, v177, v27
  v_mfma_f32_32x32x16_bf16 v[208:223], a[36:39], v[72:75], v[208:223]
  ds_read_b128 v[68:71], v20 offset:4096
  v_mul_f32 v178, v178, v28
  v_mul_f32 v179, v179, v29
  v_mul_f32 v180, v180, v30
  v_mul_f32 v181, v181, v31
  s_waitcnt lgkmcnt(2)
  v_mfma_f32_32x32x16_bf16 v[224:239], a[36:39], v[76:79], v[224:239]
  ds_read_b128 v[72:75], v20 offset:8192
  v_mul_f32 v182, v182, v32
  v_mul_f32 v183, v183, v33
  v_mul_f32 v184, v184, v96
  v_mul_f32 v185, v185, v97
  v_mfma_f32_32x32x16_bf16 v[240:255], a[36:39], v[80:83], v[240:255]
  ds_read_b128 v[76:79], v20 offset:12288
  v_mul_f32 v186, v186, v98
  v_mul_f32 v187, v187, v99
  v_mul_f32 v188, v188, v100
  v_mul_f32 v189, v189, v101
  s_waitcnt lgkmcnt(2)
  v_mfma_f32_32x32x16_bf16 v[192:207], a[40:43], v[64:67], v[192:207]
  ds_read_b128 v[80:83], v21 offset:0
  v_mul_f32 v190, v190, v102
  v_mul_f32 v191, v191, v103
  v_fma_f32 v36, v6, v128, v130
  v_fma_f32 v37, v6, v129, v131
  v_mfma_f32_32x32x16_bf16 v[208:223], a[40:43], v[68:71], v[208:223]
  ds_read_b128 v[64:67], v21 offset:4096
  v_fma_f32 v38, v6, v160, v162
  v_fma_f32 v39, v6, v161, v163
  v_fma_f32 v44, v10, v144, v146
  v_fma_f32 v45, v10, v145, v147
  s_waitcnt lgkmcnt(2)
  v_mfma_f32_32x32x16_bf16 v[224:239], a[40:43], v[72:75], v[224:239]
  ds_read_b128 v[68:71], v21 offset:8192
  v_fma_f32 v46, v10, v176, v178
  v_fma_f32 v47, v10, v177, v179
  v_fma_f32 v36, -v7, v160, v36
  v_fma_f32 v37, -v7, v161, v37
  v_mfma_f32_32x32x16_bf16 v[240:255], a[40:43], v[76:79], v[240:255]
  ds_read_b128 v[72:75], v21 offset:12288
  v_fma_f32 v38, v7, v128, v38
  v_fma_f32 v39, v7, v129, v39
  v_fma_f32 v44, -v11, v176, v44
  v_fma_f32 v45, -v11, v177, v45
  s_waitcnt lgkmcnt(2)
  v_mfma_f32_32x32x16_bf16 v[192:207], a[44:47], v[80:83], v[192:207]
  s_waitcnt vmcnt(10)
  s_barrier
  ds_read_b128 v[76:79], v18 offset:16384
  v_fma_f32 v46, v11, v144, v46
  v_fma_f32 v47, v11, v145, v47
  v_fma_f32 v40, v6, v36, v132
  v_mfma_f32_32x32x16_bf16 v[208:223], a[44:47], v[64:67], v[208:223]
  ds_read_b128 v[80:83], v18 offset:20480
  v_fma_f32 v41, v6, v37, v133
  v_fma_f32 v42, v6, v38, v164
  v_fma_f32 v43, v6, v39, v165
  v_fma_f32 v48, v10, v44, v148
  s_waitcnt lgkmcnt(2)
  v_mfma_f32_32x32x16_bf16 v[224:239], a[44:47], v[68:71], v[224:239]
  s_add_u32 m0, s90, 0
  ds_read_b128 v[64:67], v18 offset:24576
  v_fma_f32 v49, v10, v45, v149
  v_fma_f32 v50, v10, v46, v180
  v_fma_f32 v51, v10, v47, v181
  v_mfma_f32_32x32x16_bf16 v[240:255], a[44:47], v[72:75], v[240:255]
  buffer_load_dwordx4 v14, s[44:47], s88 offen offset:0 lds
  ds_read_b128 v[68:71], v18 offset:28672
  v_fma_f32 v40, -v7, v38, v40
  v_fma_f32 v41, -v7, v39, v41
  v_fma_f32 v42, v7, v36, v42
  s_waitcnt lgkmcnt(2)
  v_mfma_f32_32x32x16_bf16 v[192:207], a[48:51], v[76:79], v[192:207]
  buffer_load_dwordx4 v15, s[44:47], s88 offen offset:1024 lds
  ds_read_b128 v[72:75], v19 offset:16384
  v_fma_f32 v43, v7, v37, v43
  v_fma_f32 v48, -v11, v46, v48
  v_fma_f32 v49, -v11, v47, v49
  v_mfma_f32_16x16x32_bf16 v[104:107], v[60:63], v[76:79], v[104:107]
  v_fma_f32 v50, v11, v44, v50
  v_fma_f32 v51, v11, v45, v51
  v_fma_f32 v36, v6, v40, v134
  v_mfma_f32_32x32x16_bf16 v[208:223], a[48:51], v[80:83], v[208:223]
  buffer_load_dwordx4 v16, s[44:47], s88 offen offset:2048 lds
  ds_read_b128 v[76:79], v19 offset:20480
  v_fma_f32 v37, v6, v41, v135
  v_fma_f32 v38, v6, v42, v166
  v_fma_f32 v39, v6, v43, v167
  v_mfma_f32_16x16x32_bf16 v[108:111], v[60:63], v[80:83], v[108:111]
  v_fma_f32 v44, v10, v48, v150
  v_fma_f32 v45, v10, v49, v151
  v_fma_f32 v46, v10, v50, v182
  s_waitcnt lgkmcnt(2)
  v_mfma_f32_32x32x16_bf16 v[224:239], a[48:51], v[64:67], v[224:239]
  buffer_load_dwordx4 v17, s[44:47], s88 offen offset:3072 lds
  ds_read_b128 v[80:83], v19 offset:24576
  v_fma_f32 v47, v10, v51, v183
  v_fma_f32 v36, -v7, v42, v36
  v_fma_f32 v37, -v7, v43, v37
  v_mfma_f32_16x16x32_bf16 v[112:115], v[60:63], v[64:67], v[112:115]
  v_fma_f32 v38, v7, v40, v38
  v_fma_f32 v39, v7, v41, v39
  v_fma_f32 v44, -v11, v50, v44
  v_mfma_f32_32x32x16_bf16 v[240:255], a[48:51], v[68:71], v[240:255]
  s_add_u32 s88, s88, 128
  ds_read_b128 v[64:67], v19 offset:28672
  v_fma_f32 v45, -v11, v51, v45
  v_fma_f32 v46, v11, v48, v46
  v_fma_f32 v47, v11, v49, v47
  v_mfma_f32_16x16x32_bf16 v[116:119], v[60:63], v[68:71], v[116:119]
  v_fma_f32 v40, v6, v36, v136
  v_fma_f32 v41, v6, v37, v137
  v_fma_f32 v42, v6, v38, v168
  s_waitcnt lgkmcnt(2)
  v_mfma_f32_32x32x16_bf16 v[192:207], a[52:55], v[72:75], v[192:207]
  ds_read_b128 v[68:71], v20 offset:16384
  v_fma_f32 v43, v6, v39, v169
  v_fma_f32 v48, v10, v44, v152
  v_fma_f32 v49, v10, v45, v153
  v_fma_f32 v50, v10, v46, v184
  v_mfma_f32_32x32x16_bf16 v[208:223], a[52:55], v[76:79], v[208:223]
  ds_read_b128 v[72:75], v20 offset:20480
  v_fma_f32 v51, v10, v47, v185
  v_fma_f32 v40, -v7, v38, v40
  v_fma_f32 v41, -v7, v39, v41
  v_fma_f32 v42, v7, v36, v42
  s_waitcnt lgkmcnt(2)
  v_mfma_f32_32x32x16_bf16 v[224:239], a[52:55], v[80:83], v[224:239]
  s_mov_b64 exec, 0x3f00
  buffer_load_dword v84, v89, s[56:59], 0 offen sc1
  s_mov_b64 exec, -1
  ds_read_b128 v[76:79], v20 offset:24576
  v_fma_f32 v43, v7, v37, v43
  v_fma_f32 v48, -v11, v46, v48
  v_fma_f32 v49, -v11, v47, v49
  v_mfma_f32_32x32x16_bf16 v[240:255], a[52:55], v[64:67], v[240:255]
  ds_read_b128 v[80:83], v20 offset:28672
  v_fma_f32 v50, v11, v44, v50
  v_fma_f32 v51, v11, v45, v51
  v_fma_f32 v36, v6, v40, v138
  v_fma_f32 v37, v6, v41, v139
  s_waitcnt lgkmcnt(2)
  v_mfma_f32_32x32x16_bf16 v[192:207], a[56:59], v[68:71], v[192:207]
  ds_read_b128 v[64:67], v21 offset:16384
  v_fma_f32 v38, v6, v42, v170
  v_fma_f32 v39, v6, v43, v171
  v_fma_f32 v44, v10, v48, v154
  v_fma_f32 v45, v10, v49, v155
  v_mfma_f32_32x32x16_bf16 v[208:223], a[56:59], v[72:75], v[208:223]
  ds_read_b128 v[68:71], v21 offset:20480
  v_fma_f32 v46, v10, v50, v186
  v_fma_f32 v47, v10, v51, v187
  v_fma_f32 v36, -v7, v42, v36
  v_fma_f32 v37, -v7, v43, v37
  s_waitcnt lgkmcnt(2)
  v_mfma_f32_32x32x16_bf16 v[224:239], a[56:59], v[76:79], v[224:239]
  ds_read_b128 v[72:75], v21 offset:24576
  v_fma_f32 v38, v7, v40, v38
  v_fma_f32 v39, v7, v41, v39
  v_fma_f32 v44, -v11, v50, v44
  v_fma_f32 v45, -v11, v51, v45
  v_mfma_f32_32x32x16_bf16 v[240:255], a[56:59], v[80:83], v[240:255]
  ds_read_b128 v[76:79], v21 offset:28672
  v_fma_f32 v46, v11, v48, v46
  v_fma_f32 v47, v11, v49, v47
  v_fma_f32 v40, v6, v36, v140
  v_fma_f32 v41, v6, v37, v141
  s_waitcnt lgkmcnt(2)
  v_mfma_f32_32x32x16_bf16 v[192:207], a[60:63], v[64:67], v[192:207]
  s_waitcnt vmcnt(9)
  s_barrier
  ds_read_b128 v[80:83], v18 offset:32768
  v_fma_f32 v42, v6, v38, v172
  v_fma_f32 v43, v6, v39, v173
  v_fma_f32 v48, v10, v44, v156
  v_mfma_f32_32x32x16_bf16 v[208:223], a[60:63], v[68:71], v[208:223]
  ds_read_b128 v[64:67], v18 offset:36864
  v_fma_f32 v49, v10, v45, v157
  v_fma_f32 v50, v10, v46, v188
  v_fma_f32 v51, v10, v47, v189
  v_fma_f32 v40, -v7, v38, v40
  s_waitcnt lgkmcnt(2)
  v_mfma_f32_32x32x16_bf16 v[224:239], a[60:63], v[72:75], v[224:239]
  s_add_u32 m0, s90, 16384
  ds_read_b128 v[68:71], v18 offset:40960
  v_fma_f32 v41, -v7, v39, v41
  v_fma_f32 v42, v7, v36, v42
  v_fma_f32 v43, v7, v37, v43
  v_mfma_f32_32x32x16_bf16 v[240:255], a[60:63], v[76:79], v[240:255]
  buffer_load_dwordx4 v14, s[44:47], s88 offen offset:0 lds
  ds_read_b128 v[72:75], v18 offset:45056
  v_fma_f32 v48, -v11, v46, v48
  v_fma_f32 v49, -v11, v47, v49
  v_fma_f32 v50, v11, v44, v50
  s_waitcnt lgkmcnt(2)
  v_mfma_f32_32x32x16_bf16 v[192:207], a[64:67], v[80:83], v[192:207]
  buffer_load_dwordx4 v15, s[44:47], s88 offen offset:1024 lds
  ds_read_b128 v[76:79], v19 offset:32768
  v_fma_f32 v51, v11, v45, v51
  v_fma_f32 v36, v6, v40, v142
  v_fma_f32 v37, v6, v41, v143
  v_mfma_f32_16x16x32_bf16 v[104:107], v[60:63], v[80:83], v[104:107]
  v_fma_f32 v38, v6, v42, v174
  v_fma_f32 v39, v6, v43, v175
  v_fma_f32 v44, v10, v48, v158
  v_mfma_f32_32x32x16_bf16 v[208:223], a[64:67], v[64:67], v[208:223]
  buffer_load_dwordx4 v16, s[44:47], s88 offen offset:2048 lds
  ds_read_b128 v[80:83], v19 offset:36864
  v_fma_f32 v45, v10, v49, v159
  v_fma_f32 v46, v10, v50, v190
  v_fma_f32 v47, v10, v51, v191
  v_mfma_f32_16x16x32_bf16 v[108:111], v[60:63], v[64:67], v[108:111]
  v_fma_f32 v36, -v7, v42, v36
  v_fma_f32 v37, -v7, v43, v37
  v_fma_f32 v38, v7, v40, v38
  s_waitcnt lgkmcnt(2)
  v_mfma_f32_32x32x16_bf16 v[224:239], a[64:67], v[68:71], v[224:239]
  buffer_load_dwordx4 v17, s[44:47], s88 offen offset:3072 lds
  ds_read_b128 v[64:67], v19 offset:40960
  v_fma_f32 v39, v7, v41, v39
  v_fma_f32 v44, -v11, v50, v44
  v_mfma_f32_16x16x32_bf16 v[112:115], v[60:63], v[68:71], v[112:115]
  v_fma_f32 v45, -v11, v51, v45
  v_fma_f32 v46, v11, v48, v46
  v_mfma_f32_32x32x16_bf16 v[240:255], a[64:67], v[72:75], v[240:255]
  s_add_u32 s88, s88, 128
  ds_read_b128 v[68:71], v19 offset:45056
  v_fma_f32 v47, v11, v49, v47
  v_fma_f32 v37, v8, v36, v37
  v_fma_f32 v39, v8, v38, v39
  v_mfma_f32_16x16x32_bf16 v[116:119], v[60:63], v[72:75], v[116:119]
  v_fma_f32 v37, -v9, v38, v37
  v_fma_f32 v39, v9, v36, v39
  s_waitcnt lgkmcnt(2)
  v_mfma_f32_32x32x16_bf16 v[192:207], a[68:71], v[76:79], v[192:207]
  ds_read_b128 v[72:75], v20 offset:32768
  v_fma_f32 v45, v12, v44, v45
  v_fma_f32 v47, v12, v46, v47
  v_fma_f32 v45, -v13, v46, v45
  v_fma_f32 v47, v13, v44, v47
  v_mfma_f32_32x32x16_bf16 v[208:223], a[68:71], v[80:83], v[208:223]
  s_waitcnt vmcnt(4)
  v_cmp_ne_u32 vcc, s61, v84
  s_nop 1
  s_and_b32 vcc_lo, vcc_lo, 0x3f00
  s_cbranch_scc1 L_slow8
L_back8:
  ds_read_b128 v[76:79], v20 offset:36864
  v_mul_f32 v58, v22, v22
  v_mul_f32 v59, v22, v23
  s_waitcnt lgkmcnt(2)
  v_mfma_f32_32x32x16_bf16 v[224:239], a[68:71], v[64:67], v[224:239]
  s_add_u32 m0, s29, 86016
  s_add_u32 s15, s99, 1310720
  buffer_load_dwordx4 v35, s[52:55], s15 offen offset:0 sc1 lds
  ds_read_b128 v[80:83], v20 offset:40960
  v_fma_f32 v58, -v23, v23, v58
  v_fma_f32 v59, v23, v22, v59
  v_mfma_f32_32x32x16_bf16 v[240:255], a[68:71], v[68:71], v[240:255]
L_pgs2:
  s_cbranch_execz L_pgs6
  ds_read_b128 v[64:67], v20 offset:45056
  v_permlane32_swap_b32 v37, v45
  v_permlane32_swap_b32 v39, v47
  v_fma_f32 v48, v22, v37, v45
  v_fma_f32 v49, v22, v39, v47
  s_waitcnt lgkmcnt(2)
  v_mfma_f32_32x32x16_bf16 v[192:207], a[72:75], v[72:75], v[192:207]
  s_add_u32 m0, s29, 86016
  s_nop 0
  buffer_load_dwordx4 v35, s[52:55], s15 offen offset:1024 sc1 lds
  ds_read_b128 v[68:71], v21 offset:32768
  v_mfma_f32_32x32x16_bf16 v[208:223], a[72:75], v[76:79], v[208:223]
  ds_read_b128 v[72:75], v21 offset:36864
  v_fma_f32 v48, -v23, v39, v48
  v_fma_f32 v49, v23, v37, v49
  ds_write_b64 v126, v[48:49] offset:2048
  s_waitcnt lgkmcnt(3)
  v_mfma_f32_32x32x16_bf16 v[224:239], a[72:75], v[80:83], v[224:239]
  s_add_u32 m0, s29, 86016
  s_nop 0
  buffer_load_dwordx4 v35, s[52:55], s15 offen offset:2048 sc1 lds
  ds_read_b128 v[76:79], v21 offset:40960
  v_mfma_f32_32x32x16_bf16 v[240:255], a[72:75], v[64:67], v[240:255]
  ds_read_b128 v[80:83], v21 offset:45056
  s_waitcnt lgkmcnt(3)
  v_mfma_f32_32x32x16_bf16 v[192:207], a[76:79], v[68:71], v[192:207]
  s_add_u32 m0, s29, 86016
  s_nop 0
  buffer_load_dwordx4 v35, s[52:55], s15 offen offset:3072 sc1 lds
  s_waitcnt lgkmcnt(2)
  s_barrier
  ds_read_b128 v[64:67], v18 offset:49152
  v_mfma_f32_32x32x16_bf16 v[208:223], a[76:79], v[72:75], v[208:223]
  ds_read_b128 v[68:71], v18 offset:53248
  ds_read2st64_b64 v[52:55], v126 offset0:1 offset1:2
  ds_read_b64 v[56:57], v126 offset:1536
  v_mov_b32 v50, s61
  s_waitcnt lgkmcnt(1)
  v_fma_f32 v54, v58, v52, v54
  v_mfma_f32_32x32x16_bf16 v[224:239], a[76:79], v[76:79], v[224:239]
  s_add_u32 m0, s90, 32768
  ds_read_b128 v[72:75], v18 offset:57344
  v_fma_f32 v55, v58, v53, v55
  v_fma_f32 v54, -v59, v53, v54
  v_fma_f32 v55, v59, v52, v55
  v_mfma_f32_32x32x16_bf16 v[240:255], a[76:79], v[80:83], v[240:255]
  buffer_load_dwordx4 v14, s[44:47], s88 offen offset:0 lds
  ds_read_b128 v[76:79], v18 offset:61440
  v_mfma_f32_32x32x16_bf16 v[192:207], a[80:83], v[64:67], v[192:207]
  buffer_load_dwordx4 v15, s[44:47], s88 offen offset:1024 lds
  ds_read_b128 v[80:83], v19 offset:49152
  v_mfma_f32_16x16x32_bf16 v[104:107], v[60:63], v[64:67], v[104:107]
  s_waitcnt lgkmcnt(3)
  v_fma_f32 v42, v58, v54, v56
  v_fma_f32 v40, v58, v55, v57
  v_mfma_f32_32x32x16_bf16 v[208:223], a[80:83], v[68:71], v[208:223]
  buffer_load_dwordx4 v16, s[44:47], s88 offen offset:2048 lds
  ds_read_b128 v[64:67], v19 offset:53248
  v_mfma_f32_16x16x32_bf16 v[108:111], v[60:63], v[68:71], v[108:111]
  v_fma_f32 v42, -v59, v55, v42
  v_fma_f32 v40, v59, v54, v40
  s_waitcnt lgkmcnt(2)
  v_mfma_f32_32x32x16_bf16 v[224:239], a[80:83], v[72:75], v[224:239]
  buffer_load_dwordx4 v17, s[44:47], s88 offen offset:3072 lds
  ds_read_b128 v[68:71], v19 offset:57344
  v_mfma_f32_16x16x32_bf16 v[112:115], v[60:63], v[72:75], v[112:115]
  v_fma_f32 v48, v58, v42, v48
  v_fma_f32 v49, v58, v40, v49
  v_mfma_f32_32x32x16_bf16 v[240:255], a[80:83], v[76:79], v[240:255]
  s_add_u32 s88, s88, 128
  ds_read_b128 v[72:75], v19 offset:61440
  v_fma_f32 v48, -v59, v40, v48
  v_fma_f32 v49, v59, v42, v49
  v_mfma_f32_16x16x32_bf16 v[116:119], v[60:63], v[76:79], v[116:119]
  buffer_store_dwordx4 v[48:51], v35, s[76:79], s94 offen sc1
  s_waitcnt lgkmcnt(2)
  v_mfma_f32_32x32x16_bf16 v[192:207], a[84:87], v[80:83], v[192:207]
  ds_read_b128 v[76:79], v20 offset:49152
  v_add_u32 v126, 4294880256, v126
  v_bfe_u32 v26, v1, 3, 1
  v_lshlrev_b32 v26, 4, v26
  v_mov_b32 v27, 0x3f80
  v_mfma_f32_32x32x16_bf16 v[208:223], a[84:87], v[64:67], v[208:223]
  s_add_u32 m0, s29, 90112
  s_add_u32 s15, s99, 1314816
  buffer_load_dwordx4 v35, s[52:55], s15 offen offset:0 sc1 lds
  ds_read_b128 v[80:83], v20 offset:53248
  s_waitcnt lgkmcnt(2)
  v_mfma_f32_32x32x16_bf16 v[224:239], a[84:87], v[68:71], v[224:239]
  ds_read_b128 v[64:67], v20 offset:57344
  v_lshlrev_b32 v27, v26, v27
  v_lshrrev_b32 v26, 1, v1
  v_xor_b32 v26, v26, v1
  v_and_b32 v26, 16, v26
  v_mfma_f32_32x32x16_bf16 v[240:255], a[84:87], v[72:75], v[240:255]
  s_add_u32 m0, s29, 106496
  s_add_u32 s15, s99, 1638400
  buffer_load_dwordx4 v35, s[52:55], s15 offen offset:0 sc1 lds
  ds_read_b128 v[68:71], v20 offset:61440
  s_waitcnt lgkmcnt(2)
  v_mfma_f32_32x32x16_bf16 v[192:207], a[88:91], v[76:79], v[192:207]
  ds_read_b128 v[72:75], v21 offset:49152
  v_and_or_b32 v26, v1, 7, v26
  v_cmp_eq_u32 s[18:19], 0, v26
  s_nop 1
  v_cndmask_b32 v52, 0, v27, s[18:19]
  v_cmp_eq_u32 s[18:19], 1, v26
  v_mfma_f32_32x32x16_bf16 v[208:223], a[88:91], v[80:83], v[208:223]
  s_add_u32 m0, s29, 106496
  s_nop 0
  buffer_load_dwordx4 v35, s[52:55], s15 offen offset:1024 sc1 lds
  ds_read_b128 v[76:79], v21 offset:53248
  s_waitcnt lgkmcnt(2)
  v_mfma_f32_32x32x16_bf16 v[224:239], a[88:91], v[64:67], v[224:239]
  ds_read_b128 v[80:83], v21 offset:57344
  v_cndmask_b32 v53, 0, v27, s[18:19]
  v_cmp_eq_u32 s[18:19], 2, v26
  s_nop 1
  v_cndmask_b32 v54, 0, v27, s[18:19]
  v_cmp_eq_u32 s[18:19], 3, v26
  v_mfma_f32_32x32x16_bf16 v[240:255], a[88:91], v[68:71], v[240:255]
  s_add_u32 m0, s29, 106496
  s_nop 0
  buffer_load_dwordx4 v35, s[52:55], s15 offen offset:2048 sc1 lds
  ds_read_b128 v[64:67], v21 offset:61440
  s_waitcnt lgkmcnt(2)
  v_mfma_f32_32x32x16_bf16 v[192:207], a[92:95], v[72:75], v[192:207]
  s_barrier
  ds_read_b128 v[68:71], v18 offset:0
  v_cndmask_b32 v55, 0, v27, s[18:19]
  v_cmp_eq_u32 s[18:19], 4, v26
  v_mfma_f32_32x32x16_bf16 v[208:223], a[92:95], v[76:79], v[208:223]
  ds_read_b128 v[72:75], v18 offset:4096
  v_cndmask_b32 v56, 0, v27, s[18:19]
  v_cmp_eq_u32 s[18:19], 5, v26
  s_nop 1
  v_cndmask_b32 v57, 0, v27, s[18:19]
  v_cmp_eq_u32 s[18:19], 6, v26
  s_waitcnt lgkmcnt(2)
  v_mfma_f32_32x32x16_bf16 v[224:239], a[92:95], v[80:83], v[224:239]
  s_add_u32 m0, s90, 49152
  ds_read_b128 v[76:79], v18 offset:8192
  v_cndmask_b32 v58, 0, v27, s[18:19]
  v_cmp_eq_u32 s[18:19], 7, v26
  s_nop 1
  v_cndmask_b32 v59, 0, v27, s[18:19]
  v_mfma_f32_32x32x16_bf16 v[240:255], a[92:95], v[64:67], v[240:255]
  buffer_load_dwordx4 v14, s[44:47], s88 offen offset:0 lds
  ds_read_b128 v[80:83], v18 offset:12288
  s_waitcnt lgkmcnt(2)
  v_mfma_f32_32x32x16_bf16 v[192:207], a[96:99], v[68:71], v[192:207]
  buffer_load_dwordx4 v15, s[44:47], s88 offen offset:1024 lds
  ds_read_b128 v[64:67], v19 offset:0
  v_mfma_f32_16x16x32_bf16 v[104:107], v[60:63], v[68:71], v[104:107]
  v_mfma_f32_32x32x16_bf16 v[208:223], a[96:99], v[72:75], v[208:223]
  buffer_load_dwordx4 v16, s[44:47], s88 offen offset:2048 lds
  ds_read_b128 v[68:71], v19 offset:4096
  v_mfma_f32_16x16x32_bf16 v[108:111], v[60:63], v[72:75], v[108:111]
  s_waitcnt lgkmcnt(2)
  v_mfma_f32_32x32x16_bf16 v[224:239], a[96:99], v[76:79], v[224:239]
  buffer_load_dwordx4 v17, s[44:47], s88 offen offset:3072 lds
  ds_read_b128 v[72:75], v19 offset:8192
  v_mfma_f32_16x16x32_bf16 v[112:115], v[60:63], v[76:79], v[112:115]
  v_mfma_f32_32x32x16_bf16 v[240:255], a[96:99], v[80:83], v[240:255]
  s_add_u32 s88, s88, 128
  ds_read_b128 v[76:79], v19 offset:12288
  v_mfma_f32_16x16x32_bf16 v[116:119], v[60:63], v[80:83], v[116:119]
  s_waitcnt lgkmcnt(2)
  v_mfma_f32_32x32x16_bf16 v[192:207], a[100:103], v[64:67], v[192:207]
  ds_read_b128 v[80:83], v20 offset:0
  v_mfma_f32_32x32x16_bf16 v[208:223], a[100:103], v[68:71], v[208:223]
  s_mov_b64 exec, 0xffc0ff
  buffer_load_dword v84, v89, s[56:59], 0 offen sc1
  s_mov_b64 exec, -1
  s_add_u32 m0, s29, 106496
  s_nop 0
  buffer_load_dwordx4 v35, s[52:55], s15 offen offset:3072 sc1 lds
  ds_read_b128 v[64:67], v20 offset:4096
  s_waitcnt lgkmcnt(2)
  v_mfma_f32_32x32x16_bf16 v[224:239], a[100:103], v[72:75], v[224:239]
  ds_read_b128 v[68:71], v20 offset:8192
  v_mfma_f32_32x32x16_bf16 v[240:255], a[100:103], v[76:79], v[240:255]
  s_add_u32 m0, s29, 110592
  s_add_u32 s15, s99, 1642496
  buffer_load_dwordx4 v35, s[52:55], s15 offen offset:0 sc1 lds
  ds_read_b128 v[72:75], v20 offset:12288
  s_waitcnt lgkmcnt(2)
  v_mfma_f32_32x32x16_bf16 v[192:207], a[104:107], v[80:83], v[192:207]
  ds_read_b128 v[76:79], v21 offset:0
  v_mfma_f32_32x32x16_bf16 v[208:223], a[104:107], v[64:67], v[208:223]
  s_add_u32 m0, s29, 126976
  s_add_u32 s15, s99, 1966080
  buffer_load_dwordx4 v35, s[52:55], s15 offen offset:0 sc1 lds
  ds_read_b128 v[80:83], v21 offset:4096
  s_waitcnt lgkmcnt(2)
  v_mfma_f32_32x32x16_bf16 v[224:239], a[104:107], v[68:71], v[224:239]
  ds_read_b128 v[64:67], v21 offset:8192
  v_mfma_f32_32x32x16_bf16 v[240:255], a[104:107], v[72:75], v[240:255]
  s_add_u32 m0, s29, 126976
  s_nop 0
  buffer_load_dwordx4 v35, s[52:55], s15 offen offset:1024 sc1 lds
  ds_read_b128 v[68:71], v21 offset:12288
  s_waitcnt lgkmcnt(2)
  v_mfma_f32_32x32x16_bf16 v[192:207], a[108:111], v[76:79], v[192:207]
  s_waitcnt vmcnt(22)
  s_barrier
  ds_read_b128 v[72:75], v18 offset:16384
  v_mfma_f32_32x32x16_bf16 v[208:223], a[108:111], v[80:83], v[208:223]
  s_add_u32 s44, s76, 16384
  s_addc_u32 s45, s77, 0
  s_mov_b32 s46, 16384
  ds_read_b128 v[76:79], v18 offset:20480
  s_waitcnt lgkmcnt(2)
  v_mfma_f32_32x32x16_bf16 v[224:239], a[108:111], v[64:67], v[224:239]
  ds_read_b128 v[80:83], v18 offset:24576
  v_mfma_f32_32x32x16_bf16 v[240:255], a[108:111], v[68:71], v[240:255]
  s_add_u32 m0, s29, 126976
  s_nop 0
  buffer_load_dwordx4 v35, s[52:55], s15 offen offset:2048 sc1 lds
  ds_read_b128 v[64:67], v18 offset:28672
  s_waitcnt lgkmcnt(2)
  v_mfma_f32_32x32x16_bf16 v[192:207], a[112:115], v[72:75], v[192:207]
  ds_read_b128 v[68:71], v19 offset:16384
  v_mfma_f32_16x16x32_bf16 v[104:107], v[60:63], v[72:75], v[104:107]
  v_mfma_f32_32x32x16_bf16 v[208:223], a[112:115], v[76:79], v[208:223]
  s_add_u32 m0, s29, 126976
  s_nop 0
  buffer_load_dwordx4 v35, s[52:55], s15 offen offset:3072 sc1 lds
  ds_read_b128 v[72:75], v19 offset:20480
  v_mfma_f32_16x16x32_bf16 v[108:111], v[60:63], v[76:79], v[108:111]
  s_waitcnt lgkmcnt(2)
  v_mfma_f32_32x32x16_bf16 v[224:239], a[112:115], v[80:83], v[224:239]
  ds_read_b128 v[76:79], v19 offset:24576
  v_mfma_f32_16x16x32_bf16 v[112:115], v[60:63], v[80:83], v[112:115]
  v_mfma_f32_32x32x16_bf16 v[240:255], a[112:115], v[64:67], v[240:255]
  s_add_u32 m0, s29, 131072
  s_add_u32 s15, s99, 1970176
  buffer_load_dwordx4 v35, s[52:55], s15 offen offset:0 sc1 lds
  ds_read_b128 v[80:83], v19 offset:28672
  v_mfma_f32_16x16x32_bf16 v[116:119], v[60:63], v[64:67], v[116:119]
  s_waitcnt lgkmcnt(2)
  v_mfma_f32_32x32x16_bf16 v[192:207], a[116:119], v[68:71], v[192:207]
  ds_read_b128 v[64:67], v20 offset:16384
  v_mfma_f32_32x32x16_bf16 v[208:223], a[116:119], v[72:75], v[208:223]
  ds_read_b128 v[68:71], v20 offset:20480
  s_waitcnt lgkmcnt(2)
  v_mfma_f32_32x32x16_bf16 v[224:239], a[116:119], v[76:79], v[224:239]
  ds_read_b128 v[72:75], v20 offset:24576
  v_mfma_f32_32x32x16_bf16 v[240:255], a[116:119], v[80:83], v[240:255]
  ds_read_b128 v[76:79], v20 offset:28672
  s_waitcnt lgkmcnt(2)
  v_mfma_f32_32x32x16_bf16 v[192:207], a[120:123], v[64:67], v[192:207]
  s_waitcnt vmcnt(7)
  v_cmp_ne_u32 vcc, s61, v84
  s_nop 1
  s_and_b32 vcc_lo, vcc_lo, 0xffc0ff
  s_cbranch_scc1 L_slow9
L_back9:
  ds_read_b128 v[80:83], v21 offset:16384
  v_mfma_f32_32x32x16_bf16 v[208:223], a[120:123], v[68:71], v[208:223]
  ds_read_b128 v[64:67], v21 offset:20480
  s_waitcnt lgkmcnt(2)
  v_mfma_f32_32x32x16_bf16 v[224:239], a[120:123], v[72:75], v[224:239]
  ds_read_b128 v[68:71], v21 offset:24576
  v_mfma_f32_32x32x16_bf16 v[240:255], a[120:123], v[76:79], v[240:255]
  ds_read_b128 v[72:75], v21 offset:28672
  s_waitcnt lgkmcnt(2)
  v_mfma_f32_32x32x16_bf16 v[192:207], a[124:127], v[80:83], v[192:207]
  s_barrier
  ds_read_b128 v[76:79], v18 offset:32768
  v_mfma_f32_32x32x16_bf16 v[208:223], a[124:127], v[64:67], v[208:223]
  ds_read_b128 v[80:83], v18 offset:36864
  s_waitcnt lgkmcnt(2)
  v_mfma_f32_32x32x16_bf16 v[224:239], a[124:127], v[68:71], v[224:239]
  buffer_load_dwordx3 v[26:28], v35, s[76:79], s92 offen offset:0 sc1
  buffer_load_dwordx3 v[30:32], v35, s[76:79], s92 offen offset:1024 sc1
  buffer_load_dwordx3 v[96:98], v35, s[76:79], s92 offen offset:2048 sc1
  buffer_load_dwordx3 v[100:102], v35, s[76:79], s92 offen offset:3072 sc1
  ds_read_b128 v[64:67], v18 offset:40960
  v_mfma_f32_32x32x16_bf16 v[240:255], a[124:127], v[72:75], v[240:255]
  s_add_u32 m0, s29, 65536
  s_add_u32 s15, s99, 983040
  buffer_load_dwordx4 v35, s[52:55], s15 offen offset:0 sc1 lds
  ds_read_b128 v[68:71], v18 offset:45056
  s_waitcnt lgkmcnt(2)
  v_mfma_f32_32x32x16_bf16 v[192:207], a[128:131], v[76:79], v[192:207]
  ds_read_b128 v[72:75], v19 offset:32768
  v_mfma_f32_16x16x32_bf16 v[104:107], v[60:63], v[76:79], v[104:107]
  v_mfma_f32_32x32x16_bf16 v[208:223], a[128:131], v[80:83], v[208:223]
  s_add_u32 m0, s29, 65536
  s_nop 0
  buffer_load_dwordx4 v35, s[52:55], s15 offen offset:1024 sc1 lds
  ds_read_b128 v[76:79], v19 offset:36864
  v_mfma_f32_16x16x32_bf16 v[108:111], v[60:63], v[80:83], v[108:111]
  s_waitcnt lgkmcnt(2)
  v_mfma_f32_32x32x16_bf16 v[224:239], a[128:131], v[64:67], v[224:239]
  ds_read_b128 v[80:83], v19 offset:40960
  v_mfma_f32_16x16x32_bf16 v[112:115], v[60:63], v[64:67], v[112:115]
  v_mfma_f32_32x32x16_bf16 v[240:255], a[128:131], v[68:71], v[240:255]
  s_add_u32 m0, s29, 65536
  s_nop 0
  buffer_load_dwordx4 v35, s[52:55], s15 offen offset:2048 sc1 lds
  ds_read_b128 v[64:67], v19 offset:45056
  v_mfma_f32_16x16x32_bf16 v[116:119], v[60:63], v[68:71], v[116:119]
  s_waitcnt lgkmcnt(2)
  v_mfma_f32_32x32x16_bf16 v[192:207], a[132:135], v[72:75], v[192:207]
  ds_read_b128 v[68:71], v20 offset:32768
  v_mfma_f32_32x32x16_bf16 v[208:223], a[132:135], v[76:79], v[208:223]
  s_add_u32 m0, s29, 65536
  s_nop 0
  buffer_load_dwordx4 v35, s[52:55], s15 offen offset:3072 sc1 lds
  ds_read_b128 v[72:75], v20 offset:36864
  s_waitcnt lgkmcnt(2)
  v_mfma_f32_32x32x16_bf16 v[224:239], a[132:135], v[80:83], v[224:239]
  ds_read_b128 v[76:79], v20 offset:40960
  v_mfma_f32_32x32x16_bf16 v[240:255], a[132:135], v[64:67], v[240:255]
  s_add_u32 m0, s29, 69632
  s_add_u32 s15, s99, 987136
  buffer_load_dwordx4 v35, s[52:55], s15 offen offset:0 sc1 lds
  ds_read_b128 v[80:83], v20 offset:45056
  s_waitcnt lgkmcnt(2)
  v_mfma_f32_32x32x16_bf16 v[192:207], a[136:139], v[68:71], v[192:207]
  ds_read_b128 v[64:67], v21 offset:32768
  v_mfma_f32_32x32x16_bf16 v[208:223], a[136:139], v[72:75], v[208:223]
  ds_read_b128 v[68:71], v21 offset:36864
  s_waitcnt lgkmcnt(2)
  v_mfma_f32_32x32x16_bf16 v[224:239], a[136:139], v[76:79], v[224:239]
  ds_read_b128 v[72:75], v21 offset:40960
  v_mfma_f32_32x32x16_bf16 v[240:255], a[136:139], v[80:83], v[240:255]
  ds_read_b128 v[76:79], v21 offset:45056
  s_waitcnt lgkmcnt(2)
  v_mfma_f32_32x32x16_bf16 v[192:207], a[140:143], v[64:67], v[192:207]
  s_barrier
  ds_read_b128 v[80:83], v18 offset:49152
  v_mfma_f32_32x32x16_bf16 v[208:223], a[140:143], v[68:71], v[208:223]
  ds_read_b128 v[64:67], v18 offset:53248
  s_waitcnt lgkmcnt(2)
  v_mfma_f32_32x32x16_bf16 v[224:239], a[140:143], v[72:75], v[224:239]
  s_waitcnt vmcnt(6)
  v_add3_u32 v29, v28, v32, v98
  s_waitcnt vmcnt(5)
  v_add_u32 v29, v102, v29
  v_cmp_ne_u32 vcc, s10, v29
  s_nop 1
  s_cmp_lg_u64 vcc, 0
  s_cbranch_scc1 L_slow10
L_back10:
  ds_read_b128 v[68:71], v18 offset:57344
  v_mfma_f32_32x32x16_bf16 v[240:255], a[140:143], v[76:79], v[240:255]
  s_add_u32 m0, s29, 0
  s_add_u32 s15, s99, 0
  buffer_load_dwordx4 v35, s[52:55], s15 offen offset:0 sc1 lds
  ds_read_b128 v[72:75], v18 offset:61440
  s_waitcnt lgkmcnt(2)
  v_mfma_f32_32x32x16_bf16 v[192:207], a[144:147], v[80:83], v[192:207]
  ds_read_b128 v[76:79], v19 offset:49152
  v_lshl_add_u32 v33, v1, 3, s13
  v_fma_f32 v96, v24, v100, v96
  v_fma_f32 v97, v24, v101, v97
  v_fma_f32 v96, -v25, v101, v96
  v_mfma_f32_16x16x32_bf16 v[104:107], v[60:63], v[80:83], v[104:107]
  v_fma_f32 v97, v25, v100, v97
  v_fma_f32 v30, v24, v96, v30
  v_mfma_f32_32x32x16_bf16 v[208:223], a[144:147], v[64:67], v[208:223]
  s_add_u32 m0, s29, 0
  s_nop 0
  buffer_load_dwordx4 v35, s[52:55], s15 offen offset:1024 sc1 lds
  ds_read_b128 v[80:83], v19 offset:53248
  v_mfma_f32_16x16x32_bf16 v[108:111], v[60:63], v[64:67], v[108:111]
  v_fma_f32 v31, v24, v97, v31
  v_fma_f32 v30, -v25, v97, v30
  s_waitcnt lgkmcnt(2)
  v_mfma_f32_32x32x16_bf16 v[224:239], a[144:147], v[68:71], v[224:239]
  ds_read_b128 v[64:67], v19 offset:57344
  v_fma_f32 v31, v25, v96, v31
  v_fma_f32 v26, v24, v30, v26
  v_fma_f32 v27, v24, v31, v27
  v_fma_f32 v26, -v25, v31, v26
  v_mfma_f32_16x16x32_bf16 v[112:115], v[60:63], v[68:71], v[112:115]
  v_fma_f32 v27, v25, v30, v27
  v_mul_f32 v30, v122, v26
  v_mfma_f32_32x32x16_bf16 v[240:255], a[144:147], v[72:75], v[240:255]
  s_add_u32 m0, s29, 0
  s_nop 0
  buffer_load_dwordx4 v35, s[52:55], s15 offen offset:2048 sc1 lds
  ds_read_b128 v[68:71], v19 offset:61440
  v_mfma_f32_16x16x32_bf16 v[116:119], v[60:63], v[72:75], v[116:119]
  v_mul_f32 v31, v122, v27
  v_fma_f32 v30, -v123, v27, v30
  s_waitcnt lgkmcnt(2)
  v_mfma_f32_32x32x16_bf16 v[192:207], a[148:151], v[76:79], v[192:207]
  ds_read_b128 v[72:75], v20 offset:49152
  v_cvt_pk_bf16_f32 v3, v104, v104
  v_and_b32 v3, 0xffff0000, v3
  v_sub_f32 v5, v104, v3
  v_cvt_pk_bf16_f32 v5, v3, v5
  v_mfma_f32_32x32x16_bf16 v[208:223], a[148:151], v[80:83], v[208:223]
  s_add_u32 m0, s29, 0
  s_nop 0
  buffer_load_dwordx4 v35, s[52:55], s15 offen offset:3072 sc1 lds
  ds_read_b128 v[76:79], v20 offset:53248
  ds_write_b32 v4, v5 offset:0
  v_cvt_pk_bf16_f32 v3, v108, v108
  s_waitcnt lgkmcnt(3)
  v_mfma_f32_32x32x16_bf16 v[224:239], a[148:151], v[64:67], v[224:239]
  ds_read_b128 v[80:83], v20 offset:57344
  v_and_b32 v3, 0xffff0000, v3
  v_sub_f32 v5, v108, v3
  v_cvt_pk_bf16_f32 v5, v3, v5
  ds_write_b32 v4, v5 offset:1024
  v_mfma_f32_32x32x16_bf16 v[240:255], a[148:151], v[68:71], v[240:255]
  s_add_u32 m0, s29, 4096
  s_add_u32 s15, s99, 4096
  buffer_load_dwordx4 v35, s[52:55], s15 offen offset:0 sc1 lds
  ds_read_b128 v[64:67], v20 offset:61440
  v_cvt_pk_bf16_f32 v3, v112, v112
  v_and_b32 v3, 0xffff0000, v3
  s_waitcnt lgkmcnt(4)
  v_mfma_f32_32x32x16_bf16 v[192:207], a[152:155], v[72:75], v[192:207]
  ds_read_b128 v[68:71], v21 offset:49152
  v_sub_f32 v5, v112, v3
  v_cvt_pk_bf16_f32 v5, v3, v5
  ds_write_b32 v4, v5 offset:2048
  v_cvt_pk_bf16_f32 v3, v116, v116
  v_mfma_f32_32x32x16_bf16 v[208:223], a[152:155], v[76:79], v[208:223]
  ds_read_b128 v[72:75], v21 offset:53248
  v_and_b32 v3, 0xffff0000, v3
  v_sub_f32 v5, v116, v3
  v_cvt_pk_bf16_f32 v5, v3, v5
  ds_write_b32 v4, v5 offset:3072
  s_waitcnt lgkmcnt(4)
  v_mfma_f32_32x32x16_bf16 v[224:239], a[152:155], v[80:83], v[224:239]
  ds_read_b128 v[76:79], v21 offset:57344
  v_fma_f32 v31, v123, v26, v31
  ds_write_b64 v33, v[30:31]
  v_mfma_f32_32x32x16_bf16 v[240:255], a[152:155], v[64:67], v[240:255]
  ds_read_b128 v[80:83], v21 offset:61440
  s_waitcnt lgkmcnt(4)
  v_mfma_f32_32x32x16_bf16 v[192:207], a[156:159], v[68:71], v[192:207]
  v_mfma_f32_32x32x16_bf16 v[208:223], a[156:159], v[72:75], v[208:223]
  s_waitcnt lgkmcnt(0)
  v_mfma_f32_32x32x16_bf16 v[224:239], a[156:159], v[76:79], v[224:239]
  v_mfma_f32_32x32x16_bf16 v[240:255], a[156:159], v[80:83], v[240:255]
  s_waitcnt lgkmcnt(0)
  s_barrier
  ds_read_b128 v[26:29], v86 offset:0
  ds_read_b128 v[30:33], v86 offset:1024
  ds_read_b128 v[96:99], v86 offset:2048
  ds_read_b128 v[100:103], v86 offset:3072
  ds_read2_b32 v[64:65], v127 offset0:1 offset1:17
  ds_read2_b32 v[66:67], v127 offset0:3 offset1:19
  ds_read2_b32 v[68:69], v127 offset0:5 offset1:21
  ds_read2_b32 v[70:71], v127 offset0:7 offset1:23
  ds_read2_b32 v[72:73], v127 offset0:9 offset1:25
  ds_read2_b32 v[74:75], v127 offset0:11 offset1:27
  ds_read2_b32 v[76:77], v127 offset0:13 offset1:29
  ds_read2_b32 v[78:79], v127 offset0:15 offset1:31
  ds_read_b128 v[14:17], v87 offset:1024
  ds_read_b128 v[18:21], v87 offset:1536
  s_waitcnt lgkmcnt(11)
  ds_read_b128 v[60:63], v88 offset:3072
  v_add_u32 v2, 1024, v88
  v_mul_u32_u24 v2, s11, v2
  v_add_u32 v2, s12, v2
  ds_read_b128 v[80:83], v2
  v_mov_b32 v104, 0
  v_mov_b32 v105, 0
  ds_write_b64 v126, v[104:105]
  s_add_u32 m0, s29, 20480
  s_add_u32 s15, s99, 327680
  buffer_load_dwordx4 v35, s[52:55], s15 offen offset:0 sc1 lds
  s_add_u32 m0, s29, 20480
  s_nop 0
  buffer_load_dwordx4 v35, s[52:55], s15 offen offset:1024 sc1 lds
  v_mfma_f32_32x32x16_bf16 v[192:207], v[92:95], v[26:29], v[192:207]
  v_mfma_f32_32x32x16_bf16 v[208:223], v[92:95], v[30:33], v[208:223]
  v_mfma_f32_32x32x16_bf16 v[224:239], v[92:95], v[96:99], v[224:239]
  s_waitcnt lgkmcnt(13)
  v_mfma_f32_32x32x16_bf16 v[240:255], v[92:95], v[100:103], v[240:255]
  v_lshlrev_b32 v96, 3, v1
  v_add_u32 v96, 152576, v96
  ds_read2st64_b64 v[100:103], v96 offset0:4 offset1:5
  s_waitcnt lgkmcnt(11)
  ds_read2st64_b64 v[96:99], v96 offset0:0 offset1:1
  s_nop 2
  v_pk_mul_f32 v[192:193], v[192:193], v[64:65]
  v_pk_mul_f32 v[194:195], v[194:195], v[66:67]
  v_pk_mul_f32 v[196:197], v[196:197], v[68:69]
  s_waitcnt lgkmcnt(11)
  v_pk_mul_f32 v[198:199], v[198:199], v[70:71]
  s_waitcnt lgkmcnt(10)
  v_pk_mul_f32 v[200:201], v[200:201], v[72:73]
  s_waitcnt lgkmcnt(9)
  v_pk_mul_f32 v[202:203], v[202:203], v[74:75]
  s_waitcnt lgkmcnt(8)
  v_pk_mul_f32 v[204:205], v[204:205], v[76:77]
  s_waitcnt lgkmcnt(7)
  v_pk_mul_f32 v[206:207], v[206:207], v[78:79]
  v_pk_mul_f32 v[208:209], v[208:209], v[64:65]
  v_pk_mul_f32 v[210:211], v[210:211], v[66:67]
  s_add_u32 m0, s29, 20480
  s_nop 0
  buffer_load_dwordx4 v35, s[52:55], s15 offen offset:2048 sc1 lds
  v_pk_mul_f32 v[212:213], v[212:213], v[68:69]
  v_pk_mul_f32 v[214:215], v[214:215], v[70:71]
  v_pk_mul_f32 v[216:217], v[216:217], v[72:73]
  v_pk_mul_f32 v[218:219], v[218:219], v[74:75]
  v_pk_mul_f32 v[220:221], v[220:221], v[76:77]
  v_pk_mul_f32 v[222:223], v[222:223], v[78:79]
  v_pk_mul_f32 v[224:225], v[224:225], v[64:65]
  v_pk_mul_f32 v[226:227], v[226:227], v[66:67]
  v_pk_mul_f32 v[228:229], v[228:229], v[68:69]
  v_pk_mul_f32 v[230:231], v[230:231], v[70:71]
  s_add_u32 m0, s29, 20480
  s_nop 0
  buffer_load_dwordx4 v35, s[52:55], s15 offen offset:3072 sc1 lds
  v_pk_mul_f32 v[232:233], v[232:233], v[72:73]
  v_pk_mul_f32 v[234:235], v[234:235], v[74:75]
  v_pk_mul_f32 v[236:237], v[236:237], v[76:77]
  v_pk_mul_f32 v[238:239], v[238:239], v[78:79]
  v_pk_mul_f32 v[240:241], v[240:241], v[64:65]
  v_pk_mul_f32 v[242:243], v[242:243], v[66:67]
  v_pk_mul_f32 v[244:245], v[244:245], v[68:69]
  v_pk_mul_f32 v[246:247], v[246:247], v[70:71]
  v_pk_mul_f32 v[248:249], v[248:249], v[72:73]
  v_pk_mul_f32 v[250:251], v[250:251], v[74:75]
  s_add_u32 m0, s29, 24576
  s_add_u32 s15, s99, 331776
  buffer_load_dwordx4 v35, s[52:55], s15 offen offset:0 sc1 lds
  v_pk_mul_f32 v[252:253], v[252:253], v[76:77]
  v_pk_mul_f32 v[254:255], v[254:255], v[78:79]
  s_waitcnt lgkmcnt(6)
  v_pk_fma_f32 v[104:105], v[14:15], v[192:193], v[194:195] op_sel:[0,0,0] op_sel_hi:[0,1,1]
  v_pk_fma_f32 v[106:107], v[14:15], v[224:225], v[226:227] op_sel:[0,0,0] op_sel_hi:[0,1,1]
  s_waitcnt lgkmcnt(5)
  v_pk_fma_f32 v[112:113], v[18:19], v[208:209], v[210:211] op_sel:[0,0,0] op_sel_hi:[0,1,1]
  v_pk_fma_f32 v[114:115], v[18:19], v[240:241], v[242:243] op_sel:[0,0,0] op_sel_hi:[0,1,1]
  v_pk_fma_f32 v[104:105], v[14:15], v[224:225], v[104:105] op_sel:[1,0,0] op_sel_hi:[1,1,1] neg_lo:[1,0,0] neg_hi:[1,0,0]
  v_pk_fma_f32 v[106:107], v[14:15], v[192:193], v[106:107] op_sel:[1,0,0] op_sel_hi:[1,1,1]
  v_pk_fma_f32 v[112:113], v[18:19], v[240:241], v[112:113] op_sel:[1,0,0] op_sel_hi:[1,1,1] neg_lo:[1,0,0] neg_hi:[1,0,0]
  v_pk_fma_f32 v[114:115], v[18:19], v[208:209], v[114:115] op_sel:[1,0,0] op_sel_hi:[1,1,1]
  v_pk_fma_f32 v[108:109], v[14:15], v[104:105], v[196:197] op_sel:[0,0,0] op_sel_hi:[0,1,1]
  v_pk_fma_f32 v[110:111], v[14:15], v[106:107], v[228:229] op_sel:[0,0,0] op_sel_hi:[0,1,1]
  v_pk_fma_f32 v[116:117], v[18:19], v[112:113], v[212:213] op_sel:[0,0,0] op_sel_hi:[0,1,1]
  v_pk_fma_f32 v[118:119], v[18:19], v[114:115], v[244:245] op_sel:[0,0,0] op_sel_hi:[0,1,1]
  v_pk_fma_f32 v[108:109], v[14:15], v[106:107], v[108:109] op_sel:[1,0,0] op_sel_hi:[1,1,1] neg_lo:[1,0,0] neg_hi:[1,0,0]
  v_pk_fma_f32 v[110:111], v[14:15], v[104:105], v[110:111] op_sel:[1,0,0] op_sel_hi:[1,1,1]
  v_pk_fma_f32 v[116:117], v[18:19], v[114:115], v[116:117] op_sel:[1,0,0] op_sel_hi:[1,1,1] neg_lo:[1,0,0] neg_hi:[1,0,0]
  v_pk_fma_f32 v[118:119], v[18:19], v[112:113], v[118:119] op_sel:[1,0,0] op_sel_hi:[1,1,1]
  v_pk_fma_f32 v[104:105], v[14:15], v[108:109], v[198:199] op_sel:[0,0,0] op_sel_hi:[0,1,1]
  v_pk_fma_f32 v[106:107], v[14:15], v[110:111], v[230:231] op_sel:[0,0,0] op_sel_hi:[0,1,1]
  v_pk_fma_f32 v[112:113], v[18:19], v[116:117], v[214:215] op_sel:[0,0,0] op_sel_hi:[0,1,1]
  v_pk_fma_f32 v[114:115], v[18:19], v[118:119], v[246:247] op_sel:[0,0,0] op_sel_hi:[0,1,1]
  v_pk_fma_f32 v[104:105], v[14:15], v[110:111], v[104:105] op_sel:[1,0,0] op_sel_hi:[1,1,1] neg_lo:[1,0,0] neg_hi:[1,0,0]
  v_pk_fma_f32 v[106:107], v[14:15], v[108:109], v[106:107] op_sel:[1,0,0] op_sel_hi:[1,1,1]
  v_pk_fma_f32 v[112:113], v[18:19], v[118:119], v[112:113] op_sel:[1,0,0] op_sel_hi:[1,1,1] neg_lo:[1,0,0] neg_hi:[1,0,0]
  v_pk_fma_f32 v[114:115], v[18:19], v[116:117], v[114:115] op_sel:[1,0,0] op_sel_hi:[1,1,1]
  v_pk_fma_f32 v[108:109], v[14:15], v[104:105], v[200:201] op_sel:[0,0,0] op_sel_hi:[0,1,1]
  v_pk_fma_f32 v[110:111], v[14:15], v[106:107], v[232:233] op_sel:[0,0,0] op_sel_hi:[0,1,1]
  v_pk_fma_f32 v[116:117], v[18:19], v[112:113], v[216:217] op_sel:[0,0,0] op_sel_hi:[0,1,1]
  v_pk_fma_f32 v[118:119], v[18:19], v[114:115], v[248:249] op_sel:[0,0,0] op_sel_hi:[0,1,1]
  v_pk_fma_f32 v[108:109], v[14:15], v[106:107], v[108:109] op_sel:[1,0,0] op_sel_hi:[1,1,1] neg_lo:[1,0,0] neg_hi:[1,0,0]
  v_pk_fma_f32 v[110:111], v[14:15], v[104:105], v[110:111] op_sel:[1,0,0] op_sel_hi:[1,1,1]
  v_pk_fma_f32 v[116:117], v[18:19], v[114:115], v[116:117] op_sel:[1,0,0] op_sel_hi:[1,1,1] neg_lo:[1,0,0] neg_hi:[1,0,0]
  v_pk_fma_f32 v[118:119], v[18:19], v[112:113], v[118:119] op_sel:[1,0,0] op_sel_hi:[1,1,1]
  v_pk_fma_f32 v[104:105], v[14:15], v[108:109], v[202:203] op_sel:[0,0,0] op_sel_hi:[0,1,1]
  v_pk_fma_f32 v[106:107], v[14:15], v[110:111], v[234:235] op_sel:[0,0,0] op_sel_hi:[0,1,1]
  v_pk_fma_f32 v[112:113], v[18:19], v[116:117], v[218:219] op_sel:[0,0,0] op_sel_hi:[0,1,1]
  v_pk_fma_f32 v[114:115], v[18:19], v[118:119], v[250:251] op_sel:[0,0,0] op_sel_hi:[0,1,1]
  v_pk_fma_f32 v[104:105], v[14:15], v[110:111], v[104:105] op_sel:[1,0,0] op_sel_hi:[1,1,1] neg_lo:[1,0,0] neg_hi:[1,0,0]
  v_pk_fma_f32 v[106:107], v[14:15], v[108:109], v[106:107] op_sel:[1,0,0] op_sel_hi:[1,1,1]
  v_pk_fma_f32 v[112:113], v[18:19], v[118:119], v[112:113] op_sel:[1,0,0] op_sel_hi:[1,1,1] neg_lo:[1,0,0] neg_hi:[1,0,0]
  v_pk_fma_f32 v[114:115], v[18:19], v[116:117], v[114:115] op_sel:[1,0,0] op_sel_hi:[1,1,1]
  v_pk_fma_f32 v[108:109], v[14:15], v[104:105], v[204:205] op_sel:[0,0,0] op_sel_hi:[0,1,1]
  v_pk_fma_f32 v[110:111], v[14:15], v[106:107], v[236:237] op_sel:[0,0,0] op_sel_hi:[0,1,1]
L_pgs3:
  s_cbranch_execz L_pgsr
  v_pk_fma_f32 v[116:117], v[18:19], v[112:113], v[220:221] op_sel:[0,0,0] op_sel_hi:[0,1,1]
  v_pk_fma_f32 v[118:119], v[18:19], v[114:115], v[252:253] op_sel:[0,0,0] op_sel_hi:[0,1,1]
  v_pk_fma_f32 v[108:109], v[14:15], v[106:107], v[108:109] op_sel:[1,0,0] op_sel_hi:[1,1,1] neg_lo:[1,0,0] neg_hi:[1,0,0]
  v_pk_fma_f32 v[110:111], v[14:15], v[104:105], v[110:111] op_sel:[1,0,0] op_sel_hi:[1,1,1]
  v_pk_fma_f32 v[116:117], v[18:19], v[114:115], v[116:117] op_sel:[1,0,0] op_sel_hi:[1,1,1] neg_lo:[1,0,0] neg_hi:[1,0,0]
  v_pk_fma_f32 v[118:119], v[18:19], v[112:113], v[118:119] op_sel:[1,0,0] op_sel_hi:[1,1,1]
  v_pk_fma_f32 v[104:105], v[14:15], v[108:109], v[206:207] op_sel:[0,0,0] op_sel_hi:[0,1,1]
  v_pk_fma_f32 v[106:107], v[14:15], v[110:111], v[238:239] op_sel:[0,0,0] op_sel_hi:[0,1,1]
  v_pk_fma_f32 v[112:113], v[18:19], v[116:117], v[222:223] op_sel:[0,0,0] op_sel_hi:[0,1,1]
  v_pk_fma_f32 v[114:115], v[18:19], v[118:119], v[254:255] op_sel:[0,0,0] op_sel_hi:[0,1,1]
  v_pk_fma_f32 v[104:105], v[14:15], v[110:111], v[104:105] op_sel:[1,0,0] op_sel_hi:[1,1,1] neg_lo:[1,0,0] neg_hi:[1,0,0]
  v_pk_fma_f32 v[106:107], v[14:15], v[108:109], v[106:107] op_sel:[1,0,0] op_sel_hi:[1,1,1]
  v_pk_fma_f32 v[112:113], v[18:19], v[118:119], v[112:113] op_sel:[1,0,0] op_sel_hi:[1,1,1] neg_lo:[1,0,0] neg_hi:[1,0,0]
  v_pk_fma_f32 v[114:115], v[18:19], v[116:117], v[114:115] op_sel:[1,0,0] op_sel_hi:[1,1,1]
  v_fma_f32 v105, v16, v104, v105
  v_fma_f32 v107, v16, v106, v107
  v_fma_f32 v105, -v17, v106, v105
  v_fma_f32 v107, v17, v104, v107
  v_fma_f32 v113, v20, v112, v113
  v_fma_f32 v115, v20, v114, v115
  v_fma_f32 v113, -v21, v114, v113
  v_fma_f32 v115, v21, v112, v115
  s_waitcnt lgkmcnt(4)
  v_mul_f32 v32, v60, v60
  v_mul_f32 v33, v60, v61
  v_fma_f32 v32, -v61, v61, v32
  v_fma_f32 v33, v61, v60, v33
  v_permlane32_swap_b32 v105, v113
  v_permlane32_swap_b32 v107, v115
  v_fma_f32 v116, v60, v105, v113
  v_fma_f32 v117, v60, v107, v115
  v_fma_f32 v116, -v61, v107, v116
  v_fma_f32 v117, v61, v105, v117
  ds_write_b64 v126, v[116:117] offset:2048
  s_waitcnt lgkmcnt(0)
  s_barrier
  ds_read2st64_b64 v[26:29], v126 offset0:1 offset1:2
  ds_read_b64 v[30:31], v126 offset:1536
  v_mov_b32 v118, s61
  s_waitcnt lgkmcnt(1)
  v_fma_f32 v28, v32, v26, v28
  v_fma_f32 v29, v32, v27, v29
  v_fma_f32 v28, -v33, v27, v28
  v_fma_f32 v29, v33, v26, v29
  s_waitcnt lgkmcnt(0)
  v_fma_f32 v110, v32, v28, v30
  v_fma_f32 v108, v32, v29, v31
  v_fma_f32 v110, -v33, v29, v110
  v_fma_f32 v108, v33, v28, v108
  v_fma_f32 v116, v32, v110, v116
  v_fma_f32 v117, v32, v108, v117
  v_fma_f32 v116, -v33, v108, v116
  v_fma_f32 v117, v33, v110, v117
  buffer_store_dwordx4 v[116:119], v35, s[44:47], s94 offen sc1
  v_pk_add_f32 v[100:101], v[100:101], v[102:103]
  v_pk_add_f32 v[96:97], v[96:97], v[98:99]
  v_pk_add_f32 v[96:97], v[96:97], v[100:101]
  v_fma_f32 v42, v120, v96, v42
  v_fma_f32 v40, v120, v97, v40
  v_fma_f32 v42, -v121, v97, v42
  v_fma_f32 v40, v121, v96, v40
  v_fma_f32 v50, v22, v42, v37
  v_fma_f32 v48, v22, v40, v39
  v_fma_f32 v50, -v23, v40, v50
  v_fma_f32 v48, v23, v42, v48
  s_nop 0
  v_permlane32_swap_b32 v42, v50
  v_permlane32_swap_b32 v40, v48
  v_fma_f32 v43, v8, v42, v36
  v_fma_f32 v41, v8, v40, v38
  v_fma_f32 v43, -v9, v40, v43
  v_fma_f32 v41, v9, v42, v41
  v_fma_f32 v51, v12, v50, v44
  v_fma_f32 v49, v12, v48, v46
  v_fma_f32 v51, -v13, v48, v51
  v_fma_f32 v49, v13, v50, v49
  v_pk_fma_f32 v[128:129], v[6:7], v[42:43], v[128:129] op_sel:[0,0,0] op_sel_hi:[0,1,1]
  v_pk_fma_f32 v[160:161], v[6:7], v[40:41], v[160:161] op_sel:[0,0,0] op_sel_hi:[0,1,1]
  v_pk_fma_f32 v[144:145], v[10:11], v[50:51], v[144:145] op_sel:[0,0,0] op_sel_hi:[0,1,1]
  v_pk_fma_f32 v[176:177], v[10:11], v[48:49], v[176:177] op_sel:[0,0,0] op_sel_hi:[0,1,1]
  v_pk_fma_f32 v[128:129], v[6:7], v[40:41], v[128:129] op_sel:[1,0,0] op_sel_hi:[1,1,1] neg_lo:[1,0,0] neg_hi:[1,0,0]
  v_pk_fma_f32 v[160:161], v[6:7], v[42:43], v[160:161] op_sel:[1,0,0] op_sel_hi:[1,1,1]
  v_pk_fma_f32 v[144:145], v[10:11], v[48:49], v[144:145] op_sel:[1,0,0] op_sel_hi:[1,1,1] neg_lo:[1,0,0] neg_hi:[1,0,0]
  v_pk_fma_f32 v[176:177], v[10:11], v[50:51], v[176:177] op_sel:[1,0,0] op_sel_hi:[1,1,1]
  v_pk_fma_f32 v[130:131], v[6:7], v[128:129], v[130:131] op_sel:[0,0,0] op_sel_hi:[0,1,1]
  v_pk_fma_f32 v[162:163], v[6:7], v[160:161], v[162:163] op_sel:[0,0,0] op_sel_hi:[0,1,1]
  v_pk_fma_f32 v[146:147], v[10:11], v[144:145], v[146:147] op_sel:[0,0,0] op_sel_hi:[0,1,1]
  v_pk_fma_f32 v[178:179], v[10:11], v[176:177], v[178:179] op_sel:[0,0,0] op_sel_hi:[0,1,1]
  v_pk_fma_f32 v[130:131], v[6:7], v[160:161], v[130:131] op_sel:[1,0,0] op_sel_hi:[1,1,1] neg_lo:[1,0,0] neg_hi:[1,0,0]
  v_pk_fma_f32 v[162:163], v[6:7], v[128:129], v[162:163] op_sel:[1,0,0] op_sel_hi:[1,1,1]
  v_pk_fma_f32 v[146:147], v[10:11], v[176:177], v[146:147] op_sel:[1,0,0] op_sel_hi:[1,1,1] neg_lo:[1,0,0] neg_hi:[1,0,0]
  v_pk_fma_f32 v[178:179], v[10:11], v[144:145], v[178:179] op_sel:[1,0,0] op_sel_hi:[1,1,1]
  v_pk_fma_f32 v[132:133], v[6:7], v[130:131], v[132:133] op_sel:[0,0,0] op_sel_hi:[0,1,1]
  v_pk_fma_f32 v[164:165], v[6:7], v[162:163], v[164:165] op_sel:[0,0,0] op_sel_hi:[0,1,1]
  v_pk_fma_f32 v[148:149], v[10:11], v[146:147], v[148:149] op_sel:[0,0,0] op_sel_hi:[0,1,1]
  v_pk_fma_f32 v[180:181], v[10:11], v[178:179], v[180:181] op_sel:[0,0,0] op_sel_hi:[0,1,1]
  v_pk_fma_f32 v[132:133], v[6:7], v[162:163], v[132:133] op_sel:[1,0,0] op_sel_hi:[1,1,1] neg_lo:[1,0,0] neg_hi:[1,0,0]
  v_pk_fma_f32 v[164:165], v[6:7], v[130:131], v[164:165] op_sel:[1,0,0] op_sel_hi:[1,1,1]
  v_pk_fma_f32 v[148:149], v[10:11], v[178:179], v[148:149] op_sel:[1,0,0] op_sel_hi:[1,1,1] neg_lo:[1,0,0] neg_hi:[1,0,0]
  v_pk_fma_f32 v[180:181], v[10:11], v[146:147], v[180:181] op_sel:[1,0,0] op_sel_hi:[1,1,1]
  v_pk_fma_f32 v[134:135], v[6:7], v[132:133], v[134:135] op_sel:[0,0,0] op_sel_hi:[0,1,1]
  v_pk_fma_f32 v[166:167], v[6:7], v[164:165], v[166:167] op_sel:[0,0,0] op_sel_hi:[0,1,1]
  v_pk_fma_f32 v[150:151], v[10:11], v[148:149], v[150:151] op_sel:[0,0,0] op_sel_hi:[0,1,1]
  v_pk_fma_f32 v[182:183], v[10:11], v[180:181], v[182:183] op_sel:[0,0,0] op_sel_hi:[0,1,1]
  v_pk_fma_f32 v[134:135], v[6:7], v[164:165], v[134:135] op_sel:[1,0,0] op_sel_hi:[1,1,1] neg_lo:[1,0,0] neg_hi:[1,0,0]
  v_pk_fma_f32 v[166:167], v[6:7], v[132:133], v[166:167] op_sel:[1,0,0] op_sel_hi:[1,1,1]
  v_pk_fma_f32 v[150:151], v[10:11], v[180:181], v[150:151] op_sel:[1,0,0] op_sel_hi:[1,1,1] neg_lo:[1,0,0] neg_hi:[1,0,0]
  v_pk_fma_f32 v[182:183], v[10:11], v[148:149], v[182:183] op_sel:[1,0,0] op_sel_hi:[1,1,1]
  v_pk_fma_f32 v[136:137], v[6:7], v[134:135], v[136:137] op_sel:[0,0,0] op_sel_hi:[0,1,1]
  v_pk_fma_f32 v[168:169], v[6:7], v[166:167], v[168:169] op_sel:[0,0,0] op_sel_hi:[0,1,1]
  v_pk_fma_f32 v[152:153], v[10:11], v[150:151], v[152:153] op_sel:[0,0,0] op_sel_hi:[0,1,1]
  v_pk_fma_f32 v[184:185], v[10:11], v[182:183], v[184:185] op_sel:[0,0,0] op_sel_hi:[0,1,1]
  v_pk_fma_f32 v[136:137], v[6:7], v[166:167], v[136:137] op_sel:[1,0,0] op_sel_hi:[1,1,1] neg_lo:[1,0,0] neg_hi:[1,0,0]
  v_pk_fma_f32 v[168:169], v[6:7], v[134:135], v[168:169] op_sel:[1,0,0] op_sel_hi:[1,1,1]
  v_pk_fma_f32 v[152:153], v[10:11], v[182:183], v[152:153] op_sel:[1,0,0] op_sel_hi:[1,1,1] neg_lo:[1,0,0] neg_hi:[1,0,0]
  v_pk_fma_f32 v[184:185], v[10:11], v[150:151], v[184:185] op_sel:[1,0,0] op_sel_hi:[1,1,1]
  v_pk_fma_f32 v[138:139], v[6:7], v[136:137], v[138:139] op_sel:[0,0,0] op_sel_hi:[0,1,1]
  v_pk_fma_f32 v[170:171], v[6:7], v[168:169], v[170:171] op_sel:[0,0,0] op_sel_hi:[0,1,1]
  v_pk_fma_f32 v[154:155], v[10:11], v[152:153], v[154:155] op_sel:[0,0,0] op_sel_hi:[0,1,1]
  v_pk_fma_f32 v[186:187], v[10:11], v[184:185], v[186:187] op_sel:[0,0,0] op_sel_hi:[0,1,1]
  v_pk_fma_f32 v[138:139], v[6:7], v[168:169], v[138:139] op_sel:[1,0,0] op_sel_hi:[1,1,1] neg_lo:[1,0,0] neg_hi:[1,0,0]
  v_pk_fma_f32 v[170:171], v[6:7], v[136:137], v[170:171] op_sel:[1,0,0] op_sel_hi:[1,1,1]
  v_pk_fma_f32 v[154:155], v[10:11], v[184:185], v[154:155] op_sel:[1,0,0] op_sel_hi:[1,1,1] neg_lo:[1,0,0] neg_hi:[1,0,0]
  v_pk_fma_f32 v[186:187], v[10:11], v[152:153], v[186:187] op_sel:[1,0,0] op_sel_hi:[1,1,1]
  v_pk_fma_f32 v[140:141], v[6:7], v[138:139], v[140:141] op_sel:[0,0,0] op_sel_hi:[0,1,1]
  v_pk_fma_f32 v[172:173], v[6:7], v[170:171], v[172:173] op_sel:[0,0,0] op_sel_hi:[0,1,1]
  v_pk_fma_f32 v[156:157], v[10:11], v[154:155], v[156:157] op_sel:[0,0,0] op_sel_hi:[0,1,1]
  v_pk_fma_f32 v[188:189], v[10:11], v[186:187], v[188:189] op_sel:[0,0,0] op_sel_hi:[0,1,1]
  v_pk_fma_f32 v[140:141], v[6:7], v[170:171], v[140:141] op_sel:[1,0,0] op_sel_hi:[1,1,1] neg_lo:[1,0,0] neg_hi:[1,0,0]
  v_pk_fma_f32 v[172:173], v[6:7], v[138:139], v[172:173] op_sel:[1,0,0] op_sel_hi:[1,1,1]
  v_pk_fma_f32 v[156:157], v[10:11], v[186:187], v[156:157] op_sel:[1,0,0] op_sel_hi:[1,1,1] neg_lo:[1,0,0] neg_hi:[1,0,0]
  v_pk_fma_f32 v[188:189], v[10:11], v[154:155], v[188:189] op_sel:[1,0,0] op_sel_hi:[1,1,1]
  v_pk_fma_f32 v[142:143], v[6:7], v[140:141], v[142:143] op_sel:[0,0,0] op_sel_hi:[0,1,1]
  v_pk_fma_f32 v[174:175], v[6:7], v[172:173], v[174:175] op_sel:[0,0,0] op_sel_hi:[0,1,1]
  v_pk_fma_f32 v[158:159], v[10:11], v[156:157], v[158:159] op_sel:[0,0,0] op_sel_hi:[0,1,1]
  v_pk_fma_f32 v[190:191], v[10:11], v[188:189], v[190:191] op_sel:[0,0,0] op_sel_hi:[0,1,1]
  v_pk_fma_f32 v[142:143], v[6:7], v[172:173], v[142:143] op_sel:[1,0,0] op_sel_hi:[1,1,1] neg_lo:[1,0,0] neg_hi:[1,0,0]
  v_pk_fma_f32 v[174:175], v[6:7], v[140:141], v[174:175] op_sel:[1,0,0] op_sel_hi:[1,1,1]
  v_pk_fma_f32 v[158:159], v[10:11], v[188:189], v[158:159] op_sel:[1,0,0] op_sel_hi:[1,1,1] neg_lo:[1,0,0] neg_hi:[1,0,0]
  v_pk_fma_f32 v[190:191], v[10:11], v[156:157], v[190:191] op_sel:[1,0,0] op_sel_hi:[1,1,1]
  s_mov_b64 exec, 0xffff
  buffer_load_dword v84, v85, s[56:59], 0 offen offset:0 sc1
  s_mov_b64 exec, -1
  v_cvt_pk_bf16_f32 v128, v128, v129
  v_cvt_pk_bf16_f32 v129, v130, v131
  v_cvt_pk_bf16_f32 v130, v132, v133
  v_cvt_pk_bf16_f32 v131, v134, v135
  v_cvt_pk_bf16_f32 v132, v136, v137
  v_cvt_pk_bf16_f32 v133, v138, v139
  v_cvt_pk_bf16_f32 v134, v140, v141
  v_cvt_pk_bf16_f32 v135, v142, v143
  v_mfma_f32_32x32x16_bf16 v[64:79], v[128:131], v[52:55], 0
  v_cvt_pk_bf16_f32 v160, v160, v161
  v_cvt_pk_bf16_f32 v161, v162, v163
  v_cvt_pk_bf16_f32 v162, v164, v165
  v_cvt_pk_bf16_f32 v163, v166, v167
  v_cvt_pk_bf16_f32 v164, v168, v169
  v_cvt_pk_bf16_f32 v165, v170, v171
  v_cvt_pk_bf16_f32 v166, v172, v173
  v_cvt_pk_bf16_f32 v167, v174, v175
  v_mfma_f32_32x32x16_bf16 v[64:79], v[132:135], v[56:59], v[64:79]
  v_mfma_f32_32x32x16_bf16 v[36:51], v[160:163], v[52:55], 0
  v_cvt_pk_bf16_f32 v144, v144, v145
  v_cvt_pk_bf16_f32 v145, v146, v147
  v_cvt_pk_bf16_f32 v146, v148, v149
  v_cvt_pk_bf16_f32 v147, v150, v151
  v_cvt_pk_bf16_f32 v148, v152, v153
  v_cvt_pk_bf16_f32 v149, v154, v155
  v_cvt_pk_bf16_f32 v150, v156, v157
  v_cvt_pk_bf16_f32 v151, v158, v159
  v_mfma_f32_32x32x16_bf16 v[36:51], v[164:167], v[56:59], v[36:51]
  s_nop 1
  v_cvt_pk_bf16_f32 v64, v64, v65
  v_cvt_pk_bf16_f32 v65, v66, v67
  v_cvt_pk_bf16_f32 v66, v68, v69
  v_cvt_pk_bf16_f32 v67, v70, v71
  buffer_store_dwordx4 v[64:67], v34, s[48:51], s91 offen offset:0 sc1
  v_cvt_pk_bf16_f32 v68, v72, v73
  v_cvt_pk_bf16_f32 v69, v74, v75
  v_cvt_pk_bf16_f32 v70, v76, v77
  v_cvt_pk_bf16_f32 v71, v78, v79
  buffer_store_dwordx4 v[68:71], v34, s[48:51], s91 offen offset:512 sc1
  s_add_u32 s91, s91, 32768
  v_mfma_f32_32x32x16_bf16 v[128:143], v[144:147], v[52:55], 0
  v_cvt_pk_bf16_f32 v176, v176, v177
  v_cvt_pk_bf16_f32 v177, v178, v179
  v_cvt_pk_bf16_f32 v178, v180, v181
  v_cvt_pk_bf16_f32 v179, v182, v183
  v_cvt_pk_bf16_f32 v180, v184, v185
  v_cvt_pk_bf16_f32 v181, v186, v187
  v_cvt_pk_bf16_f32 v182, v188, v189
  v_cvt_pk_bf16_f32 v183, v190, v191
  v_mfma_f32_32x32x16_bf16 v[128:143], v[148:151], v[56:59], v[128:143]
  v_cvt_pk_bf16_f32 v36, v36, v37
  v_cvt_pk_bf16_f32 v37, v38, v39
  v_cvt_pk_bf16_f32 v38, v40, v41
  v_cvt_pk_bf16_f32 v39, v42, v43
  buffer_store_dwordx4 v[36:39], v34, s[48:51], s91 offen offset:0 sc1
  v_cvt_pk_bf16_f32 v40, v44, v45
  v_cvt_pk_bf16_f32 v41, v46, v47
  v_cvt_pk_bf16_f32 v42, v48, v49
  v_cvt_pk_bf16_f32 v43, v50, v51
  buffer_store_dwordx4 v[40:43], v34, s[48:51], s91 offen offset:512 sc1
  s_add_u32 s91, s91, 32768
  v_mfma_f32_32x32x16_bf16 v[160:175], v[176:179], v[52:55], 0
  v_mfma_f32_32x32x16_bf16 v[160:175], v[180:183], v[56:59], v[160:175]
  buffer_load_dwordx3 v[26:28], v35, s[44:47], s92 offen offset:0 sc1
  buffer_load_dwordx3 v[30:32], v35, s[44:47], s92 offen offset:1024 sc1
  buffer_load_dwordx3 v[96:98], v35, s[44:47], s92 offen offset:2048 sc1
  buffer_load_dwordx3 v[100:102], v35, s[44:47], s92 offen offset:3072 sc1
  v_cvt_pk_bf16_f32 v128, v128, v129
  v_cvt_pk_bf16_f32 v129, v130, v131
  v_cvt_pk_bf16_f32 v130, v132, v133
  v_cvt_pk_bf16_f32 v131, v134, v135
  buffer_store_dwordx4 v[128:131], v34, s[48:51], s91 offen offset:0 sc1
  v_cvt_pk_bf16_f32 v132, v136, v137
  v_cvt_pk_bf16_f32 v133, v138, v139
  v_cvt_pk_bf16_f32 v134, v140, v141
  v_cvt_pk_bf16_f32 v135, v142, v143
  buffer_store_dwordx4 v[132:135], v34, s[48:51], s91 offen offset:512 sc1
  s_add_u32 s91, s91, 32768
  v_cvt_pk_bf16_f32 v160, v160, v161
  v_cvt_pk_bf16_f32 v161, v162, v163
  v_cvt_pk_bf16_f32 v162, v164, v165
  v_cvt_pk_bf16_f32 v163, v166, v167
  buffer_store_dwordx4 v[160:163], v34, s[48:51], s91 offen offset:0 sc1
  v_cvt_pk_bf16_f32 v164, v168, v169
  v_cvt_pk_bf16_f32 v165, v170, v171
  v_cvt_pk_bf16_f32 v166, v172, v173
  v_cvt_pk_bf16_f32 v167, v174, v175
  buffer_store_dwordx4 v[164:167], v34, s[48:51], s91 offen offset:512 sc1
  s_add_u32 s91, s91, 557056
  s_waitcnt vmcnt(5)
  v_add3_u32 v29, v28, v32, v98
  s_waitcnt vmcnt(4)
  v_add_u32 v29, v102, v29
  v_cmp_ne_u32 vcc, s10, v29
  s_nop 1
  s_cmp_lg_u64 vcc, 0
  s_cbranch_scc1 L_slow13
L_back13:
  s_waitcnt vmcnt(0)
  v_bitop3_b32 v2, v125, 8, s61 bitop3:0x6a
  buffer_store_dword v2, v125, s[56:59], s101 offen sc1
  v_cmp_ne_u32 vcc, s61, v84
  s_nop 1
  s_and_b32 vcc_lo, vcc_lo, 0x7ff
  s_cbranch_scc1 L_slow12
L_back12:
  s_add_u32 s98, s35, 0
  buffer_load_dwordx4 a[160:163], v90, s[48:51], s98 offen sc1
  buffer_load_dwordx4 a[164:167], v91, s[48:51], s98 offen sc1
  s_add_u32 s98, s35, 65536
  buffer_load_dwordx4 a[168:171], v90, s[48:51], s98 offen sc1
  buffer_load_dwordx4 a[172:175], v91, s[48:51], s98 offen sc1
  s_add_u32 s98, s35, 131072
  buffer_load_dwordx4 a[176:179], v90, s[48:51], s98 offen sc1
  buffer_load_dwordx4 a[180:183], v91, s[48:51], s98 offen sc1
  v_lshl_add_u32 v33, v1, 3, s13
  v_fma_f32 v96, v62, v100, v96
  v_fma_f32 v97, v62, v101, v97
  v_fma_f32 v96, -v63, v101, v96
  v_fma_f32 v97, v63, v100, v97
  v_fma_f32 v30, v62, v96, v30
  v_fma_f32 v31, v62, v97, v31
  v_fma_f32 v30, -v63, v97, v30
  v_fma_f32 v31, v63, v96, v31
  v_fma_f32 v26, v62, v30, v26
  v_fma_f32 v27, v62, v31, v27
  v_fma_f32 v26, -v63, v31, v26
  v_fma_f32 v27, v63, v30, v27
  v_mul_f32 v30, v82, v26
  v_mul_f32 v31, v82, v27
  v_fma_f32 v30, -v83, v27, v30
  v_fma_f32 v31, v83, v26, v31
  ds_write_b64 v33, v[30:31]
  s_add_u32 s98, s35, 196608
  buffer_load_dwordx4 a[184:187], v90, s[48:51], s98 offen sc1
  buffer_load_dwordx4 a[188:191], v91, s[48:51], s98 offen sc1
  s_waitcnt lgkmcnt(0)
  s_barrier
  v_lshlrev_b32 v96, 3, v1
  v_add_u32 v96, 152576, v96
  ds_read2st64_b64 v[100:103], v96 offset0:4 offset1:5
  ds_read2st64_b64 v[96:99], v96 offset0:0 offset1:1
  s_add_u32 s98, s35, 262144
  buffer_load_dwordx4 a[192:195], v90, s[48:51], s98 offen sc1
  buffer_load_dwordx4 a[196:199], v91, s[48:51], s98 offen sc1
  s_waitcnt lgkmcnt(1)
  v_pk_add_f32 v[100:101], v[100:101], v[102:103]
  s_waitcnt lgkmcnt(0)
  v_pk_add_f32 v[96:97], v[96:97], v[98:99]
  v_pk_add_f32 v[96:97], v[96:97], v[100:101]
  v_fma_f32 v110, v80, v96, v110
  v_fma_f32 v108, v80, v97, v108
  v_fma_f32 v110, -v81, v97, v110
  v_fma_f32 v108, v81, v96, v108
  v_fma_f32 v118, v60, v110, v105
  v_fma_f32 v116, v60, v108, v107
  v_fma_f32 v118, -v61, v108, v118
  v_fma_f32 v116, v61, v110, v116
  s_nop 0
  v_permlane32_swap_b32 v110, v118
  v_permlane32_swap_b32 v108, v116
  v_fma_f32 v111, v16, v110, v104
  v_fma_f32 v109, v16, v108, v106
  v_fma_f32 v111, -v17, v108, v111
  v_fma_f32 v109, v17, v110, v109
  v_fma_f32 v119, v20, v118, v112
  v_fma_f32 v117, v20, v116, v114
  v_fma_f32 v119, -v21, v116, v119
  v_fma_f32 v117, v21, v118, v117
  v_pk_fma_f32 v[192:193], v[14:15], v[110:111], v[192:193] op_sel:[0,0,0] op_sel_hi:[0,1,1]
  v_pk_fma_f32 v[224:225], v[14:15], v[108:109], v[224:225] op_sel:[0,0,0] op_sel_hi:[0,1,1]
  v_pk_fma_f32 v[208:209], v[18:19], v[118:119], v[208:209] op_sel:[0,0,0] op_sel_hi:[0,1,1]
  v_pk_fma_f32 v[240:241], v[18:19], v[116:117], v[240:241] op_sel:[0,0,0] op_sel_hi:[0,1,1]
  v_pk_fma_f32 v[192:193], v[14:15], v[108:109], v[192:193] op_sel:[1,0,0] op_sel_hi:[1,1,1] neg_lo:[1,0,0] neg_hi:[1,0,0]
  v_pk_fma_f32 v[224:225], v[14:15], v[110:111], v[224:225] op_sel:[1,0,0] op_sel_hi:[1,1,1]
  v_pk_fma_f32 v[208:209], v[18:19], v[116:117], v[208:209] op_sel:[1,0,0] op_sel_hi:[1,1,1] neg_lo:[1,0,0] neg_hi:[1,0,0]
  s_add_u32 s98, s35, 327680
  buffer_load_dwordx4 a[200:203], v90, s[48:51], s98 offen sc1
  v_pk_fma_f32 v[240:241], v[18:19], v[118:119], v[240:241] op_sel:[1,0,0] op_sel_hi:[1,1,1]
  v_pk_fma_f32 v[194:195], v[14:15], v[192:193], v[194:195] op_sel:[0,0,0] op_sel_hi:[0,1,1]
  v_pk_fma_f32 v[226:227], v[14:15], v[224:225], v[226:227] op_sel:[0,0,0] op_sel_hi:[0,1,1]
  v_pk_fma_f32 v[210:211], v[18:19], v[208:209], v[210:211] op_sel:[0,0,0] op_sel_hi:[0,1,1]
  v_pk_fma_f32 v[242:243], v[18:19], v[240:241], v[242:243] op_sel:[0,0,0] op_sel_hi:[0,1,1]
  v_pk_fma_f32 v[194:195], v[14:15], v[224:225], v[194:195] op_sel:[1,0,0] op_sel_hi:[1,1,1] neg_lo:[1,0,0] neg_hi:[1,0,0]
  v_pk_fma_f32 v[226:227], v[14:15], v[192:193], v[226:227] op_sel:[1,0,0] op_sel_hi:[1,1,1]
  buffer_load_dwordx4 a[204:207], v91, s[48:51], s98 offen sc1
  v_pk_fma_f32 v[210:211], v[18:19], v[240:241], v[210:211] op_sel:[1,0,0] op_sel_hi:[1,1,1] neg_lo:[1,0,0] neg_hi:[1,0,0]
  v_pk_fma_f32 v[242:243], v[18:19], v[208:209], v[242:243] op_sel:[1,0,0] op_sel_hi:[1,1,1]
  v_pk_fma_f32 v[196:197], v[14:15], v[194:195], v[196:197] op_sel:[0,0,0] op_sel_hi:[0,1,1]
  v_pk_fma_f32 v[228:229], v[14:15], v[226:227], v[228:229] op_sel:[0,0,0] op_sel_hi:[0,1,1]
  v_pk_fma_f32 v[212:213], v[18:19], v[210:211], v[212:213] op_sel:[0,0,0] op_sel_hi:[0,1,1]
  v_pk_fma_f32 v[244:245], v[18:19], v[242:243], v[244:245] op_sel:[0,0,0] op_sel_hi:[0,1,1]
  v_pk_fma_f32 v[196:197], v[14:15], v[226:227], v[196:197] op_sel:[1,0,0] op_sel_hi:[1,1,1] neg_lo:[1,0,0] neg_hi:[1,0,0]
  s_add_u32 s98, s35, 393216
  buffer_load_dwordx4 a[208:211], v90, s[48:51], s98 offen sc1
  v_pk_fma_f32 v[228:229], v[14:15], v[194:195], v[228:229] op_sel:[1,0,0] op_sel_hi:[1,1,1]
  v_pk_fma_f32 v[212:213], v[18:19], v[242:243], v[212:213] op_sel:[1,0,0] op_sel_hi:[1,1,1] neg_lo:[1,0,0] neg_hi:[1,0,0]
  v_pk_fma_f32 v[244:245], v[18:19], v[210:211], v[244:245] op_sel:[1,0,0] op_sel_hi:[1,1,1]
  v_pk_fma_f32 v[198:199], v[14:15], v[196:197], v[198:199] op_sel:[0,0,0] op_sel_hi:[0,1,1]
  v_pk_fma_f32 v[230:231], v[14:15], v[228:229], v[230:231] op_sel:[0,0,0] op_sel_hi:[0,1,1]
  v_pk_fma_f32 v[214:215], v[18:19], v[212:213], v[214:215] op_sel:[0,0,0] op_sel_hi:[0,1,1]
  v_pk_fma_f32 v[246:247], v[18:19], v[244:245], v[246:247] op_sel:[0,0,0] op_sel_hi:[0,1,1]
  buffer_load_dwordx4 a[212:215], v91, s[48:51], s98 offen sc1
  v_pk_fma_f32 v[198:199], v[14:15], v[228:229], v[198:199] op_sel:[1,0,0] op_sel_hi:[1,1,1] neg_lo:[1,0,0] neg_hi:[1,0,0]
  v_pk_fma_f32 v[230:231], v[14:15], v[196:197], v[230:231] op_sel:[1,0,0] op_sel_hi:[1,1,1]
  v_pk_fma_f32 v[214:215], v[18:19], v[244:245], v[214:215] op_sel:[1,0,0] op_sel_hi:[1,1,1] neg_lo:[1,0,0] neg_hi:[1,0,0]
  v_pk_fma_f32 v[246:247], v[18:19], v[212:213], v[246:247] op_sel:[1,0,0] op_sel_hi:[1,1,1]
  v_pk_fma_f32 v[200:201], v[14:15], v[198:199], v[200:201] op_sel:[0,0,0] op_sel_hi:[0,1,1]
  v_pk_fma_f32 v[232:233], v[14:15], v[230:231], v[232:233] op_sel:[0,0,0] op_sel_hi:[0,1,1]
  v_pk_fma_f32 v[216:217], v[18:19], v[214:215], v[216:217] op_sel:[0,0,0] op_sel_hi:[0,1,1]
  s_add_u32 s98, s35, 458752
  buffer_load_dwordx4 a[216:219], v90, s[48:51], s98 offen sc1
  v_pk_fma_f32 v[248:249], v[18:19], v[246:247], v[248:249] op_sel:[0,0,0] op_sel_hi:[0,1,1]
  v_pk_fma_f32 v[200:201], v[14:15], v[230:231], v[200:201] op_sel:[1,0,0] op_sel_hi:[1,1,1] neg_lo:[1,0,0] neg_hi:[1,0,0]
  v_pk_fma_f32 v[232:233], v[14:15], v[198:199], v[232:233] op_sel:[1,0,0] op_sel_hi:[1,1,1]
  v_pk_fma_f32 v[216:217], v[18:19], v[246:247], v[216:217] op_sel:[1,0,0] op_sel_hi:[1,1,1] neg_lo:[1,0,0] neg_hi:[1,0,0]
  v_pk_fma_f32 v[248:249], v[18:19], v[214:215], v[248:249] op_sel:[1,0,0] op_sel_hi:[1,1,1]
  v_pk_fma_f32 v[202:203], v[14:15], v[200:201], v[202:203] op_sel:[0,0,0] op_sel_hi:[0,1,1]
  v_pk_fma_f32 v[234:235], v[14:15], v[232:233], v[234:235] op_sel:[0,0,0] op_sel_hi:[0,1,1]
  buffer_load_dwordx4 a[220:223], v91, s[48:51], s98 offen sc1
  v_pk_fma_f32 v[218:219], v[18:19], v[216:217], v[218:219] op_sel:[0,0,0] op_sel_hi:[0,1,1]
  v_pk_fma_f32 v[250:251], v[18:19], v[248:249], v[250:251] op_sel:[0,0,0] op_sel_hi:[0,1,1]
  v_pk_fma_f32 v[202:203], v[14:15], v[232:233], v[202:203] op_sel:[1,0,0] op_sel_hi:[1,1,1] neg_lo:[1,0,0] neg_hi:[1,0,0]
  v_pk_fma_f32 v[234:235], v[14:15], v[200:201], v[234:235] op_sel:[1,0,0] op_sel_hi:[1,1,1]
  v_pk_fma_f32 v[218:219], v[18:19], v[248:249], v[218:219] op_sel:[1,0,0] op_sel_hi:[1,1,1] neg_lo:[1,0,0] neg_hi:[1,0,0]
  v_pk_fma_f32 v[250:251], v[18:19], v[216:217], v[250:251] op_sel:[1,0,0] op_sel_hi:[1,1,1]
  v_pk_fma_f32 v[204:205], v[14:15], v[202:203], v[204:205] op_sel:[0,0,0] op_sel_hi:[0,1,1]
  s_add_u32 s98, s35, 524288
  buffer_load_dwordx4 a[224:227], v90, s[48:51], s98 offen sc1
  v_pk_fma_f32 v[236:237], v[14:15], v[234:235], v[236:237] op_sel:[0,0,0] op_sel_hi:[0,1,1]
  v_pk_fma_f32 v[220:221], v[18:19], v[218:219], v[220:221] op_sel:[0,0,0] op_sel_hi:[0,1,1]
  v_pk_fma_f32 v[252:253], v[18:19], v[250:251], v[252:253] op_sel:[0,0,0] op_sel_hi:[0,1,1]
  v_pk_fma_f32 v[204:205], v[14:15], v[234:235], v[204:205] op_sel:[1,0,0] op_sel_hi:[1,1,1] neg_lo:[1,0,0] neg_hi:[1,0,0]
  v_pk_fma_f32 v[236:237], v[14:15], v[202:203], v[236:237] op_sel:[1,0,0] op_sel_hi:[1,1,1]
  v_pk_fma_f32 v[220:221], v[18:19], v[250:251], v[220:221] op_sel:[1,0,0] op_sel_hi:[1,1,1] neg_lo:[1,0,0] neg_hi:[1,0,0]
  v_pk_fma_f32 v[252:253], v[18:19], v[218:219], v[252:253] op_sel:[1,0,0] op_sel_hi:[1,1,1]
  buffer_load_dwordx4 a[228:231], v91, s[48:51], s98 offen sc1
  v_pk_fma_f32 v[206:207], v[14:15], v[204:205], v[206:207] op_sel:[0,0,0] op_sel_hi:[0,1,1]
  v_pk_fma_f32 v[238:239], v[14:15], v[236:237], v[238:239] op_sel:[0,0,0] op_sel_hi:[0,1,1]
  v_pk_fma_f32 v[222:223], v[18:19], v[220:221], v[222:223] op_sel:[0,0,0] op_sel_hi:[0,1,1]
  v_pk_fma_f32 v[254:255], v[18:19], v[252:253], v[254:255] op_sel:[0,0,0] op_sel_hi:[0,1,1]
  v_pk_fma_f32 v[206:207], v[14:15], v[236:237], v[206:207] op_sel:[1,0,0] op_sel_hi:[1,1,1] neg_lo:[1,0,0] neg_hi:[1,0,0]
  v_pk_fma_f32 v[238:239], v[14:15], v[204:205], v[238:239] op_sel:[1,0,0] op_sel_hi:[1,1,1]
  v_pk_fma_f32 v[222:223], v[18:19], v[252:253], v[222:223] op_sel:[1,0,0] op_sel_hi:[1,1,1] neg_lo:[1,0,0] neg_hi:[1,0,0]
  v_pk_fma_f32 v[254:255], v[18:19], v[220:221], v[254:255] op_sel:[1,0,0] op_sel_hi:[1,1,1]
  v_cvt_pk_bf16_f32 v192, v192, v193
  v_cvt_pk_bf16_f32 v193, v194, v195
  v_cvt_pk_bf16_f32 v194, v196, v197
  v_cvt_pk_bf16_f32 v195, v198, v199
  v_cvt_pk_bf16_f32 v196, v200, v201
  v_cvt_pk_bf16_f32 v197, v202, v203
  v_cvt_pk_bf16_f32 v198, v204, v205
  v_cvt_pk_bf16_f32 v199, v206, v207
  v_mfma_f32_32x32x16_bf16 v[64:79], v[192:195], v[52:55], 0
  v_cvt_pk_bf16_f32 v224, v224, v225
  v_cvt_pk_bf16_f32 v225, v226, v227
  v_cvt_pk_bf16_f32 v226, v228, v229
  v_cvt_pk_bf16_f32 v227, v230, v231
  v_cvt_pk_bf16_f32 v228, v232, v233
  v_cvt_pk_bf16_f32 v229, v234, v235
  v_cvt_pk_bf16_f32 v230, v236, v237
  v_cvt_pk_bf16_f32 v231, v238, v239
  v_mfma_f32_32x32x16_bf16 v[64:79], v[196:199], v[56:59], v[64:79]
  s_add_u32 s98, s35, 589824
  buffer_load_dwordx4 a[232:235], v90, s[48:51], s98 offen sc1
  v_mfma_f32_32x32x16_bf16 v[36:51], v[224:227], v[52:55], 0
  v_cvt_pk_bf16_f32 v208, v208, v209
  v_cvt_pk_bf16_f32 v209, v210, v211
  v_cvt_pk_bf16_f32 v210, v212, v213
  v_cvt_pk_bf16_f32 v211, v214, v215
  v_cvt_pk_bf16_f32 v212, v216, v217
  v_cvt_pk_bf16_f32 v213, v218, v219
  v_cvt_pk_bf16_f32 v214, v220, v221
  v_cvt_pk_bf16_f32 v215, v222, v223
  v_mfma_f32_32x32x16_bf16 v[36:51], v[228:231], v[56:59], v[36:51]
  buffer_load_dwordx4 a[236:239], v91, s[48:51], s98 offen sc1
  v_cvt_pk_bf16_f32 v64, v64, v65
  v_cvt_pk_bf16_f32 v65, v66, v67
  v_cvt_pk_bf16_f32 v66, v68, v69
  v_cvt_pk_bf16_f32 v67, v70, v71
  v_cvt_pk_bf16_f32 v68, v72, v73
  v_cvt_pk_bf16_f32 v69, v74, v75
  v_cvt_pk_bf16_f32 v70, v76, v77
  v_cvt_pk_bf16_f32 v71, v78, v79
  v_mfma_f32_32x32x16_bf16 v[192:207], v[208:211], v[52:55], 0
  v_cvt_pk_bf16_f32 v240, v240, v241
  v_cvt_pk_bf16_f32 v241, v242, v243
  v_cvt_pk_bf16_f32 v242, v244, v245
  v_cvt_pk_bf16_f32 v243, v246, v247
  v_cvt_pk_bf16_f32 v244, v248, v249
  v_cvt_pk_bf16_f32 v245, v250, v251
  v_cvt_pk_bf16_f32 v246, v252, v253
  v_cvt_pk_bf16_f32 v247, v254, v255
  v_mfma_f32_32x32x16_bf16 v[192:207], v[212:215], v[56:59], v[192:207]
  s_add_u32 s98, s35, 655360
  buffer_load_dwordx4 a[240:243], v90, s[48:51], s98 offen sc1
  v_cvt_pk_bf16_f32 v36, v36, v37
  v_cvt_pk_bf16_f32 v37, v38, v39
  v_cvt_pk_bf16_f32 v38, v40, v41
  v_cvt_pk_bf16_f32 v39, v42, v43
  v_cvt_pk_bf16_f32 v40, v44, v45
  v_cvt_pk_bf16_f32 v41, v46, v47
  v_cvt_pk_bf16_f32 v42, v48, v49
  v_cvt_pk_bf16_f32 v43, v50, v51
  v_mfma_f32_32x32x16_bf16 v[224:239], v[240:243], v[52:55], 0
  v_mfma_f32_32x32x16_bf16 v[224:239], v[244:247], v[56:59], v[224:239]
  buffer_load_dwordx4 a[244:247], v91, s[48:51], s98 offen sc1
  v_cvt_pk_bf16_f32 v192, v192, v193
  v_cvt_pk_bf16_f32 v193, v194, v195
  v_cvt_pk_bf16_f32 v194, v196, v197
  v_cvt_pk_bf16_f32 v195, v198, v199
  v_cvt_pk_bf16_f32 v196, v200, v201
  v_cvt_pk_bf16_f32 v197, v202, v203
  v_cvt_pk_bf16_f32 v198, v204, v205
  v_cvt_pk_bf16_f32 v199, v206, v207
  s_nop 2
  v_cvt_pk_bf16_f32 v224, v224, v225
  v_cvt_pk_bf16_f32 v225, v226, v227
  v_cvt_pk_bf16_f32 v226, v228, v229
  v_cvt_pk_bf16_f32 v227, v230, v231
  v_cvt_pk_bf16_f32 v228, v232, v233
  v_cvt_pk_bf16_f32 v229, v234, v235
  v_cvt_pk_bf16_f32 v230, v236, v237
  v_cvt_pk_bf16_f32 v231, v238, v239
  s_mov_b64 exec, 0xffff
  buffer_load_dword v84, v85, s[56:59], 0 offen offset:4 sc1
  s_mov_b64 exec, -1
  buffer_store_dwordx4 v[64:67], v34, s[48:51], s91 offen offset:0 sc1
  buffer_store_dwordx4 v[68:71], v34, s[48:51], s91 offen offset:512 sc1
  s_add_u32 s91, s91, 32768
  buffer_store_dwordx4 v[36:39], v34, s[48:51], s91 offen offset:0 sc1
  buffer_store_dwordx4 v[40:43], v34, s[48:51], s91 offen offset:512 sc1
  s_add_u32 s91, s91, 32768
  buffer_store_dwordx4 v[192:195], v34, s[48:51], s91 offen offset:0 sc1
  buffer_store_dwordx4 v[196:199], v34, s[48:51], s91 offen offset:512 sc1
  s_add_u32 s91, s91, 32768
  buffer_store_dwordx4 v[224:227], v34, s[48:51], s91 offen offset:0 sc1
  buffer_store_dwordx4 v[228:231], v34, s[48:51], s91 offen offset:512 sc1
  s_add_u32 s91, s91, 557056
  v_add_u32 v37, 65536, v35
  v_add_u32 v38, 131072, v35
  s_barrier
  ds_read_b128 v[128:131], v35 offset:0
  ds_read_b128 v[132:135], v35 offset:1024
  ds_read_b128 v[136:139], v35 offset:2048
  ds_read_b128 v[140:143], v35 offset:3072
  ds_read_b128 v[144:147], v35 offset:4096
  s_waitcnt vmcnt(30) lgkmcnt(4)
  v_mfma_f32_16x16x32_bf16 v[216:219], v[128:131], a[160:163], 0
  ds_read_b128 v[148:151], v35 offset:5120
  s_waitcnt vmcnt(29)
  v_mfma_f32_16x16x32_bf16 v[220:223], v[128:131], a[164:167], 0
  v_bfe_u32 v40, v1, 2, 2
  s_waitcnt lgkmcnt(4)
  v_mfma_f32_16x16x32_bf16 v[224:227], v[132:135], a[160:163], 0
  ds_read_b128 v[152:155], v35 offset:6144
  v_sub_u32 v40, 0, v40
  s_lshl2_add_u32 s83, s30, s82
  s_lshl1_add_u32 s83, s83, s28
  s_lshl_b32 s5, s83, 8
  v_mfma_f32_16x16x32_bf16 v[228:231], v[132:135], a[164:167], 0
  v_lshrrev_b32 v41, 4, v1
  s_add_u32 s5, s5, 6899712
  s_mul_i32 s3, s83, 20480
  s_and_b32 s4, s34, 7
  s_waitcnt lgkmcnt(4)
  v_mfma_f32_16x16x32_bf16 v[232:235], v[136:139], a[160:163], 0
  ds_read_b128 v[156:159], v35 offset:7168
  v_xor_b32 v40, v40, v41
  s_mul_i32 s4, s4, 160
  s_add_u32 s3, s3, s4
  v_lshrrev_b32 v73, 2, v1
  v_mfma_f32_16x16x32_bf16 v[236:239], v[136:139], a[164:167], 0
  v_and_b32 v40, 3, v40
  v_and_b32 v74, 3, v1
  v_lshlrev_b32 v46, 4, v73
  v_mul_u32_u24 v36, 1280, v73
  s_waitcnt lgkmcnt(4)
  v_mfma_f32_16x16x32_bf16 v[240:243], v[140:143], a[160:163], 0
  ds_read_b128 v[160:163], v35 offset:8192
  v_and_b32 v41, 15, v1
  v_lshl_add_u32 v36, v74, 3, v36
  v_add_lshl_u32 v36, v36, s3, 1
  v_mfma_f32_16x16x32_bf16 v[244:247], v[140:143], a[164:167], 0
  v_lshl_add_u32 v40, v41, 2, v40
  s_lshl_b32 s84, s82, 12
  s_add_u32 s89, s84, 147456
  s_waitcnt lgkmcnt(4)
  v_mfma_f32_16x16x32_bf16 v[248:251], v[144:147], a[160:163], 0
  ds_read_b128 v[164:167], v35 offset:9216
  v_lshlrev_b32 v40, 4, v40
  v_lshl_add_u32 v72, v74, 3, s89
  v_mul_u32_u24 v71, 160, v73
  v_mfma_f32_16x16x32_bf16 v[252:255], v[144:147], a[164:167], 0
  v_add_u32 v41, 65536, v40
  v_add_u32 v71, v71, v72
  v_add_u32 v68, 0, v1
  s_waitcnt vmcnt(28) lgkmcnt(4)
  v_mfma_f32_16x16x32_bf16 v[216:219], v[148:151], a[168:171], v[216:219]
  ds_read_b128 v[128:131], v35 offset:10240
  v_add_u32 v42, 131072, v40
  v_mul_u32_u24 v68, 205, v68
L_pgs4:
  s_cbranch_execz L_pgsr
  v_lshrrev_b32 v68, 11, v68
  s_waitcnt vmcnt(27)
  v_mfma_f32_16x16x32_bf16 v[220:223], v[148:151], a[172:175], v[220:223]
  v_mul_u32_u24 v68, 1120, v68
  v_add_u32 v68, v68, v35
  s_waitcnt lgkmcnt(4)
  v_mfma_f32_16x16x32_bf16 v[224:227], v[152:155], a[168:171], v[224:227]
  ds_read_b128 v[132:135], v35 offset:11264
  v_add_u32 v69, 64, v1
  v_mul_u32_u24 v69, 205, v69
  v_mfma_f32_16x16x32_bf16 v[228:231], v[152:155], a[172:175], v[228:231]
  s_add_u32 m0, s29, 40960
  s_add_u32 s15, s99, 655360
  buffer_load_dwordx4 v35, s[52:55], s15 offen offset:0 sc1 lds
  v_lshrrev_b32 v69, 11, v69
  v_mul_u32_u24 v69, 1120, v69
  s_waitcnt lgkmcnt(4)
  v_mfma_f32_16x16x32_bf16 v[232:235], v[156:159], a[168:171], v[232:235]
  ds_read_b128 v[136:139], v35 offset:12288
  v_add_u32 v69, v69, v35
  v_add_u32 v70, 128, v1
  v_mfma_f32_16x16x32_bf16 v[236:239], v[156:159], a[172:175], v[236:239]
  v_mul_u32_u24 v70, 205, v70
  v_lshrrev_b32 v70, 11, v70
  s_waitcnt lgkmcnt(4)
  v_mfma_f32_16x16x32_bf16 v[240:243], v[160:163], a[168:171], v[240:243]
  ds_read_b128 v[140:143], v35 offset:13312
  v_mul_u32_u24 v70, 1120, v70
  v_add_u32 v70, v70, v35
  v_mfma_f32_16x16x32_bf16 v[244:247], v[160:163], a[172:175], v[244:247]
  s_add_u32 m0, s29, 40960
  s_nop 0
  buffer_load_dwordx4 v35, s[52:55], s15 offen offset:1024 sc1 lds
  s_mov_b32 s72, s24
  s_and_b32 s73, s25, 0xffff
  s_waitcnt lgkmcnt(4)
  v_mfma_f32_16x16x32_bf16 v[248:251], v[164:167], a[168:171], v[248:251]
  ds_read_b128 v[144:147], v35 offset:14336
  s_mov_b32 s74, 1280
  s_mov_b32 s75, 0x20000
  v_mfma_f32_16x16x32_bf16 v[252:255], v[164:167], a[172:175], v[252:255]
  s_mul_i32 s12, s82, 10240
  s_add_u32 s12, s12, 106496
  s_waitcnt vmcnt(28) lgkmcnt(4)
  v_mfma_f32_16x16x32_bf16 v[216:219], v[128:131], a[176:179], v[216:219]
  ds_read_b128 v[148:151], v35 offset:15360
  v_lshrrev_b32 v45, 4, v1
  v_and_b32 v44, 3, v73
  s_waitcnt vmcnt(27)
  v_mfma_f32_16x16x32_bf16 v[220:223], v[128:131], a[180:183], v[220:223]
  s_add_u32 m0, s29, 40960
  s_nop 0
  buffer_load_dwordx4 v35, s[52:55], s15 offen offset:2048 sc1 lds
  v_xor_b32 v43, v45, v44
  v_lshl_add_u32 v43, v44, 2, v43
  s_waitcnt lgkmcnt(4)
  v_mfma_f32_16x16x32_bf16 v[224:227], v[132:135], a[176:179], v[224:227]
  ds_read_b128 v[152:155], v35 offset:16384
  v_lshl_add_u32 v43, v43, 2, v74
  v_xor_b32 v73, v45, v74
  v_mfma_f32_16x16x32_bf16 v[228:231], v[132:135], a[180:183], v[228:231]
  v_lshl_add_u32 v45, v45, 2, v73
  v_lshl_add_u32 v45, v45, 2, v44
  s_waitcnt lgkmcnt(4)
  v_mfma_f32_16x16x32_bf16 v[232:235], v[136:139], a[176:179], v[232:235]
  ds_read_b128 v[156:159], v35 offset:17408
  v_lshlrev_b32 v43, 4, v43
  v_add_u32 v44, s12, v43
  v_mfma_f32_16x16x32_bf16 v[236:239], v[136:139], a[180:183], v[236:239]
  s_add_u32 m0, s29, 40960
  s_nop 0
  buffer_load_dwordx4 v35, s[52:55], s15 offen offset:3072 sc1 lds
  v_lshl_add_u32 v45, v45, 4, s12
  s_lshl_b32 s83, s30, 4
  s_waitcnt lgkmcnt(4)
  v_mfma_f32_16x16x32_bf16 v[240:243], v[140:143], a[176:179], v[240:243]
  ds_read_b128 v[160:163], v35 offset:18432
  s_add_u32 s83, s83, s34
  s_lshl_b32 s83, s83, 2
  v_mfma_f32_16x16x32_bf16 v[244:247], v[140:143], a[180:183], v[244:247]
  s_add_u32 s83, s83, s82
  s_mul_i32 s87, s83, 5120
  s_waitcnt lgkmcnt(4)
  v_mfma_f32_16x16x32_bf16 v[248:251], v[144:147], a[176:179], v[248:251]
  ds_read_b128 v[164:167], v35 offset:19456
  s_add_u32 s87, s87, 786432
  s_xor_b32 s83, s83, 32
  v_mfma_f32_16x16x32_bf16 v[252:255], v[144:147], a[180:183], v[252:255]
  s_add_u32 m0, s29, 45056
  s_add_u32 s15, s99, 659456
  buffer_load_dwordx4 v35, s[52:55], s15 offen offset:0 sc1 lds
  s_mul_i32 s88, s83, 5120
  s_add_u32 s88, s88, 786432
  s_waitcnt vmcnt(29) lgkmcnt(4)
  v_mfma_f32_16x16x32_bf16 v[216:219], v[148:151], a[184:187], v[216:219]
  s_barrier
  ds_read_b128 v[128:131], v35 offset:20480
  s_add_u32 s62, s87, 4096
  s_add_u32 s63, s88, 4096
  s_waitcnt vmcnt(28)
  v_mfma_f32_16x16x32_bf16 v[220:223], v[148:151], a[188:191], v[220:223]
  s_lshr_b32 s69, s61, 8
  s_lshr_b32 s70, s61, 16
  s_waitcnt lgkmcnt(4)
  v_mfma_f32_16x16x32_bf16 v[224:227], v[152:155], a[184:187], v[224:227]
  ds_read_b128 v[132:135], v35 offset:21504
  s_lshr_b32 s71, s61, 24
  s_mov_b32 s68, s61
  v_mfma_f32_16x16x32_bf16 v[228:231], v[152:155], a[188:191], v[228:231]
  s_add_u32 m0, s29, 0
  s_add_u32 s15, s99, 2293760
  buffer_load_dwordx4 v35, s[52:55], s15 offen offset:0 sc1 lds
  v_mov_b32 v39, 0xff
  s_min_u32 s7, s2, 1
  s_waitcnt lgkmcnt(4)
  v_mfma_f32_16x16x32_bf16 v[232:235], v[156:159], a[184:187], v[232:235]
  ds_read_b128 v[136:139], v35 offset:22528
  s_mul_i32 s7, s7, 2130706432
  s_or_b32 s7, s7, s6
  v_mfma_f32_16x16x32_bf16 v[236:239], v[156:159], a[188:191], v[236:239]
  v_and_b32 v208, 15, v1
  v_lshlrev_b32 v208, 7, v208
  s_waitcnt lgkmcnt(4)
  v_mfma_f32_16x16x32_bf16 v[240:243], v[160:163], a[184:187], v[240:243]
  ds_read_b128 v[140:143], v35 offset:23552
  v_lshrrev_b32 v209, 4, v1
  v_lshl_add_u32 v208, v209, 13, v208
  v_mfma_f32_16x16x32_bf16 v[244:247], v[160:163], a[188:191], v[244:247]
  s_add_u32 m0, s29, 0
  s_nop 0
  buffer_load_dwordx4 v35, s[52:55], s15 offen offset:1024 sc1 lds
  s_waitcnt lgkmcnt(4)
  v_mfma_f32_16x16x32_bf16 v[248:251], v[164:167], a[184:187], v[248:251]
  ds_read_b128 v[144:147], v35 offset:24576
  v_mfma_f32_16x16x32_bf16 v[252:255], v[164:167], a[188:191], v[252:255]
  s_waitcnt vmcnt(29) lgkmcnt(4)
  v_mfma_f32_16x16x32_bf16 v[216:219], v[128:131], a[192:195], v[216:219]
  ds_read_b128 v[148:151], v35 offset:25600
  s_mov_b32 m0, s89
  s_nop 0
  buffer_load_dwordx4 v68, s[40:43], s3 offen offset:0 lds
  s_waitcnt vmcnt(29)
  v_mfma_f32_16x16x32_bf16 v[220:223], v[128:131], a[196:199], v[220:223]
  s_add_u32 m0, s29, 0
  s_nop 0
  buffer_load_dwordx4 v35, s[52:55], s15 offen offset:2048 sc1 lds
  s_waitcnt lgkmcnt(4)
  v_mfma_f32_16x16x32_bf16 v[224:227], v[132:135], a[192:195], v[224:227]
  ds_read_b128 v[152:155], v35 offset:26624
  s_mov_b32 m0, s89
  s_nop 0
  buffer_load_dwordx4 v69, s[40:43], s3 offen offset:1024 lds
  v_mfma_f32_16x16x32_bf16 v[228:231], v[132:135], a[196:199], v[228:231]
  s_waitcnt lgkmcnt(4)
  v_mfma_f32_16x16x32_bf16 v[232:235], v[136:139], a[192:195], v[232:235]
  ds_read_b128 v[156:159], v35 offset:27648
  s_mov_b32 m0, s89
  s_mov_b32 exec_hi, 0
  buffer_load_dwordx4 v70, s[40:43], s3 offen offset:2048 lds
  s_mov_b32 exec_hi, -1
  v_mfma_f32_16x16x32_bf16 v[236:239], v[136:139], a[196:199], v[236:239]
  s_add_u32 m0, s29, 0
  s_nop 0
  buffer_load_dwordx4 v35, s[52:55], s15 offen offset:3072 sc1 lds
  s_waitcnt lgkmcnt(4)
  v_mfma_f32_16x16x32_bf16 v[240:243], v[140:143], a[192:195], v[240:243]
  ds_read_b128 v[160:163], v35 offset:28672
  s_add_u32 m0, s89, 3072
  s_mov_b64 exec, 0x3ff
  buffer_load_dwordx4 v35, s[72:75], s4 offen lds
  s_mov_b64 exec, -1
  v_mfma_f32_16x16x32_bf16 v[244:247], v[140:143], a[196:199], v[244:247]
  s_waitcnt lgkmcnt(4)
  v_mfma_f32_16x16x32_bf16 v[248:251], v[144:147], a[192:195], v[248:251]
  ds_read_b128 v[164:167], v35 offset:29696
  buffer_load_dwordx2 v[46:47], v46, s[56:59], s5 offen sc1
  v_mfma_f32_16x16x32_bf16 v[252:255], v[144:147], a[196:199], v[252:255]
  s_add_u32 m0, s29, 4096
  s_add_u32 s15, s99, 2297856
  buffer_load_dwordx4 v35, s[52:55], s15 offen offset:0 sc1 lds
  s_waitcnt vmcnt(35) lgkmcnt(4)
  v_mfma_f32_16x16x32_bf16 v[216:219], v[148:151], a[200:203], v[216:219]
  ds_read_b128 v[128:131], v35 offset:30720
  s_waitcnt vmcnt(34)
  v_mfma_f32_16x16x32_bf16 v[220:223], v[148:151], a[204:207], v[220:223]
  s_waitcnt lgkmcnt(4)
  v_mfma_f32_16x16x32_bf16 v[224:227], v[152:155], a[200:203], v[224:227]
  ds_read_b128 v[132:135], v35 offset:31744
  v_mfma_f32_16x16x32_bf16 v[228:231], v[152:155], a[204:207], v[228:231]
  s_waitcnt lgkmcnt(4)
  v_mfma_f32_16x16x32_bf16 v[232:235], v[156:159], a[200:203], v[232:235]
  ds_read_b128 v[136:139], v35 offset:32768
  v_mfma_f32_16x16x32_bf16 v[236:239], v[156:159], a[204:207], v[236:239]
  s_waitcnt lgkmcnt(4)
  v_mfma_f32_16x16x32_bf16 v[240:243], v[160:163], a[200:203], v[240:243]
  ds_read_b128 v[140:143], v35 offset:33792
  v_mfma_f32_16x16x32_bf16 v[244:247], v[160:163], a[204:207], v[244:247]
  s_waitcnt lgkmcnt(4)
  v_mfma_f32_16x16x32_bf16 v[248:251], v[164:167], a[200:203], v[248:251]
  ds_read_b128 v[144:147], v35 offset:34816
  v_mfma_f32_16x16x32_bf16 v[252:255], v[164:167], a[204:207], v[252:255]
  s_waitcnt vmcnt(33) lgkmcnt(4)
  v_mfma_f32_16x16x32_bf16 v[216:219], v[128:131], a[208:211], v[216:219]
  ds_read_b128 v[148:151], v35 offset:35840
  s_waitcnt vmcnt(32)
  v_mfma_f32_16x16x32_bf16 v[220:223], v[128:131], a[212:215], v[220:223]
  s_waitcnt vmcnt(23)
  v_cmp_ne_u32 vcc, s61, v84
  s_nop 1
  s_and_b32 vcc_lo, vcc_lo, 0xffff
  s_cbranch_scc1 L_slow14
L_back14:
  s_waitcnt lgkmcnt(4)
  v_mfma_f32_16x16x32_bf16 v[224:227], v[132:135], a[208:211], v[224:227]
  ds_read_b128 v[152:155], v35 offset:36864
  v_mfma_f32_16x16x32_bf16 v[228:231], v[132:135], a[212:215], v[228:231]
  s_waitcnt lgkmcnt(4)
  v_mfma_f32_16x16x32_bf16 v[232:235], v[136:139], a[208:211], v[232:235]
  ds_read_b128 v[156:159], v35 offset:37888
  v_mfma_f32_16x16x32_bf16 v[236:239], v[136:139], a[212:215], v[236:239]
  s_add_u32 s98, s35, 720896
  buffer_load_dwordx4 a[248:251], v90, s[48:51], s98 offen sc1
  s_waitcnt vmcnt(16)
  v_mov_b32 v2, s61
  buffer_store_dword v2, v125, s[56:59], s101 offen sc1
  s_waitcnt lgkmcnt(4)
  v_mfma_f32_16x16x32_bf16 v[240:243], v[140:143], a[208:211], v[240:243]
  ds_read_b128 v[160:163], v35 offset:38912
  v_mfma_f32_16x16x32_bf16 v[244:247], v[140:143], a[212:215], v[244:247]
  buffer_load_dwordx4 a[0:3], v91, s[48:51], s98 offen sc1
  s_waitcnt lgkmcnt(4)
  v_mfma_f32_16x16x32_bf16 v[248:251], v[144:147], a[208:211], v[248:251]
  ds_read_b128 v[164:167], v35 offset:39936
  v_mfma_f32_16x16x32_bf16 v[252:255], v[144:147], a[212:215], v[252:255]
  s_add_u32 s98, s35, 786432
  buffer_load_dwordx4 a[4:7], v90, s[48:51], s98 offen sc1
  s_waitcnt lgkmcnt(4)
  v_mfma_f32_16x16x32_bf16 v[216:219], v[148:151], a[216:219], v[216:219]
  s_waitcnt vmcnt(14)
  s_barrier
  ds_read_b128 v[128:131], v35 offset:40960
  v_mfma_f32_16x16x32_bf16 v[220:223], v[148:151], a[220:223], v[220:223]
  buffer_load_dwordx4 a[8:11], v91, s[48:51], s98 offen sc1
  s_waitcnt lgkmcnt(4)
  v_mfma_f32_16x16x32_bf16 v[224:227], v[152:155], a[216:219], v[224:227]
  ds_read_b128 v[132:135], v35 offset:41984
  v_mfma_f32_16x16x32_bf16 v[228:231], v[152:155], a[220:223], v[228:231]
  s_add_u32 s98, s35, 851968
  buffer_load_dwordx4 a[12:15], v90, s[48:51], s98 offen sc1
  s_waitcnt lgkmcnt(4)
  v_mfma_f32_16x16x32_bf16 v[232:235], v[156:159], a[216:219], v[232:235]
  ds_read_b128 v[136:139], v35 offset:43008
  v_mfma_f32_16x16x32_bf16 v[236:239], v[156:159], a[220:223], v[236:239]
  s_waitcnt lgkmcnt(4)
  v_mfma_f32_16x16x32_bf16 v[240:243], v[160:163], a[216:219], v[240:243]
  ds_read_b128 v[140:143], v35 offset:44032
  v_mfma_f32_16x16x32_bf16 v[244:247], v[160:163], a[220:223], v[244:247]
  buffer_load_dwordx4 a[16:19], v91, s[48:51], s98 offen sc1
  s_waitcnt lgkmcnt(4)
  v_mfma_f32_16x16x32_bf16 v[248:251], v[164:167], a[216:219], v[248:251]
  ds_read_b128 v[144:147], v35 offset:45056
  v_mfma_f32_16x16x32_bf16 v[252:255], v[164:167], a[220:223], v[252:255]
  s_waitcnt lgkmcnt(4)
  v_mfma_f32_16x16x32_bf16 v[216:219], v[128:131], a[224:227], v[216:219]
  ds_read_b128 v[148:151], v35 offset:46080
  v_mfma_f32_16x16x32_bf16 v[220:223], v[128:131], a[228:231], v[220:223]
  s_add_u32 s98, s35, 917504
  buffer_load_dwordx4 a[20:23], v90, s[48:51], s98 offen sc1
  s_waitcnt lgkmcnt(4)
  v_mfma_f32_16x16x32_bf16 v[224:227], v[132:135], a[224:227], v[224:227]
  ds_read_b128 v[152:155], v35 offset:47104
  v_mfma_f32_16x16x32_bf16 v[228:231], v[132:135], a[228:231], v[228:231]
  s_waitcnt lgkmcnt(4)
  v_mfma_f32_16x16x32_bf16 v[232:235], v[136:139], a[224:227], v[232:235]
  ds_read_b128 v[156:159], v35 offset:48128
  v_mfma_f32_16x16x32_bf16 v[236:239], v[136:139], a[228:231], v[236:239]
  buffer_load_dwordx4 a[24:27], v91, s[48:51], s98 offen sc1
  s_waitcnt lgkmcnt(4)
  v_mfma_f32_16x16x32_bf16 v[240:243], v[140:143], a[224:227], v[240:243]
  ds_read_b128 v[160:163], v35 offset:49152
  v_mfma_f32_16x16x32_bf16 v[244:247], v[140:143], a[228:231], v[244:247]
  s_waitcnt lgkmcnt(4)
  v_mfma_f32_16x16x32_bf16 v[248:251], v[144:147], a[224:227], v[248:251]
  ds_read_b128 v[164:167], v35 offset:50176
  v_mfma_f32_16x16x32_bf16 v[252:255], v[144:147], a[228:231], v[252:255]
  s_add_u32 s98, s35, 983040
  buffer_load_dwordx4 a[28:31], v90, s[48:51], s98 offen sc1
  s_waitcnt lgkmcnt(4)
  v_mfma_f32_16x16x32_bf16 v[216:219], v[148:151], a[232:235], v[216:219]
  ds_read_b128 v[128:131], v35 offset:51200
  v_mfma_f32_16x16x32_bf16 v[220:223], v[148:151], a[236:239], v[220:223]
  s_waitcnt lgkmcnt(4)
  v_mfma_f32_16x16x32_bf16 v[224:227], v[152:155], a[232:235], v[224:227]
  ds_read_b128 v[132:135], v35 offset:52224
  v_mfma_f32_16x16x32_bf16 v[228:231], v[152:155], a[236:239], v[228:231]
  buffer_load_dwordx4 a[32:35], v91, s[48:51], s98 offen sc1
  s_waitcnt lgkmcnt(4)
  v_mfma_f32_16x16x32_bf16 v[232:235], v[156:159], a[232:235], v[232:235]
  ds_read_b128 v[136:139], v35 offset:53248
  v_mfma_f32_16x16x32_bf16 v[236:239], v[156:159], a[236:239], v[236:239]
  s_waitcnt lgkmcnt(4)
  v_mfma_f32_16x16x32_bf16 v[240:243], v[160:163], a[232:235], v[240:243]
  ds_read_b128 v[140:143], v35 offset:54272
  v_mfma_f32_16x16x32_bf16 v[244:247], v[160:163], a[236:239], v[244:247]
  s_add_u32 s98, s35, 1048576
  buffer_load_dwordx4 a[36:39], v90, s[48:51], s98 offen sc1
  s_waitcnt lgkmcnt(4)
  v_mfma_f32_16x16x32_bf16 v[248:251], v[164:167], a[232:235], v[248:251]
  ds_read_b128 v[144:147], v35 offset:55296
  v_mfma_f32_16x16x32_bf16 v[252:255], v[164:167], a[236:239], v[252:255]
  s_waitcnt lgkmcnt(4)
  v_mfma_f32_16x16x32_bf16 v[216:219], v[128:131], a[240:243], v[216:219]
  ds_read_b128 v[148:151], v35 offset:56320
  v_mfma_f32_16x16x32_bf16 v[220:223], v[128:131], a[244:247], v[220:223]
  buffer_load_dwordx4 a[40:43], v91, s[48:51], s98 offen sc1
  s_waitcnt lgkmcnt(4)
  v_mfma_f32_16x16x32_bf16 v[224:227], v[132:135], a[240:243], v[224:227]
  ds_read_b128 v[152:155], v35 offset:57344
  v_mfma_f32_16x16x32_bf16 v[228:231], v[132:135], a[244:247], v[228:231]
  s_waitcnt lgkmcnt(4)
  v_mfma_f32_16x16x32_bf16 v[232:235], v[136:139], a[240:243], v[232:235]
  ds_read_b128 v[156:159], v35 offset:58368
  v_mfma_f32_16x16x32_bf16 v[236:239], v[136:139], a[244:247], v[236:239]
  s_add_u32 s98, s35, 1114112
  buffer_load_dwordx4 a[44:47], v90, s[48:51], s98 offen sc1
  s_waitcnt lgkmcnt(4)
  v_mfma_f32_16x16x32_bf16 v[240:243], v[140:143], a[240:243], v[240:243]
  ds_read_b128 v[160:163], v35 offset:59392
  v_mfma_f32_16x16x32_bf16 v[244:247], v[140:143], a[244:247], v[244:247]
  s_waitcnt lgkmcnt(4)
  v_mfma_f32_16x16x32_bf16 v[248:251], v[144:147], a[240:243], v[248:251]
  ds_read_b128 v[164:167], v35 offset:60416
  v_mfma_f32_16x16x32_bf16 v[252:255], v[144:147], a[244:247], v[252:255]
  buffer_load_dwordx4 a[48:51], v91, s[48:51], s98 offen sc1
  s_waitcnt vmcnt(14) lgkmcnt(4)
  v_mfma_f32_16x16x32_bf16 v[216:219], v[148:151], a[248:251], v[216:219]
  s_barrier
  ds_read_b128 v[128:131], v37 offset:0
  s_waitcnt vmcnt(12)
  v_mfma_f32_16x16x32_bf16 v[220:223], v[148:151], a[0:3], v[220:223]
  s_waitcnt lgkmcnt(4)
  v_mfma_f32_16x16x32_bf16 v[224:227], v[152:155], a[248:251], v[224:227]
  ds_read_b128 v[132:135], v37 offset:1024
  v_mfma_f32_16x16x32_bf16 v[228:231], v[152:155], a[0:3], v[228:231]
  s_add_u32 s98, s35, 1179648
  buffer_load_dwordx4 a[52:55], v90, s[48:51], s98 offen sc1
  s_waitcnt lgkmcnt(4)
  v_mfma_f32_16x16x32_bf16 v[232:235], v[156:159], a[248:251], v[232:235]
  ds_read_b128 v[136:139], v37 offset:2048
  v_mfma_f32_16x16x32_bf16 v[236:239], v[156:159], a[0:3], v[236:239]
  s_waitcnt lgkmcnt(4)
  v_mfma_f32_16x16x32_bf16 v[240:243], v[160:163], a[248:251], v[240:243]
  ds_read_b128 v[140:143], v37 offset:3072
  v_mfma_f32_16x16x32_bf16 v[244:247], v[160:163], a[0:3], v[244:247]
  buffer_load_dwordx4 a[56:59], v91, s[48:51], s98 offen sc1
  s_waitcnt lgkmcnt(4)
  v_mfma_f32_16x16x32_bf16 v[248:251], v[164:167], a[248:251], v[248:251]
  ds_read_b128 v[144:147], v37 offset:4096
  v_mfma_f32_16x16x32_bf16 v[252:255], v[164:167], a[0:3], v[252:255]
  s_waitcnt vmcnt(13) lgkmcnt(4)
  v_mfma_f32_16x16x32_bf16 v[216:219], v[128:131], a[4:7], v[216:219]
  ds_read_b128 v[148:151], v37 offset:5120
  s_waitcnt vmcnt(12)
  v_mfma_f32_16x16x32_bf16 v[220:223], v[128:131], a[8:11], v[220:223]
  s_add_u32 s98, s35, 1245184
  buffer_load_dwordx4 a[60:63], v90, s[48:51], s98 offen sc1
  s_waitcnt lgkmcnt(4)
  v_mfma_f32_16x16x32_bf16 v[224:227], v[132:135], a[4:7], v[224:227]
  ds_read_b128 v[152:155], v37 offset:6144
  v_mfma_f32_16x16x32_bf16 v[228:231], v[132:135], a[8:11], v[228:231]
  s_waitcnt lgkmcnt(4)
  v_mfma_f32_16x16x32_bf16 v[232:235], v[136:139], a[4:7], v[232:235]
  ds_read_b128 v[156:159], v37 offset:7168
  v_mfma_f32_16x16x32_bf16 v[236:239], v[136:139], a[8:11], v[236:239]
  buffer_load_dwordx4 a[64:67], v91, s[48:51], s98 offen sc1
  s_waitcnt lgkmcnt(4)
  v_mfma_f32_16x16x32_bf16 v[240:243], v[140:143], a[4:7], v[240:243]
  ds_read_b128 v[160:163], v37 offset:8192
  v_mfma_f32_16x16x32_bf16 v[244:247], v[140:143], a[8:11], v[244:247]
  s_waitcnt lgkmcnt(4)
  v_mfma_f32_16x16x32_bf16 v[248:251], v[144:147], a[4:7], v[248:251]
  ds_read_b128 v[164:167], v37 offset:9216
  v_mfma_f32_16x16x32_bf16 v[252:255], v[144:147], a[8:11], v[252:255]
  s_add_u32 s98, s35, 1310720
  buffer_load_dwordx4 a[68:71], v90, s[48:51], s98 offen sc1
  s_waitcnt vmcnt(14) lgkmcnt(4)
  v_mfma_f32_16x16x32_bf16 v[216:219], v[148:151], a[12:15], v[216:219]
  ds_read_b128 v[128:131], v37 offset:10240
  s_waitcnt vmcnt(13)
  v_mfma_f32_16x16x32_bf16 v[220:223], v[148:151], a[16:19], v[220:223]
  s_waitcnt lgkmcnt(4)
  v_mfma_f32_16x16x32_bf16 v[224:227], v[152:155], a[12:15], v[224:227]
  ds_read_b128 v[132:135], v37 offset:11264
  v_mfma_f32_16x16x32_bf16 v[228:231], v[152:155], a[16:19], v[228:231]
  buffer_load_dwordx4 a[72:75], v91, s[48:51], s98 offen sc1
  s_waitcnt lgkmcnt(4)
  v_mfma_f32_16x16x32_bf16 v[232:235], v[156:159], a[12:15], v[232:235]
  ds_read_b128 v[136:139], v37 offset:12288
  v_mfma_f32_16x16x32_bf16 v[236:239], v[156:159], a[16:19], v[236:239]
  s_waitcnt lgkmcnt(4)
  v_mfma_f32_16x16x32_bf16 v[240:243], v[160:163], a[12:15], v[240:243]
  ds_read_b128 v[140:143], v37 offset:13312
  v_mfma_f32_16x16x32_bf16 v[244:247], v[160:163], a[16:19], v[244:247]
  s_add_u32 s98, s35, 1376256
  buffer_load_dwordx4 a[76:79], v90, s[48:51], s98 offen sc1
  s_waitcnt lgkmcnt(4)
  v_mfma_f32_16x16x32_bf16 v[248:251], v[164:167], a[12:15], v[248:251]
  ds_read_b128 v[144:147], v37 offset:14336
  v_mfma_f32_16x16x32_bf16 v[252:255], v[164:167], a[16:19], v[252:255]
  s_waitcnt vmcnt(14) lgkmcnt(4)
  v_mfma_f32_16x16x32_bf16 v[216:219], v[128:131], a[20:23], v[216:219]
  ds_read_b128 v[148:151], v37 offset:15360
  s_waitcnt vmcnt(13)
  v_mfma_f32_16x16x32_bf16 v[220:223], v[128:131], a[24:27], v[220:223]
  buffer_load_dwordx4 a[80:83], v91, s[48:51], s98 offen sc1
  s_waitcnt lgkmcnt(4)
  v_mfma_f32_16x16x32_bf16 v[224:227], v[132:135], a[20:23], v[224:227]
  ds_read_b128 v[152:155], v37 offset:16384
  v_mfma_f32_16x16x32_bf16 v[228:231], v[132:135], a[24:27], v[228:231]
  s_waitcnt lgkmcnt(4)
  v_mfma_f32_16x16x32_bf16 v[232:235], v[136:139], a[20:23], v[232:235]
  ds_read_b128 v[156:159], v37 offset:17408
  v_mfma_f32_16x16x32_bf16 v[236:239], v[136:139], a[24:27], v[236:239]
  s_add_u32 s98, s35, 1441792
  buffer_load_dwordx4 a[84:87], v90, s[48:51], s98 offen sc1
  s_waitcnt lgkmcnt(4)
  v_mfma_f32_16x16x32_bf16 v[240:243], v[140:143], a[20:23], v[240:243]
  ds_read_b128 v[160:163], v37 offset:18432
  v_mfma_f32_16x16x32_bf16 v[244:247], v[140:143], a[24:27], v[244:247]
  s_waitcnt lgkmcnt(4)
  v_mfma_f32_16x16x32_bf16 v[248:251], v[144:147], a[20:23], v[248:251]
  ds_read_b128 v[164:167], v37 offset:19456
  v_mfma_f32_16x16x32_bf16 v[252:255], v[144:147], a[24:27], v[252:255]
  buffer_load_dwordx4 a[88:91], v91, s[48:51], s98 offen sc1
  s_waitcnt vmcnt(15) lgkmcnt(4)
  v_mfma_f32_16x16x32_bf16 v[216:219], v[148:151], a[28:31], v[216:219]
  s_barrier
  ds_read_b128 v[128:131], v41 offset:20480
  s_waitcnt vmcnt(14)
  v_mfma_f32_16x16x32_bf16 v[220:223], v[148:151], a[32:35], v[220:223]
  s_waitcnt lgkmcnt(4)
  v_mfma_f32_16x16x32_bf16 v[224:227], v[152:155], a[28:31], v[224:227]
  ds_read_b128 v[132:135], v41 offset:21504
  v_mfma_f32_16x16x32_bf16 v[228:231], v[152:155], a[32:35], v[228:231]
  s_add_u32 s98, s35, 1507328
  buffer_load_dwordx4 a[92:95], v90, s[48:51], s98 offen sc1
  s_waitcnt lgkmcnt(4)
  v_mfma_f32_16x16x32_bf16 v[232:235], v[156:159], a[28:31], v[232:235]
  ds_read_b128 v[136:139], v41 offset:22528
  v_mfma_f32_16x16x32_bf16 v[236:239], v[156:159], a[32:35], v[236:239]
  s_waitcnt lgkmcnt(4)
  v_mfma_f32_16x16x32_bf16 v[240:243], v[160:163], a[28:31], v[240:243]
  ds_read_b128 v[140:143], v41 offset:23552
  v_mfma_f32_16x16x32_bf16 v[244:247], v[160:163], a[32:35], v[244:247]
  buffer_load_dwordx4 a[96:99], v91, s[48:51], s98 offen sc1
  s_waitcnt lgkmcnt(4)
  v_mfma_f32_16x16x32_bf16 v[248:251], v[164:167], a[28:31], v[248:251]
  ds_read_b128 v[144:147], v41 offset:24576
  v_mfma_f32_16x16x32_bf16 v[252:255], v[164:167], a[32:35], v[252:255]
  s_waitcnt vmcnt(15) lgkmcnt(4)
  v_mfma_f32_16x16x32_bf16 v[216:219], v[128:131], a[36:39], v[216:219]
  ds_read_b128 v[148:151], v41 offset:25600
  s_waitcnt vmcnt(14)
  v_mfma_f32_16x16x32_bf16 v[220:223], v[128:131], a[40:43], v[220:223]
  s_add_u32 s98, s35, 1572864
  buffer_load_dwordx4 a[100:103], v90, s[48:51], s98 offen sc1
  s_waitcnt lgkmcnt(4)
  v_mfma_f32_16x16x32_bf16 v[224:227], v[132:135], a[36:39], v[224:227]
  ds_read_b128 v[152:155], v41 offset:26624
  v_mfma_f32_16x16x32_bf16 v[228:231], v[132:135], a[40:43], v[228:231]
  s_waitcnt lgkmcnt(4)
  v_mfma_f32_16x16x32_bf16 v[232:235], v[136:139], a[36:39], v[232:235]
  ds_read_b128 v[156:159], v41 offset:27648
  v_mfma_f32_16x16x32_bf16 v[236:239], v[136:139], a[40:43], v[236:239]
  buffer_load_dwordx4 a[104:107], v91, s[48:51], s98 offen sc1
  s_waitcnt lgkmcnt(4)
  v_mfma_f32_16x16x32_bf16 v[240:243], v[140:143], a[36:39], v[240:243]
  ds_read_b128 v[160:163], v41 offset:28672
  v_mfma_f32_16x16x32_bf16 v[244:247], v[140:143], a[40:43], v[244:247]
  s_waitcnt lgkmcnt(4)
  v_mfma_f32_16x16x32_bf16 v[248:251], v[144:147], a[36:39], v[248:251]
  ds_read_b128 v[164:167], v41 offset:29696
  v_mfma_f32_16x16x32_bf16 v[252:255], v[144:147], a[40:43], v[252:255]
  s_add_u32 s98, s35, 1638400
  buffer_load_dwordx4 a[108:111], v90, s[48:51], s98 offen sc1
  s_waitcnt vmcnt(16) lgkmcnt(4)
  v_mfma_f32_16x16x32_bf16 v[216:219], v[148:151], a[44:47], v[216:219]
  ds_read_b128 v[128:131], v41 offset:30720
  s_waitcnt vmcnt(15)
  v_mfma_f32_16x16x32_bf16 v[220:223], v[148:151], a[48:51], v[220:223]
  s_waitcnt lgkmcnt(4)
  v_mfma_f32_16x16x32_bf16 v[224:227], v[152:155], a[44:47], v[224:227]
  ds_read_b128 v[132:135], v41 offset:31744
  v_mfma_f32_16x16x32_bf16 v[228:231], v[152:155], a[48:51], v[228:231]
  buffer_load_dwordx4 a[112:115], v91, s[48:51], s98 offen sc1
  s_waitcnt lgkmcnt(4)
  v_mfma_f32_16x16x32_bf16 v[232:235], v[156:159], a[44:47], v[232:235]
  ds_read_b128 v[136:139], v41 offset:32768
  v_mfma_f32_16x16x32_bf16 v[236:239], v[156:159], a[48:51], v[236:239]
  s_waitcnt lgkmcnt(4)
  v_mfma_f32_16x16x32_bf16 v[240:243], v[160:163], a[44:47], v[240:243]
  ds_read_b128 v[140:143], v41 offset:33792
  v_mfma_f32_16x16x32_bf16 v[244:247], v[160:163], a[48:51], v[244:247]
  s_add_u32 m0, s29, 20480
  s_add_u32 s15, s99, 2621440
  buffer_load_dwordx4 v35, s[52:55], s15 offen offset:0 sc1 lds
  s_waitcnt lgkmcnt(4)
  v_mfma_f32_16x16x32_bf16 v[248:251], v[164:167], a[44:47], v[248:251]
  ds_read_b128 v[144:147], v41 offset:34816
  v_mfma_f32_16x16x32_bf16 v[252:255], v[164:167], a[48:51], v[252:255]
  s_waitcnt vmcnt(16) lgkmcnt(4)
  v_mfma_f32_16x16x32_bf16 v[216:219], v[128:131], a[52:55], v[216:219]
  ds_read_b128 v[148:151], v41 offset:35840
  s_waitcnt vmcnt(15)
  v_mfma_f32_16x16x32_bf16 v[220:223], v[128:131], a[56:59], v[220:223]
  s_add_u32 m0, s29, 20480
  s_nop 0
  buffer_load_dwordx4 v35, s[52:55], s15 offen offset:1024 sc1 lds
  s_waitcnt lgkmcnt(4)
  v_mfma_f32_16x16x32_bf16 v[224:227], v[132:135], a[52:55], v[224:227]
  ds_read_b128 v[152:155], v41 offset:36864
  v_mfma_f32_16x16x32_bf16 v[228:231], v[132:135], a[56:59], v[228:231]
  s_waitcnt lgkmcnt(4)
  v_mfma_f32_16x16x32_bf16 v[232:235], v[136:139], a[52:55], v[232:235]
  ds_read_b128 v[156:159], v41 offset:37888
  v_mfma_f32_16x16x32_bf16 v[236:239], v[136:139], a[56:59], v[236:239]
  s_add_u32 m0, s29, 20480
  s_nop 0
  buffer_load_dwordx4 v35, s[52:55], s15 offen offset:2048 sc1 lds
  s_waitcnt lgkmcnt(4)
  v_mfma_f32_16x16x32_bf16 v[240:243], v[140:143], a[52:55], v[240:243]
  ds_read_b128 v[160:163], v41 offset:38912
  v_mfma_f32_16x16x32_bf16 v[244:247], v[140:143], a[56:59], v[244:247]
  ds_read_b64 v[48:49], v71 offset:0
  s_waitcnt lgkmcnt(5)
  v_mfma_f32_16x16x32_bf16 v[248:251], v[144:147], a[52:55], v[248:251]
  ds_read_b128 v[164:167], v41 offset:39936
  ds_read_b64 v[50:51], v71 offset:32
  v_mfma_f32_16x16x32_bf16 v[252:255], v[144:147], a[56:59], v[252:255]
  s_add_u32 m0, s29, 20480
  s_nop 0
  buffer_load_dwordx4 v35, s[52:55], s15 offen offset:3072 sc1 lds
  s_waitcnt vmcnt(17) lgkmcnt(6)
  v_mfma_f32_16x16x32_bf16 v[216:219], v[148:151], a[60:63], v[216:219]
  s_barrier
  ds_read_b128 v[128:131], v41 offset:40960
  s_waitcnt vmcnt(16)
  v_mfma_f32_16x16x32_bf16 v[220:223], v[148:151], a[64:67], v[220:223]
  ds_read_b64 v[52:53], v71 offset:64
  s_waitcnt lgkmcnt(7)
  v_mfma_f32_16x16x32_bf16 v[224:227], v[152:155], a[60:63], v[224:227]
  ds_read_b128 v[132:135], v41 offset:41984
  ds_read_b64 v[54:55], v71 offset:96
  v_mfma_f32_16x16x32_bf16 v[228:231], v[152:155], a[64:67], v[228:231]
  s_add_u32 m0, s29, 24576
  s_add_u32 s15, s99, 2625536
  buffer_load_dwordx4 v35, s[52:55], s15 offen offset:0 sc1 lds
  ds_read_b64 v[56:57], v71 offset:128
  s_waitcnt lgkmcnt(9)
  v_mfma_f32_16x16x32_bf16 v[232:235], v[156:159], a[60:63], v[232:235]
  ds_read_b128 v[136:139], v41 offset:43008
  ds_read_b64 v[58:59], v72 offset:3072
  v_mfma_f32_16x16x32_bf16 v[236:239], v[156:159], a[64:67], v[236:239]
  ds_read_b64 v[60:61], v72 offset:3104
  s_waitcnt lgkmcnt(11)
  v_mfma_f32_16x16x32_bf16 v[240:243], v[160:163], a[60:63], v[240:243]
  ds_read_b128 v[140:143], v41 offset:44032
  ds_read_b64 v[62:63], v72 offset:3136
  v_mfma_f32_16x16x32_bf16 v[244:247], v[160:163], a[64:67], v[244:247]
  s_add_u32 m0, s29, 40960
  s_add_u32 s15, s99, 2949120
  buffer_load_dwordx4 v35, s[52:55], s15 offen offset:0 sc1 lds
  ds_read_b64 v[64:65], v72 offset:3168
  s_waitcnt lgkmcnt(12)
  v_mfma_f32_16x16x32_bf16 v[248:251], v[164:167], a[60:63], v[248:251]
  ds_read_b128 v[144:147], v41 offset:45056
  ds_read_b64 v[66:67], v72 offset:3200
  v_mfma_f32_16x16x32_bf16 v[252:255], v[164:167], a[64:67], v[252:255]
  s_waitcnt vmcnt(17) lgkmcnt(12)
  v_mfma_f32_16x16x32_bf16 v[216:219], v[128:131], a[68:71], v[216:219]
  ds_read_b128 v[148:151], v41 offset:46080
  s_waitcnt vmcnt(16)
  v_mfma_f32_16x16x32_bf16 v[220:223], v[128:131], a[72:75], v[220:223]
  s_add_u32 m0, s29, 40960
  s_nop 0
  buffer_load_dwordx4 v35, s[52:55], s15 offen offset:1024 sc1 lds
  s_waitcnt lgkmcnt(11)
  v_mfma_f32_16x16x32_bf16 v[224:227], v[132:135], a[68:71], v[224:227]
  ds_read_b128 v[152:155], v41 offset:47104
  v_mfma_f32_16x16x32_bf16 v[228:231], v[132:135], a[72:75], v[228:231]
  s_waitcnt lgkmcnt(9)
  v_mfma_f32_16x16x32_bf16 v[232:235], v[136:139], a[68:71], v[232:235]
  ds_read_b128 v[156:159], v41 offset:48128
  v_mfma_f32_16x16x32_bf16 v[236:239], v[136:139], a[72:75], v[236:239]
  s_add_u32 m0, s29, 40960
  s_nop 0
  buffer_load_dwordx4 v35, s[52:55], s15 offen offset:2048 sc1 lds
  s_waitcnt lgkmcnt(7)
  v_mfma_f32_16x16x32_bf16 v[240:243], v[140:143], a[68:71], v[240:243]
  ds_read_b128 v[160:163], v41 offset:49152
  v_mfma_f32_16x16x32_bf16 v[244:247], v[140:143], a[72:75], v[244:247]
L_pgs5:
  s_cbranch_execz L_pgsr
  s_waitcnt lgkmcnt(5)
  v_mfma_f32_16x16x32_bf16 v[248:251], v[144:147], a[68:71], v[248:251]
  ds_read_b128 v[164:167], v41 offset:50176
  v_mfma_f32_16x16x32_bf16 v[252:255], v[144:147], a[72:75], v[252:255]
  s_add_u32 m0, s29, 40960
  s_nop 0
  buffer_load_dwordx4 v35, s[52:55], s15 offen offset:3072 sc1 lds
  s_waitcnt vmcnt(18) lgkmcnt(4)
  v_mfma_f32_16x16x32_bf16 v[216:219], v[148:151], a[76:79], v[216:219]
  ds_read_b128 v[128:131], v41 offset:51200
  s_waitcnt vmcnt(17)
  v_mfma_f32_16x16x32_bf16 v[220:223], v[148:151], a[80:83], v[220:223]
  s_waitcnt lgkmcnt(4)
  v_mfma_f32_16x16x32_bf16 v[224:227], v[152:155], a[76:79], v[224:227]
  ds_read_b128 v[132:135], v41 offset:52224
  v_mfma_f32_16x16x32_bf16 v[228:231], v[152:155], a[80:83], v[228:231]
  s_add_u32 m0, s29, 45056
  s_add_u32 s15, s99, 2953216
  buffer_load_dwordx4 v35, s[52:55], s15 offen offset:0 sc1 lds
  s_waitcnt lgkmcnt(4)
  v_mfma_f32_16x16x32_bf16 v[232:235], v[156:159], a[76:79], v[232:235]
  ds_read_b128 v[136:139], v41 offset:53248
  v_mfma_f32_16x16x32_bf16 v[236:239], v[156:159], a[80:83], v[236:239]
  s_mov_b64 exec, 0xffff
  buffer_load_dword v84, v85, s[56:59], 0 offen offset:8 sc1
  s_mov_b64 exec, -1
  s_waitcnt lgkmcnt(4)
  v_mfma_f32_16x16x32_bf16 v[240:243], v[160:163], a[76:79], v[240:243]
  ds_read_b128 v[140:143], v41 offset:54272
  v_mfma_f32_16x16x32_bf16 v[244:247], v[160:163], a[80:83], v[244:247]
  s_add_u32 m0, s29, 65536
  s_add_u32 s15, s99, 3276800
  buffer_load_dwordx4 v35, s[52:55], s15 offen offset:0 sc1 lds
  s_waitcnt lgkmcnt(4)
  v_mfma_f32_16x16x32_bf16 v[248:251], v[164:167], a[76:79], v[248:251]
  ds_read_b128 v[144:147], v41 offset:55296
  v_mfma_f32_16x16x32_bf16 v[252:255], v[164:167], a[80:83], v[252:255]
  s_waitcnt vmcnt(19) lgkmcnt(4)
  v_mfma_f32_16x16x32_bf16 v[216:219], v[128:131], a[84:87], v[216:219]
  ds_read_b128 v[148:151], v41 offset:56320
  s_waitcnt vmcnt(18)
  v_mfma_f32_16x16x32_bf16 v[220:223], v[128:131], a[88:91], v[220:223]
  s_add_u32 m0, s29, 65536
  s_nop 0
  buffer_load_dwordx4 v35, s[52:55], s15 offen offset:1024 sc1 lds
  s_waitcnt lgkmcnt(4)
  v_mfma_f32_16x16x32_bf16 v[224:227], v[132:135], a[84:87], v[224:227]
  ds_read_b128 v[152:155], v41 offset:57344
  v_mfma_f32_16x16x32_bf16 v[228:231], v[132:135], a[88:91], v[228:231]
  s_waitcnt lgkmcnt(4)
  v_mfma_f32_16x16x32_bf16 v[232:235], v[136:139], a[84:87], v[232:235]
  ds_read_b128 v[156:159], v41 offset:58368
  v_mfma_f32_16x16x32_bf16 v[236:239], v[136:139], a[88:91], v[236:239]
  s_add_u32 m0, s29, 65536
  s_nop 0
  buffer_load_dwordx4 v35, s[52:55], s15 offen offset:2048 sc1 lds
  s_waitcnt lgkmcnt(4)
  v_mfma_f32_16x16x32_bf16 v[240:243], v[140:143], a[84:87], v[240:243]
  ds_read_b128 v[160:163], v41 offset:59392
  v_mfma_f32_16x16x32_bf16 v[244:247], v[140:143], a[88:91], v[244:247]
  s_waitcnt lgkmcnt(4)
  v_mfma_f32_16x16x32_bf16 v[248:251], v[144:147], a[84:87], v[248:251]
  ds_read_b128 v[164:167], v41 offset:60416
  v_mfma_f32_16x16x32_bf16 v[252:255], v[144:147], a[88:91], v[252:255]
  s_add_u32 m0, s29, 65536
  s_nop 0
  buffer_load_dwordx4 v35, s[52:55], s15 offen offset:3072 sc1 lds
  s_waitcnt vmcnt(20) lgkmcnt(4)
  v_mfma_f32_16x16x32_bf16 v[216:219], v[148:151], a[92:95], v[216:219]
  s_barrier
  ds_read_b128 v[128:131], v41 offset:61440
  s_waitcnt vmcnt(19)
  v_mfma_f32_16x16x32_bf16 v[220:223], v[148:151], a[96:99], v[220:223]
  s_waitcnt lgkmcnt(4)
  v_mfma_f32_16x16x32_bf16 v[224:227], v[152:155], a[92:95], v[224:227]
  ds_read_b128 v[132:135], v41 offset:62464
  v_mfma_f32_16x16x32_bf16 v[228:231], v[152:155], a[96:99], v[228:231]
  s_add_u32 m0, s29, 69632
  s_add_u32 s15, s99, 3280896
  buffer_load_dwordx4 v35, s[52:55], s15 offen offset:0 sc1 lds
  s_waitcnt lgkmcnt(4)
  v_mfma_f32_16x16x32_bf16 v[232:235], v[156:159], a[92:95], v[232:235]
  ds_read_b128 v[136:139], v41 offset:63488
  v_mfma_f32_16x16x32_bf16 v[236:239], v[156:159], a[96:99], v[236:239]
  s_waitcnt lgkmcnt(4)
  v_mfma_f32_16x16x32_bf16 v[240:243], v[160:163], a[92:95], v[240:243]
  ds_read_b128 v[140:143], v41 offset:64512
  v_mfma_f32_16x16x32_bf16 v[244:247], v[160:163], a[96:99], v[244:247]
  s_add_u32 m0, s29, 86016
  s_add_u32 s15, s99, 3604480
  buffer_load_dwordx4 v35, s[52:55], s15 offen offset:0 sc1 lds
  s_waitcnt lgkmcnt(4)
  v_mfma_f32_16x16x32_bf16 v[248:251], v[164:167], a[92:95], v[248:251]
  ds_read_b128 v[144:147], v42 offset:0
  v_mfma_f32_16x16x32_bf16 v[252:255], v[164:167], a[96:99], v[252:255]
  s_waitcnt vmcnt(20) lgkmcnt(4)
  v_mfma_f32_16x16x32_bf16 v[216:219], v[128:131], a[100:103], v[216:219]
  ds_read_b128 v[148:151], v42 offset:1024
  s_waitcnt vmcnt(19)
  v_mfma_f32_16x16x32_bf16 v[220:223], v[128:131], a[104:107], v[220:223]
  s_add_u32 m0, s29, 86016
  s_nop 0
  buffer_load_dwordx4 v35, s[52:55], s15 offen offset:1024 sc1 lds
  s_waitcnt lgkmcnt(4)
  v_mfma_f32_16x16x32_bf16 v[224:227], v[132:135], a[100:103], v[224:227]
  ds_read_b128 v[152:155], v42 offset:2048
  v_mfma_f32_16x16x32_bf16 v[228:231], v[132:135], a[104:107], v[228:231]
  s_waitcnt lgkmcnt(4)
  v_mfma_f32_16x16x32_bf16 v[232:235], v[136:139], a[100:103], v[232:235]
  ds_read_b128 v[156:159], v42 offset:3072
  v_mfma_f32_16x16x32_bf16 v[236:239], v[136:139], a[104:107], v[236:239]
  s_add_u32 m0, s29, 86016
  s_nop 0
  buffer_load_dwordx4 v35, s[52:55], s15 offen offset:2048 sc1 lds
  s_waitcnt lgkmcnt(4)
  v_mfma_f32_16x16x32_bf16 v[240:243], v[140:143], a[100:103], v[240:243]
  ds_read_b128 v[160:163], v42 offset:4096
  v_mfma_f32_16x16x32_bf16 v[244:247], v[140:143], a[104:107], v[244:247]
  s_waitcnt lgkmcnt(4)
  v_mfma_f32_16x16x32_bf16 v[248:251], v[144:147], a[100:103], v[248:251]
  ds_read_b128 v[164:167], v42 offset:5120
  v_mfma_f32_16x16x32_bf16 v[252:255], v[144:147], a[104:107], v[252:255]
  s_add_u32 m0, s29, 86016
  s_nop 0
  buffer_load_dwordx4 v35, s[52:55], s15 offen offset:3072 sc1 lds
  s_waitcnt vmcnt(21) lgkmcnt(4)
  v_mfma_f32_16x16x32_bf16 v[216:219], v[148:151], a[108:111], v[216:219]
  ds_read_b128 v[128:131], v42 offset:6144
  s_waitcnt vmcnt(9)
  v_cmp_ne_u32 vcc, s61, v84
  s_nop 1
  s_and_b32 vcc_lo, vcc_lo, 0xffff
  s_cbranch_scc1 L_slow15
L_back15:
  v_mfma_f32_16x16x32_bf16 v[220:223], v[148:151], a[112:115], v[220:223]
  s_add_u32 s98, s35, 1703936
  buffer_load_dwordx4 a[116:119], v91, s[48:51], s98 offen sc1
  s_add_u32 s98, s35, 1769472
  buffer_load_dwordx4 a[120:123], v91, s[48:51], s98 offen sc1
  v_lshlrev_b32 v180, 16, v48
  v_and_b32 v181, 0xffff0000, v48
  v_lshlrev_b32 v182, 16, v49
  v_and_b32 v183, 0xffff0000, v49
  v_lshlrev_b32 v184, 16, v50
  v_and_b32 v185, 0xffff0000, v50
  v_lshlrev_b32 v186, 16, v51
  v_and_b32 v187, 0xffff0000, v51
  v_lshlrev_b32 v188, 16, v52
  v_and_b32 v189, 0xffff0000, v52
  v_lshlrev_b32 v190, 16, v53
  v_and_b32 v191, 0xffff0000, v53
  v_lshlrev_b32 v192, 16, v54
  v_and_b32 v193, 0xffff0000, v54
  v_lshlrev_b32 v194, 16, v55
  v_and_b32 v195, 0xffff0000, v55
  v_lshlrev_b32 v196, 16, v56
  v_and_b32 v197, 0xffff0000, v56
  v_lshlrev_b32 v198, 16, v57
  v_and_b32 v199, 0xffff0000, v57
  v_sub_f32 v104, v180, v46
  v_sub_f32 v105, v181, v46
  v_sub_f32 v106, v182, v46
  v_sub_f32 v107, v183, v46
  s_waitcnt lgkmcnt(4)
  v_mfma_f32_16x16x32_bf16 v[224:227], v[152:155], a[108:111], v[224:227]
  ds_read_b128 v[132:135], v42 offset:7168
  s_add_u32 s98, s35, 1835008
  buffer_load_dwordx4 a[124:127], v91, s[48:51], s98 offen sc1
  s_add_u32 s98, s35, 1900544
  buffer_load_dwordx4 a[128:131], v91, s[48:51], s98 offen sc1
  v_sub_f32 v108, v184, v46
  v_sub_f32 v109, v185, v46
  v_sub_f32 v110, v186, v46
  v_sub_f32 v111, v187, v46
  v_sub_f32 v112, v188, v46
  v_sub_f32 v113, v189, v46
  v_sub_f32 v114, v190, v46
  v_sub_f32 v115, v191, v46
  v_sub_f32 v116, v192, v46
  v_sub_f32 v117, v193, v46
  v_sub_f32 v118, v194, v46
  v_sub_f32 v119, v195, v46
  v_sub_f32 v120, v196, v46
  v_sub_f32 v121, v197, v46
  v_sub_f32 v122, v198, v46
  v_sub_f32 v123, v199, v46
  v_cvt_pk_bf16_f32 v105, v104, v105
  v_cvt_pk_bf16_f32 v107, v106, v107
  v_cvt_pk_bf16_f32 v109, v108, v109
  v_cvt_pk_bf16_f32 v111, v110, v111
  v_cvt_pk_bf16_f32 v113, v112, v113
  v_cvt_pk_bf16_f32 v115, v114, v115
  v_cvt_pk_bf16_f32 v117, v116, v117
  v_cvt_pk_bf16_f32 v119, v118, v119
  v_mfma_f32_16x16x32_bf16 v[228:231], v[152:155], a[112:115], v[228:231]
  s_add_u32 s98, s35, 1966080
  buffer_load_dwordx4 a[132:135], v91, s[48:51], s98 offen sc1
  s_add_u32 s98, s35, 2031616
  buffer_load_dwordx4 a[136:139], v91, s[48:51], s98 offen sc1
  v_cvt_pk_bf16_f32 v121, v120, v121
  v_cvt_pk_bf16_f32 v123, v122, v123
  v_lshlrev_b32 v104, 16, v105
  v_and_b32 v105, 0xffff0000, v105
  v_lshlrev_b32 v106, 16, v107
  v_and_b32 v107, 0xffff0000, v107
  v_lshlrev_b32 v108, 16, v109
  v_and_b32 v109, 0xffff0000, v109
  v_lshlrev_b32 v110, 16, v111
  v_and_b32 v111, 0xffff0000, v111
  v_lshlrev_b32 v112, 16, v113
  v_and_b32 v113, 0xffff0000, v113
  v_lshlrev_b32 v114, 16, v115
  v_and_b32 v115, 0xffff0000, v115
  v_lshlrev_b32 v116, 16, v117
  v_and_b32 v117, 0xffff0000, v117
  v_lshlrev_b32 v118, 16, v119
  v_and_b32 v119, 0xffff0000, v119
  v_lshlrev_b32 v120, 16, v121
  v_and_b32 v121, 0xffff0000, v121
  v_lshlrev_b32 v122, 16, v123
  v_and_b32 v123, 0xffff0000, v123
  v_mul_f32 v104, v104, v47
  v_mul_f32 v105, v105, v47
  s_waitcnt lgkmcnt(4)
  v_mfma_f32_16x16x32_bf16 v[232:235], v[156:159], a[108:111], v[232:235]
  ds_read_b128 v[136:139], v42 offset:8192
  s_add_u32 s98, s35, 2097152
  buffer_load_dwordx4 a[140:143], v91, s[48:51], s98 offen sc1
  s_add_u32 s98, s35, 2162688
  buffer_load_dwordx4 a[144:147], v91, s[48:51], s98 offen sc1
  v_mul_f32 v106, v106, v47
  v_mul_f32 v107, v107, v47
  v_mul_f32 v108, v108, v47
  v_mul_f32 v109, v109, v47
  v_mul_f32 v110, v110, v47
  v_mul_f32 v111, v111, v47
  v_mul_f32 v112, v112, v47
  v_mul_f32 v113, v113, v47
  v_mul_f32 v114, v114, v47
  v_mul_f32 v115, v115, v47
  v_mul_f32 v116, v116, v47
  v_mul_f32 v117, v117, v47
  v_mul_f32 v118, v118, v47
  v_mul_f32 v119, v119, v47
  v_mul_f32 v120, v120, v47
  v_mul_f32 v121, v121, v47
  v_mul_f32 v122, v122, v47
  v_mul_f32 v123, v123, v47
  v_cvt_pk_bf16_f32 v105, v104, v105
  v_cvt_pk_bf16_f32 v107, v106, v107
  v_cvt_pk_bf16_f32 v109, v108, v109
  v_cvt_pk_bf16_f32 v111, v110, v111
  v_cvt_pk_bf16_f32 v113, v112, v113
  v_mfma_f32_16x16x32_bf16 v[236:239], v[156:159], a[112:115], v[236:239]
  s_add_u32 s14, s35, 2228224
  s_mov_b32 exec_lo, 0x1fff
  s_mov_b32 exec_hi, 0
  buffer_load_dword a255, v124, s[48:51], s14 offen sc1
  s_mov_b64 exec, -1
  v_cvt_pk_bf16_f32 v115, v114, v115
  v_cvt_pk_bf16_f32 v117, v116, v117
  v_cvt_pk_bf16_f32 v119, v118, v119
  v_cvt_pk_bf16_f32 v121, v120, v121
  v_cvt_pk_bf16_f32 v123, v122, v123
  v_lshlrev_b32 v104, 16, v105
  v_and_b32 v105, 0xffff0000, v105
  v_lshlrev_b32 v106, 16, v107
  v_and_b32 v107, 0xffff0000, v107
  v_lshlrev_b32 v108, 16, v109
  v_and_b32 v109, 0xffff0000, v109
  v_lshlrev_b32 v110, 16, v111
  v_and_b32 v111, 0xffff0000, v111
  v_lshlrev_b32 v112, 16, v113
  v_and_b32 v113, 0xffff0000, v113
  v_lshlrev_b32 v114, 16, v115
  v_and_b32 v115, 0xffff0000, v115
  v_lshlrev_b32 v116, 16, v117
  v_and_b32 v117, 0xffff0000, v117
  v_lshlrev_b32 v118, 16, v119
  v_and_b32 v119, 0xffff0000, v119
  v_lshlrev_b32 v120, 16, v121
  v_and_b32 v121, 0xffff0000, v121
  s_waitcnt lgkmcnt(4)
  v_mfma_f32_16x16x32_bf16 v[240:243], v[160:163], a[108:111], v[240:243]
  ds_read_b128 v[140:143], v42 offset:9216
  s_add_u32 s98, s35, 2228224
  buffer_load_dwordx4 a[148:151], v91, s[48:51], s98 offen sc1
  s_add_u32 s98, s35, 2293760
  buffer_load_dwordx4 a[152:155], v91, s[48:51], s98 offen sc1
  v_lshlrev_b32 v122, 16, v123
  v_and_b32 v123, 0xffff0000, v123
  v_lshlrev_b32 v6, 16, v58
  v_and_b32 v7, 0xffff0000, v58
  v_lshlrev_b32 v8, 16, v59
  v_and_b32 v9, 0xffff0000, v59
  v_lshlrev_b32 v10, 16, v60
  v_and_b32 v11, 0xffff0000, v60
  v_lshlrev_b32 v12, 16, v61
  v_and_b32 v13, 0xffff0000, v61
  v_lshlrev_b32 v14, 16, v62
  v_and_b32 v15, 0xffff0000, v62
  v_lshlrev_b32 v16, 16, v63
  v_and_b32 v17, 0xffff0000, v63
  v_lshlrev_b32 v18, 16, v64
  v_and_b32 v19, 0xffff0000, v64
  v_lshlrev_b32 v20, 16, v65
  v_and_b32 v21, 0xffff0000, v65
  v_lshlrev_b32 v22, 16, v66
  v_and_b32 v23, 0xffff0000, v66
  v_lshlrev_b32 v24, 16, v67
  v_and_b32 v25, 0xffff0000, v67
  v_mul_f32 v104, v104, v6
  v_mfma_f32_16x16x32_bf16 v[244:247], v[160:163], a[112:115], v[244:247]
  ds_read_b128 v[144:147], v42 offset:10240
  s_add_u32 s98, s35, 2359296
  buffer_load_dwordx4 a[156:159], v91, s[48:51], s98 offen sc1
  s_add_u32 s98, s35, 2424832
  buffer_load_dwordx4 a[160:163], v91, s[48:51], s98 offen sc1
  v_mul_f32 v105, v105, v7
  v_mul_f32 v106, v106, v8
  v_mul_f32 v107, v107, v9
  v_mul_f32 v108, v108, v10
  v_mul_f32 v109, v109, v11
  v_mul_f32 v110, v110, v12
  v_mul_f32 v111, v111, v13
  v_mul_f32 v112, v112, v14
  v_mul_f32 v113, v113, v15
  v_mul_f32 v114, v114, v16
  v_mul_f32 v115, v115, v17
  v_mul_f32 v116, v116, v18
  v_mul_f32 v117, v117, v19
  v_mul_f32 v118, v118, v20
  v_mul_f32 v119, v119, v21
  v_mul_f32 v120, v120, v22
  v_mul_f32 v121, v121, v23
  v_mul_f32 v122, v122, v24
  v_mul_f32 v123, v123, v25
  v_cvt_pk_bf16_f32 v105, v104, v105
  v_cvt_pk_bf16_f32 v107, v106, v107
  v_cvt_pk_bf16_f32 v109, v108, v109
  v_cvt_pk_bf16_f32 v111, v110, v111
  s_waitcnt lgkmcnt(5)
  v_mfma_f32_16x16x32_bf16 v[248:251], v[164:167], a[108:111], v[248:251]
  ds_read_b128 v[148:151], v42 offset:11264
  s_add_u32 s14, s35, 1703936
  s_mov_b32 exec_lo, 0
  s_mov_b32 exec_hi, 0x1fffff
  buffer_load_dword a255, v124, s[48:51], s14 offen sc1
  s_mov_b64 exec, -1
  v_cvt_pk_bf16_f32 v113, v112, v113
  v_cvt_pk_bf16_f32 v115, v114, v115
  v_cvt_pk_bf16_f32 v117, v116, v117
  v_cvt_pk_bf16_f32 v119, v118, v119
  v_cvt_pk_bf16_f32 v121, v120, v121
  v_cvt_pk_bf16_f32 v123, v122, v123
  v_lshlrev_b32 v104, 16, v105
  v_and_b32 v105, 0xffff0000, v105
  v_lshlrev_b32 v106, 16, v107
  v_and_b32 v107, 0xffff0000, v107
  v_lshlrev_b32 v108, 16, v109
  v_and_b32 v109, 0xffff0000, v109
  v_lshlrev_b32 v110, 16, v111
  v_and_b32 v111, 0xffff0000, v111
  v_lshlrev_b32 v112, 16, v113
  v_and_b32 v113, 0xffff0000, v113
  v_lshlrev_b32 v114, 16, v115
  v_and_b32 v115, 0xffff0000, v115
  v_lshlrev_b32 v116, 16, v117
  v_and_b32 v117, 0xffff0000, v117
  v_lshlrev_b32 v118, 16, v119
  v_and_b32 v119, 0xffff0000, v119
  v_lshlrev_b32 v120, 16, v121
  v_mfma_f32_16x16x32_bf16 v[252:255], v[164:167], a[112:115], v[252:255]
  ds_read_b128 v[152:155], v42 offset:12288
  s_add_u32 s98, s35, 2490368
  buffer_load_dwordx4 a[164:167], v91, s[48:51], s98 offen sc1
  s_add_u32 s98, s35, 2555904
  buffer_load_dwordx4 a[168:171], v91, s[48:51], s98 offen sc1
  v_and_b32 v121, 0xffff0000, v121
  v_lshlrev_b32 v122, 16, v123
  v_and_b32 v123, 0xffff0000, v123
  v_add_f32 v180, v180, v104
  v_add_f32 v181, v181, v105
  v_add_f32 v182, v182, v106
  v_add_f32 v183, v183, v107
  v_add_f32 v184, v184, v108
  v_add_f32 v185, v185, v109
  v_add_f32 v186, v186, v110
  v_add_f32 v187, v187, v111
  v_add_f32 v188, v188, v112
  v_add_f32 v189, v189, v113
  v_add_f32 v190, v190, v114
  v_add_f32 v191, v191, v115
  v_add_f32 v192, v192, v116
  v_add_f32 v193, v193, v117
  v_add_f32 v194, v194, v118
  v_add_f32 v195, v195, v119
  v_add_f32 v196, v196, v120
  v_add_f32 v197, v197, v121
  v_add_f32 v198, v198, v122
  v_add_f32 v199, v199, v123
  s_waitcnt vmcnt(15) lgkmcnt(6)
  v_mfma_f32_16x16x32_bf16 v[220:223], v[128:131], a[116:119], v[220:223]
  ds_read_b128 v[156:159], v42 offset:13312
  s_add_u32 s98, s35, 2621440
  buffer_load_dwordx4 a[172:175], v91, s[48:51], s98 offen sc1
  s_add_u32 s98, s35, 2686976
  buffer_load_dwordx4 a[176:179], v91, s[48:51], s98 offen sc1
  s_waitcnt lgkmcnt(6)
  v_mfma_f32_16x16x32_bf16 v[228:231], v[132:135], a[116:119], v[228:231]
  ds_read_b128 v[160:163], v42 offset:14336
  s_add_u32 s98, s35, 2752512
  buffer_load_dwordx4 a[180:183], v91, s[48:51], s98 offen sc1
  s_waitcnt lgkmcnt(6)
  v_mfma_f32_16x16x32_bf16 v[236:239], v[136:139], a[116:119], v[236:239]
  ds_read_b128 v[164:167], v42 offset:15360
  s_waitcnt lgkmcnt(6)
  v_mfma_f32_16x16x32_bf16 v[244:247], v[140:143], a[116:119], v[244:247]
  s_barrier
  ds_read_b128 v[128:131], v40 offset:0
  s_waitcnt lgkmcnt(6)
  v_mfma_f32_16x16x32_bf16 v[252:255], v[144:147], a[116:119], v[252:255]
  ds_read_b128 v[132:135], v40 offset:1024
  s_waitcnt vmcnt(17) lgkmcnt(6)
  v_mfma_f32_16x16x32_bf16 v[220:223], v[148:151], a[120:123], v[220:223]
  ds_read_b128 v[136:139], v40 offset:2048
  s_add_u32 m0, s29, 90112
  s_add_u32 s15, s99, 3608576
  buffer_load_dwordx4 v35, s[52:55], s15 offen offset:0 sc1 lds
  s_waitcnt lgkmcnt(6)
  v_mfma_f32_16x16x32_bf16 v[228:231], v[152:155], a[120:123], v[228:231]
  ds_read_b128 v[140:143], v40 offset:3072
  s_waitcnt lgkmcnt(6)
  v_mfma_f32_16x16x32_bf16 v[236:239], v[156:159], a[120:123], v[236:239]
  ds_read_b128 v[144:147], v40 offset:4096
  s_waitcnt lgkmcnt(6)
  v_mfma_f32_16x16x32_bf16 v[244:247], v[160:163], a[120:123], v[244:247]
  ds_read_b128 v[148:151], v40 offset:5120
  s_waitcnt lgkmcnt(6)
  v_mfma_f32_16x16x32_bf16 v[252:255], v[164:167], a[120:123], v[252:255]
  ds_read_b128 v[152:155], v40 offset:6144
  s_waitcnt vmcnt(17) lgkmcnt(6)
  v_mfma_f32_16x16x32_bf16 v[220:223], v[128:131], a[124:127], v[220:223]
  ds_read_b128 v[156:159], v40 offset:7168
  s_add_u32 s98, s35, 2818048
  buffer_load_dwordx4 a[184:187], v91, s[48:51], s98 offen sc1
  s_waitcnt lgkmcnt(6)
  v_mfma_f32_16x16x32_bf16 v[228:231], v[132:135], a[124:127], v[228:231]
  ds_read_b128 v[160:163], v40 offset:8192
  s_waitcnt lgkmcnt(6)
  v_mfma_f32_16x16x32_bf16 v[236:239], v[136:139], a[124:127], v[236:239]
  ds_read_b128 v[164:167], v40 offset:9216
  s_waitcnt lgkmcnt(6)
  v_mfma_f32_16x16x32_bf16 v[244:247], v[140:143], a[124:127], v[244:247]
  ds_read_b128 v[128:131], v40 offset:10240
  s_waitcnt lgkmcnt(6)
  v_mfma_f32_16x16x32_bf16 v[252:255], v[144:147], a[124:127], v[252:255]
  ds_read_b128 v[132:135], v40 offset:11264
  s_waitcnt vmcnt(17) lgkmcnt(6)
  v_mfma_f32_16x16x32_bf16 v[220:223], v[148:151], a[128:131], v[220:223]
  ds_read_b128 v[136:139], v40 offset:12288
  s_add_u32 s98, s35, 2883584
  buffer_load_dwordx4 a[188:191], v91, s[48:51], s98 offen sc1
  s_waitcnt lgkmcnt(6)
  v_mfma_f32_16x16x32_bf16 v[228:231], v[152:155], a[128:131], v[228:231]
  ds_read_b128 v[140:143], v40 offset:13312
  s_waitcnt lgkmcnt(6)
  v_mfma_f32_16x16x32_bf16 v[236:239], v[156:159], a[128:131], v[236:239]
  ds_read_b128 v[144:147], v40 offset:14336
  s_waitcnt lgkmcnt(6)
  v_mfma_f32_16x16x32_bf16 v[244:247], v[160:163], a[128:131], v[244:247]
  ds_read_b128 v[148:151], v40 offset:15360
  s_waitcnt lgkmcnt(6)
  v_mfma_f32_16x16x32_bf16 v[252:255], v[164:167], a[128:131], v[252:255]
  ds_read_b128 v[152:155], v40 offset:16384
  s_waitcnt vmcnt(17) lgkmcnt(6)
  v_mfma_f32_16x16x32_bf16 v[220:223], v[128:131], a[132:135], v[220:223]
  ds_read_b128 v[156:159], v40 offset:17408
  s_add_u32 s98, s35, 2949120
  buffer_load_dwordx4 a[192:195], v91, s[48:51], s98 offen sc1
  s_waitcnt lgkmcnt(6)
  v_mfma_f32_16x16x32_bf16 v[228:231], v[132:135], a[132:135], v[228:231]
  ds_read_b128 v[160:163], v40 offset:18432
  s_waitcnt lgkmcnt(6)
  v_mfma_f32_16x16x32_bf16 v[236:239], v[136:139], a[132:135], v[236:239]
  ds_read_b128 v[164:167], v40 offset:19456
  s_waitcnt lgkmcnt(6)
  v_mfma_f32_16x16x32_bf16 v[244:247], v[140:143], a[132:135], v[244:247]
  s_barrier
  ds_read_b128 v[128:131], v40 offset:20480
  s_waitcnt lgkmcnt(6)
  v_mfma_f32_16x16x32_bf16 v[252:255], v[144:147], a[132:135], v[252:255]
  ds_read_b128 v[132:135], v40 offset:21504
  s_waitcnt vmcnt(17) lgkmcnt(6)
  v_mfma_f32_16x16x32_bf16 v[220:223], v[148:151], a[136:139], v[220:223]
  ds_read_b128 v[136:139], v40 offset:22528
  s_add_u32 s98, s35, 3014656
  buffer_load_dwordx4 a[196:199], v91, s[48:51], s98 offen sc1
  s_waitcnt lgkmcnt(6)
  v_mfma_f32_16x16x32_bf16 v[228:231], v[152:155], a[136:139], v[228:231]
  ds_read_b128 v[140:143], v40 offset:23552
  s_waitcnt lgkmcnt(6)
  v_mfma_f32_16x16x32_bf16 v[236:239], v[156:159], a[136:139], v[236:239]
  ds_read_b128 v[144:147], v40 offset:24576
  s_waitcnt lgkmcnt(6)
  v_mfma_f32_16x16x32_bf16 v[244:247], v[160:163], a[136:139], v[244:247]
  ds_read_b128 v[148:151], v40 offset:25600
  s_waitcnt lgkmcnt(6)
  v_mfma_f32_16x16x32_bf16 v[252:255], v[164:167], a[136:139], v[252:255]
  ds_read_b128 v[152:155], v40 offset:26624
  s_waitcnt vmcnt(17) lgkmcnt(6)
  v_mfma_f32_16x16x32_bf16 v[220:223], v[128:131], a[140:143], v[220:223]
  ds_read_b128 v[156:159], v40 offset:27648
  s_add_u32 s98, s35, 1703936
  buffer_load_dwordx4 a[200:203], v90, s[48:51], s98 offen sc1
  s_waitcnt lgkmcnt(6)
  v_mfma_f32_16x16x32_bf16 v[228:231], v[132:135], a[140:143], v[228:231]
  ds_read_b128 v[160:163], v40 offset:28672
  s_waitcnt lgkmcnt(6)
  v_mfma_f32_16x16x32_bf16 v[236:239], v[136:139], a[140:143], v[236:239]
  ds_read_b128 v[164:167], v40 offset:29696
  s_waitcnt lgkmcnt(6)
  v_mfma_f32_16x16x32_bf16 v[244:247], v[140:143], a[140:143], v[244:247]
  ds_read_b128 v[128:131], v40 offset:30720
  s_waitcnt lgkmcnt(6)
  v_mfma_f32_16x16x32_bf16 v[252:255], v[144:147], a[140:143], v[252:255]
  ds_read_b128 v[132:135], v40 offset:31744
  s_waitcnt vmcnt(17) lgkmcnt(6)
  v_mfma_f32_16x16x32_bf16 v[220:223], v[148:151], a[144:147], v[220:223]
  ds_read_b128 v[136:139], v40 offset:32768
  s_add_u32 s98, s35, 1769472
  buffer_load_dwordx4 a[204:207], v90, s[48:51], s98 offen sc1
  s_waitcnt lgkmcnt(6)
  v_mfma_f32_16x16x32_bf16 v[228:231], v[152:155], a[144:147], v[228:231]
  ds_read_b128 v[140:143], v40 offset:33792
  s_waitcnt lgkmcnt(6)
  v_mfma_f32_16x16x32_bf16 v[236:239], v[156:159], a[144:147], v[236:239]
  ds_read_b128 v[144:147], v40 offset:34816
  s_waitcnt lgkmcnt(6)
  v_mfma_f32_16x16x32_bf16 v[244:247], v[160:163], a[144:147], v[244:247]
  ds_read_b128 v[148:151], v40 offset:35840
  s_waitcnt lgkmcnt(6)
  v_mfma_f32_16x16x32_bf16 v[252:255], v[164:167], a[144:147], v[252:255]
  ds_read_b128 v[152:155], v40 offset:36864
  s_waitcnt vmcnt(16) lgkmcnt(6)
  v_mfma_f32_16x16x32_bf16 v[220:223], v[128:131], a[148:151], v[220:223]
  ds_read_b128 v[156:159], v40 offset:37888
  s_add_u32 s98, s35, 1835008
  buffer_load_dwordx4 a[208:211], v90, s[48:51], s98 offen sc1
  s_waitcnt lgkmcnt(6)
  v_mfma_f32_16x16x32_bf16 v[228:231], v[132:135], a[148:151], v[228:231]
  ds_read_b128 v[160:163], v40 offset:38912
  s_waitcnt lgkmcnt(6)
  v_mfma_f32_16x16x32_bf16 v[236:239], v[136:139], a[148:151], v[236:239]
  ds_read_b128 v[164:167], v40 offset:39936
  s_waitcnt lgkmcnt(6)
  v_mfma_f32_16x16x32_bf16 v[244:247], v[140:143], a[148:151], v[244:247]
  s_barrier
  ds_read_b128 v[128:131], v35 offset:40960
  s_waitcnt lgkmcnt(6)
  v_mfma_f32_16x16x32_bf16 v[252:255], v[144:147], a[148:151], v[252:255]
  ds_read_b128 v[132:135], v35 offset:41984
  s_waitcnt vmcnt(16) lgkmcnt(6)
  v_mfma_f32_16x16x32_bf16 v[220:223], v[148:151], a[152:155], v[220:223]
  ds_read_b128 v[136:139], v35 offset:43008
  s_add_u32 s98, s35, 1900544
  buffer_load_dwordx4 a[212:215], v90, s[48:51], s98 offen sc1
  s_waitcnt lgkmcnt(6)
  v_mfma_f32_16x16x32_bf16 v[228:231], v[152:155], a[152:155], v[228:231]
  ds_read_b128 v[140:143], v35 offset:44032
  s_waitcnt lgkmcnt(6)
  v_mfma_f32_16x16x32_bf16 v[236:239], v[156:159], a[152:155], v[236:239]
  ds_read_b128 v[144:147], v35 offset:45056
  s_waitcnt lgkmcnt(6)
  v_mfma_f32_16x16x32_bf16 v[244:247], v[160:163], a[152:155], v[244:247]
  ds_read_b128 v[148:151], v35 offset:46080
  s_waitcnt lgkmcnt(6)
  v_mfma_f32_16x16x32_bf16 v[252:255], v[164:167], a[152:155], v[252:255]
  ds_read_b128 v[152:155], v35 offset:47104
  s_waitcnt vmcnt(16) lgkmcnt(6)
  v_mfma_f32_16x16x32_bf16 v[220:223], v[128:131], a[156:159], v[220:223]
  ds_read_b128 v[156:159], v35 offset:48128
  s_add_u32 s98, s35, 1966080
  buffer_load_dwordx4 a[216:219], v90, s[48:51], s98 offen sc1
  s_waitcnt lgkmcnt(6)
  v_mfma_f32_16x16x32_bf16 v[228:231], v[132:135], a[156:159], v[228:231]
  ds_read_b128 v[160:163], v35 offset:49152
  s_waitcnt lgkmcnt(6)
  v_mfma_f32_16x16x32_bf16 v[236:239], v[136:139], a[156:159], v[236:239]
  ds_read_b128 v[164:167], v35 offset:50176
  s_waitcnt lgkmcnt(6)
  v_mfma_f32_16x16x32_bf16 v[244:247], v[140:143], a[156:159], v[244:247]
  ds_read_b128 v[128:131], v35 offset:51200
  s_waitcnt lgkmcnt(6)
  v_mfma_f32_16x16x32_bf16 v[252:255], v[144:147], a[156:159], v[252:255]
  ds_read_b128 v[132:135], v35 offset:52224
  s_waitcnt vmcnt(16) lgkmcnt(6)
  v_mfma_f32_16x16x32_bf16 v[220:223], v[148:151], a[160:163], v[220:223]
  ds_read_b128 v[136:139], v35 offset:53248
  s_add_u32 s98, s35, 2031616
  buffer_load_dwordx4 a[220:223], v90, s[48:51], s98 offen sc1
  s_waitcnt lgkmcnt(6)
  v_mfma_f32_16x16x32_bf16 v[228:231], v[152:155], a[160:163], v[228:231]
  ds_read_b128 v[140:143], v35 offset:54272
  s_waitcnt lgkmcnt(6)
  v_mfma_f32_16x16x32_bf16 v[236:239], v[156:159], a[160:163], v[236:239]
  ds_read_b128 v[144:147], v35 offset:55296
  s_waitcnt lgkmcnt(6)
  v_mfma_f32_16x16x32_bf16 v[244:247], v[160:163], a[160:163], v[244:247]
  ds_read_b128 v[148:151], v35 offset:56320
  s_waitcnt lgkmcnt(6)
  v_mfma_f32_16x16x32_bf16 v[252:255], v[164:167], a[160:163], v[252:255]
  ds_read_b128 v[152:155], v35 offset:57344
  s_waitcnt vmcnt(15) lgkmcnt(6)
  v_mfma_f32_16x16x32_bf16 v[220:223], v[128:131], a[164:167], v[220:223]
  ds_read_b128 v[156:159], v35 offset:58368
  s_add_u32 s98, s35, 2097152
  buffer_load_dwordx4 a[224:227], v90, s[48:51], s98 offen sc1
  s_waitcnt lgkmcnt(6)
  v_mfma_f32_16x16x32_bf16 v[228:231], v[132:135], a[164:167], v[228:231]
  ds_read_b128 v[160:163], v35 offset:59392
  s_waitcnt lgkmcnt(6)
  v_mfma_f32_16x16x32_bf16 v[236:239], v[136:139], a[164:167], v[236:239]
  ds_read_b128 v[164:167], v35 offset:60416
  s_waitcnt lgkmcnt(6)
  v_mfma_f32_16x16x32_bf16 v[244:247], v[140:143], a[164:167], v[244:247]
  s_barrier
  ds_read_b128 v[128:131], v37 offset:0
  s_add_u32 s98, s35, 2162688
  buffer_load_dwordx4 a[228:231], v90, s[48:51], s98 offen sc1
  s_waitcnt lgkmcnt(6)
  v_mfma_f32_16x16x32_bf16 v[252:255], v[144:147], a[164:167], v[252:255]
  ds_read_b128 v[132:135], v37 offset:1024
  s_waitcnt vmcnt(16) lgkmcnt(6)
  v_mfma_f32_16x16x32_bf16 v[220:223], v[148:151], a[168:171], v[220:223]
  ds_read_b128 v[136:139], v37 offset:2048
L_pgs6:
  s_cbranch_execz L_pgsr
  s_waitcnt lgkmcnt(6)
  v_mfma_f32_16x16x32_bf16 v[228:231], v[152:155], a[168:171], v[228:231]
  ds_read_b128 v[140:143], v37 offset:3072
  s_add_u32 s98, s35, 2228224
  buffer_load_dwordx4 a[232:235], v90, s[48:51], s98 offen sc1
  s_waitcnt lgkmcnt(6)
  v_mfma_f32_16x16x32_bf16 v[236:239], v[156:159], a[168:171], v[236:239]
  ds_read_b128 v[144:147], v37 offset:4096
  s_waitcnt lgkmcnt(6)
  v_mfma_f32_16x16x32_bf16 v[244:247], v[160:163], a[168:171], v[244:247]
  ds_read_b128 v[148:151], v37 offset:5120
  s_waitcnt lgkmcnt(6)
  v_mfma_f32_16x16x32_bf16 v[252:255], v[164:167], a[168:171], v[252:255]
  ds_read_b128 v[152:155], v37 offset:6144
  s_add_u32 s98, s35, 2293760
  buffer_load_dwordx4 a[236:239], v90, s[48:51], s98 offen sc1
  s_waitcnt vmcnt(17) lgkmcnt(6)
  v_mfma_f32_16x16x32_bf16 v[220:223], v[128:131], a[172:175], v[220:223]
  ds_read_b128 v[156:159], v37 offset:7168
  s_waitcnt lgkmcnt(6)
  v_mfma_f32_16x16x32_bf16 v[228:231], v[132:135], a[172:175], v[228:231]
  ds_read_b128 v[160:163], v37 offset:8192
  s_waitcnt lgkmcnt(6)
  v_mfma_f32_16x16x32_bf16 v[236:239], v[136:139], a[172:175], v[236:239]
  ds_read_b128 v[164:167], v37 offset:9216
  s_add_u32 s98, s35, 2359296
  buffer_load_dwordx4 a[240:243], v90, s[48:51], s98 offen sc1
  s_waitcnt lgkmcnt(6)
  v_mfma_f32_16x16x32_bf16 v[244:247], v[140:143], a[172:175], v[244:247]
  ds_read_b128 v[128:131], v37 offset:10240
  s_waitcnt lgkmcnt(6)
  v_mfma_f32_16x16x32_bf16 v[252:255], v[144:147], a[172:175], v[252:255]
  ds_read_b128 v[132:135], v37 offset:11264
  s_waitcnt vmcnt(17) lgkmcnt(6)
  v_mfma_f32_16x16x32_bf16 v[220:223], v[148:151], a[176:179], v[220:223]
  ds_read_b128 v[136:139], v37 offset:12288
  s_add_u32 s98, s35, 2424832
  buffer_load_dwordx4 a[244:247], v90, s[48:51], s98 offen sc1
  s_waitcnt lgkmcnt(6)
  v_mfma_f32_16x16x32_bf16 v[228:231], v[152:155], a[176:179], v[228:231]
  ds_read_b128 v[140:143], v37 offset:13312
  s_waitcnt lgkmcnt(6)
  v_mfma_f32_16x16x32_bf16 v[236:239], v[156:159], a[176:179], v[236:239]
  ds_read_b128 v[144:147], v37 offset:14336
  s_add_u32 s98, s35, 2490368
  buffer_load_dwordx4 a[248:251], v90, s[48:51], s98 offen sc1
  s_waitcnt lgkmcnt(6)
  v_mfma_f32_16x16x32_bf16 v[244:247], v[160:163], a[176:179], v[244:247]
  ds_read_b128 v[148:151], v37 offset:15360
  s_waitcnt lgkmcnt(6)
  v_mfma_f32_16x16x32_bf16 v[252:255], v[164:167], a[176:179], v[252:255]
  ds_read_b128 v[152:155], v37 offset:16384
  s_waitcnt vmcnt(18) lgkmcnt(6)
  v_mfma_f32_16x16x32_bf16 v[220:223], v[128:131], a[180:183], v[220:223]
  ds_read_b128 v[156:159], v37 offset:17408
  s_add_u32 s98, s35, 2555904
  buffer_load_dwordx4 a[0:3], v90, s[48:51], s98 offen sc1
  s_waitcnt lgkmcnt(6)
  v_mfma_f32_16x16x32_bf16 v[228:231], v[132:135], a[180:183], v[228:231]
  ds_read_b128 v[160:163], v37 offset:18432
  s_waitcnt lgkmcnt(6)
  v_mfma_f32_16x16x32_bf16 v[236:239], v[136:139], a[180:183], v[236:239]
  ds_read_b128 v[164:167], v37 offset:19456
  s_waitcnt lgkmcnt(6)
  v_mfma_f32_16x16x32_bf16 v[244:247], v[140:143], a[180:183], v[244:247]
  s_waitcnt vmcnt(18)
  s_barrier
  ds_read_b128 v[128:131], v37 offset:20480
  s_add_u32 s98, s35, 2621440
  buffer_load_dwordx4 a[4:7], v90, s[48:51], s98 offen sc1
  s_waitcnt lgkmcnt(6)
  v_mfma_f32_16x16x32_bf16 v[252:255], v[144:147], a[180:183], v[252:255]
  ds_read_b128 v[132:135], v37 offset:21504
  s_waitcnt vmcnt(18) lgkmcnt(6)
  v_mfma_f32_16x16x32_bf16 v[220:223], v[148:151], a[184:187], v[220:223]
  ds_read_b128 v[136:139], v37 offset:22528
  s_waitcnt lgkmcnt(6)
  v_mfma_f32_16x16x32_bf16 v[228:231], v[152:155], a[184:187], v[228:231]
  ds_read_b128 v[140:143], v37 offset:23552
  s_add_u32 s98, s35, 2686976
  buffer_load_dwordx4 a[8:11], v90, s[48:51], s98 offen sc1
  s_waitcnt lgkmcnt(6)
  v_mfma_f32_16x16x32_bf16 v[236:239], v[156:159], a[184:187], v[236:239]
  ds_read_b128 v[144:147], v37 offset:24576
  s_waitcnt lgkmcnt(6)
  v_mfma_f32_16x16x32_bf16 v[244:247], v[160:163], a[184:187], v[244:247]
  ds_read_b128 v[148:151], v37 offset:25600
  s_waitcnt lgkmcnt(6)
  v_mfma_f32_16x16x32_bf16 v[252:255], v[164:167], a[184:187], v[252:255]
  ds_read_b128 v[152:155], v37 offset:26624
  s_add_u32 s98, s35, 2752512
  buffer_load_dwordx4 a[12:15], v90, s[48:51], s98 offen sc1
  s_waitcnt vmcnt(19) lgkmcnt(6)
  v_mfma_f32_16x16x32_bf16 v[220:223], v[128:131], a[188:191], v[220:223]
  ds_read_b128 v[156:159], v37 offset:27648
  s_waitcnt lgkmcnt(6)
  v_mfma_f32_16x16x32_bf16 v[228:231], v[132:135], a[188:191], v[228:231]
  ds_read_b128 v[160:163], v37 offset:28672
  s_waitcnt lgkmcnt(6)
  v_mfma_f32_16x16x32_bf16 v[236:239], v[136:139], a[188:191], v[236:239]
  ds_read_b128 v[164:167], v37 offset:29696
  s_add_u32 s98, s35, 2818048
  buffer_load_dwordx4 a[16:19], v90, s[48:51], s98 offen sc1
  s_waitcnt lgkmcnt(6)
  v_mfma_f32_16x16x32_bf16 v[244:247], v[140:143], a[188:191], v[244:247]
  ds_read_b128 v[128:131], v37 offset:30720
  s_waitcnt lgkmcnt(6)
  v_mfma_f32_16x16x32_bf16 v[252:255], v[144:147], a[188:191], v[252:255]
  ds_read_b128 v[132:135], v37 offset:31744
  s_waitcnt vmcnt(19) lgkmcnt(6)
  v_mfma_f32_16x16x32_bf16 v[220:223], v[148:151], a[192:195], v[220:223]
  ds_read_b128 v[136:139], v37 offset:32768
  s_add_u32 s98, s35, 2883584
  buffer_load_dwordx4 a[20:23], v90, s[48:51], s98 offen sc1
  s_waitcnt lgkmcnt(6)
  v_mfma_f32_16x16x32_bf16 v[228:231], v[152:155], a[192:195], v[228:231]
  ds_read_b128 v[140:143], v37 offset:33792
  s_waitcnt lgkmcnt(6)
  v_mfma_f32_16x16x32_bf16 v[236:239], v[156:159], a[192:195], v[236:239]
  ds_read_b128 v[144:147], v37 offset:34816
  s_waitcnt lgkmcnt(6)
  v_mfma_f32_16x16x32_bf16 v[244:247], v[160:163], a[192:195], v[244:247]
  ds_read_b128 v[148:151], v42 offset:6144
  s_add_u32 s98, s35, 2949120
  buffer_load_dwordx4 a[24:27], v90, s[48:51], s98 offen sc1
  s_waitcnt lgkmcnt(6)
  v_mfma_f32_16x16x32_bf16 v[252:255], v[164:167], a[192:195], v[252:255]
  ds_read_b128 v[152:155], v42 offset:7168
  s_waitcnt vmcnt(20) lgkmcnt(6)
  v_mfma_f32_16x16x32_bf16 v[220:223], v[128:131], a[196:199], v[220:223]
  ds_read_b128 v[156:159], v42 offset:8192
  s_add_u32 s98, s35, 3014656
  buffer_load_dwordx4 a[28:31], v90, s[48:51], s98 offen sc1
  s_waitcnt lgkmcnt(6)
  v_mfma_f32_16x16x32_bf16 v[228:231], v[132:135], a[196:199], v[228:231]
  ds_read_b128 v[160:163], v42 offset:9216
  s_waitcnt lgkmcnt(6)
  v_mfma_f32_16x16x32_bf16 v[236:239], v[136:139], a[196:199], v[236:239]
  ds_read_b128 v[164:167], v42 offset:10240
  s_waitcnt lgkmcnt(6)
  v_mfma_f32_16x16x32_bf16 v[244:247], v[140:143], a[196:199], v[244:247]
  ds_read_b128 v[128:131], v42 offset:11264
  s_waitcnt lgkmcnt(6)
  v_mfma_f32_16x16x32_bf16 v[252:255], v[144:147], a[196:199], v[252:255]
  ds_read_b128 v[132:135], v42 offset:12288
  s_waitcnt vmcnt(20) lgkmcnt(6)
  v_mfma_f32_16x16x32_bf16 v[216:219], v[148:151], a[200:203], v[216:219]
  ds_read_b128 v[136:139], v42 offset:13312
  s_waitcnt lgkmcnt(6)
  v_mfma_f32_16x16x32_bf16 v[224:227], v[152:155], a[200:203], v[224:227]
  ds_read_b128 v[140:143], v42 offset:14336
  v_bfi_b32 v220, v39, s68, v220
  v_bfi_b32 v221, v39, s69, v221
  v_bfi_b32 v222, v39, s70, v222
  s_waitcnt lgkmcnt(6)
  v_mfma_f32_16x16x32_bf16 v[232:235], v[156:159], a[200:203], v[232:235]
  ds_read_b128 v[144:147], v42 offset:15360
  v_bfi_b32 v223, v39, s71, v223
  buffer_store_dwordx4 v[220:223], v43, s[56:59], s87 offen offset:0 sc1
  v_bfi_b32 v228, v39, s68, v228
  s_waitcnt lgkmcnt(6)
  v_mfma_f32_16x16x32_bf16 v[240:243], v[160:163], a[200:203], v[240:243]
  ds_read_b128 v[148:151], v40 offset:0
  v_bfi_b32 v229, v39, s69, v229
  v_bfi_b32 v230, v39, s70, v230
  v_bfi_b32 v231, v39, s71, v231
  s_waitcnt lgkmcnt(6)
  v_mfma_f32_16x16x32_bf16 v[248:251], v[164:167], a[200:203], v[248:251]
  ds_read_b128 v[152:155], v40 offset:1024
  buffer_store_dwordx4 v[228:231], v43, s[56:59], s87 offen offset:1024 sc1
  v_bfi_b32 v236, v39, s68, v236
  s_waitcnt vmcnt(21) lgkmcnt(6)
  v_mfma_f32_16x16x32_bf16 v[216:219], v[128:131], a[204:207], v[216:219]
  ds_read_b128 v[156:159], v40 offset:2048
  v_bfi_b32 v237, v39, s69, v237
  v_bfi_b32 v238, v39, s70, v238
  s_waitcnt lgkmcnt(6)
  v_mfma_f32_16x16x32_bf16 v[224:227], v[132:135], a[204:207], v[224:227]
  ds_read_b128 v[160:163], v40 offset:3072
  v_bfi_b32 v239, v39, s71, v239
  buffer_store_dwordx4 v[236:239], v43, s[56:59], s87 offen offset:2048 sc1
  s_waitcnt lgkmcnt(6)
  v_mfma_f32_16x16x32_bf16 v[232:235], v[136:139], a[204:207], v[232:235]
  ds_read_b128 v[164:167], v40 offset:4096
  v_bfi_b32 v244, v39, s68, v244
  v_bfi_b32 v245, v39, s69, v245
  s_waitcnt lgkmcnt(6)
  v_mfma_f32_16x16x32_bf16 v[240:243], v[140:143], a[204:207], v[240:243]
  ds_read_b128 v[128:131], v40 offset:5120
  v_bfi_b32 v246, v39, s70, v246
  v_bfi_b32 v247, v39, s71, v247
  s_waitcnt lgkmcnt(6)
  v_mfma_f32_16x16x32_bf16 v[248:251], v[144:147], a[204:207], v[248:251]
  ds_read_b128 v[132:135], v40 offset:6144
  s_barrier
  buffer_store_dwordx4 v[244:247], v43, s[56:59], s87 offen offset:3072 sc1
  v_bfi_b32 v252, v39, s68, v252
  s_waitcnt vmcnt(22) lgkmcnt(6)
  v_mfma_f32_16x16x32_bf16 v[216:219], v[148:151], a[208:211], v[216:219]
  ds_read_b128 v[136:139], v40 offset:7168
  v_bfi_b32 v253, v39, s69, v253
  v_bfi_b32 v254, v39, s70, v254
  s_waitcnt lgkmcnt(6)
  v_mfma_f32_16x16x32_bf16 v[224:227], v[152:155], a[208:211], v[224:227]
  ds_read_b128 v[140:143], v40 offset:8192
  v_bfi_b32 v255, v39, s71, v255
  buffer_store_dwordx4 v[252:255], v43, s[56:59], s62 offen offset:0 sc1
  s_waitcnt lgkmcnt(6)
  v_mfma_f32_16x16x32_bf16 v[232:235], v[156:159], a[208:211], v[232:235]
  ds_read_b128 v[144:147], v40 offset:9216
  s_waitcnt lgkmcnt(6)
  v_mfma_f32_16x16x32_bf16 v[240:243], v[160:163], a[208:211], v[240:243]
  ds_read_b128 v[148:151], v40 offset:10240
  s_waitcnt lgkmcnt(6)
  v_mfma_f32_16x16x32_bf16 v[248:251], v[164:167], a[208:211], v[248:251]
  ds_read_b128 v[152:155], v40 offset:11264
  s_waitcnt vmcnt(22) lgkmcnt(6)
  v_mfma_f32_16x16x32_bf16 v[216:219], v[128:131], a[212:215], v[216:219]
  ds_read_b128 v[156:159], v40 offset:12288
  s_waitcnt lgkmcnt(6)
  v_mfma_f32_16x16x32_bf16 v[224:227], v[132:135], a[212:215], v[224:227]
  ds_read_b128 v[160:163], v40 offset:13312
  s_waitcnt lgkmcnt(6)
  v_mfma_f32_16x16x32_bf16 v[232:235], v[136:139], a[212:215], v[232:235]
  ds_read_b128 v[164:167], v40 offset:14336
  s_waitcnt lgkmcnt(6)
  v_mfma_f32_16x16x32_bf16 v[240:243], v[140:143], a[212:215], v[240:243]
  ds_read_b128 v[128:131], v40 offset:15360
  s_waitcnt lgkmcnt(6)
  v_mfma_f32_16x16x32_bf16 v[248:251], v[144:147], a[212:215], v[248:251]
  ds_read_b128 v[132:135], v40 offset:16384
  s_waitcnt vmcnt(21) lgkmcnt(6)
  v_mfma_f32_16x16x32_bf16 v[216:219], v[148:151], a[216:219], v[216:219]
  ds_read_b128 v[136:139], v40 offset:17408
  s_waitcnt lgkmcnt(6)
  v_mfma_f32_16x16x32_bf16 v[224:227], v[152:155], a[216:219], v[224:227]
  ds_read_b128 v[140:143], v40 offset:18432
  s_waitcnt lgkmcnt(6)
  v_mfma_f32_16x16x32_bf16 v[232:235], v[156:159], a[216:219], v[232:235]
  ds_read_b128 v[144:147], v40 offset:19456
  s_waitcnt lgkmcnt(6)
  v_mfma_f32_16x16x32_bf16 v[240:243], v[160:163], a[216:219], v[240:243]
  ds_read_b128 v[148:151], v40 offset:20480
  s_waitcnt lgkmcnt(6)
  v_mfma_f32_16x16x32_bf16 v[248:251], v[164:167], a[216:219], v[248:251]
  ds_read_b128 v[152:155], v40 offset:21504
  s_waitcnt vmcnt(20) lgkmcnt(6)
  v_mfma_f32_16x16x32_bf16 v[216:219], v[128:131], a[220:223], v[216:219]
  ds_read_b128 v[156:159], v40 offset:22528
  s_waitcnt lgkmcnt(6)
  v_mfma_f32_16x16x32_bf16 v[224:227], v[132:135], a[220:223], v[224:227]
  ds_read_b128 v[160:163], v40 offset:23552
  s_waitcnt lgkmcnt(6)
  v_mfma_f32_16x16x32_bf16 v[232:235], v[136:139], a[220:223], v[232:235]
  ds_read_b128 v[164:167], v40 offset:24576
  s_waitcnt lgkmcnt(6)
  v_mfma_f32_16x16x32_bf16 v[240:243], v[140:143], a[220:223], v[240:243]
  ds_read_b128 v[128:131], v40 offset:25600
  s_waitcnt lgkmcnt(6)
  v_mfma_f32_16x16x32_bf16 v[248:251], v[144:147], a[220:223], v[248:251]
  ds_read_b128 v[132:135], v40 offset:26624
  s_waitcnt vmcnt(19) lgkmcnt(6)
  v_mfma_f32_16x16x32_bf16 v[216:219], v[148:151], a[224:227], v[216:219]
  ds_read_b128 v[136:139], v40 offset:27648
  s_waitcnt lgkmcnt(6)
  v_mfma_f32_16x16x32_bf16 v[224:227], v[152:155], a[224:227], v[224:227]
  ds_read_b128 v[140:143], v40 offset:28672
  s_waitcnt lgkmcnt(6)
  v_mfma_f32_16x16x32_bf16 v[232:235], v[156:159], a[224:227], v[232:235]
  ds_read_b128 v[144:147], v40 offset:29696
  s_waitcnt lgkmcnt(6)
  v_mfma_f32_16x16x32_bf16 v[240:243], v[160:163], a[224:227], v[240:243]
  ds_read_b128 v[148:151], v40 offset:30720
  s_waitcnt lgkmcnt(6)
  v_mfma_f32_16x16x32_bf16 v[248:251], v[164:167], a[224:227], v[248:251]
  ds_read_b128 v[152:155], v40 offset:31744
  s_waitcnt vmcnt(18) lgkmcnt(6)
  v_mfma_f32_16x16x32_bf16 v[216:219], v[128:131], a[228:231], v[216:219]
  ds_read_b128 v[156:159], v40 offset:32768
  s_waitcnt lgkmcnt(6)
  v_mfma_f32_16x16x32_bf16 v[224:227], v[132:135], a[228:231], v[224:227]
  ds_read_b128 v[160:163], v40 offset:33792
  s_waitcnt lgkmcnt(6)
  v_mfma_f32_16x16x32_bf16 v[232:235], v[136:139], a[228:231], v[232:235]
  ds_read_b128 v[164:167], v40 offset:34816
  s_waitcnt lgkmcnt(6)
  v_mfma_f32_16x16x32_bf16 v[240:243], v[140:143], a[228:231], v[240:243]
  ds_read_b128 v[128:131], v40 offset:35840
  s_waitcnt lgkmcnt(6)
  v_mfma_f32_16x16x32_bf16 v[248:251], v[144:147], a[228:231], v[248:251]
  ds_read_b128 v[132:135], v40 offset:36864
  s_waitcnt vmcnt(17) lgkmcnt(6)
  v_mfma_f32_16x16x32_bf16 v[216:219], v[148:151], a[232:235], v[216:219]
  ds_read_b128 v[136:139], v40 offset:37888
  s_waitcnt lgkmcnt(6)
  v_mfma_f32_16x16x32_bf16 v[224:227], v[152:155], a[232:235], v[224:227]
  ds_read_b128 v[140:143], v40 offset:38912
  s_waitcnt lgkmcnt(6)
  v_mfma_f32_16x16x32_bf16 v[232:235], v[156:159], a[232:235], v[232:235]
  ds_read_b128 v[144:147], v40 offset:39936
  s_waitcnt lgkmcnt(6)
  v_mfma_f32_16x16x32_bf16 v[240:243], v[160:163], a[232:235], v[240:243]
  ds_read_b128 v[148:151], v35 offset:40960
  s_waitcnt lgkmcnt(6)
  v_mfma_f32_16x16x32_bf16 v[248:251], v[164:167], a[232:235], v[248:251]
  ds_read_b128 v[152:155], v35 offset:41984
  s_waitcnt vmcnt(16) lgkmcnt(6)
  v_mfma_f32_16x16x32_bf16 v[216:219], v[128:131], a[236:239], v[216:219]
  ds_read_b128 v[156:159], v35 offset:43008
  s_waitcnt lgkmcnt(6)
  v_mfma_f32_16x16x32_bf16 v[224:227], v[132:135], a[236:239], v[224:227]
  ds_read_b128 v[160:163], v35 offset:44032
  s_waitcnt lgkmcnt(6)
  v_mfma_f32_16x16x32_bf16 v[232:235], v[136:139], a[236:239], v[232:235]
  ds_read_b128 v[164:167], v35 offset:45056
  s_waitcnt lgkmcnt(6)
  v_mfma_f32_16x16x32_bf16 v[240:243], v[140:143], a[236:239], v[240:243]
  ds_read_b128 v[128:131], v35 offset:46080
  s_waitcnt lgkmcnt(6)
  v_mfma_f32_16x16x32_bf16 v[248:251], v[144:147], a[236:239], v[248:251]
  ds_read_b128 v[132:135], v35 offset:47104
  s_waitcnt vmcnt(15) lgkmcnt(6)
  v_mfma_f32_16x16x32_bf16 v[216:219], v[148:151], a[240:243], v[216:219]
  ds_read_b128 v[136:139], v35 offset:48128
  s_waitcnt lgkmcnt(6)
  v_mfma_f32_16x16x32_bf16 v[224:227], v[152:155], a[240:243], v[224:227]
  ds_read_b128 v[140:143], v35 offset:49152
  s_waitcnt lgkmcnt(6)
  v_mfma_f32_16x16x32_bf16 v[232:235], v[156:159], a[240:243], v[232:235]
  ds_read_b128 v[144:147], v35 offset:50176
  s_waitcnt lgkmcnt(6)
  v_mfma_f32_16x16x32_bf16 v[240:243], v[160:163], a[240:243], v[240:243]
  ds_read_b128 v[148:151], v35 offset:51200
  s_waitcnt lgkmcnt(6)
  v_mfma_f32_16x16x32_bf16 v[248:251], v[164:167], a[240:243], v[248:251]
  ds_read_b128 v[152:155], v35 offset:52224
  s_waitcnt vmcnt(14) lgkmcnt(6)
  v_mfma_f32_16x16x32_bf16 v[216:219], v[128:131], a[244:247], v[216:219]
  ds_read_b128 v[156:159], v35 offset:53248
  s_waitcnt lgkmcnt(6)
  v_mfma_f32_16x16x32_bf16 v[224:227], v[132:135], a[244:247], v[224:227]
  ds_read_b128 v[160:163], v35 offset:54272
  s_waitcnt lgkmcnt(6)
  v_mfma_f32_16x16x32_bf16 v[232:235], v[136:139], a[244:247], v[232:235]
  ds_read_b128 v[164:167], v35 offset:55296
  s_waitcnt lgkmcnt(6)
  v_mfma_f32_16x16x32_bf16 v[240:243], v[140:143], a[244:247], v[240:243]
  ds_read_b128 v[128:131], v35 offset:56320
  s_waitcnt lgkmcnt(6)
  v_mfma_f32_16x16x32_bf16 v[248:251], v[144:147], a[244:247], v[248:251]
  ds_read_b128 v[132:135], v35 offset:57344
  s_waitcnt vmcnt(13) lgkmcnt(6)
  v_mfma_f32_16x16x32_bf16 v[216:219], v[148:151], a[248:251], v[216:219]
  ds_read_b128 v[136:139], v35 offset:58368
  s_waitcnt lgkmcnt(6)
  v_mfma_f32_16x16x32_bf16 v[224:227], v[152:155], a[248:251], v[224:227]
  ds_read_b128 v[140:143], v35 offset:59392
  s_waitcnt lgkmcnt(6)
  v_mfma_f32_16x16x32_bf16 v[232:235], v[156:159], a[248:251], v[232:235]
  ds_read_b128 v[144:147], v35 offset:60416
  s_waitcnt lgkmcnt(6)
  v_mfma_f32_16x16x32_bf16 v[240:243], v[160:163], a[248:251], v[240:243]
  ds_read_b128 v[148:151], v37 offset:0
  s_waitcnt lgkmcnt(6)
  v_mfma_f32_16x16x32_bf16 v[248:251], v[164:167], a[248:251], v[248:251]
  ds_read_b128 v[152:155], v37 offset:1024
  s_waitcnt vmcnt(12) lgkmcnt(6)
  v_mfma_f32_16x16x32_bf16 v[216:219], v[128:131], a[0:3], v[216:219]
  ds_read_b128 v[156:159], v37 offset:2048
  s_waitcnt lgkmcnt(6)
  v_mfma_f32_16x16x32_bf16 v[224:227], v[132:135], a[0:3], v[224:227]
  ds_read_b128 v[160:163], v37 offset:3072
  s_waitcnt lgkmcnt(6)
  v_mfma_f32_16x16x32_bf16 v[232:235], v[136:139], a[0:3], v[232:235]
  ds_read_b128 v[164:167], v37 offset:4096
  s_waitcnt lgkmcnt(6)
  v_mfma_f32_16x16x32_bf16 v[240:243], v[140:143], a[0:3], v[240:243]
  ds_read_b128 v[128:131], v37 offset:5120
  s_waitcnt lgkmcnt(6)
  v_mfma_f32_16x16x32_bf16 v[248:251], v[144:147], a[0:3], v[248:251]
  ds_read_b128 v[132:135], v37 offset:6144
  s_waitcnt vmcnt(11) lgkmcnt(6)
  v_mfma_f32_16x16x32_bf16 v[216:219], v[148:151], a[4:7], v[216:219]
  ds_read_b128 v[136:139], v37 offset:7168
  s_waitcnt lgkmcnt(6)
  v_mfma_f32_16x16x32_bf16 v[224:227], v[152:155], a[4:7], v[224:227]
  ds_read_b128 v[140:143], v37 offset:8192
  s_cmp_lg_u32 s7, 0
  s_cbranch_scc1 L_tka1
  s_add_u32 s95, s7, 0
  buffer_load_dword v204, v208, s[56:59], s95 offen sc1
  s_add_u32 s95, s7, 32768
  buffer_load_dword v205, v208, s[56:59], s95 offen sc1
  s_add_u32 s95, s7, 65536
  buffer_load_dword v206, v208, s[56:59], s95 offen sc1
  s_add_u32 s95, s7, 98304
  buffer_load_dword v207, v208, s[56:59], s95 offen sc1
L_tka1:
  s_add_u32 m0, s12, 5120
  s_nop 0
  buffer_load_dwordx4 v35, s[56:59], s88 offen offset:0 sc1 lds
  buffer_load_dwordx4 v35, s[56:59], s88 offen offset:1024 sc1 lds
  buffer_load_dwordx4 v35, s[56:59], s88 offen offset:2048 sc1 lds
  buffer_load_dwordx4 v35, s[56:59], s88 offen offset:3072 sc1 lds
  s_add_u32 m0, s12, 9216
  s_nop 0
  buffer_load_dwordx4 v35, s[56:59], s63 offen offset:0 sc1 lds
  s_waitcnt lgkmcnt(6)
  v_mfma_f32_16x16x32_bf16 v[232:235], v[156:159], a[4:7], v[232:235]
  ds_read_b128 v[144:147], v37 offset:9216
  s_waitcnt lgkmcnt(6)
  v_mfma_f32_16x16x32_bf16 v[240:243], v[160:163], a[4:7], v[240:243]
  ds_read_b128 v[148:151], v37 offset:10240
  s_waitcnt lgkmcnt(6)
  v_mfma_f32_16x16x32_bf16 v[248:251], v[164:167], a[4:7], v[248:251]
  ds_read_b128 v[152:155], v37 offset:11264
  s_waitcnt vmcnt(15) lgkmcnt(6)
  v_mfma_f32_16x16x32_bf16 v[216:219], v[128:131], a[8:11], v[216:219]
  ds_read_b128 v[156:159], v37 offset:12288
  s_waitcnt lgkmcnt(6)
  v_mfma_f32_16x16x32_bf16 v[224:227], v[132:135], a[8:11], v[224:227]
  ds_read_b128 v[160:163], v37 offset:13312
  s_waitcnt lgkmcnt(6)
  v_mfma_f32_16x16x32_bf16 v[232:235], v[136:139], a[8:11], v[232:235]
  ds_read_b128 v[164:167], v37 offset:14336
  s_waitcnt lgkmcnt(6)
  v_mfma_f32_16x16x32_bf16 v[240:243], v[140:143], a[8:11], v[240:243]
  ds_read_b128 v[128:131], v37 offset:15360
  s_waitcnt lgkmcnt(6)
  v_mfma_f32_16x16x32_bf16 v[248:251], v[144:147], a[8:11], v[248:251]
  ds_read_b128 v[132:135], v37 offset:16384
  s_waitcnt vmcnt(14) lgkmcnt(6)
  v_mfma_f32_16x16x32_bf16 v[216:219], v[148:151], a[12:15], v[216:219]
  ds_read_b128 v[136:139], v37 offset:17408
  s_waitcnt lgkmcnt(6)
  v_mfma_f32_16x16x32_bf16 v[224:227], v[152:155], a[12:15], v[224:227]
  ds_read_b128 v[140:143], v37 offset:18432
  s_waitcnt lgkmcnt(6)
  v_mfma_f32_16x16x32_bf16 v[232:235], v[156:159], a[12:15], v[232:235]
  ds_read_b128 v[144:147], v37 offset:19456
  s_waitcnt lgkmcnt(6)
  v_mfma_f32_16x16x32_bf16 v[240:243], v[160:163], a[12:15], v[240:243]
  ds_read_b128 v[148:151], v37 offset:20480
  s_waitcnt lgkmcnt(6)
  v_mfma_f32_16x16x32_bf16 v[248:251], v[164:167], a[12:15], v[248:251]
  ds_read_b128 v[152:155], v37 offset:21504
  s_waitcnt vmcnt(13) lgkmcnt(6)
  v_mfma_f32_16x16x32_bf16 v[216:219], v[128:131], a[16:19], v[216:219]
  ds_read_b128 v[156:159], v37 offset:22528
  s_waitcnt lgkmcnt(6)
  v_mfma_f32_16x16x32_bf16 v[224:227], v[132:135], a[16:19], v[224:227]
  ds_read_b128 v[160:163], v37 offset:23552
  s_waitcnt lgkmcnt(6)
  v_mfma_f32_16x16x32_bf16 v[232:235], v[136:139], a[16:19], v[232:235]
  ds_read_b128 v[164:167], v37 offset:24576
  s_waitcnt lgkmcnt(6)
  v_mfma_f32_16x16x32_bf16 v[240:243], v[140:143], a[16:19], v[240:243]
  ds_read_b128 v[128:131], v37 offset:25600
  s_waitcnt lgkmcnt(6)
  v_mfma_f32_16x16x32_bf16 v[248:251], v[144:147], a[16:19], v[248:251]
  ds_read_b128 v[132:135], v37 offset:26624
  s_waitcnt vmcnt(12) lgkmcnt(6)
  v_mfma_f32_16x16x32_bf16 v[216:219], v[148:151], a[20:23], v[216:219]
  ds_read_b128 v[136:139], v37 offset:27648
  s_waitcnt lgkmcnt(6)
  v_mfma_f32_16x16x32_bf16 v[224:227], v[152:155], a[20:23], v[224:227]
  ds_read_b128 v[140:143], v37 offset:28672
  s_waitcnt lgkmcnt(6)
  v_mfma_f32_16x16x32_bf16 v[232:235], v[156:159], a[20:23], v[232:235]
  ds_read_b128 v[144:147], v37 offset:29696
  s_waitcnt lgkmcnt(6)
  v_mfma_f32_16x16x32_bf16 v[240:243], v[160:163], a[20:23], v[240:243]
  ds_read_b128 v[148:151], v37 offset:30720
  s_waitcnt lgkmcnt(6)
  v_mfma_f32_16x16x32_bf16 v[248:251], v[164:167], a[20:23], v[248:251]
  ds_read_b128 v[152:155], v37 offset:31744
  s_waitcnt vmcnt(11) lgkmcnt(6)
  v_mfma_f32_16x16x32_bf16 v[216:219], v[128:131], a[24:27], v[216:219]
  ds_read_b128 v[156:159], v37 offset:32768
  s_waitcnt lgkmcnt(6)
  v_mfma_f32_16x16x32_bf16 v[224:227], v[132:135], a[24:27], v[224:227]
  ds_read_b128 v[160:163], v37 offset:33792
  s_waitcnt lgkmcnt(6)
  v_mfma_f32_16x16x32_bf16 v[232:235], v[136:139], a[24:27], v[232:235]
  ds_read_b128 v[164:167], v37 offset:34816
  s_waitcnt lgkmcnt(6)
  v_mfma_f32_16x16x32_bf16 v[240:243], v[140:143], a[24:27], v[240:243]
  s_waitcnt lgkmcnt(5)
  v_mfma_f32_16x16x32_bf16 v[248:251], v[144:147], a[24:27], v[248:251]
  s_waitcnt vmcnt(10) lgkmcnt(4)
  v_mfma_f32_16x16x32_bf16 v[216:219], v[148:151], a[28:31], v[216:219]
  s_waitcnt lgkmcnt(3)
  v_mfma_f32_16x16x32_bf16 v[224:227], v[152:155], a[28:31], v[224:227]
  s_waitcnt lgkmcnt(2)
  v_mfma_f32_16x16x32_bf16 v[232:235], v[156:159], a[28:31], v[232:235]
  s_waitcnt lgkmcnt(1)
  v_mfma_f32_16x16x32_bf16 v[240:243], v[160:163], a[28:31], v[240:243]
  s_waitcnt lgkmcnt(0)
  v_mfma_f32_16x16x32_bf16 v[248:251], v[164:167], a[28:31], v[248:251]
  ds_write_b128 v44, v[216:219] offset:0
  s_nop 0
  ds_write_b128 v44, v[224:227] offset:1024
  s_nop 0
  ds_write_b128 v44, v[232:235] offset:2048
  s_nop 0
  ds_write_b128 v44, v[240:243] offset:3072
  s_nop 0
  ds_write_b128 v44, v[248:251] offset:4096
  ds_read_b128 v[104:107], v45 offset:0
  ds_read_b128 v[108:111], v45 offset:1024
  ds_read_b128 v[112:115], v45 offset:2048
  ds_read_b128 v[116:119], v45 offset:3072
  ds_read_b128 v[120:123], v45 offset:4096
  s_waitcnt vmcnt(4)
  ds_read_b128 v[6:9], v45 offset:5120
  s_waitcnt vmcnt(3)
  ds_read_b128 v[10:13], v45 offset:6144
  s_waitcnt vmcnt(2)
  ds_read_b128 v[14:17], v45 offset:7168
  s_waitcnt vmcnt(1)
  ds_read_b128 v[18:21], v45 offset:8192
  s_waitcnt vmcnt(0)
  s_waitcnt lgkmcnt(11)
  ds_read_b128 v[22:25], v45 offset:9216
  s_waitcnt lgkmcnt(9)
  v_pk_add_f32 v[104:105], v[104:105], v[180:181]
  v_pk_add_f32 v[106:107], v[106:107], v[182:183]
  s_waitcnt lgkmcnt(8)
  v_pk_add_f32 v[108:109], v[108:109], v[184:185]
  v_pk_add_f32 v[110:111], v[110:111], v[186:187]
  s_waitcnt lgkmcnt(7)
  v_pk_add_f32 v[112:113], v[112:113], v[188:189]
  v_pk_add_f32 v[114:115], v[114:115], v[190:191]
  s_waitcnt lgkmcnt(6)
  v_pk_add_f32 v[116:117], v[116:117], v[192:193]
  v_pk_add_f32 v[118:119], v[118:119], v[194:195]
  s_waitcnt lgkmcnt(5)
  v_pk_add_f32 v[120:121], v[120:121], v[196:197]
  v_pk_add_f32 v[122:123], v[122:123], v[198:199]
  s_waitcnt lgkmcnt(4)
  v_xor_b32 v200, s68, v6
  v_xor_b32 v201, s69, v7
  v_xor_b32 v202, s70, v8
  v_xor_b32 v203, s71, v9
  s_waitcnt lgkmcnt(3)
  v_bitop3_b32 v200, v200, v10, s68 bitop3:0xf6
  v_bitop3_b32 v201, v201, v11, s69 bitop3:0xf6
  v_bitop3_b32 v202, v202, v12, s70 bitop3:0xf6
  v_bitop3_b32 v203, v203, v13, s71 bitop3:0xf6
  s_waitcnt lgkmcnt(2)
  v_bitop3_b32 v200, v200, v14, s68 bitop3:0xf6
  v_bitop3_b32 v201, v201, v15, s69 bitop3:0xf6
  v_bitop3_b32 v202, v202, v16, s70 bitop3:0xf6
  v_bitop3_b32 v203, v203, v17, s71 bitop3:0xf6
  s_waitcnt lgkmcnt(1)
  v_bitop3_b32 v200, v200, v18, s68 bitop3:0xf6
  v_bitop3_b32 v201, v201, v19, s69 bitop3:0xf6
  v_bitop3_b32 v202, v202, v20, s70 bitop3:0xf6
  v_bitop3_b32 v203, v203, v21, s71 bitop3:0xf6
  s_waitcnt lgkmcnt(0)
  v_bitop3_b32 v200, v200, v22, s68 bitop3:0xf6
  v_bitop3_b32 v201, v201, v23, s69 bitop3:0xf6
  v_bitop3_b32 v202, v202, v24, s70 bitop3:0xf6
  v_bitop3_b32 v203, v203, v25, s71 bitop3:0xf6
  v_or3_b32 v200, v200, v201, v202
  v_bitop3_b32 v200, v200, v203, v39 bitop3:0xa8
  v_cmp_ne_u32 vcc, 0, v200
  s_nop 1
  s_cmp_lg_u64 vcc, 0
  s_cbranch_scc1 L_slow16
L_back16:
  v_pk_add_f32 v[104:105], v[104:105], v[6:7]
  v_pk_add_f32 v[106:107], v[106:107], v[8:9]
  buffer_store_dwordx4 v[104:107], v36, s[64:67], 0 offen offset:0
  v_pk_add_f32 v[108:109], v[108:109], v[10:11]
  v_pk_add_f32 v[110:111], v[110:111], v[12:13]
  buffer_store_dwordx4 v[108:111], v36, s[64:67], 0 offen offset:64
  v_pk_add_f32 v[112:113], v[112:113], v[14:15]
  v_pk_add_f32 v[114:115], v[114:115], v[16:17]
  buffer_store_dwordx4 v[112:115], v36, s[64:67], 0 offen offset:128
  v_pk_add_f32 v[116:117], v[116:117], v[18:19]
  v_pk_add_f32 v[118:119], v[118:119], v[20:21]
  buffer_store_dwordx4 v[116:119], v36, s[64:67], 0 offen offset:192
  v_pk_add_f32 v[120:121], v[120:121], v[22:23]
  v_pk_add_f32 v[122:123], v[122:123], v[24:25]
  buffer_store_dwordx4 v[120:123], v36, s[64:67], 0 offen offset:256
  s_cmp_lg_u32 s7, 0
  s_cbranch_scc1 L_tkb1
  v_xor_b32 v204, s61, v204
  v_xor_b32 v205, s61, v205
  v_xor_b32 v206, s61, v206
  v_xor_b32 v207, s61, v207
  v_or3_b32 v204, v204, v205, v206
  v_or_b32 v204, v204, v207
  v_cmp_ne_u32 vcc, 0, v204
  s_nop 1
  s_cmp_lg_u64 vcc, 0
  s_cbranch_scc1 L_slow17
L_back17:
  s_add_u32 s83, s7, 327680
  v_mov_b32 v2, s61
  buffer_store_dword v2, off, s[56:59], s83 sc1
L_tkb1:
  s_endpgm
L_slow0:
  s_sleep 2
  s_mov_b64 exec, 0xffffff
  buffer_load_dword v84, v89, s[56:59], 0 offen sc1
  s_mov_b64 exec, -1
  s_waitcnt vmcnt(0)
  s_sub_u32 s100, s100, 1
  s_cbranch_scc1 L_back0
  v_cmp_ne_u32 vcc, s61, v84
  s_nop 1
  s_and_b32 vcc_lo, vcc_lo, 0xffffff
  s_cbranch_scc1 L_slow0
  s_branch L_back0
L_slow1:
  s_sleep 2
  s_mov_b64 exec, 0xffff
  buffer_load_dword v84, v85, s[56:59], 0 offen offset:0 sc1
  s_mov_b64 exec, -1
  s_waitcnt vmcnt(0)
  s_sub_u32 s100, s100, 1
  s_cbranch_scc1 L_back1
  v_cmp_ne_u32 vcc, s61, v84
  s_nop 1
  s_and_b32 vcc_lo, vcc_lo, 0x7ff
  s_cbranch_scc1 L_slow1
  s_branch L_back1
L_slow2:
  s_sleep 2
  s_mov_b64 exec, 0xffff
  buffer_load_dword v84, v85, s[56:59], 0 offen offset:4 sc1
  s_mov_b64 exec, -1
  s_waitcnt vmcnt(0)
  v_mov_b32 v2, s61
  buffer_store_dword v2, v125, s[56:59], s101 offen sc1
  s_sub_u32 s100, s100, 1
  s_cbranch_scc1 L_back2
  v_cmp_ne_u32 vcc, s61, v84
  s_nop 1
  s_and_b32 vcc_lo, vcc_lo, 0xf800
  s_cbranch_scc1 L_slow2
  s_branch L_back2
L_slow3:
  s_sleep 2
  s_mov_b64 exec, 0xffff
  buffer_load_dword v84, v85, s[56:59], 0 offen offset:4 sc1
  s_mov_b64 exec, -1
  s_waitcnt vmcnt(0)
  v_mov_b32 v2, s61
  buffer_store_dword v2, v125, s[56:59], s101 offen sc1
  s_sub_u32 s100, s100, 1
  s_cbranch_scc1 L_back3
  v_cmp_ne_u32 vcc, s61, v84
  s_nop 1
  s_and_b32 vcc_lo, vcc_lo, 0x7ff
  s_cbranch_scc1 L_slow3
  s_branch L_back3
L_slow4:
  s_sleep 2
  buffer_load_dwordx4 v[104:107], v42, s[56:59], 0 offen sc1
  s_waitcnt vmcnt(0)
  s_sub_u32 s100, s100, 1
  s_cbranch_scc1 L_back4
  v_cmp_ne_u32 vcc, s61, v107
  s_nop 1
  s_cmp_lg_u64 vcc, 0
  s_cbranch_scc1 L_slow4
  s_branch L_back4
L_slow5:
  s_sleep 2
  s_mov_b64 exec, 0xffff
  buffer_load_dword v84, v85, s[56:59], 0 offen offset:8 sc1
  s_mov_b64 exec, -1
  s_waitcnt vmcnt(0)
  s_sub_u32 s100, s100, 1
  s_cbranch_scc1 L_back5
  v_cmp_ne_u32 vcc, s61, v84
  s_nop 1
  s_and_b32 vcc_lo, vcc_lo, 0xffff
  s_cbranch_scc1 L_slow5
  s_branch L_back5
L_slow6:
  s_sleep 1
  s_add_u32 m0, s12, 5120
  s_nop 0
  buffer_load_dwordx4 v35, s[56:59], s88 offen offset:0 sc1 lds
  buffer_load_dwordx4 v35, s[56:59], s88 offen offset:1024 sc1 lds
  buffer_load_dwordx4 v35, s[56:59], s88 offen offset:2048 sc1 lds
  buffer_load_dwordx4 v35, s[56:59], s88 offen offset:3072 sc1 lds
  s_add_u32 m0, s12, 9216
  s_nop 0
  buffer_load_dwordx4 v35, s[56:59], s63 offen offset:0 sc1 lds
  s_waitcnt vmcnt(0)
  ds_read_b128 v[6:9], v45 offset:5120
  ds_read_b128 v[10:13], v45 offset:6144
  ds_read_b128 v[14:17], v45 offset:7168
  ds_read_b128 v[18:21], v45 offset:8192
  ds_read_b128 v[22:25], v45 offset:9216
  s_sub_u32 s100, s100, 1
  s_cbranch_scc1 L_back6
  s_waitcnt lgkmcnt(4)
  v_xor_b32 v200, s68, v6
  v_xor_b32 v201, s69, v7
  v_xor_b32 v202, s70, v8
  v_xor_b32 v203, s71, v9
  s_waitcnt lgkmcnt(3)
  v_bitop3_b32 v200, v200, v10, s68 bitop3:0xf6
  v_bitop3_b32 v201, v201, v11, s69 bitop3:0xf6
  v_bitop3_b32 v202, v202, v12, s70 bitop3:0xf6
  v_bitop3_b32 v203, v203, v13, s71 bitop3:0xf6
  s_waitcnt lgkmcnt(2)
  v_bitop3_b32 v200, v200, v14, s68 bitop3:0xf6
  v_bitop3_b32 v201, v201, v15, s69 bitop3:0xf6
  v_bitop3_b32 v202, v202, v16, s70 bitop3:0xf6
  v_bitop3_b32 v203, v203, v17, s71 bitop3:0xf6
  s_waitcnt lgkmcnt(1)
  v_bitop3_b32 v200, v200, v18, s68 bitop3:0xf6
  v_bitop3_b32 v201, v201, v19, s69 bitop3:0xf6
  v_bitop3_b32 v202, v202, v20, s70 bitop3:0xf6
  v_bitop3_b32 v203, v203, v21, s71 bitop3:0xf6
  s_waitcnt lgkmcnt(0)
  v_bitop3_b32 v200, v200, v22, s68 bitop3:0xf6
  v_bitop3_b32 v201, v201, v23, s69 bitop3:0xf6
  v_bitop3_b32 v202, v202, v24, s70 bitop3:0xf6
  v_bitop3_b32 v203, v203, v25, s71 bitop3:0xf6
  v_or3_b32 v200, v200, v201, v202
  v_bitop3_b32 v200, v200, v203, v39 bitop3:0xa8
  v_cmp_ne_u32 vcc, 0, v200
  s_nop 1
  s_cmp_lg_u64 vcc, 0
  s_cbranch_scc1 L_slow6
  s_branch L_back6
L_slow7:
  s_sleep 2
  s_add_u32 s95, s7, 0
  buffer_load_dword v204, v208, s[56:59], s95 offen sc1
  s_add_u32 s95, s7, 32768
  buffer_load_dword v205, v208, s[56:59], s95 offen sc1
  s_add_u32 s95, s7, 65536
  buffer_load_dword v206, v208, s[56:59], s95 offen sc1
  s_add_u32 s95, s7, 98304
  buffer_load_dword v207, v208, s[56:59], s95 offen sc1
  s_waitcnt vmcnt(0)
  s_sub_u32 s100, s100, 1
  s_cbranch_scc1 L_back7
  v_xor_b32 v204, s61, v204
  v_xor_b32 v205, s61, v205
  v_xor_b32 v206, s61, v206
  v_xor_b32 v207, s61, v207
  v_or3_b32 v204, v204, v205, v206
  v_or_b32 v204, v204, v207
  v_cmp_ne_u32 vcc, 0, v204
  s_nop 1
  s_cmp_lg_u64 vcc, 0
  s_cbranch_scc1 L_slow7
  s_branch L_back7
L_slow8:
  s_sleep 2
  s_mov_b64 exec, 0x3f00
  buffer_load_dword v84, v89, s[56:59], 0 offen sc1
  s_mov_b64 exec, -1
  s_waitcnt vmcnt(0)
  s_sub_u32 s100, s100, 1
  s_cbranch_scc1 L_back8
  v_cmp_ne_u32 vcc, s61, v84
  s_nop 1
  s_and_b32 vcc_lo, vcc_lo, 0x3f00
  s_cbranch_scc1 L_slow8
  s_branch L_back8
L_slow9:
  s_sleep 2
  s_mov_b64 exec, 0xffc0ff
  buffer_load_dword v84, v89, s[56:59], 0 offen sc1
  s_mov_b64 exec, -1
  s_waitcnt vmcnt(0)
  s_sub_u32 s100, s100, 1
  s_cbranch_scc1 L_back9
  v_cmp_ne_u32 vcc, s61, v84
  s_nop 1
  s_and_b32 vcc_lo, vcc_lo, 0xffc0ff
  s_cbranch_scc1 L_slow9
  s_branch L_back9
L_slow10:
  s_sleep 2
  buffer_load_dwordx3 v[26:28], v35, s[76:79], s92 offen offset:0 sc1
  buffer_load_dwordx3 v[30:32], v35, s[76:79], s92 offen offset:1024 sc1
  buffer_load_dwordx3 v[96:98], v35, s[76:79], s92 offen offset:2048 sc1
  buffer_load_dwordx3 v[100:102], v35, s[76:79], s92 offen offset:3072 sc1
  s_waitcnt vmcnt(0)
  s_sub_u32 s100, s100, 1
  s_cbranch_scc1 L_back10
  v_add3_u32 v29, v28, v32, v98
  v_add_u32 v29, v102, v29
  v_cmp_ne_u32 vcc, s10, v29
  s_nop 1
  s_cmp_lg_u64 vcc, 0
  s_cbranch_scc1 L_slow10
  s_branch L_back10
L_slow11:
  s_sleep 2
  buffer_load_dwordx4 v[36:39], v42, s[56:59], 0 offen sc1
  s_waitcnt vmcnt(0)
  s_sub_u32 s100, s100, 1
  s_cbranch_scc1 L_back11
  v_cmp_ne_u32 vcc, s61, v39
  s_nop 1
  s_cmp_lg_u64 vcc, 0
  s_cbranch_scc1 L_slow11
  s_branch L_back11
L_slow12:
  s_sleep 2
  s_mov_b64 exec, 0xffff
  buffer_load_dword v84, v85, s[56:59], 0 offen offset:0 sc1
  s_mov_b64 exec, -1
  s_waitcnt vmcnt(0)
  s_sub_u32 s100, s100, 1
  s_cbranch_scc1 L_back12
  v_cmp_ne_u32 vcc, s61, v84
  s_nop 1
  s_and_b32 vcc_lo, vcc_lo, 0x7ff
  s_cbranch_scc1 L_slow12
  s_branch L_back12
L_slow13:
  s_sleep 2
  buffer_load_dwordx3 v[26:28], v35, s[44:47], s92 offen offset:0 sc1
  buffer_load_dwordx3 v[30:32], v35, s[44:47], s92 offen offset:1024 sc1
  buffer_load_dwordx3 v[96:98], v35, s[44:47], s92 offen offset:2048 sc1
  buffer_load_dwordx3 v[100:102], v35, s[44:47], s92 offen offset:3072 sc1
  s_waitcnt vmcnt(0)
  s_sub_u32 s100, s100, 1
  s_cbranch_scc1 L_back13
  v_add3_u32 v29, v28, v32, v98
  v_add_u32 v29, v102, v29
  v_cmp_ne_u32 vcc, s10, v29
  s_nop 1
  s_cmp_lg_u64 vcc, 0
  s_cbranch_scc1 L_slow13
  s_branch L_back13
L_slow14:
  s_sleep 2
  s_mov_b64 exec, 0xffff
  buffer_load_dword v84, v85, s[56:59], 0 offen offset:4 sc1
  s_mov_b64 exec, -1
  s_waitcnt vmcnt(0)
  v_mov_b32 v2, s61
  buffer_store_dword v2, v125, s[56:59], s101 offen sc1
  s_sub_u32 s100, s100, 1
  s_cbranch_scc1 L_back14
  v_cmp_ne_u32 vcc, s61, v84
  s_nop 1
  s_and_b32 vcc_lo, vcc_lo, 0xffff
  s_cbranch_scc1 L_slow14
  s_branch L_back14
L_slow15:
  s_sleep 2
  s_mov_b64 exec, 0xffff
  buffer_load_dword v84, v85, s[56:59], 0 offen offset:8 sc1
  s_mov_b64 exec, -1
  s_waitcnt vmcnt(0)
  s_sub_u32 s100, s100, 1
  s_cbranch_scc1 L_back15
  v_cmp_ne_u32 vcc, s61, v84
  s_nop 1
  s_and_b32 vcc_lo, vcc_lo, 0xffff
  s_cbranch_scc1 L_slow15
  s_branch L_back15
L_slow16:
  s_sleep 1
  s_add_u32 m0, s12, 5120
  s_nop 0
  buffer_load_dwordx4 v35, s[56:59], s88 offen offset:0 sc1 lds
  buffer_load_dwordx4 v35, s[56:59], s88 offen offset:1024 sc1 lds
  buffer_load_dwordx4 v35, s[56:59], s88 offen offset:2048 sc1 lds
  buffer_load_dwordx4 v35, s[56:59], s88 offen offset:3072 sc1 lds
  s_add_u32 m0, s12, 9216
  s_nop 0
  buffer_load_dwordx4 v35, s[56:59], s63 offen offset:0 sc1 lds
  s_waitcnt vmcnt(0)
  ds_read_b128 v[6:9], v45 offset:5120
  ds_read_b128 v[10:13], v45 offset:6144
  ds_read_b128 v[14:17], v45 offset:7168
  ds_read_b128 v[18:21], v45 offset:8192
  ds_read_b128 v[22:25], v45 offset:9216
  s_sub_u32 s100, s100, 1
  s_cbranch_scc1 L_back16
  s_waitcnt lgkmcnt(4)
  v_xor_b32 v200, s68, v6
  v_xor_b32 v201, s69, v7
  v_xor_b32 v202, s70, v8
  v_xor_b32 v203, s71, v9
  s_waitcnt lgkmcnt(3)
  v_bitop3_b32 v200, v200, v10, s68 bitop3:0xf6
  v_bitop3_b32 v201, v201, v11, s69 bitop3:0xf6
  v_bitop3_b32 v202, v202, v12, s70 bitop3:0xf6
  v_bitop3_b32 v203, v203, v13, s71 bitop3:0xf6
  s_waitcnt lgkmcnt(2)
  v_bitop3_b32 v200, v200, v14, s68 bitop3:0xf6
  v_bitop3_b32 v201, v201, v15, s69 bitop3:0xf6
  v_bitop3_b32 v202, v202, v16, s70 bitop3:0xf6
  v_bitop3_b32 v203, v203, v17, s71 bitop3:0xf6
  s_waitcnt lgkmcnt(1)
  v_bitop3_b32 v200, v200, v18, s68 bitop3:0xf6
  v_bitop3_b32 v201, v201, v19, s69 bitop3:0xf6
  v_bitop3_b32 v202, v202, v20, s70 bitop3:0xf6
  v_bitop3_b32 v203, v203, v21, s71 bitop3:0xf6
  s_waitcnt lgkmcnt(0)
  v_bitop3_b32 v200, v200, v22, s68 bitop3:0xf6
  v_bitop3_b32 v201, v201, v23, s69 bitop3:0xf6
  v_bitop3_b32 v202, v202, v24, s70 bitop3:0xf6
  v_bitop3_b32 v203, v203, v25, s71 bitop3:0xf6
  v_or3_b32 v200, v200, v201, v202
  v_bitop3_b32 v200, v200, v203, v39 bitop3:0xa8
  v_cmp_ne_u32 vcc, 0, v200
  s_nop 1
  s_cmp_lg_u64 vcc, 0
  s_cbranch_scc1 L_slow16
  s_branch L_back16
L_slow17:
  s_sleep 2
  s_add_u32 s95, s7, 0
  buffer_load_dword v204, v208, s[56:59], s95 offen sc1
  s_add_u32 s95, s7, 32768
  buffer_load_dword v205, v208, s[56:59], s95 offen sc1
  s_add_u32 s95, s7, 65536
  buffer_load_dword v206, v208, s[56:59], s95 offen sc1
  s_add_u32 s95, s7, 98304
  buffer_load_dword v207, v208, s[56:59], s95 offen sc1
  s_waitcnt vmcnt(0)
  s_sub_u32 s100, s100, 1
  s_cbranch_scc1 L_back17
  v_xor_b32 v204, s61, v204
  v_xor_b32 v205, s61, v205
  v_xor_b32 v206, s61, v206
  v_xor_b32 v207, s61, v207
  v_or3_b32 v204, v204, v205, v206
  v_or_b32 v204, v204, v207
  v_cmp_ne_u32 vcc, 0, v204
  s_nop 1
  s_cmp_lg_u64 vcc, 0
  s_cbranch_scc1 L_slow17
  s_branch L_back17
L_end:
  s_endpgm
.section .rodata,"a"
.p2align 6
.amdhsa_kernel parallel_sum__ssm_conv_s5__geglu_ffn__prompt_kernel
  .amdhsa_next_free_vgpr 512
  .amdhsa_next_free_sgpr 102
  .amdhsa_accum_offset 256
  .amdhsa_group_segment_fixed_size 0
  .amdhsa_kernarg_size 128
  .amdhsa_user_sgpr_count 2
  .amdhsa_user_sgpr_kernarg_segment_ptr 1
  .amdhsa_system_sgpr_workgroup_id_x 1
.end_amdhsa_kernel
```
